```python
import torch

def _softmax(x, axis=-1):
    return torch.softmax(x, dim=axis)

def _gelu(x):
    return torch.nn.functional.gelu(x, approximate='tanh')

def _silu(x):
    return torch.nn.functional.silu(x)

def _sigmoid(x):
    return torch.sigmoid(x)

def _layernorm(x, axis=-1, eps=1e-05):
    m = x.mean(dim=axis, keepdim=True)
    v = x.var(dim=axis, keepdim=True, unbiased=False)
    return (x - m) / torch.sqrt(v + eps)

def _scatter_add(tgt, idx, src, axis=0):
    return tgt.clone().index_add_(axis, idx, src)

def _segment_sum(src, seg, n):
    out = torch.zeros((n,) + src.shape[1:], dtype=src.dtype)
    return out.index_add_(0, seg, src)

def _pad(x, pw):
    flat = tuple((v for pair in reversed(pw) for v in pair))
    return torch.nn.functional.pad(x, flat)
kernel_name = 'gated_mix__memory_aug_recurrent_mem_tr__glu_gated_geglu__prompt'

def setup_inputs():

    _w = lambda a: (lambda t: t.to(torch.bfloat16) if t.is_floating_point() else t)(torch.as_tensor(a))

    def _A_setup():
        B, S, Dm = (1, 2048, 576)
        H, Dh = (32, 128)
        M, seg = (8, 32)
        seg = min(seg, S)
        S = S // seg * seg
        return {'x': _w((lambda *s: torch.randn(*s, dtype=torch.bfloat16) * 0.05)(B, S, Dm)), 'mem0': _w((lambda *s: torch.randn(*s, dtype=torch.bfloat16) * 0.4)(B, M, Dm)), 'Wq': _w((lambda *s: torch.randn(*s, dtype=torch.bfloat16) * 6.4)(Dm, H, Dh) * Dm ** (-0.5)), 'Wk': _w((lambda *s: torch.randn(*s, dtype=torch.bfloat16) * 6.4)(Dm, H, Dh) * Dm ** (-0.5)), 'Wv': _w((lambda *s: torch.randn(*s, dtype=torch.bfloat16) * 0.4)(Dm, H, Dh) * Dm ** (-0.5)), 'Wo': _w((lambda *s: torch.randn(*s, dtype=torch.bfloat16) * 0.4)(H, Dh, Dm) * (H * Dh) ** (-0.5)), 'seg_len': seg}
    _A_in = _A_setup()

    def _B_setup():
        B, S, Dm, Df = (1, 2048, 576, 4608)
        return {'x': _w((lambda *s: torch.randn(*s, dtype=torch.bfloat16) * 0.05)(B, S, Dm)), 'w_gate': _w((lambda *s: torch.randn(*s, dtype=torch.bfloat16) * 1.6)(Dm, Df) * Dm ** (-0.5)), 'w_up': _w((lambda *s: torch.randn(*s, dtype=torch.bfloat16) * 1.6)(Dm, Df) * Dm ** (-0.5)), 'w_down': _w((lambda *s: torch.randn(*s, dtype=torch.bfloat16) * 1.6)(Df, Dm) * Df ** (-0.5))}
    _B_in = _B_setup()
    return {'A_x': _A_in['x'], 'A_mem0': _A_in['mem0'], 'A_Wq': _A_in['Wq'], 'A_Wk': _A_in['Wk'], 'A_Wv': _A_in['Wv'], 'A_Wo': _A_in['Wo'], 'A_seg_len': _A_in['seg_len'], 'B_x': _B_in['x'], 'B_w_gate': _B_in['w_gate'], 'B_w_up': _B_in['w_up'], 'B_w_down': _B_in['w_down'], 'gate_w': _w((lambda *s: torch.randn(*s, dtype=torch.bfloat16) * 0.05)(576) * 16.0)}

def reference(A_x, A_mem0, A_Wq, A_Wk, A_Wv, A_Wo, A_seg_len, B_x, B_w_gate, B_w_up, B_w_down, gate_w):

    def _A_ref(x, mem0, Wq, Wk, Wv, Wo, seg_len):
        B, S, Dm = x.shape
        H, Dh = (Wq.shape[1], Wq.shape[2])
        M = mem0.shape[1]
        scale = Dh ** (-0.5)
        n_seg = S // seg_len
        L = M + seg_len
        idx = torch.arange(L)
        mask = (idx[:, None] < M) | (idx[:, None] >= idx[None, :])
        mem = mem0
        outs = []
        for s in range(n_seg):
            xs = x[:, s * seg_len:(s + 1) * seg_len, :].clone()
            h = torch.concatenate([mem, xs], axis=1)
            q = torch.einsum('btd,dhe->bhte', h, Wq)
            k = torch.einsum('btd,dhe->bhte', h, Wk)
            v = torch.einsum('btd,dhe->bhte', h, Wv)
            scores = torch.einsum('bhqe,bhke->bhqk', q, k) * scale
            scores = torch.where(mask[None, None], scores, -1000000000.0)
            p = _softmax(scores, axis=-1)
            o = torch.einsum('bhqk,bhke->bhqe', p, v)
            o = torch.einsum('bhte,hed->btd', o, Wo)
            mem = o[:, :M, :].clone()
            outs.append(o[:, M:, :])
        return torch.concatenate(outs, axis=1)

    def _B_ref(x, w_gate, w_up, w_down):
        g = torch.einsum('bsd,df->bsf', x, w_gate)
        u = torch.einsum('bsd,df->bsf', x, w_up)
        h = _gelu(g) * u
        return torch.einsum('bsf,fd->bsd', h, w_down)
    x = A_x
    g = _sigmoid((x * gate_w).sum(-1, keepdims=True))
    a = _A_ref(x, A_mem0, A_Wq, A_Wk, A_Wv, A_Wo, A_seg_len)
    b = _B_ref(x, B_w_gate, B_w_up, B_w_down)
    return g * a + (1 - g) * b
```

```asm
; @launch grid=(256,1,1) block=(256,1,1) lds=163840
.amdgcn_target "amdgcn-amd-amdhsa--gfx950"
.text
.globl gated_mix__memory_aug_recurrent_mem_tr__glu_gated_geglu__prompt_kernel
.p2align 8
.type gated_mix__memory_aug_recurrent_mem_tr__glu_gated_geglu__prompt_kernel,@function
gated_mix__memory_aug_recurrent_mem_tr__glu_gated_geglu__prompt_kernel:
    s_cmp_ge_u32 s2, 256
    s_cbranch_scc1 L_main_exit
    s_load_dwordx2 s[6:7], s[0:1], 104
    s_getreg_b32 s79, hwreg(HW_REG_XCC_ID)
    s_and_b32 s79, s79, 7
    s_waitcnt lgkmcnt(0)
    s_add_u32 s80, s79, 55
    s_cmp_eq_u32 s79, 0
    s_cselect_b32 s80, 0, s80
    v_cmp_eq_u32 vcc, 0, v0
    s_and_saveexec_b64 s[48:49], vcc
    s_cbranch_execz L_norank
    s_lshl_b32 s80, s80, 2
    v_mov_b32 v1, s80
    v_mov_b32 v2, 1
    global_atomic_add v3, v1, v2, s[6:7] sc0 sc1
    s_waitcnt vmcnt(0)
    v_mov_b32 v1, 44
    global_atomic_add v1, v2, s[6:7] sc1
    v_mov_b32 v1, 0
    ds_write_b32 v1, v3
    s_waitcnt lgkmcnt(0)
L_norank:
    s_mov_b64 exec, -1
    s_barrier
    v_mov_b32 v1, 0
    ds_read_b32 v3, v1
    s_waitcnt lgkmcnt(0)
    v_readfirstlane_b32 s72, v3
    s_barrier
    s_cmp_lg_u32 s79, 0
    s_cbranch_scc1 L_to_worker
    s_cmp_ge_u32 s72, 32
    s_cbranch_scc1 L_to_worker
    s_branch L_to_team
L_to_worker:
    s_cmp_eq_u32 s79, 0
    s_cselect_b32 s17, -1, s72
    s_max_u32 s79, s79, 1
    s_sub_u32 s23, s79, 1
    s_branch L_worker_entry
L_to_team:
    s_load_dwordx2 s[4:5], s[0:1], 112
    s_load_dwordx2 s[6:7], s[0:1], 104
    s_load_dwordx2 s[8:9], s[0:1], 8
    v_lshrrev_b32 v20, 6, v0
    v_and_b32 v16, 63, v0
    v_readfirstlane_b32 s73, v20
    v_and_b32 v17, 15, v16
    v_lshrrev_b32 v18, 4, v16
    s_waitcnt lgkmcnt(0)
    v_lshrrev_b32 v19, 2, v17
    v_lshlrev_b32 v34, 1, v19
    v_and_b32 v35, 1, v17
    v_add_u32 v34, v34, v35
    v_mul_u32_u24 v34, 1152, v34
    v_lshl_add_u32 v34, v18, 5, v34
    v_bfe_u32 v35, v17, 1, 1
    v_lshl_add_u32 v34, v35, 4, v34
    s_min_u32 s79, s72, 8
    s_lshl_b32 s79, s79, 7
    v_add_u32 v34, s79, v34
    global_load_dwordx4 v[48:51], v34, s[8:9]
    s_load_dwordx2 s[56:57], s[0:1], 16
    s_load_dwordx2 s[60:61], s[0:1], 24
    s_load_dwordx2 s[64:65], s[0:1], 32
    s_load_dwordx2 s[68:69], s[0:1], 40
    s_waitcnt lgkmcnt(0)
    s_mov_b32 s58, 4718592
    s_mov_b32 s59, 0x00020000
    s_mov_b32 s62, 4718592
    s_mov_b32 s63, 0x00020000
    s_mov_b32 s66, 4718592
    s_mov_b32 s67, 0x00020000
    s_mov_b32 s70, 4718592
    s_mov_b32 s71, 0x00020000
    v_and_b32 v34, 1, v18
    s_lshl_b32 s79, s73, 1
    v_or_b32 v34, s79, v34
    v_lshlrev_b32 v34, 1, v34
    v_xor_b32 v34, v34, v17
    v_lshlrev_b32 v34, 4, v34
    v_lshl_add_u32 v33, v18, 13, v34
    s_lshl_b32 s79, s72, 8
    v_add_u32 v33, s79, v33
    s_lshl_b32 s76, s73, 15
    s_add_u32 s76, s76, 0
    s_lshl_b32 s79, s73, 10
    s_add_u32 m0, s79, 16384
    s_nop 0
    buffer_load_dwordx4 v33, s[56:59], s76 offen lds
    s_lshl_b32 s76, s73, 15
    s_add_u32 s76, s76, 131072
    s_lshl_b32 s79, s73, 10
    s_add_u32 m0, s79, 20480
    s_nop 0
    buffer_load_dwordx4 v33, s[56:59], s76 offen lds
    s_lshl_b32 s76, s73, 15
    s_add_u32 s76, s76, 262144
    s_lshl_b32 s79, s73, 10
    s_add_u32 m0, s79, 24576
    s_nop 0
    buffer_load_dwordx4 v33, s[56:59], s76 offen lds
    s_lshl_b32 s76, s73, 15
    s_add_u32 s76, s76, 393216
    s_lshl_b32 s79, s73, 10
    s_add_u32 m0, s79, 28672
    s_nop 0
    buffer_load_dwordx4 v33, s[56:59], s76 offen lds
    s_lshl_b32 s76, s73, 15
    s_add_u32 s76, s76, 524288
    s_lshl_b32 s79, s73, 10
    s_add_u32 m0, s79, 32768
    s_nop 0
    buffer_load_dwordx4 v33, s[56:59], s76 offen lds
    s_lshl_b32 s76, s73, 15
    s_add_u32 s76, s76, 655360
    s_lshl_b32 s79, s73, 10
    s_add_u32 m0, s79, 36864
    s_nop 0
    buffer_load_dwordx4 v33, s[56:59], s76 offen lds
    s_lshl_b32 s76, s73, 15
    s_add_u32 s76, s76, 786432
    s_lshl_b32 s79, s73, 10
    s_add_u32 m0, s79, 40960
    s_nop 0
    buffer_load_dwordx4 v33, s[56:59], s76 offen lds
    s_lshl_b32 s76, s73, 15
    s_add_u32 s76, s76, 917504
    s_lshl_b32 s79, s73, 10
    s_add_u32 m0, s79, 45056
    s_nop 0
    buffer_load_dwordx4 v33, s[56:59], s76 offen lds
    s_lshl_b32 s76, s73, 15
    s_add_u32 s76, s76, 1048576
    s_lshl_b32 s79, s73, 10
    s_add_u32 m0, s79, 49152
    s_nop 0
    buffer_load_dwordx4 v33, s[56:59], s76 offen lds
    s_lshl_b32 s76, s73, 15
    s_add_u32 s76, s76, 1179648
    s_lshl_b32 s79, s73, 10
    s_add_u32 m0, s79, 53248
    s_nop 0
    buffer_load_dwordx4 v33, s[56:59], s76 offen lds
    s_lshl_b32 s76, s73, 15
    s_add_u32 s76, s76, 1310720
    s_lshl_b32 s79, s73, 10
    s_add_u32 m0, s79, 57344
    s_nop 0
    buffer_load_dwordx4 v33, s[56:59], s76 offen lds
    s_lshl_b32 s76, s73, 15
    s_add_u32 s76, s76, 1441792
    s_lshl_b32 s79, s73, 10
    s_add_u32 m0, s79, 61440
    s_nop 0
    buffer_load_dwordx4 v33, s[56:59], s76 offen lds
    s_lshl_b32 s76, s73, 15
    s_add_u32 s76, s76, 1572864
    s_lshl_b32 s79, s73, 10
    s_add_u32 m0, s79, 65536
    s_nop 0
    buffer_load_dwordx4 v33, s[56:59], s76 offen lds
    s_lshl_b32 s76, s73, 15
    s_add_u32 s76, s76, 1703936
    s_lshl_b32 s79, s73, 10
    s_add_u32 m0, s79, 69632
    s_nop 0
    buffer_load_dwordx4 v33, s[56:59], s76 offen lds
    s_lshl_b32 s76, s73, 15
    s_add_u32 s76, s76, 1835008
    s_lshl_b32 s79, s73, 10
    s_add_u32 m0, s79, 73728
    s_nop 0
    buffer_load_dwordx4 v33, s[56:59], s76 offen lds
    s_lshl_b32 s76, s73, 15
    s_add_u32 s76, s76, 1966080
    s_lshl_b32 s79, s73, 10
    s_add_u32 m0, s79, 77824
    s_nop 0
    buffer_load_dwordx4 v33, s[56:59], s76 offen lds
    s_lshl_b32 s76, s73, 15
    s_add_u32 s76, s76, 2097152
    s_lshl_b32 s79, s73, 10
    s_add_u32 m0, s79, 81920
    s_nop 0
    buffer_load_dwordx4 v33, s[56:59], s76 offen lds
    s_lshl_b32 s76, s73, 15
    s_add_u32 s76, s76, 2228224
    s_lshl_b32 s79, s73, 10
    s_add_u32 m0, s79, 86016
    s_nop 0
    buffer_load_dwordx4 v33, s[56:59], s76 offen lds
    s_lshl_b32 s76, s73, 15
    s_add_u32 s76, s76, 2359296
    s_lshl_b32 s79, s73, 10
    s_add_u32 m0, s79, 90112
    s_nop 0
    buffer_load_dwordx4 v33, s[56:59], s76 offen lds
    s_lshl_b32 s76, s73, 15
    s_add_u32 s76, s76, 2490368
    s_lshl_b32 s79, s73, 10
    s_add_u32 m0, s79, 94208
    s_nop 0
    buffer_load_dwordx4 v33, s[56:59], s76 offen lds
    s_lshl_b32 s76, s73, 15
    s_add_u32 s76, s76, 2621440
    s_lshl_b32 s79, s73, 10
    s_add_u32 m0, s79, 98304
    s_nop 0
    buffer_load_dwordx4 v33, s[56:59], s76 offen lds
    s_lshl_b32 s76, s73, 15
    s_add_u32 s76, s76, 2752512
    s_lshl_b32 s79, s73, 10
    s_add_u32 m0, s79, 102400
    s_nop 0
    buffer_load_dwordx4 v33, s[56:59], s76 offen lds
    s_lshl_b32 s76, s73, 15
    s_add_u32 s76, s76, 2883584
    s_lshl_b32 s79, s73, 10
    s_add_u32 m0, s79, 106496
    s_nop 0
    buffer_load_dwordx4 v33, s[56:59], s76 offen lds
    s_lshl_b32 s76, s73, 15
    s_add_u32 s76, s76, 3014656
    s_lshl_b32 s79, s73, 10
    s_add_u32 m0, s79, 110592
    s_nop 0
    buffer_load_dwordx4 v33, s[56:59], s76 offen lds
    s_lshl_b32 s76, s73, 15
    s_add_u32 s76, s76, 3145728
    s_lshl_b32 s79, s73, 10
    s_add_u32 m0, s79, 114688
    s_nop 0
    buffer_load_dwordx4 v33, s[56:59], s76 offen lds
    s_lshl_b32 s76, s73, 15
    s_add_u32 s76, s76, 3276800
    s_lshl_b32 s79, s73, 10
    s_add_u32 m0, s79, 118784
    s_nop 0
    buffer_load_dwordx4 v33, s[56:59], s76 offen lds
    s_lshl_b32 s76, s73, 15
    s_add_u32 s76, s76, 3407872
    s_lshl_b32 s79, s73, 10
    s_add_u32 m0, s79, 122880
    s_nop 0
    buffer_load_dwordx4 v33, s[56:59], s76 offen lds
    s_lshl_b32 s76, s73, 15
    s_add_u32 s76, s76, 3538944
    s_lshl_b32 s79, s73, 10
    s_add_u32 m0, s79, 126976
    s_nop 0
    buffer_load_dwordx4 v33, s[56:59], s76 offen lds
    s_lshl_b32 s76, s73, 15
    s_add_u32 s76, s76, 3670016
    s_lshl_b32 s79, s73, 10
    s_add_u32 m0, s79, 131072
    s_nop 0
    buffer_load_dwordx4 v33, s[56:59], s76 offen lds
    s_lshl_b32 s76, s73, 15
    s_add_u32 s76, s76, 3801088
    s_lshl_b32 s79, s73, 10
    s_add_u32 m0, s79, 135168
    s_nop 0
    buffer_load_dwordx4 v33, s[56:59], s76 offen lds
    s_lshl_b32 s76, s73, 15
    s_add_u32 s76, s76, 3932160
    s_lshl_b32 s79, s73, 10
    s_add_u32 m0, s79, 139264
    s_nop 0
    buffer_load_dwordx4 v33, s[56:59], s76 offen lds
    s_lshl_b32 s76, s73, 15
    s_add_u32 s76, s76, 4063232
    s_lshl_b32 s79, s73, 10
    s_add_u32 m0, s79, 143360
    s_nop 0
    buffer_load_dwordx4 v33, s[56:59], s76 offen lds
    s_lshl_b32 s76, s73, 15
    s_add_u32 s76, s76, 4194304
    s_lshl_b32 s79, s73, 10
    s_add_u32 m0, s79, 147456
    s_nop 0
    buffer_load_dwordx4 v33, s[56:59], s76 offen lds
    s_lshl_b32 s76, s73, 15
    s_add_u32 s76, s76, 4325376
    s_lshl_b32 s79, s73, 10
    s_add_u32 m0, s79, 151552
    s_nop 0
    buffer_load_dwordx4 v33, s[56:59], s76 offen lds
    s_lshl_b32 s76, s73, 15
    s_add_u32 s76, s76, 4456448
    s_lshl_b32 s79, s73, 10
    s_add_u32 m0, s79, 155648
    s_nop 0
    buffer_load_dwordx4 v33, s[56:59], s76 offen lds
    s_lshl_b32 s76, s73, 15
    s_add_u32 s76, s76, 4587520
    s_lshl_b32 s79, s73, 10
    s_add_u32 m0, s79, 159744
    s_nop 0
    buffer_load_dwordx4 v33, s[56:59], s76 offen lds
    v_and_b32 v20, 2, v16
    v_cmp_ne_u32 vcc, 0, v20
    v_mov_b32 v21, 0x4444
    v_mov_b32 v22, 0xeeee
    v_cndmask_b32 v0, v21, v22, vcc
    v_lshlrev_b32 v1, 4, v16
    s_lshl_b32 s79, s73, 10
    v_add_u32 v2, s79, v1
    s_lshl_b32 s79, s73, 12
    s_add_u32 s79, s79, 16384
    v_add_u32 v3, s79, v1
    v_lshrrev_b32 v19, 2, v17
    v_and_b32 v20, 3, v17
    v_lshrrev_b32 v21, 1, v18
    v_lshlrev_b32 v21, 4, v21
    v_and_b32 v22, 1, v18
    v_lshl_add_u32 v21, v22, 2, v21
    v_and_b32 v23, 1, v19
    v_add_u32 v21, v21, v23
    v_lshrrev_b32 v24, 1, v19
    v_lshl_add_u32 v21, v24, 3, v21
    v_lshl_add_u32 v25, v24, 1, v22
    v_lshl_add_u32 v26, v25, 1, v23
    v_mov_b32 v27, v21
    v_lshlrev_b32 v28, 3, v20
    v_lshlrev_b32 v29, 8, v27
    v_add_u32 v29, v29, v28
    v_add_u32 v29, 16384, v29
    s_lshl_b32 s79, s73, 1
    v_xor_b32 v30, s79, v26
    v_lshl_add_u32 v44, v30, 5, v29
    v_xor_b32 v30, 1, v30
    v_lshl_add_u32 v45, v30, 5, v29
    v_lshrrev_b32 v31, 1, v18
    v_lshlrev_b32 v30, 4, v17
    v_lshl_add_u32 v30, v18, 2, v30
    s_lshl_b32 s79, s73, 10
    s_add_u32 s79, s79, 9216
    v_add_u32 v4, s79, v30
    v_lshl_add_u32 v30, v18, 3, v19
    v_lshlrev_b32 v30, 4, v30
    v_and_b32 v31, 1, v20
    v_lshl_add_u32 v30, v31, 3, v30
    v_add_u32 v5, s79, v30
    s_lshl_b32 s79, s73, 2
    v_lshrrev_b32 v30, 1, v18
    v_add_u32 v30, s79, v30
    v_lshlrev_b32 v31, 1, v17
    v_and_b32 v31, 15, v31
    v_xor_b32 v30, v30, v31
    v_lshlrev_b32 v30, 4, v30
    v_lshl_add_u32 v30, v22, 3, v30
    v_and_b32 v31, 7, v17
    v_lshl_add_u32 v30, v31, 8, v30
    v_add_u32 v6, 14336, v30
    v_lshlrev_b32 v31, 1, v19
    v_and_b32 v32, 1, v17
    v_add_u32 v31, v31, v32
    v_bfe_u32 v30, v17, 1, 1
    v_lshl_add_u32 v30, v18, 1, v30
    v_lshlrev_b32 v32, 1, v31
    v_xor_b32 v30, v30, v32
    v_lshlrev_b32 v30, 4, v30
    v_lshl_add_u32 v30, v31, 8, v30
    v_add_u32 v7, 14336, v30
    s_lshl_b32 s79, s73, 4
    s_add_u32 s79, s79, s72
    s_and_b32 s80, s73, 1
    s_lshl_b32 s80, s80, 6
    s_add_u32 s79, s79, s80
    s_cmp_lt_u32 s79, 36
    s_cselect_b32 s78, 1, 0
    s_cselect_b32 s79, s79, 0
    s_lshl_b32 s80, s79, 13
    s_add_u32 s34, s4, 0x5200000
    s_addc_u32 s35, s5, 0
    s_add_u32 s34, s34, s80
    s_addc_u32 s35, s35, 0
    s_add_u32 s36, s34, 0x1000
    s_addc_u32 s37, s35, 0
    s_mul_i32 s80, s79, 29
    s_lshr_b32 s80, s80, 8
    s_mul_i32 s77, s80, 9
    s_sub_u32 s79, s79, s77
    s_lshr_b32 s76, s79, 2
    s_lshl_b32 s76, s76, 2
    s_add_u32 s76, s76, s77
    s_and_b32 s81, s79, 3
    s_lshl_b32 s81, s81, 1
    s_mov_b32 s83, s81
    s_mov_b32 s84, s76
    s_cmp_eq_u32 s79, 8
    s_cselect_b32 s85, 1, 0
    v_mov_b32 v8, 0x3f803f80
    v_mov_b32 v9, 0x3f803f80
    v_mov_b32 v10, 0x3f803f80
    v_mov_b32 v11, 0x3f803f80
    s_mul_i32 s79, s73, 73728
    s_lshl_b32 s80, s72, 8
    s_add_u32 s79, s79, s80
    s_add_u32 s28, s4, 0x5200000
    s_addc_u32 s29, s5, 0
    s_add_u32 s28, s28, s79
    s_addc_u32 s29, s29, 0
    s_add_u32 s30, s4, 0x5208000
    s_addc_u32 s31, s5, 0
    s_add_u32 s30, s30, s79
    s_addc_u32 s31, s31, 0
    s_add_u32 s32, s4, 0x5210000
    s_addc_u32 s33, s5, 0
    s_add_u32 s32, s32, s79
    s_addc_u32 s33, s33, 0
    s_lshl_b32 s79, s72, 13
    s_lshl_b32 s80, s73, 11
    s_add_u32 s79, s79, s80
    s_add_u32 s10, s4, 0x0
    s_addc_u32 s11, s5, 0
    s_add_u32 s10, s10, s79
    s_addc_u32 s11, s11, 0
    s_add_u32 s12, s4, 0x1000000
    s_addc_u32 s13, s5, 0
    s_add_u32 s12, s12, s79
    s_addc_u32 s13, s13, 0
    s_lshl_b32 s79, s72, 11
    s_add_u32 s14, s4, 0x7a00000
    s_addc_u32 s15, s5, 0
    s_add_u32 s14, s14, s79
    s_addc_u32 s15, s15, 0
    s_add_u32 s16, s4, 0x4e00000
    s_addc_u32 s17, s5, 0
    s_add_u32 s16, s16, s79
    s_addc_u32 s17, s17, 0
    s_lshl_b32 s79, s72, 7
    s_add_u32 s44, s4, 0x5310000
    s_addc_u32 s45, s5, 0
    s_add_u32 s44, s44, s79
    s_addc_u32 s45, s45, 0
    s_lshl_b32 s79, s73, 9
    s_add_u32 s14, s14, s79
    s_addc_u32 s15, s15, 0
    s_add_u32 s16, s16, s79
    s_addc_u32 s17, s17, 0
    s_mov_b32 s38, 0x00ff00ff
    s_mov_b32 s39, 0x00ff00ff
    s_mov_b32 s40, 0x0000ffff
    s_mov_b32 s41, 0x0000ffff
    s_mov_b32 s42, 0x0f0f0f0f
    s_mov_b32 s43, 0x0f0f0f0f
    s_mov_b32 s46, 0x3e0293ee
    s_mov_b32 s47, s46
    s_mov_b32 s75, 1
    s_mul_i32 s79, s72, 9216
    s_lshl_b32 s80, s73, 10
    s_add_u32 s79, s79, s80
    v_lshlrev_b32 v32, 4, v16
    v_add_u32 v32, s79, v32
    v_mov_b32 v36, 0
    v_mov_b32 v37, 0
    v_mov_b32 v38, 0
    v_mov_b32 v39, 0
    v_mov_b32 v40, -1
    v_mov_b32 v41, -1
    v_mov_b32 v42, -1
    v_mov_b32 v43, -1
    s_add_u32 s50, s4, 0x5200000
    s_addc_u32 s51, s5, 0
    s_add_u32 s52, s4, 0x5300000
    s_addc_u32 s53, s5, 0
    global_store_dwordx4 v32, v[36:39], s[50:51]
    v_add_u32 v33, 4096, v32
    global_store_dwordx4 v33, v[36:39], s[50:51]
    s_lshl_b32 s79, s72, 11
    s_and_b32 s80, s73, 1
    s_lshl_b32 s80, s80, 10
    s_add_u32 s79, s79, s80
    s_mov_b32 s80, 0x7d60000
    s_cmp_ge_u32 s73, 2
    s_cselect_b32 s80, 0x5160000, s80
    s_add_u32 s79, s79, s80
    v_add_u32 v34, s79, v1
    global_store_dwordx4 v34, v[40:43], s[4:5] sc1
    v_add_u32 v34, 0x10000, v34
    global_store_dwordx4 v34, v[40:43], s[4:5] sc1
    v_add_u32 v34, 0x10000, v34
    global_store_dwordx4 v34, v[40:43], s[4:5] sc1
    v_add_u32 v34, 0x10000, v34
    global_store_dwordx4 v34, v[40:43], s[4:5] sc1
    v_add_u32 v34, 0x10000, v34
    global_store_dwordx4 v34, v[40:43], s[4:5] sc1
    v_add_u32 v34, 0x10000, v34
    global_store_dwordx4 v34, v[40:43], s[4:5] sc1
    v_add_u32 v34, 0x10000, v34
    global_store_dwordx4 v34, v[40:43], s[4:5] sc1
    v_add_u32 v34, 0x10000, v34
    global_store_dwordx4 v34, v[40:43], s[4:5] sc1
    v_add_u32 v34, 0x10000, v34
    global_store_dwordx4 v34, v[40:43], s[4:5] sc1
    v_add_u32 v34, 0x10000, v34
    global_store_dwordx4 v34, v[40:43], s[4:5] sc1
    v_add_u32 v34, 0x10000, v34
    s_cmp_lg_u32 s73, 0
    s_cbranch_scc1 L_clr_skipF
    v_add_u32 v33, 8192, v32
    global_store_dwordx4 v33, v[36:39], s[50:51]
    v_mov_b32 v33, 0
    s_mov_b64 exec, 1
    global_store_dword v33, v36, s[44:45] sc1
    s_mov_b64 exec, -1
    s_cmp_lg_u32 s72, 31
    s_cbranch_scc1 L_clr_pcF
    s_add_u32 s50, s4, 0x5320000
    s_addc_u32 s51, s5, 0
    global_store_dwordx4 v1, v[36:39], s[50:51] sc1
    s_add_u32 s50, s4, 0x5200000
    s_addc_u32 s51, s5, 0
L_clr_pcF:
    s_cmp_gt_u32 s72, 26
    s_cbranch_scc1 L_clr_skipF
    s_cmp_gt_u32 s72, 8
    s_cbranch_scc1 L_clr_sentF
    s_waitcnt vmcnt(40)
    v_min_u32 v40, -2, v48
    v_min_u32 v41, -2, v49
    v_min_u32 v42, -2, v50
    v_min_u32 v43, -2, v51
L_clr_sentF:
    s_lshl_b32 s79, s72, 10
    v_add_u32 v33, s79, v1
    global_store_dwordx4 v33, v[40:43], s[52:53]
L_clr_skipF:
    v_and_b32 v34, 1, v18
    s_lshl_b32 s79, s73, 1
    v_or_b32 v34, s79, v34
    v_lshlrev_b32 v34, 1, v34
    v_xor_b32 v34, v34, v17
    v_lshlrev_b32 v34, 4, v34
    v_lshl_add_u32 v33, v18, 13, v34
    s_lshl_b32 s79, s72, 8
    v_add_u32 v33, s79, v33
    s_waitcnt vmcnt(32)
    s_barrier
    v_add_u32 v36, 0, v44
    v_add_u32 v37, 0, v45
    ds_read_b64_tr_b16 a[0:1], v36 offset:0
    ds_read_b64_tr_b16 a[2:3], v36 offset:512
    ds_read_b64_tr_b16 a[4:5], v36 offset:8192
    ds_read_b64_tr_b16 a[6:7], v36 offset:8704
    ds_read_b64_tr_b16 a[72:73], v37 offset:0
    ds_read_b64_tr_b16 a[74:75], v37 offset:512
    ds_read_b64_tr_b16 a[76:77], v37 offset:8192
    ds_read_b64_tr_b16 a[78:79], v37 offset:8704
    s_waitcnt lgkmcnt(0)
    s_barrier
    s_lshl_b32 s76, s73, 15
    s_add_u32 s76, s76, 0
    s_lshl_b32 s79, s73, 10
    s_add_u32 m0, s79, 16384
    s_nop 0
    buffer_load_dwordx4 v33, s[60:63], s76 offen lds
    s_lshl_b32 s76, s73, 15
    s_add_u32 s76, s76, 131072
    s_lshl_b32 s79, s73, 10
    s_add_u32 m0, s79, 20480
    s_nop 0
    buffer_load_dwordx4 v33, s[60:63], s76 offen lds
    s_lshl_b32 s76, s73, 15
    s_add_u32 s76, s76, 262144
    s_lshl_b32 s79, s73, 10
    s_add_u32 m0, s79, 24576
    s_nop 0
    buffer_load_dwordx4 v33, s[60:63], s76 offen lds
    s_lshl_b32 s76, s73, 15
    s_add_u32 s76, s76, 393216
    s_lshl_b32 s79, s73, 10
    s_add_u32 m0, s79, 28672
    s_nop 0
    buffer_load_dwordx4 v33, s[60:63], s76 offen lds
    s_waitcnt vmcnt(32)
    s_barrier
    v_add_u32 v36, 0, v44
    v_add_u32 v37, 0, v45
    ds_read_b64_tr_b16 a[8:9], v36 offset:16384
    ds_read_b64_tr_b16 a[10:11], v36 offset:16896
    ds_read_b64_tr_b16 a[12:13], v36 offset:24576
    ds_read_b64_tr_b16 a[14:15], v36 offset:25088
    ds_read_b64_tr_b16 a[80:81], v37 offset:16384
    ds_read_b64_tr_b16 a[82:83], v37 offset:16896
    ds_read_b64_tr_b16 a[84:85], v37 offset:24576
    ds_read_b64_tr_b16 a[86:87], v37 offset:25088
    s_waitcnt lgkmcnt(0)
    s_barrier
    s_lshl_b32 s76, s73, 15
    s_add_u32 s76, s76, 524288
    s_lshl_b32 s79, s73, 10
    s_add_u32 m0, s79, 32768
    s_nop 0
    buffer_load_dwordx4 v33, s[60:63], s76 offen lds
    s_lshl_b32 s76, s73, 15
    s_add_u32 s76, s76, 655360
    s_lshl_b32 s79, s73, 10
    s_add_u32 m0, s79, 36864
    s_nop 0
    buffer_load_dwordx4 v33, s[60:63], s76 offen lds
    s_lshl_b32 s76, s73, 15
    s_add_u32 s76, s76, 786432
    s_lshl_b32 s79, s73, 10
    s_add_u32 m0, s79, 40960
    s_nop 0
    buffer_load_dwordx4 v33, s[60:63], s76 offen lds
    s_lshl_b32 s76, s73, 15
    s_add_u32 s76, s76, 917504
    s_lshl_b32 s79, s73, 10
    s_add_u32 m0, s79, 45056
    s_nop 0
    buffer_load_dwordx4 v33, s[60:63], s76 offen lds
    s_waitcnt vmcnt(32)
    s_barrier
    v_add_u32 v36, 0, v44
    v_add_u32 v37, 0, v45
    ds_read_b64_tr_b16 a[16:17], v36 offset:32768
    ds_read_b64_tr_b16 a[18:19], v36 offset:33280
    ds_read_b64_tr_b16 a[20:21], v36 offset:40960
    ds_read_b64_tr_b16 a[22:23], v36 offset:41472
    ds_read_b64_tr_b16 a[88:89], v37 offset:32768
    ds_read_b64_tr_b16 a[90:91], v37 offset:33280
    ds_read_b64_tr_b16 a[92:93], v37 offset:40960
    ds_read_b64_tr_b16 a[94:95], v37 offset:41472
    s_waitcnt lgkmcnt(0)
    s_barrier
    s_lshl_b32 s76, s73, 15
    s_add_u32 s76, s76, 1048576
    s_lshl_b32 s79, s73, 10
    s_add_u32 m0, s79, 49152
    s_nop 0
    buffer_load_dwordx4 v33, s[60:63], s76 offen lds
    s_lshl_b32 s76, s73, 15
    s_add_u32 s76, s76, 1179648
    s_lshl_b32 s79, s73, 10
    s_add_u32 m0, s79, 53248
    s_nop 0
    buffer_load_dwordx4 v33, s[60:63], s76 offen lds
    s_lshl_b32 s76, s73, 15
    s_add_u32 s76, s76, 1310720
    s_lshl_b32 s79, s73, 10
    s_add_u32 m0, s79, 57344
    s_nop 0
    buffer_load_dwordx4 v33, s[60:63], s76 offen lds
    s_lshl_b32 s76, s73, 15
    s_add_u32 s76, s76, 1441792
    s_lshl_b32 s79, s73, 10
    s_add_u32 m0, s79, 61440
    s_nop 0
    buffer_load_dwordx4 v33, s[60:63], s76 offen lds
    s_waitcnt vmcnt(32)
    s_barrier
    v_add_u32 v36, 0, v44
    v_add_u32 v37, 0, v45
    ds_read_b64_tr_b16 a[24:25], v36 offset:49152
    ds_read_b64_tr_b16 a[26:27], v36 offset:49664
    ds_read_b64_tr_b16 a[28:29], v36 offset:57344
    ds_read_b64_tr_b16 a[30:31], v36 offset:57856
    ds_read_b64_tr_b16 a[96:97], v37 offset:49152
    ds_read_b64_tr_b16 a[98:99], v37 offset:49664
    ds_read_b64_tr_b16 a[100:101], v37 offset:57344
    ds_read_b64_tr_b16 a[102:103], v37 offset:57856
    s_waitcnt lgkmcnt(0)
    s_barrier
    s_lshl_b32 s76, s73, 15
    s_add_u32 s76, s76, 1572864
    s_lshl_b32 s79, s73, 10
    s_add_u32 m0, s79, 65536
    s_nop 0
    buffer_load_dwordx4 v33, s[60:63], s76 offen lds
    s_lshl_b32 s76, s73, 15
    s_add_u32 s76, s76, 1703936
    s_lshl_b32 s79, s73, 10
    s_add_u32 m0, s79, 69632
    s_nop 0
    buffer_load_dwordx4 v33, s[60:63], s76 offen lds
    s_lshl_b32 s76, s73, 15
    s_add_u32 s76, s76, 1835008
    s_lshl_b32 s79, s73, 10
    s_add_u32 m0, s79, 73728
    s_nop 0
    buffer_load_dwordx4 v33, s[60:63], s76 offen lds
    s_lshl_b32 s76, s73, 15
    s_add_u32 s76, s76, 1966080
    s_lshl_b32 s79, s73, 10
    s_add_u32 m0, s79, 77824
    s_nop 0
    buffer_load_dwordx4 v33, s[60:63], s76 offen lds
    s_waitcnt vmcnt(32)
    s_barrier
    v_add_u32 v36, 65536, v44
    v_add_u32 v37, 65536, v45
    ds_read_b64_tr_b16 a[32:33], v36 offset:0
    ds_read_b64_tr_b16 a[34:35], v36 offset:512
    ds_read_b64_tr_b16 a[36:37], v36 offset:8192
    ds_read_b64_tr_b16 a[38:39], v36 offset:8704
    ds_read_b64_tr_b16 a[104:105], v37 offset:0
    ds_read_b64_tr_b16 a[106:107], v37 offset:512
    ds_read_b64_tr_b16 a[108:109], v37 offset:8192
    ds_read_b64_tr_b16 a[110:111], v37 offset:8704
    s_waitcnt lgkmcnt(0)
    s_barrier
    s_lshl_b32 s76, s73, 15
    s_add_u32 s76, s76, 2097152
    s_lshl_b32 s79, s73, 10
    s_add_u32 m0, s79, 81920
    s_nop 0
    buffer_load_dwordx4 v33, s[60:63], s76 offen lds
    s_lshl_b32 s76, s73, 15
    s_add_u32 s76, s76, 2228224
    s_lshl_b32 s79, s73, 10
    s_add_u32 m0, s79, 86016
    s_nop 0
    buffer_load_dwordx4 v33, s[60:63], s76 offen lds
    s_lshl_b32 s76, s73, 15
    s_add_u32 s76, s76, 2359296
    s_lshl_b32 s79, s73, 10
    s_add_u32 m0, s79, 90112
    s_nop 0
    buffer_load_dwordx4 v33, s[60:63], s76 offen lds
    s_lshl_b32 s76, s73, 15
    s_add_u32 s76, s76, 2490368
    s_lshl_b32 s79, s73, 10
    s_add_u32 m0, s79, 94208
    s_nop 0
    buffer_load_dwordx4 v33, s[60:63], s76 offen lds
    s_waitcnt vmcnt(32)
    s_barrier
    v_add_u32 v36, 65536, v44
    v_add_u32 v37, 65536, v45
    ds_read_b64_tr_b16 a[40:41], v36 offset:16384
    ds_read_b64_tr_b16 a[42:43], v36 offset:16896
    ds_read_b64_tr_b16 a[44:45], v36 offset:24576
    ds_read_b64_tr_b16 a[46:47], v36 offset:25088
    ds_read_b64_tr_b16 a[112:113], v37 offset:16384
    ds_read_b64_tr_b16 a[114:115], v37 offset:16896
    ds_read_b64_tr_b16 a[116:117], v37 offset:24576
    ds_read_b64_tr_b16 a[118:119], v37 offset:25088
    s_waitcnt lgkmcnt(0)
    s_barrier
    s_lshl_b32 s76, s73, 15
    s_add_u32 s76, s76, 2621440
    s_lshl_b32 s79, s73, 10
    s_add_u32 m0, s79, 98304
    s_nop 0
    buffer_load_dwordx4 v33, s[60:63], s76 offen lds
    s_lshl_b32 s76, s73, 15
    s_add_u32 s76, s76, 2752512
    s_lshl_b32 s79, s73, 10
    s_add_u32 m0, s79, 102400
    s_nop 0
    buffer_load_dwordx4 v33, s[60:63], s76 offen lds
    s_lshl_b32 s76, s73, 15
    s_add_u32 s76, s76, 2883584
    s_lshl_b32 s79, s73, 10
    s_add_u32 m0, s79, 106496
    s_nop 0
    buffer_load_dwordx4 v33, s[60:63], s76 offen lds
    s_lshl_b32 s76, s73, 15
    s_add_u32 s76, s76, 3014656
    s_lshl_b32 s79, s73, 10
    s_add_u32 m0, s79, 110592
    s_nop 0
    buffer_load_dwordx4 v33, s[60:63], s76 offen lds
    s_waitcnt vmcnt(32)
    s_barrier
    v_add_u32 v36, 65536, v44
    v_add_u32 v37, 65536, v45
    ds_read_b64_tr_b16 a[48:49], v36 offset:32768
    ds_read_b64_tr_b16 a[50:51], v36 offset:33280
    ds_read_b64_tr_b16 a[52:53], v36 offset:40960
    ds_read_b64_tr_b16 a[54:55], v36 offset:41472
    ds_read_b64_tr_b16 a[120:121], v37 offset:32768
    ds_read_b64_tr_b16 a[122:123], v37 offset:33280
    ds_read_b64_tr_b16 a[124:125], v37 offset:40960
    ds_read_b64_tr_b16 a[126:127], v37 offset:41472
    s_waitcnt lgkmcnt(0)
    s_barrier
    s_lshl_b32 s76, s73, 15
    s_add_u32 s76, s76, 3145728
    s_lshl_b32 s79, s73, 10
    s_add_u32 m0, s79, 114688
    s_nop 0
    buffer_load_dwordx4 v33, s[60:63], s76 offen lds
    s_lshl_b32 s76, s73, 15
    s_add_u32 s76, s76, 3276800
    s_lshl_b32 s79, s73, 10
    s_add_u32 m0, s79, 118784
    s_nop 0
    buffer_load_dwordx4 v33, s[60:63], s76 offen lds
    s_lshl_b32 s76, s73, 15
    s_add_u32 s76, s76, 3407872
    s_lshl_b32 s79, s73, 10
    s_add_u32 m0, s79, 122880
    s_nop 0
    buffer_load_dwordx4 v33, s[60:63], s76 offen lds
    s_lshl_b32 s76, s73, 15
    s_add_u32 s76, s76, 3538944
    s_lshl_b32 s79, s73, 10
    s_add_u32 m0, s79, 126976
    s_nop 0
    buffer_load_dwordx4 v33, s[60:63], s76 offen lds
    s_waitcnt vmcnt(32)
    s_barrier
    v_add_u32 v36, 65536, v44
    v_add_u32 v37, 65536, v45
    ds_read_b64_tr_b16 a[56:57], v36 offset:49152
    ds_read_b64_tr_b16 a[58:59], v36 offset:49664
    ds_read_b64_tr_b16 a[60:61], v36 offset:57344
    ds_read_b64_tr_b16 a[62:63], v36 offset:57856
    ds_read_b64_tr_b16 a[128:129], v37 offset:49152
    ds_read_b64_tr_b16 a[130:131], v37 offset:49664
    ds_read_b64_tr_b16 a[132:133], v37 offset:57344
    ds_read_b64_tr_b16 a[134:135], v37 offset:57856
    s_waitcnt lgkmcnt(0)
    s_barrier
    s_lshl_b32 s76, s73, 15
    s_add_u32 s76, s76, 3670016
    s_lshl_b32 s79, s73, 10
    s_add_u32 m0, s79, 131072
    s_nop 0
    buffer_load_dwordx4 v33, s[60:63], s76 offen lds
    s_lshl_b32 s76, s73, 15
    s_add_u32 s76, s76, 3801088
    s_lshl_b32 s79, s73, 10
    s_add_u32 m0, s79, 135168
    s_nop 0
    buffer_load_dwordx4 v33, s[60:63], s76 offen lds
    s_lshl_b32 s76, s73, 15
    s_add_u32 s76, s76, 3932160
    s_lshl_b32 s79, s73, 10
    s_add_u32 m0, s79, 139264
    s_nop 0
    buffer_load_dwordx4 v33, s[60:63], s76 offen lds
    s_lshl_b32 s76, s73, 15
    s_add_u32 s76, s76, 4063232
    s_lshl_b32 s79, s73, 10
    s_add_u32 m0, s79, 143360
    s_nop 0
    buffer_load_dwordx4 v33, s[60:63], s76 offen lds
    s_waitcnt vmcnt(32)
    s_barrier
    v_add_u32 v36, 131072, v44
    v_add_u32 v37, 131072, v45
    ds_read_b64_tr_b16 a[64:65], v36 offset:0
    ds_read_b64_tr_b16 a[66:67], v36 offset:512
    ds_read_b64_tr_b16 a[68:69], v36 offset:8192
    ds_read_b64_tr_b16 a[70:71], v36 offset:8704
    ds_read_b64_tr_b16 a[136:137], v37 offset:0
    ds_read_b64_tr_b16 a[138:139], v37 offset:512
    ds_read_b64_tr_b16 a[140:141], v37 offset:8192
    ds_read_b64_tr_b16 a[142:143], v37 offset:8704
    s_waitcnt lgkmcnt(0)
    s_barrier
    s_lshl_b32 s76, s73, 15
    s_add_u32 s76, s76, 4194304
    s_lshl_b32 s79, s73, 10
    s_add_u32 m0, s79, 147456
    s_nop 0
    buffer_load_dwordx4 v33, s[60:63], s76 offen lds
    s_lshl_b32 s76, s73, 15
    s_add_u32 s76, s76, 4325376
    s_lshl_b32 s79, s73, 10
    s_add_u32 m0, s79, 151552
    s_nop 0
    buffer_load_dwordx4 v33, s[60:63], s76 offen lds
    s_lshl_b32 s76, s73, 15
    s_add_u32 s76, s76, 4456448
    s_lshl_b32 s79, s73, 10
    s_add_u32 m0, s79, 155648
    s_nop 0
    buffer_load_dwordx4 v33, s[60:63], s76 offen lds
    s_lshl_b32 s76, s73, 15
    s_add_u32 s76, s76, 4587520
    s_lshl_b32 s79, s73, 10
    s_add_u32 m0, s79, 159744
    s_nop 0
    buffer_load_dwordx4 v33, s[60:63], s76 offen lds
    s_waitcnt vmcnt(32)
    s_barrier
    s_cmp_lg_u32 s73, 0
    s_cbranch_scc1 L_ta_doneF
    v_mov_b32 v42, 32
    v_mov_b32 v43, 1
    s_mov_b64 exec, 1
    global_atomic_add v42, v43, s[6:7] sc1
    s_mov_b64 exec, -1
L_ta_doneF:
    v_add_u32 v36, 0, v44
    v_add_u32 v37, 0, v45
    ds_read_b64_tr_b16 a[144:145], v36 offset:0
    ds_read_b64_tr_b16 a[146:147], v36 offset:512
    ds_read_b64_tr_b16 a[148:149], v36 offset:8192
    ds_read_b64_tr_b16 a[150:151], v36 offset:8704
    ds_read_b64_tr_b16 a[216:217], v37 offset:0
    ds_read_b64_tr_b16 a[218:219], v37 offset:512
    ds_read_b64_tr_b16 a[220:221], v37 offset:8192
    ds_read_b64_tr_b16 a[222:223], v37 offset:8704
    s_waitcnt lgkmcnt(0)
    s_barrier
    s_lshl_b32 s79, s73, 6
    s_add_u32 s79, s79, 0
    v_add_u32 v38, s79, v16
    v_mul_u32_u24 v39, 14564, v38
    v_lshrrev_b32 v39, 20, v39
    v_mul_u32_u24 v40, 72, v39
    v_sub_u32 v38, v38, v40
    v_bfe_u32 v40, v39, 2, 2
    v_lshlrev_b32 v40, 1, v40
    v_xor_b32 v38, v38, v40
    v_mul_u32_u24 v39, 1152, v39
    v_lshl_add_u32 v38, v38, 4, v39
    s_mul_i32 s76, s72, 147456
    s_lshl_b32 s79, s73, 10
    s_add_u32 m0, s79, 16384
    s_nop 0
    buffer_load_dwordx4 v38, s[68:71], s76 offen lds
    s_lshl_b32 s79, s73, 6
    s_add_u32 s79, s79, 256
    v_add_u32 v38, s79, v16
    v_mul_u32_u24 v39, 14564, v38
    v_lshrrev_b32 v39, 20, v39
    v_mul_u32_u24 v40, 72, v39
    v_sub_u32 v38, v38, v40
    v_bfe_u32 v40, v39, 2, 2
    v_lshlrev_b32 v40, 1, v40
    v_xor_b32 v38, v38, v40
    v_mul_u32_u24 v39, 1152, v39
    v_lshl_add_u32 v38, v38, 4, v39
    s_mul_i32 s76, s72, 147456
    s_lshl_b32 s79, s73, 10
    s_add_u32 m0, s79, 20480
    s_nop 0
    buffer_load_dwordx4 v38, s[68:71], s76 offen lds
    s_lshl_b32 s79, s73, 6
    s_add_u32 s79, s79, 512
    v_add_u32 v38, s79, v16
    v_mul_u32_u24 v39, 14564, v38
    v_lshrrev_b32 v39, 20, v39
    v_mul_u32_u24 v40, 72, v39
    v_sub_u32 v38, v38, v40
    v_bfe_u32 v40, v39, 2, 2
    v_lshlrev_b32 v40, 1, v40
    v_xor_b32 v38, v38, v40
    v_mul_u32_u24 v39, 1152, v39
    v_lshl_add_u32 v38, v38, 4, v39
    s_mul_i32 s76, s72, 147456
    s_lshl_b32 s79, s73, 10
    s_add_u32 m0, s79, 24576
    s_nop 0
    buffer_load_dwordx4 v38, s[68:71], s76 offen lds
    s_lshl_b32 s79, s73, 6
    s_add_u32 s79, s79, 768
    v_add_u32 v38, s79, v16
    v_mul_u32_u24 v39, 14564, v38
    v_lshrrev_b32 v39, 20, v39
    v_mul_u32_u24 v40, 72, v39
    v_sub_u32 v38, v38, v40
    v_bfe_u32 v40, v39, 2, 2
    v_lshlrev_b32 v40, 1, v40
    v_xor_b32 v38, v38, v40
    v_mul_u32_u24 v39, 1152, v39
    v_lshl_add_u32 v38, v38, 4, v39
    s_mul_i32 s76, s72, 147456
    s_lshl_b32 s79, s73, 10
    s_add_u32 m0, s79, 28672
    s_nop 0
    buffer_load_dwordx4 v38, s[68:71], s76 offen lds
    s_waitcnt vmcnt(32)
    s_barrier
    v_add_u32 v36, 0, v44
    v_add_u32 v37, 0, v45
    ds_read_b64_tr_b16 a[152:153], v36 offset:16384
    ds_read_b64_tr_b16 a[154:155], v36 offset:16896
    ds_read_b64_tr_b16 a[156:157], v36 offset:24576
    ds_read_b64_tr_b16 a[158:159], v36 offset:25088
    ds_read_b64_tr_b16 a[224:225], v37 offset:16384
    ds_read_b64_tr_b16 a[226:227], v37 offset:16896
    ds_read_b64_tr_b16 a[228:229], v37 offset:24576
    ds_read_b64_tr_b16 a[230:231], v37 offset:25088
    s_waitcnt lgkmcnt(0)
    s_barrier
    s_lshl_b32 s79, s73, 6
    s_add_u32 s79, s79, 1024
    v_add_u32 v38, s79, v16
    v_mul_u32_u24 v39, 14564, v38
    v_lshrrev_b32 v39, 20, v39
    v_mul_u32_u24 v40, 72, v39
    v_sub_u32 v38, v38, v40
    v_bfe_u32 v40, v39, 2, 2
    v_lshlrev_b32 v40, 1, v40
    v_xor_b32 v38, v38, v40
    v_mul_u32_u24 v39, 1152, v39
    v_lshl_add_u32 v38, v38, 4, v39
    s_mul_i32 s76, s72, 147456
    s_lshl_b32 s79, s73, 10
    s_add_u32 m0, s79, 32768
    s_nop 0
    buffer_load_dwordx4 v38, s[68:71], s76 offen lds
    s_lshl_b32 s79, s73, 6
    s_add_u32 s79, s79, 1280
    v_add_u32 v38, s79, v16
    v_mul_u32_u24 v39, 14564, v38
    v_lshrrev_b32 v39, 20, v39
    v_mul_u32_u24 v40, 72, v39
    v_sub_u32 v38, v38, v40
    v_bfe_u32 v40, v39, 2, 2
    v_lshlrev_b32 v40, 1, v40
    v_xor_b32 v38, v38, v40
    v_mul_u32_u24 v39, 1152, v39
    v_lshl_add_u32 v38, v38, 4, v39
    s_mul_i32 s76, s72, 147456
    s_lshl_b32 s79, s73, 10
    s_add_u32 m0, s79, 36864
    s_nop 0
    buffer_load_dwordx4 v38, s[68:71], s76 offen lds
    s_lshl_b32 s79, s73, 6
    s_add_u32 s79, s79, 1536
    v_add_u32 v38, s79, v16
    v_mul_u32_u24 v39, 14564, v38
    v_lshrrev_b32 v39, 20, v39
    v_mul_u32_u24 v40, 72, v39
    v_sub_u32 v38, v38, v40
    v_bfe_u32 v40, v39, 2, 2
    v_lshlrev_b32 v40, 1, v40
    v_xor_b32 v38, v38, v40
    v_mul_u32_u24 v39, 1152, v39
    v_lshl_add_u32 v38, v38, 4, v39
    s_mul_i32 s76, s72, 147456
    s_lshl_b32 s79, s73, 10
    s_add_u32 m0, s79, 40960
    s_nop 0
    buffer_load_dwordx4 v38, s[68:71], s76 offen lds
    s_lshl_b32 s79, s73, 6
    s_add_u32 s79, s79, 1792
    v_add_u32 v38, s79, v16
    v_mul_u32_u24 v39, 14564, v38
    v_lshrrev_b32 v39, 20, v39
    v_mul_u32_u24 v40, 72, v39
    v_sub_u32 v38, v38, v40
    v_bfe_u32 v40, v39, 2, 2
    v_lshlrev_b32 v40, 1, v40
    v_xor_b32 v38, v38, v40
    v_mul_u32_u24 v39, 1152, v39
    v_lshl_add_u32 v38, v38, 4, v39
    s_mul_i32 s76, s72, 147456
    s_lshl_b32 s79, s73, 10
    s_add_u32 m0, s79, 45056
    s_nop 0
    buffer_load_dwordx4 v38, s[68:71], s76 offen lds
    s_waitcnt vmcnt(32)
    s_barrier
    v_add_u32 v36, 0, v44
    v_add_u32 v37, 0, v45
    ds_read_b64_tr_b16 a[160:161], v36 offset:32768
    ds_read_b64_tr_b16 a[162:163], v36 offset:33280
    ds_read_b64_tr_b16 a[164:165], v36 offset:40960
    ds_read_b64_tr_b16 a[166:167], v36 offset:41472
    ds_read_b64_tr_b16 a[232:233], v37 offset:32768
    ds_read_b64_tr_b16 a[234:235], v37 offset:33280
    ds_read_b64_tr_b16 a[236:237], v37 offset:40960
    ds_read_b64_tr_b16 a[238:239], v37 offset:41472
    s_waitcnt lgkmcnt(0)
    s_barrier
    s_lshl_b32 s79, s73, 6
    s_add_u32 s79, s79, 2048
    v_add_u32 v38, s79, v16
    v_mul_u32_u24 v39, 14564, v38
    v_lshrrev_b32 v39, 20, v39
    v_mul_u32_u24 v40, 72, v39
    v_sub_u32 v38, v38, v40
    v_bfe_u32 v40, v39, 2, 2
    v_lshlrev_b32 v40, 1, v40
    v_xor_b32 v38, v38, v40
    v_mul_u32_u24 v39, 1152, v39
    v_lshl_add_u32 v38, v38, 4, v39
    s_mul_i32 s76, s72, 147456
    s_lshl_b32 s79, s73, 10
    s_add_u32 m0, s79, 49152
    s_nop 0
    buffer_load_dwordx4 v38, s[68:71], s76 offen lds
    s_lshl_b32 s79, s73, 6
    s_add_u32 s79, s79, 2304
    v_add_u32 v38, s79, v16
    v_mul_u32_u24 v39, 14564, v38
    v_lshrrev_b32 v39, 20, v39
    v_mul_u32_u24 v40, 72, v39
    v_sub_u32 v38, v38, v40
    v_bfe_u32 v40, v39, 2, 2
    v_lshlrev_b32 v40, 1, v40
    v_xor_b32 v38, v38, v40
    v_mul_u32_u24 v39, 1152, v39
    v_lshl_add_u32 v38, v38, 4, v39
    s_mul_i32 s76, s72, 147456
    s_lshl_b32 s79, s73, 10
    s_add_u32 m0, s79, 53248
    s_nop 0
    buffer_load_dwordx4 v38, s[68:71], s76 offen lds
    s_lshl_b32 s79, s73, 6
    s_add_u32 s79, s79, 2560
    v_add_u32 v38, s79, v16
    v_mul_u32_u24 v39, 14564, v38
    v_lshrrev_b32 v39, 20, v39
    v_mul_u32_u24 v40, 72, v39
    v_sub_u32 v38, v38, v40
    v_bfe_u32 v40, v39, 2, 2
    v_lshlrev_b32 v40, 1, v40
    v_xor_b32 v38, v38, v40
    v_mul_u32_u24 v39, 1152, v39
    v_lshl_add_u32 v38, v38, 4, v39
    s_mul_i32 s76, s72, 147456
    s_lshl_b32 s79, s73, 10
    s_add_u32 m0, s79, 57344
    s_nop 0
    buffer_load_dwordx4 v38, s[68:71], s76 offen lds
    s_lshl_b32 s79, s73, 6
    s_add_u32 s79, s79, 2816
    v_add_u32 v38, s79, v16
    v_mul_u32_u24 v39, 14564, v38
    v_lshrrev_b32 v39, 20, v39
    v_mul_u32_u24 v40, 72, v39
    v_sub_u32 v38, v38, v40
    v_bfe_u32 v40, v39, 2, 2
    v_lshlrev_b32 v40, 1, v40
    v_xor_b32 v38, v38, v40
    v_mul_u32_u24 v39, 1152, v39
    v_lshl_add_u32 v38, v38, 4, v39
    s_mul_i32 s76, s72, 147456
    s_lshl_b32 s79, s73, 10
    s_add_u32 m0, s79, 61440
    s_nop 0
    buffer_load_dwordx4 v38, s[68:71], s76 offen lds
    s_waitcnt vmcnt(32)
    s_barrier
    v_add_u32 v36, 0, v44
    v_add_u32 v37, 0, v45
    ds_read_b64_tr_b16 a[168:169], v36 offset:49152
    ds_read_b64_tr_b16 a[170:171], v36 offset:49664
    ds_read_b64_tr_b16 a[172:173], v36 offset:57344
    ds_read_b64_tr_b16 a[174:175], v36 offset:57856
    ds_read_b64_tr_b16 a[240:241], v37 offset:49152
    ds_read_b64_tr_b16 a[242:243], v37 offset:49664
    ds_read_b64_tr_b16 a[244:245], v37 offset:57344
    ds_read_b64_tr_b16 a[246:247], v37 offset:57856
    s_waitcnt lgkmcnt(0)
    s_barrier
    s_lshl_b32 s79, s73, 6
    s_add_u32 s79, s79, 3072
    v_add_u32 v38, s79, v16
    v_mul_u32_u24 v39, 14564, v38
    v_lshrrev_b32 v39, 20, v39
    v_mul_u32_u24 v40, 72, v39
    v_sub_u32 v38, v38, v40
    v_bfe_u32 v40, v39, 2, 2
    v_lshlrev_b32 v40, 1, v40
    v_xor_b32 v38, v38, v40
    v_mul_u32_u24 v39, 1152, v39
    v_lshl_add_u32 v38, v38, 4, v39
    s_mul_i32 s76, s72, 147456
    s_lshl_b32 s79, s73, 10
    s_add_u32 m0, s79, 65536
    s_nop 0
    buffer_load_dwordx4 v38, s[68:71], s76 offen lds
    s_lshl_b32 s79, s73, 6
    s_add_u32 s79, s79, 3328
    v_add_u32 v38, s79, v16
    v_mul_u32_u24 v39, 14564, v38
    v_lshrrev_b32 v39, 20, v39
    v_mul_u32_u24 v40, 72, v39
    v_sub_u32 v38, v38, v40
    v_bfe_u32 v40, v39, 2, 2
    v_lshlrev_b32 v40, 1, v40
    v_xor_b32 v38, v38, v40
    v_mul_u32_u24 v39, 1152, v39
    v_lshl_add_u32 v38, v38, 4, v39
    s_mul_i32 s76, s72, 147456
    s_lshl_b32 s79, s73, 10
    s_add_u32 m0, s79, 69632
    s_nop 0
    buffer_load_dwordx4 v38, s[68:71], s76 offen lds
    s_lshl_b32 s79, s73, 6
    s_add_u32 s79, s79, 3584
    v_add_u32 v38, s79, v16
    v_mul_u32_u24 v39, 14564, v38
    v_lshrrev_b32 v39, 20, v39
    v_mul_u32_u24 v40, 72, v39
    v_sub_u32 v38, v38, v40
    v_bfe_u32 v40, v39, 2, 2
    v_lshlrev_b32 v40, 1, v40
    v_xor_b32 v38, v38, v40
    v_mul_u32_u24 v39, 1152, v39
    v_lshl_add_u32 v38, v38, 4, v39
    s_mul_i32 s76, s72, 147456
    s_lshl_b32 s79, s73, 10
    s_add_u32 m0, s79, 73728
    s_nop 0
    buffer_load_dwordx4 v38, s[68:71], s76 offen lds
    s_lshl_b32 s79, s73, 6
    s_add_u32 s79, s79, 3840
    v_add_u32 v38, s79, v16
    v_mul_u32_u24 v39, 14564, v38
    v_lshrrev_b32 v39, 20, v39
    v_mul_u32_u24 v40, 72, v39
    v_sub_u32 v38, v38, v40
    v_bfe_u32 v40, v39, 2, 2
    v_lshlrev_b32 v40, 1, v40
    v_xor_b32 v38, v38, v40
    v_mul_u32_u24 v39, 1152, v39
    v_lshl_add_u32 v38, v38, 4, v39
    s_mul_i32 s76, s72, 147456
    s_lshl_b32 s79, s73, 10
    s_add_u32 m0, s79, 77824
    s_nop 0
    buffer_load_dwordx4 v38, s[68:71], s76 offen lds
    s_waitcnt vmcnt(32)
    s_barrier
    v_add_u32 v36, 65536, v44
    v_add_u32 v37, 65536, v45
    ds_read_b64_tr_b16 a[176:177], v36 offset:0
    ds_read_b64_tr_b16 a[178:179], v36 offset:512
    ds_read_b64_tr_b16 a[180:181], v36 offset:8192
    ds_read_b64_tr_b16 a[182:183], v36 offset:8704
    ds_read_b64_tr_b16 a[248:249], v37 offset:0
    ds_read_b64_tr_b16 a[250:251], v37 offset:512
    ds_read_b64_tr_b16 a[252:253], v37 offset:8192
    ds_read_b64_tr_b16 a[254:255], v37 offset:8704
    s_waitcnt lgkmcnt(0)
    s_barrier
    s_lshl_b32 s79, s73, 6
    s_add_u32 s79, s79, 4096
    v_add_u32 v38, s79, v16
    v_mul_u32_u24 v39, 14564, v38
    v_lshrrev_b32 v39, 20, v39
    v_mul_u32_u24 v40, 72, v39
    v_sub_u32 v38, v38, v40
    v_bfe_u32 v40, v39, 2, 2
    v_lshlrev_b32 v40, 1, v40
    v_xor_b32 v38, v38, v40
    v_mul_u32_u24 v39, 1152, v39
    v_lshl_add_u32 v38, v38, 4, v39
    s_mul_i32 s76, s72, 147456
    s_lshl_b32 s79, s73, 10
    s_add_u32 m0, s79, 81920
    s_nop 0
    buffer_load_dwordx4 v38, s[68:71], s76 offen lds
    s_lshl_b32 s79, s73, 6
    s_add_u32 s79, s79, 4352
    v_add_u32 v38, s79, v16
    v_mul_u32_u24 v39, 14564, v38
    v_lshrrev_b32 v39, 20, v39
    v_mul_u32_u24 v40, 72, v39
    v_sub_u32 v38, v38, v40
    v_bfe_u32 v40, v39, 2, 2
    v_lshlrev_b32 v40, 1, v40
    v_xor_b32 v38, v38, v40
    v_mul_u32_u24 v39, 1152, v39
    v_lshl_add_u32 v38, v38, 4, v39
    s_mul_i32 s76, s72, 147456
    s_lshl_b32 s79, s73, 10
    s_add_u32 m0, s79, 86016
    s_nop 0
    buffer_load_dwordx4 v38, s[68:71], s76 offen lds
    s_lshl_b32 s79, s73, 6
    s_add_u32 s79, s79, 4608
    v_add_u32 v38, s79, v16
    v_mul_u32_u24 v39, 14564, v38
    v_lshrrev_b32 v39, 20, v39
    v_mul_u32_u24 v40, 72, v39
    v_sub_u32 v38, v38, v40
    v_bfe_u32 v40, v39, 2, 2
    v_lshlrev_b32 v40, 1, v40
    v_xor_b32 v38, v38, v40
    v_mul_u32_u24 v39, 1152, v39
    v_lshl_add_u32 v38, v38, 4, v39
    s_mul_i32 s76, s72, 147456
    s_lshl_b32 s79, s73, 10
    s_add_u32 m0, s79, 90112
    s_nop 0
    buffer_load_dwordx4 v38, s[68:71], s76 offen lds
    s_lshl_b32 s79, s73, 6
    s_add_u32 s79, s79, 4864
    v_add_u32 v38, s79, v16
    v_mul_u32_u24 v39, 14564, v38
    v_lshrrev_b32 v39, 20, v39
    v_mul_u32_u24 v40, 72, v39
    v_sub_u32 v38, v38, v40
    v_bfe_u32 v40, v39, 2, 2
    v_lshlrev_b32 v40, 1, v40
    v_xor_b32 v38, v38, v40
    v_mul_u32_u24 v39, 1152, v39
    v_lshl_add_u32 v38, v38, 4, v39
    s_mul_i32 s76, s72, 147456
    s_lshl_b32 s79, s73, 10
    s_add_u32 m0, s79, 94208
    s_nop 0
    buffer_load_dwordx4 v38, s[68:71], s76 offen lds
    s_waitcnt vmcnt(32)
    s_barrier
    v_add_u32 v36, 65536, v44
    v_add_u32 v37, 65536, v45
    ds_read_b64_tr_b16 a[184:185], v36 offset:16384
    ds_read_b64_tr_b16 a[186:187], v36 offset:16896
    ds_read_b64_tr_b16 a[188:189], v36 offset:24576
    ds_read_b64_tr_b16 a[190:191], v36 offset:25088
    ds_read_b64_tr_b16 v[224:225], v37 offset:16384
    ds_read_b64_tr_b16 v[226:227], v37 offset:16896
    ds_read_b64_tr_b16 v[228:229], v37 offset:24576
    ds_read_b64_tr_b16 v[230:231], v37 offset:25088
    s_waitcnt lgkmcnt(0)
    s_barrier
    s_lshl_b32 s79, s73, 6
    s_add_u32 s79, s79, 5120
    v_add_u32 v38, s79, v16
    v_mul_u32_u24 v39, 14564, v38
    v_lshrrev_b32 v39, 20, v39
    v_mul_u32_u24 v40, 72, v39
    v_sub_u32 v38, v38, v40
    v_bfe_u32 v40, v39, 2, 2
    v_lshlrev_b32 v40, 1, v40
    v_xor_b32 v38, v38, v40
    v_mul_u32_u24 v39, 1152, v39
    v_lshl_add_u32 v38, v38, 4, v39
    s_mul_i32 s76, s72, 147456
    s_lshl_b32 s79, s73, 10
    s_add_u32 m0, s79, 98304
    s_nop 0
    buffer_load_dwordx4 v38, s[68:71], s76 offen lds
    s_lshl_b32 s79, s73, 6
    s_add_u32 s79, s79, 5376
    v_add_u32 v38, s79, v16
    v_mul_u32_u24 v39, 14564, v38
    v_lshrrev_b32 v39, 20, v39
    v_mul_u32_u24 v40, 72, v39
    v_sub_u32 v38, v38, v40
    v_bfe_u32 v40, v39, 2, 2
    v_lshlrev_b32 v40, 1, v40
    v_xor_b32 v38, v38, v40
    v_mul_u32_u24 v39, 1152, v39
    v_lshl_add_u32 v38, v38, 4, v39
    s_mul_i32 s76, s72, 147456
    s_lshl_b32 s79, s73, 10
    s_add_u32 m0, s79, 102400
    s_nop 0
    buffer_load_dwordx4 v38, s[68:71], s76 offen lds
    s_lshl_b32 s79, s73, 6
    s_add_u32 s79, s79, 5632
    v_add_u32 v38, s79, v16
    v_mul_u32_u24 v39, 14564, v38
    v_lshrrev_b32 v39, 20, v39
    v_mul_u32_u24 v40, 72, v39
    v_sub_u32 v38, v38, v40
    v_bfe_u32 v40, v39, 2, 2
    v_lshlrev_b32 v40, 1, v40
    v_xor_b32 v38, v38, v40
    v_mul_u32_u24 v39, 1152, v39
    v_lshl_add_u32 v38, v38, 4, v39
    s_mul_i32 s76, s72, 147456
    s_lshl_b32 s79, s73, 10
    s_add_u32 m0, s79, 106496
    s_nop 0
    buffer_load_dwordx4 v38, s[68:71], s76 offen lds
    s_lshl_b32 s79, s73, 6
    s_add_u32 s79, s79, 5888
    v_add_u32 v38, s79, v16
    v_mul_u32_u24 v39, 14564, v38
    v_lshrrev_b32 v39, 20, v39
    v_mul_u32_u24 v40, 72, v39
    v_sub_u32 v38, v38, v40
    v_bfe_u32 v40, v39, 2, 2
    v_lshlrev_b32 v40, 1, v40
    v_xor_b32 v38, v38, v40
    v_mul_u32_u24 v39, 1152, v39
    v_lshl_add_u32 v38, v38, 4, v39
    s_mul_i32 s76, s72, 147456
    s_lshl_b32 s79, s73, 10
    s_add_u32 m0, s79, 110592
    s_nop 0
    buffer_load_dwordx4 v38, s[68:71], s76 offen lds
    s_waitcnt vmcnt(32)
    s_barrier
    v_add_u32 v36, 65536, v44
    v_add_u32 v37, 65536, v45
    ds_read_b64_tr_b16 a[192:193], v36 offset:32768
    ds_read_b64_tr_b16 a[194:195], v36 offset:33280
    ds_read_b64_tr_b16 a[196:197], v36 offset:40960
    ds_read_b64_tr_b16 a[198:199], v36 offset:41472
    ds_read_b64_tr_b16 v[232:233], v37 offset:32768
    ds_read_b64_tr_b16 v[234:235], v37 offset:33280
    ds_read_b64_tr_b16 v[236:237], v37 offset:40960
    ds_read_b64_tr_b16 v[238:239], v37 offset:41472
    s_waitcnt lgkmcnt(0)
    s_barrier
    s_lshl_b32 s79, s73, 6
    s_add_u32 s79, s79, 6144
    v_add_u32 v38, s79, v16
    v_mul_u32_u24 v39, 14564, v38
    v_lshrrev_b32 v39, 20, v39
    v_mul_u32_u24 v40, 72, v39
    v_sub_u32 v38, v38, v40
    v_bfe_u32 v40, v39, 2, 2
    v_lshlrev_b32 v40, 1, v40
    v_xor_b32 v38, v38, v40
    v_mul_u32_u24 v39, 1152, v39
    v_lshl_add_u32 v38, v38, 4, v39
    s_mul_i32 s76, s72, 147456
    s_lshl_b32 s79, s73, 10
    s_add_u32 m0, s79, 114688
    s_nop 0
    buffer_load_dwordx4 v38, s[68:71], s76 offen lds
    s_lshl_b32 s79, s73, 6
    s_add_u32 s79, s79, 6400
    v_add_u32 v38, s79, v16
    v_mul_u32_u24 v39, 14564, v38
    v_lshrrev_b32 v39, 20, v39
    v_mul_u32_u24 v40, 72, v39
    v_sub_u32 v38, v38, v40
    v_bfe_u32 v40, v39, 2, 2
    v_lshlrev_b32 v40, 1, v40
    v_xor_b32 v38, v38, v40
    v_mul_u32_u24 v39, 1152, v39
    v_lshl_add_u32 v38, v38, 4, v39
    s_mul_i32 s76, s72, 147456
    s_lshl_b32 s79, s73, 10
    s_add_u32 m0, s79, 118784
    s_nop 0
    buffer_load_dwordx4 v38, s[68:71], s76 offen lds
    s_lshl_b32 s79, s73, 6
    s_add_u32 s79, s79, 6656
    v_add_u32 v38, s79, v16
    v_mul_u32_u24 v39, 14564, v38
    v_lshrrev_b32 v39, 20, v39
    v_mul_u32_u24 v40, 72, v39
    v_sub_u32 v38, v38, v40
    v_bfe_u32 v40, v39, 2, 2
    v_lshlrev_b32 v40, 1, v40
    v_xor_b32 v38, v38, v40
    v_mul_u32_u24 v39, 1152, v39
    v_lshl_add_u32 v38, v38, 4, v39
    s_mul_i32 s76, s72, 147456
    s_lshl_b32 s79, s73, 10
    s_add_u32 m0, s79, 122880
    s_nop 0
    buffer_load_dwordx4 v38, s[68:71], s76 offen lds
    s_lshl_b32 s79, s73, 6
    s_add_u32 s79, s79, 6912
    v_add_u32 v38, s79, v16
    v_mul_u32_u24 v39, 14564, v38
    v_lshrrev_b32 v39, 20, v39
    v_mul_u32_u24 v40, 72, v39
    v_sub_u32 v38, v38, v40
    v_bfe_u32 v40, v39, 2, 2
    v_lshlrev_b32 v40, 1, v40
    v_xor_b32 v38, v38, v40
    v_mul_u32_u24 v39, 1152, v39
    v_lshl_add_u32 v38, v38, 4, v39
    s_mul_i32 s76, s72, 147456
    s_lshl_b32 s79, s73, 10
    s_add_u32 m0, s79, 126976
    s_nop 0
    buffer_load_dwordx4 v38, s[68:71], s76 offen lds
    s_waitcnt vmcnt(32)
    s_barrier
    v_add_u32 v36, 65536, v44
    v_add_u32 v37, 65536, v45
    ds_read_b64_tr_b16 a[200:201], v36 offset:49152
    ds_read_b64_tr_b16 a[202:203], v36 offset:49664
    ds_read_b64_tr_b16 a[204:205], v36 offset:57344
    ds_read_b64_tr_b16 a[206:207], v36 offset:57856
    ds_read_b64_tr_b16 v[240:241], v37 offset:49152
    ds_read_b64_tr_b16 v[242:243], v37 offset:49664
    ds_read_b64_tr_b16 v[244:245], v37 offset:57344
    ds_read_b64_tr_b16 v[246:247], v37 offset:57856
    s_waitcnt lgkmcnt(0)
    s_barrier
    s_lshl_b32 s79, s73, 6
    s_add_u32 s79, s79, 7168
    v_add_u32 v38, s79, v16
    v_mul_u32_u24 v39, 14564, v38
    v_lshrrev_b32 v39, 20, v39
    v_mul_u32_u24 v40, 72, v39
    v_sub_u32 v38, v38, v40
    v_bfe_u32 v40, v39, 2, 2
    v_lshlrev_b32 v40, 1, v40
    v_xor_b32 v38, v38, v40
    v_mul_u32_u24 v39, 1152, v39
    v_lshl_add_u32 v38, v38, 4, v39
    s_mul_i32 s76, s72, 147456
    s_lshl_b32 s79, s73, 10
    s_add_u32 m0, s79, 131072
    s_nop 0
    buffer_load_dwordx4 v38, s[68:71], s76 offen lds
    s_lshl_b32 s79, s73, 6
    s_add_u32 s79, s79, 7424
    v_add_u32 v38, s79, v16
    v_mul_u32_u24 v39, 14564, v38
    v_lshrrev_b32 v39, 20, v39
    v_mul_u32_u24 v40, 72, v39
    v_sub_u32 v38, v38, v40
    v_bfe_u32 v40, v39, 2, 2
    v_lshlrev_b32 v40, 1, v40
    v_xor_b32 v38, v38, v40
    v_mul_u32_u24 v39, 1152, v39
    v_lshl_add_u32 v38, v38, 4, v39
    s_mul_i32 s76, s72, 147456
    s_lshl_b32 s79, s73, 10
    s_add_u32 m0, s79, 135168
    s_nop 0
    buffer_load_dwordx4 v38, s[68:71], s76 offen lds
    s_lshl_b32 s79, s73, 6
    s_add_u32 s79, s79, 7680
    v_add_u32 v38, s79, v16
    v_mul_u32_u24 v39, 14564, v38
    v_lshrrev_b32 v39, 20, v39
    v_mul_u32_u24 v40, 72, v39
    v_sub_u32 v38, v38, v40
    v_bfe_u32 v40, v39, 2, 2
    v_lshlrev_b32 v40, 1, v40
    v_xor_b32 v38, v38, v40
    v_mul_u32_u24 v39, 1152, v39
    v_lshl_add_u32 v38, v38, 4, v39
    s_mul_i32 s76, s72, 147456
    s_lshl_b32 s79, s73, 10
    s_add_u32 m0, s79, 139264
    s_nop 0
    buffer_load_dwordx4 v38, s[68:71], s76 offen lds
    s_lshl_b32 s79, s73, 6
    s_add_u32 s79, s79, 7936
    v_add_u32 v38, s79, v16
    v_mul_u32_u24 v39, 14564, v38
    v_lshrrev_b32 v39, 20, v39
    v_mul_u32_u24 v40, 72, v39
    v_sub_u32 v38, v38, v40
    v_bfe_u32 v40, v39, 2, 2
    v_lshlrev_b32 v40, 1, v40
    v_xor_b32 v38, v38, v40
    v_mul_u32_u24 v39, 1152, v39
    v_lshl_add_u32 v38, v38, 4, v39
    s_mul_i32 s76, s72, 147456
    s_lshl_b32 s79, s73, 10
    s_add_u32 m0, s79, 143360
    s_nop 0
    buffer_load_dwordx4 v38, s[68:71], s76 offen lds
    s_waitcnt vmcnt(32)
    s_barrier
    v_add_u32 v36, 131072, v44
    v_add_u32 v37, 131072, v45
    ds_read_b64_tr_b16 a[208:209], v36 offset:0
    ds_read_b64_tr_b16 a[210:211], v36 offset:512
    ds_read_b64_tr_b16 a[212:213], v36 offset:8192
    ds_read_b64_tr_b16 a[214:215], v36 offset:8704
    ds_read_b64_tr_b16 v[248:249], v37 offset:0
    ds_read_b64_tr_b16 v[250:251], v37 offset:512
    ds_read_b64_tr_b16 v[252:253], v37 offset:8192
    ds_read_b64_tr_b16 v[254:255], v37 offset:8704
    s_waitcnt lgkmcnt(0)
    s_barrier
    s_lshl_b32 s79, s73, 6
    s_add_u32 s79, s79, 8192
    v_add_u32 v38, s79, v16
    v_mul_u32_u24 v39, 14564, v38
    v_lshrrev_b32 v39, 20, v39
    v_mul_u32_u24 v40, 72, v39
    v_sub_u32 v38, v38, v40
    v_bfe_u32 v40, v39, 2, 2
    v_lshlrev_b32 v40, 1, v40
    v_xor_b32 v38, v38, v40
    v_mul_u32_u24 v39, 1152, v39
    v_lshl_add_u32 v38, v38, 4, v39
    s_mul_i32 s76, s72, 147456
    s_lshl_b32 s79, s73, 10
    s_add_u32 m0, s79, 147456
    s_nop 0
    buffer_load_dwordx4 v38, s[68:71], s76 offen lds
    s_lshl_b32 s79, s73, 6
    s_add_u32 s79, s79, 8448
    v_add_u32 v38, s79, v16
    v_mul_u32_u24 v39, 14564, v38
    v_lshrrev_b32 v39, 20, v39
    v_mul_u32_u24 v40, 72, v39
    v_sub_u32 v38, v38, v40
    v_bfe_u32 v40, v39, 2, 2
    v_lshlrev_b32 v40, 1, v40
    v_xor_b32 v38, v38, v40
    v_mul_u32_u24 v39, 1152, v39
    v_lshl_add_u32 v38, v38, 4, v39
    s_mul_i32 s76, s72, 147456
    s_lshl_b32 s79, s73, 10
    s_add_u32 m0, s79, 151552
    s_nop 0
    buffer_load_dwordx4 v38, s[68:71], s76 offen lds
    s_lshl_b32 s79, s73, 6
    s_add_u32 s79, s79, 8704
    v_add_u32 v38, s79, v16
    v_mul_u32_u24 v39, 14564, v38
    v_lshrrev_b32 v39, 20, v39
    v_mul_u32_u24 v40, 72, v39
    v_sub_u32 v38, v38, v40
    v_bfe_u32 v40, v39, 2, 2
    v_lshlrev_b32 v40, 1, v40
    v_xor_b32 v38, v38, v40
    v_mul_u32_u24 v39, 1152, v39
    v_lshl_add_u32 v38, v38, 4, v39
    s_mul_i32 s76, s72, 147456
    s_lshl_b32 s79, s73, 10
    s_add_u32 m0, s79, 155648
    s_nop 0
    buffer_load_dwordx4 v38, s[68:71], s76 offen lds
    s_lshl_b32 s79, s73, 6
    s_add_u32 s79, s79, 8960
    v_add_u32 v38, s79, v16
    v_mul_u32_u24 v39, 14564, v38
    v_lshrrev_b32 v39, 20, v39
    v_mul_u32_u24 v40, 72, v39
    v_sub_u32 v38, v38, v40
    v_bfe_u32 v40, v39, 2, 2
    v_lshlrev_b32 v40, 1, v40
    v_xor_b32 v38, v38, v40
    v_mul_u32_u24 v39, 1152, v39
    v_lshl_add_u32 v38, v38, 4, v39
    s_mul_i32 s76, s72, 147456
    s_lshl_b32 s79, s73, 10
    s_add_u32 m0, s79, 159744
    s_nop 0
    buffer_load_dwordx4 v38, s[68:71], s76 offen lds
    s_waitcnt vmcnt(16)
    s_barrier
    v_mul_u32_u24 v36, 1152, v27
    v_add_u32 v36, v36, v28
    v_add_u32 v36, 16384, v36
    s_mul_i32 s79, s73, 9
    s_add_u32 s80, s79, 0
    v_xor_b32 v37, s80, v25
    v_lshl_add_u32 v37, v37, 5, v36
    ds_read_b64_tr_b16 v[80:81], v37 offset:0
    ds_read_b64_tr_b16 v[82:83], v37 offset:2304
    ds_read_b64_tr_b16 v[84:85], v37 offset:36864
    ds_read_b64_tr_b16 v[86:87], v37 offset:39168
    s_add_u32 s80, s79, 1
    v_xor_b32 v37, s80, v25
    v_lshl_add_u32 v37, v37, 5, v36
    ds_read_b64_tr_b16 v[96:97], v37 offset:0
    ds_read_b64_tr_b16 v[98:99], v37 offset:2304
    ds_read_b64_tr_b16 v[100:101], v37 offset:36864
    ds_read_b64_tr_b16 v[102:103], v37 offset:39168
    s_add_u32 s80, s79, 2
    v_xor_b32 v37, s80, v25
    v_lshl_add_u32 v37, v37, 5, v36
    ds_read_b64_tr_b16 v[112:113], v37 offset:0
    ds_read_b64_tr_b16 v[114:115], v37 offset:2304
    ds_read_b64_tr_b16 v[116:117], v37 offset:36864
    ds_read_b64_tr_b16 v[118:119], v37 offset:39168
    s_add_u32 s80, s79, 3
    v_xor_b32 v37, s80, v25
    v_lshl_add_u32 v37, v37, 5, v36
    ds_read_b64_tr_b16 v[128:129], v37 offset:0
    ds_read_b64_tr_b16 v[130:131], v37 offset:2304
    ds_read_b64_tr_b16 v[132:133], v37 offset:36864
    ds_read_b64_tr_b16 v[134:135], v37 offset:39168
    s_add_u32 s80, s79, 4
    v_xor_b32 v37, s80, v25
    v_lshl_add_u32 v37, v37, 5, v36
    ds_read_b64_tr_b16 v[144:145], v37 offset:0
    ds_read_b64_tr_b16 v[146:147], v37 offset:2304
    ds_read_b64_tr_b16 v[148:149], v37 offset:36864
    ds_read_b64_tr_b16 v[150:151], v37 offset:39168
    s_add_u32 s80, s79, 5
    v_xor_b32 v37, s80, v25
    v_lshl_add_u32 v37, v37, 5, v36
    ds_read_b64_tr_b16 v[160:161], v37 offset:0
    ds_read_b64_tr_b16 v[162:163], v37 offset:2304
    ds_read_b64_tr_b16 v[164:165], v37 offset:36864
    ds_read_b64_tr_b16 v[166:167], v37 offset:39168
    s_add_u32 s80, s79, 6
    v_xor_b32 v37, s80, v25
    v_lshl_add_u32 v37, v37, 5, v36
    ds_read_b64_tr_b16 v[176:177], v37 offset:0
    ds_read_b64_tr_b16 v[178:179], v37 offset:2304
    ds_read_b64_tr_b16 v[180:181], v37 offset:36864
    ds_read_b64_tr_b16 v[182:183], v37 offset:39168
    s_add_u32 s80, s79, 7
    v_xor_b32 v37, s80, v25
    v_lshl_add_u32 v37, v37, 5, v36
    ds_read_b64_tr_b16 v[192:193], v37 offset:0
    ds_read_b64_tr_b16 v[194:195], v37 offset:2304
    ds_read_b64_tr_b16 v[196:197], v37 offset:36864
    ds_read_b64_tr_b16 v[198:199], v37 offset:39168
    s_add_u32 s80, s79, 8
    v_xor_b32 v37, s80, v25
    v_lshl_add_u32 v37, v37, 5, v36
    ds_read_b64_tr_b16 v[208:209], v37 offset:0
    ds_read_b64_tr_b16 v[210:211], v37 offset:2304
    ds_read_b64_tr_b16 v[212:213], v37 offset:36864
    ds_read_b64_tr_b16 v[214:215], v37 offset:39168
    s_waitcnt lgkmcnt(0)
    s_barrier
    s_lshl_b32 s76, s73, 15
    s_add_u32 s76, s76, 0
    s_lshl_b32 s79, s73, 10
    s_add_u32 m0, s79, 16384
    s_nop 0
    buffer_load_dwordx4 v33, s[64:67], s76 offen lds
    s_lshl_b32 s76, s73, 15
    s_add_u32 s76, s76, 131072
    s_lshl_b32 s79, s73, 10
    s_add_u32 m0, s79, 20480
    s_nop 0
    buffer_load_dwordx4 v33, s[64:67], s76 offen lds
    s_lshl_b32 s76, s73, 15
    s_add_u32 s76, s76, 262144
    s_lshl_b32 s79, s73, 10
    s_add_u32 m0, s79, 24576
    s_nop 0
    buffer_load_dwordx4 v33, s[64:67], s76 offen lds
    s_lshl_b32 s76, s73, 15
    s_add_u32 s76, s76, 393216
    s_lshl_b32 s79, s73, 10
    s_add_u32 m0, s79, 28672
    s_nop 0
    buffer_load_dwordx4 v33, s[64:67], s76 offen lds
    s_lshl_b32 s76, s73, 15
    s_add_u32 s76, s76, 524288
    s_lshl_b32 s79, s73, 10
    s_add_u32 m0, s79, 32768
    s_nop 0
    buffer_load_dwordx4 v33, s[64:67], s76 offen lds
    s_lshl_b32 s76, s73, 15
    s_add_u32 s76, s76, 655360
    s_lshl_b32 s79, s73, 10
    s_add_u32 m0, s79, 36864
    s_nop 0
    buffer_load_dwordx4 v33, s[64:67], s76 offen lds
    s_lshl_b32 s76, s73, 15
    s_add_u32 s76, s76, 786432
    s_lshl_b32 s79, s73, 10
    s_add_u32 m0, s79, 40960
    s_nop 0
    buffer_load_dwordx4 v33, s[64:67], s76 offen lds
    s_lshl_b32 s76, s73, 15
    s_add_u32 s76, s76, 917504
    s_lshl_b32 s79, s73, 10
    s_add_u32 m0, s79, 45056
    s_nop 0
    buffer_load_dwordx4 v33, s[64:67], s76 offen lds
    s_lshl_b32 s76, s73, 15
    s_add_u32 s76, s76, 1048576
    s_lshl_b32 s79, s73, 10
    s_add_u32 m0, s79, 49152
    s_nop 0
    buffer_load_dwordx4 v33, s[64:67], s76 offen lds
    s_lshl_b32 s76, s73, 15
    s_add_u32 s76, s76, 1179648
    s_lshl_b32 s79, s73, 10
    s_add_u32 m0, s79, 53248
    s_nop 0
    buffer_load_dwordx4 v33, s[64:67], s76 offen lds
    s_lshl_b32 s76, s73, 15
    s_add_u32 s76, s76, 1310720
    s_lshl_b32 s79, s73, 10
    s_add_u32 m0, s79, 57344
    s_nop 0
    buffer_load_dwordx4 v33, s[64:67], s76 offen lds
    s_lshl_b32 s76, s73, 15
    s_add_u32 s76, s76, 1441792
    s_lshl_b32 s79, s73, 10
    s_add_u32 m0, s79, 61440
    s_nop 0
    buffer_load_dwordx4 v33, s[64:67], s76 offen lds
    s_lshl_b32 s76, s73, 15
    s_add_u32 s76, s76, 1572864
    s_lshl_b32 s79, s73, 10
    s_add_u32 m0, s79, 65536
    s_nop 0
    buffer_load_dwordx4 v33, s[64:67], s76 offen lds
    s_lshl_b32 s76, s73, 15
    s_add_u32 s76, s76, 1703936
    s_lshl_b32 s79, s73, 10
    s_add_u32 m0, s79, 69632
    s_nop 0
    buffer_load_dwordx4 v33, s[64:67], s76 offen lds
    s_lshl_b32 s76, s73, 15
    s_add_u32 s76, s76, 1835008
    s_lshl_b32 s79, s73, 10
    s_add_u32 m0, s79, 73728
    s_nop 0
    buffer_load_dwordx4 v33, s[64:67], s76 offen lds
    s_lshl_b32 s76, s73, 15
    s_add_u32 s76, s76, 1966080
    s_lshl_b32 s79, s73, 10
    s_add_u32 m0, s79, 77824
    s_nop 0
    buffer_load_dwordx4 v33, s[64:67], s76 offen lds
    s_lshl_b32 s76, s73, 15
    s_add_u32 s76, s76, 2097152
    s_lshl_b32 s79, s73, 10
    s_add_u32 m0, s79, 81920
    s_nop 0
    buffer_load_dwordx4 v33, s[64:67], s76 offen lds
    s_lshl_b32 s76, s73, 15
    s_add_u32 s76, s76, 2228224
    s_lshl_b32 s79, s73, 10
    s_add_u32 m0, s79, 86016
    s_nop 0
    buffer_load_dwordx4 v33, s[64:67], s76 offen lds
    s_waitcnt vmcnt(18)
    s_barrier
    v_mul_u32_u24 v36, 1152, v27
    v_add_u32 v36, v36, v28
    v_add_u32 v36, 90112, v36
    s_mul_i32 s79, s73, 9
    s_add_u32 s80, s79, 0
    v_xor_b32 v37, s80, v25
    v_lshl_add_u32 v37, v37, 5, v36
    ds_read_b64_tr_b16 v[88:89], v37 offset:0
    ds_read_b64_tr_b16 v[90:91], v37 offset:2304
    ds_read_b64_tr_b16 v[92:93], v37 offset:36864
    ds_read_b64_tr_b16 v[94:95], v37 offset:39168
    s_add_u32 s80, s79, 1
    v_xor_b32 v37, s80, v25
    v_lshl_add_u32 v37, v37, 5, v36
    ds_read_b64_tr_b16 v[104:105], v37 offset:0
    ds_read_b64_tr_b16 v[106:107], v37 offset:2304
    ds_read_b64_tr_b16 v[108:109], v37 offset:36864
    ds_read_b64_tr_b16 v[110:111], v37 offset:39168
    s_add_u32 s80, s79, 2
    v_xor_b32 v37, s80, v25
    v_lshl_add_u32 v37, v37, 5, v36
    ds_read_b64_tr_b16 v[120:121], v37 offset:0
    ds_read_b64_tr_b16 v[122:123], v37 offset:2304
    ds_read_b64_tr_b16 v[124:125], v37 offset:36864
    ds_read_b64_tr_b16 v[126:127], v37 offset:39168
    s_add_u32 s80, s79, 3
    v_xor_b32 v37, s80, v25
    v_lshl_add_u32 v37, v37, 5, v36
    ds_read_b64_tr_b16 v[136:137], v37 offset:0
    ds_read_b64_tr_b16 v[138:139], v37 offset:2304
    ds_read_b64_tr_b16 v[140:141], v37 offset:36864
    ds_read_b64_tr_b16 v[142:143], v37 offset:39168
    s_add_u32 s80, s79, 4
    v_xor_b32 v37, s80, v25
    v_lshl_add_u32 v37, v37, 5, v36
    ds_read_b64_tr_b16 v[152:153], v37 offset:0
    ds_read_b64_tr_b16 v[154:155], v37 offset:2304
    ds_read_b64_tr_b16 v[156:157], v37 offset:36864
    ds_read_b64_tr_b16 v[158:159], v37 offset:39168
    s_add_u32 s80, s79, 5
    v_xor_b32 v37, s80, v25
    v_lshl_add_u32 v37, v37, 5, v36
    ds_read_b64_tr_b16 v[168:169], v37 offset:0
    ds_read_b64_tr_b16 v[170:171], v37 offset:2304
    ds_read_b64_tr_b16 v[172:173], v37 offset:36864
    ds_read_b64_tr_b16 v[174:175], v37 offset:39168
    s_add_u32 s80, s79, 6
    v_xor_b32 v37, s80, v25
    v_lshl_add_u32 v37, v37, 5, v36
    ds_read_b64_tr_b16 v[184:185], v37 offset:0
    ds_read_b64_tr_b16 v[186:187], v37 offset:2304
    ds_read_b64_tr_b16 v[188:189], v37 offset:36864
    ds_read_b64_tr_b16 v[190:191], v37 offset:39168
    s_add_u32 s80, s79, 7
    v_xor_b32 v37, s80, v25
    v_lshl_add_u32 v37, v37, 5, v36
    ds_read_b64_tr_b16 v[200:201], v37 offset:0
    ds_read_b64_tr_b16 v[202:203], v37 offset:2304
    ds_read_b64_tr_b16 v[204:205], v37 offset:36864
    ds_read_b64_tr_b16 v[206:207], v37 offset:39168
    s_add_u32 s80, s79, 8
    v_xor_b32 v37, s80, v25
    v_lshl_add_u32 v37, v37, 5, v36
    ds_read_b64_tr_b16 v[216:217], v37 offset:0
    ds_read_b64_tr_b16 v[218:219], v37 offset:2304
    ds_read_b64_tr_b16 v[220:221], v37 offset:36864
    ds_read_b64_tr_b16 v[222:223], v37 offset:39168
    s_waitcnt lgkmcnt(0)
    s_barrier
    s_lshl_b32 s76, s73, 15
    s_add_u32 s76, s76, 2359296
    s_lshl_b32 s79, s73, 10
    s_add_u32 m0, s79, 90112
    s_nop 0
    buffer_load_dwordx4 v33, s[64:67], s76 offen lds
    s_lshl_b32 s76, s73, 15
    s_add_u32 s76, s76, 2490368
    s_lshl_b32 s79, s73, 10
    s_add_u32 m0, s79, 94208
    s_nop 0
    buffer_load_dwordx4 v33, s[64:67], s76 offen lds
    s_lshl_b32 s76, s73, 15
    s_add_u32 s76, s76, 2621440
    s_lshl_b32 s79, s73, 10
    s_add_u32 m0, s79, 98304
    s_nop 0
    buffer_load_dwordx4 v33, s[64:67], s76 offen lds
    s_lshl_b32 s76, s73, 15
    s_add_u32 s76, s76, 2752512
    s_lshl_b32 s79, s73, 10
    s_add_u32 m0, s79, 102400
    s_nop 0
    buffer_load_dwordx4 v33, s[64:67], s76 offen lds
    s_lshl_b32 s76, s73, 15
    s_add_u32 s76, s76, 2883584
    s_lshl_b32 s79, s73, 10
    s_add_u32 m0, s79, 106496
    s_nop 0
    buffer_load_dwordx4 v33, s[64:67], s76 offen lds
    s_lshl_b32 s76, s73, 15
    s_add_u32 s76, s76, 3014656
    s_lshl_b32 s79, s73, 10
    s_add_u32 m0, s79, 110592
    s_nop 0
    buffer_load_dwordx4 v33, s[64:67], s76 offen lds
    s_lshl_b32 s76, s73, 15
    s_add_u32 s76, s76, 3145728
    s_lshl_b32 s79, s73, 10
    s_add_u32 m0, s79, 114688
    s_nop 0
    buffer_load_dwordx4 v33, s[64:67], s76 offen lds
    s_lshl_b32 s76, s73, 15
    s_add_u32 s76, s76, 3276800
    s_lshl_b32 s79, s73, 10
    s_add_u32 m0, s79, 118784
    s_nop 0
    buffer_load_dwordx4 v33, s[64:67], s76 offen lds
    s_lshl_b32 s76, s73, 15
    s_add_u32 s76, s76, 3407872
    s_lshl_b32 s79, s73, 10
    s_add_u32 m0, s79, 122880
    s_nop 0
    buffer_load_dwordx4 v33, s[64:67], s76 offen lds
    s_lshl_b32 s76, s73, 15
    s_add_u32 s76, s76, 3538944
    s_lshl_b32 s79, s73, 10
    s_add_u32 m0, s79, 126976
    s_nop 0
    buffer_load_dwordx4 v33, s[64:67], s76 offen lds
    s_lshl_b32 s76, s73, 15
    s_add_u32 s76, s76, 3670016
    s_lshl_b32 s79, s73, 10
    s_add_u32 m0, s79, 131072
    s_nop 0
    buffer_load_dwordx4 v33, s[64:67], s76 offen lds
    s_lshl_b32 s76, s73, 15
    s_add_u32 s76, s76, 3801088
    s_lshl_b32 s79, s73, 10
    s_add_u32 m0, s79, 135168
    s_nop 0
    buffer_load_dwordx4 v33, s[64:67], s76 offen lds
    s_lshl_b32 s76, s73, 15
    s_add_u32 s76, s76, 3932160
    s_lshl_b32 s79, s73, 10
    s_add_u32 m0, s79, 139264
    s_nop 0
    buffer_load_dwordx4 v33, s[64:67], s76 offen lds
    s_lshl_b32 s76, s73, 15
    s_add_u32 s76, s76, 4063232
    s_lshl_b32 s79, s73, 10
    s_add_u32 m0, s79, 143360
    s_nop 0
    buffer_load_dwordx4 v33, s[64:67], s76 offen lds
    s_lshl_b32 s76, s73, 15
    s_add_u32 s76, s76, 4194304
    s_lshl_b32 s79, s73, 10
    s_add_u32 m0, s79, 147456
    s_nop 0
    buffer_load_dwordx4 v33, s[64:67], s76 offen lds
    s_lshl_b32 s76, s73, 15
    s_add_u32 s76, s76, 4325376
    s_lshl_b32 s79, s73, 10
    s_add_u32 m0, s79, 151552
    s_nop 0
    buffer_load_dwordx4 v33, s[64:67], s76 offen lds
    s_lshl_b32 s76, s73, 15
    s_add_u32 s76, s76, 4456448
    s_lshl_b32 s79, s73, 10
    s_add_u32 m0, s79, 155648
    s_nop 0
    buffer_load_dwordx4 v33, s[64:67], s76 offen lds
    s_lshl_b32 s76, s73, 15
    s_add_u32 s76, s76, 4587520
    s_lshl_b32 s79, s73, 10
    s_add_u32 m0, s79, 159744
    s_nop 0
    buffer_load_dwordx4 v33, s[64:67], s76 offen lds
    v_mov_b32 v46, 32
    v_mov_b32 v47, 64
    v_mov_b32 v40, 0
    s_waitcnt vmcnt(32)
    s_barrier
    v_add_u32 v36, 0, v44
    v_add_u32 v37, 0, v45
    ds_read_b64_tr_b16 v[48:49], v36 offset:0
    ds_read_b64_tr_b16 v[50:51], v36 offset:512
    ds_read_b64_tr_b16 v[52:53], v36 offset:8192
    ds_read_b64_tr_b16 v[54:55], v36 offset:8704
    ds_read_b64_tr_b16 v[56:57], v37 offset:0
    ds_read_b64_tr_b16 v[58:59], v37 offset:512
    ds_read_b64_tr_b16 v[60:61], v37 offset:8192
    ds_read_b64_tr_b16 v[62:63], v37 offset:8704
    s_waitcnt lgkmcnt(0)
    s_barrier
    v_add_u32 v36, 0, v3
    ds_write_b128 v36, v[48:51] offset:0
    ds_write_b128 v36, v[52:55] offset:1024
    ds_write_b128 v36, v[56:59] offset:2048
    ds_write_b128 v36, v[60:63] offset:3072
    s_waitcnt vmcnt(28)
    s_barrier
    v_add_u32 v36, 0, v44
    v_add_u32 v37, 0, v45
    ds_read_b64_tr_b16 v[48:49], v36 offset:16384
    ds_read_b64_tr_b16 v[50:51], v36 offset:16896
    ds_read_b64_tr_b16 v[52:53], v36 offset:24576
    ds_read_b64_tr_b16 v[54:55], v36 offset:25088
    ds_read_b64_tr_b16 v[56:57], v37 offset:16384
    ds_read_b64_tr_b16 v[58:59], v37 offset:16896
    ds_read_b64_tr_b16 v[60:61], v37 offset:24576
    ds_read_b64_tr_b16 v[62:63], v37 offset:25088
    s_waitcnt lgkmcnt(0)
    s_barrier
    v_add_u32 v36, 16384, v3
    ds_write_b128 v36, v[48:51] offset:0
    ds_write_b128 v36, v[52:55] offset:1024
    ds_write_b128 v36, v[56:59] offset:2048
    ds_write_b128 v36, v[60:63] offset:3072
    s_waitcnt vmcnt(24)
    s_barrier
    v_add_u32 v36, 0, v44
    v_add_u32 v37, 0, v45
    ds_read_b64_tr_b16 v[48:49], v36 offset:32768
    ds_read_b64_tr_b16 v[50:51], v36 offset:33280
    ds_read_b64_tr_b16 v[52:53], v36 offset:40960
    ds_read_b64_tr_b16 v[54:55], v36 offset:41472
    ds_read_b64_tr_b16 v[56:57], v37 offset:32768
    ds_read_b64_tr_b16 v[58:59], v37 offset:33280
    ds_read_b64_tr_b16 v[60:61], v37 offset:40960
    ds_read_b64_tr_b16 v[62:63], v37 offset:41472
    s_waitcnt lgkmcnt(0)
    s_barrier
    v_add_u32 v36, 32768, v3
    ds_write_b128 v36, v[48:51] offset:0
    ds_write_b128 v36, v[52:55] offset:1024
    ds_write_b128 v36, v[56:59] offset:2048
    ds_write_b128 v36, v[60:63] offset:3072
    s_waitcnt vmcnt(20)
    s_barrier
    v_add_u32 v36, 0, v44
    v_add_u32 v37, 0, v45
    ds_read_b64_tr_b16 v[48:49], v36 offset:49152
    ds_read_b64_tr_b16 v[50:51], v36 offset:49664
    ds_read_b64_tr_b16 v[52:53], v36 offset:57344
    ds_read_b64_tr_b16 v[54:55], v36 offset:57856
    ds_read_b64_tr_b16 v[56:57], v37 offset:49152
    ds_read_b64_tr_b16 v[58:59], v37 offset:49664
    ds_read_b64_tr_b16 v[60:61], v37 offset:57344
    ds_read_b64_tr_b16 v[62:63], v37 offset:57856
    s_waitcnt lgkmcnt(0)
    s_barrier
    v_add_u32 v36, 49152, v3
    ds_write_b128 v36, v[48:51] offset:0
    ds_write_b128 v36, v[52:55] offset:1024
    ds_write_b128 v36, v[56:59] offset:2048
    ds_write_b128 v36, v[60:63] offset:3072
    s_waitcnt vmcnt(16)
    s_barrier
    v_add_u32 v36, 65536, v44
    v_add_u32 v37, 65536, v45
    ds_read_b64_tr_b16 v[48:49], v36 offset:0
    ds_read_b64_tr_b16 v[50:51], v36 offset:512
    ds_read_b64_tr_b16 v[52:53], v36 offset:8192
    ds_read_b64_tr_b16 v[54:55], v36 offset:8704
    ds_read_b64_tr_b16 v[56:57], v37 offset:0
    ds_read_b64_tr_b16 v[58:59], v37 offset:512
    ds_read_b64_tr_b16 v[60:61], v37 offset:8192
    ds_read_b64_tr_b16 v[62:63], v37 offset:8704
    s_waitcnt lgkmcnt(0)
    s_barrier
    v_add_u32 v36, 65536, v3
    ds_write_b128 v36, v[48:51] offset:0
    ds_write_b128 v36, v[52:55] offset:1024
    ds_write_b128 v36, v[56:59] offset:2048
    ds_write_b128 v36, v[60:63] offset:3072
    s_waitcnt vmcnt(12)
    s_barrier
    v_add_u32 v36, 65536, v44
    v_add_u32 v37, 65536, v45
    ds_read_b64_tr_b16 v[48:49], v36 offset:16384
    ds_read_b64_tr_b16 v[50:51], v36 offset:16896
    ds_read_b64_tr_b16 v[52:53], v36 offset:24576
    ds_read_b64_tr_b16 v[54:55], v36 offset:25088
    ds_read_b64_tr_b16 v[56:57], v37 offset:16384
    ds_read_b64_tr_b16 v[58:59], v37 offset:16896
    ds_read_b64_tr_b16 v[60:61], v37 offset:24576
    ds_read_b64_tr_b16 v[62:63], v37 offset:25088
    s_waitcnt lgkmcnt(0)
    s_barrier
    v_add_u32 v36, 81920, v3
    ds_write_b128 v36, v[48:51] offset:0
    ds_write_b128 v36, v[52:55] offset:1024
    ds_write_b128 v36, v[56:59] offset:2048
    ds_write_b128 v36, v[60:63] offset:3072
    s_waitcnt vmcnt(8)
    s_barrier
    global_load_dword v42, v46, s[6:7] sc1
    global_load_dword v43, v47, s[6:7] sc1
    global_load_dword v41, v40, s[6:7] sc1
    v_add_u32 v36, 65536, v44
    v_add_u32 v37, 65536, v45
    ds_read_b64_tr_b16 v[48:49], v36 offset:32768
    ds_read_b64_tr_b16 v[50:51], v36 offset:33280
    ds_read_b64_tr_b16 v[52:53], v36 offset:40960
    ds_read_b64_tr_b16 v[54:55], v36 offset:41472
    ds_read_b64_tr_b16 v[56:57], v37 offset:32768
    ds_read_b64_tr_b16 v[58:59], v37 offset:33280
    ds_read_b64_tr_b16 v[60:61], v37 offset:40960
    ds_read_b64_tr_b16 v[62:63], v37 offset:41472
    s_waitcnt lgkmcnt(0)
    s_barrier
    v_add_u32 v36, 98304, v3
    ds_write_b128 v36, v[48:51] offset:0
    ds_write_b128 v36, v[52:55] offset:1024
    ds_write_b128 v36, v[56:59] offset:2048
    ds_write_b128 v36, v[60:63] offset:3072
    s_waitcnt vmcnt(4)
    s_barrier
    v_add_u32 v36, 65536, v44
    v_add_u32 v37, 65536, v45
    ds_read_b64_tr_b16 v[48:49], v36 offset:49152
    ds_read_b64_tr_b16 v[50:51], v36 offset:49664
    ds_read_b64_tr_b16 v[52:53], v36 offset:57344
    ds_read_b64_tr_b16 v[54:55], v36 offset:57856
    ds_read_b64_tr_b16 v[56:57], v37 offset:49152
    ds_read_b64_tr_b16 v[58:59], v37 offset:49664
    ds_read_b64_tr_b16 v[60:61], v37 offset:57344
    ds_read_b64_tr_b16 v[62:63], v37 offset:57856
    s_waitcnt lgkmcnt(0)
    s_barrier
    v_add_u32 v36, 114688, v3
    ds_write_b128 v36, v[48:51] offset:0
    ds_write_b128 v36, v[52:55] offset:1024
    ds_write_b128 v36, v[56:59] offset:2048
    ds_write_b128 v36, v[60:63] offset:3072
    s_waitcnt vmcnt(0)
    s_barrier
    v_add_u32 v36, 131072, v44
    v_add_u32 v37, 131072, v45
    ds_read_b64_tr_b16 v[48:49], v36 offset:0
    ds_read_b64_tr_b16 v[50:51], v36 offset:512
    ds_read_b64_tr_b16 v[52:53], v36 offset:8192
    ds_read_b64_tr_b16 v[54:55], v36 offset:8704
    ds_read_b64_tr_b16 v[56:57], v37 offset:0
    ds_read_b64_tr_b16 v[58:59], v37 offset:512
    ds_read_b64_tr_b16 v[60:61], v37 offset:8192
    ds_read_b64_tr_b16 v[62:63], v37 offset:8704
    s_waitcnt lgkmcnt(0)
    s_barrier
    v_add_u32 v36, 131072, v3
    ds_write_b128 v36, v[48:51] offset:0
    ds_write_b128 v36, v[52:55] offset:1024
    ds_write_b128 v36, v[56:59] offset:2048
    ds_write_b128 v36, v[60:63] offset:3072
    s_waitcnt lgkmcnt(0)
    s_cmp_lg_u32 s73, 3
    s_cbranch_scc1 L_dec1
    v_mov_b32 v32, 0
    v_mov_b32 v33, 44
    s_mov_b32 s81, 0
    s_mov_b32 s77, 0
    s_waitcnt vmcnt(0)
    v_readfirstlane_b32 s79, v41
    s_cmp_ge_u32 s79, 32
    s_cbranch_scc1 L_dec2
L_dec0:
    global_load_dword v34, v32, s[6:7] sc1
    global_load_dword v35, v33, s[6:7] sc1
    s_waitcnt vmcnt(0)
    v_readfirstlane_b32 s79, v34
    v_readfirstlane_b32 s80, v35
    s_cmp_ge_u32 s79, 32
    s_cbranch_scc1 L_dec2
    s_add_u32 s81, s81, 1
    s_cmp_gt_u32 s81, 1000000
    s_cbranch_scc1 L_team_failF
    s_cmp_lt_u32 s80, 256
    s_cbranch_scc1 L_dec0
    global_load_dword v34, v32, s[6:7] sc1
    s_waitcnt vmcnt(0)
    v_readfirstlane_b32 s79, v34
    s_cmp_ge_u32 s79, 32
    s_cbranch_scc1 L_dec2
    s_mov_b32 s77, 1
L_dec2:
    v_mov_b32 v32, 13312
    v_mov_b32 v33, s77
    ds_write_b32 v32, v33
    s_waitcnt lgkmcnt(0)
L_dec1:
    s_barrier
    v_mov_b32 v32, 13312
    ds_read_b32 v33, v32
    s_waitcnt lgkmcnt(0)
    v_readfirstlane_b32 s77, v33
    s_cmp_lg_u32 s77, 0
    s_cbranch_scc1 L_team_slow
    s_cmp_lg_u32 s73, 3
    s_cbranch_scc1 L_tb_doneF
    v_mov_b32 v32, 32
    v_mov_b32 v33, 64
    s_mov_b32 s81, 0
    s_waitcnt vmcnt(0)
    v_lshrrev_b32 v43, 1, v43
    v_min_u32 v34, v42, v43
    s_nop 0
    v_readfirstlane_b32 s79, v34
    s_cmp_ge_u32 s79, 32
    s_cbranch_scc1 L_tb_doneF
L_tb_pollF:
    global_load_dword v34, v32, s[6:7] sc1
    global_load_dword v35, v33, s[6:7] sc1
    s_waitcnt vmcnt(0)
    v_lshrrev_b32 v35, 1, v35
    v_min_u32 v34, v34, v35
    s_nop 0
    v_readfirstlane_b32 s79, v34
    s_add_u32 s81, s81, 1
    s_cmp_gt_u32 s81, 1000000
    s_cbranch_scc1 L_team_failF
    s_cmp_lt_u32 s79, 32
    s_cbranch_scc1 L_tb_pollF
L_tb_doneF:
    s_mov_b32 s74, 0
    s_add_u32 s18, s4, 0x5300000
    s_addc_u32 s19, s5, 0
    s_add_u32 s20, s4, 0x5302400
    s_addc_u32 s21, s5, 0
    s_add_u32 s22, s4, 0x5304800
    s_addc_u32 s23, s5, 0
    s_mov_b32 s82, 2
    v_mov_b64 v[24:25], 0
    v_mov_b64 v[26:27], 0
    v_mov_b64 v[28:29], 0
    v_mov_b64 v[30:31], 0
    v_mov_b64 v[32:33], 0
    v_mov_b64 v[34:35], 0
    v_mov_b64 v[36:37], 0
    v_mov_b64 v[38:39], 0
    v_mov_b64 v[40:41], 0
    v_mov_b64 v[42:43], 0
    v_mov_b64 v[44:45], 0
    v_mov_b64 v[46:47], 0
    s_barrier
L_stepF:
    s_cmp_lg_u32 s73, 1
    s_cbranch_scc1 L_nowarmF
    s_add_u32 s77, s74, 2
    s_cmp_gt_u32 s77, 63
    s_cbranch_scc1 L_nowarmF
    s_cmp_lg_u32 s77, 4
    s_cbranch_scc1 L_kvnF
    s_mov_b32 s77, 4294967292
    s_mov_b32 s76, 64
    s_branch L_kvgF
L_kvnF:
    s_mov_b32 s76, 32
    s_and_b32 s79, s77, 7
    s_cmp_lg_u32 s79, 0
    s_cbranch_scc1 L_nowarmF
    s_lshr_b32 s77, s77, 3
L_kvgF:
    s_lshl_b32 s80, s77, 2
    s_add_u32 s80, s80, 64
    v_mov_b32 v21, s80
    s_mov_b32 s81, 0
L_kvbF:
    global_load_dword v20, v21, s[6:7] sc1
    s_waitcnt vmcnt(0)
    v_readfirstlane_b32 s79, v20
    s_add_u32 s81, s81, 1
    s_cmp_gt_u32 s81, 1000000
    s_cbranch_scc1 L_team_failF
    s_cmp_lt_u32 s79, s76
    s_cbranch_scc1 L_kvbF
L_nowarmF:
    s_mov_b32 s81, 0
    ds_read_b128 v[48:51], v3 offset:0
    ds_read_b128 v[52:55], v3 offset:1024
    ds_read_b128 v[56:59], v3 offset:2048
    ds_read_b128 v[60:63], v3 offset:3072
    ds_read_b128 v[72:75], v3 offset:16384
    ds_read_b128 v[76:79], v3 offset:17408
    v_mov_b64 v[24:25], 0
    v_mov_b64 v[26:27], 0
    v_mov_b64 v[28:29], 0
    v_mov_b64 v[30:31], 0
    v_mov_b64 v[32:33], 0
    v_mov_b64 v[34:35], 0
    v_mov_b64 v[36:37], 0
    v_mov_b64 v[38:39], 0
    v_mov_b64 v[40:41], 0
    v_mov_b64 v[42:43], 0
    v_mov_b64 v[44:45], 0
    v_mov_b64 v[46:47], 0
    s_add_u32 s24, s18, 0x1000
    s_addc_u32 s25, s19, 0
    s_add_u32 s26, s18, 0x2000
    s_addc_u32 s27, s19, 0
    s_cmp_lg_u32 s73, 0
    s_cbranch_scc1 L_A_twoF
    global_load_dwordx4 v[12:15], v2, s[18:19] offset:0 sc1
    global_load_dwordx4 v[16:19], v2, s[24:25] offset:0 sc1
    global_load_dwordx4 v[20:23], v1, s[26:27] offset:0 sc1
L_A_chk3F:
    s_waitcnt vmcnt(2)
    ds_write_b128 v2, v[12:15] offset:0
    v_max3_u32 v65, v12, v13, v14
    v_max_u32 v65, v65, v15
    s_waitcnt vmcnt(1)
    ds_write_b128 v2, v[16:19] offset:4096
    v_max3_u32 v65, v65, v16, v17
    v_max3_u32 v65, v65, v18, v19
    s_waitcnt vmcnt(0)
    ds_write_b128 v1, v[20:23] offset:8192
    v_max3_u32 v65, v65, v20, v21
    v_max3_u32 v65, v65, v22, v23
    v_cmp_eq_u32 vcc, -1, v65
    s_cbranch_vccnz L_Ar3F
    s_branch L_A_okF
L_A_twoF:
    global_load_dwordx4 v[12:15], v2, s[18:19] offset:0 sc1
    global_load_dwordx4 v[16:19], v2, s[24:25] offset:0 sc1
L_A_chk2F:
    s_waitcnt vmcnt(1)
    ds_write_b128 v2, v[12:15] offset:0
    v_max3_u32 v65, v12, v13, v14
    v_max_u32 v65, v65, v15
    s_waitcnt vmcnt(0)
    ds_write_b128 v2, v[16:19] offset:4096
    v_max3_u32 v65, v65, v16, v17
    v_max3_u32 v65, v65, v18, v19
    v_cmp_eq_u32 vcc, -1, v65
    s_cbranch_vccnz L_Ar2F
L_A_okF:
    s_waitcnt lgkmcnt(0)
L_A_barF:
    s_barrier
    ds_read_b128 v[12:15], v1 offset:0
    ds_read_b128 v[16:19], v1 offset:1024
    global_load_dwordx4 v[64:67], v1, s[10:11]
    global_load_dwordx4 v[68:71], v1, s[10:11] offset:1024
    s_waitcnt lgkmcnt(1)
    v_smfmac_f32_16x16x64_bf16 v[24:27], v[12:15], a[0:7], v0
    v_smfmac_f32_16x16x64_bf16 v[32:35], v[12:15], a[144:151], v0
    v_smfmac_f32_16x16x64_bf16 v[40:43], v[12:15], v[48:55], v0
    ds_read_b128 v[48:51], v3 offset:18432
    v_smfmac_f32_16x16x64_bf16 v[28:31], v[12:15], a[72:79], v0
    ds_read_b128 v[52:55], v3 offset:19456
    v_smfmac_f32_16x16x64_bf16 v[36:39], v[12:15], a[216:223], v0
    ds_read_b128 v[20:23], v1 offset:2048
    v_smfmac_f32_16x16x64_bf16 v[44:47], v[12:15], v[56:63], v0
    s_waitcnt lgkmcnt(3)
    v_smfmac_f32_16x16x64_bf16 v[24:27], v[16:19], a[8:15], v0
    ds_read_b128 v[56:59], v3 offset:32768
    v_smfmac_f32_16x16x64_bf16 v[32:35], v[16:19], a[152:159], v0
    ds_read_b128 v[60:63], v3 offset:33792
    v_smfmac_f32_16x16x64_bf16 v[40:43], v[16:19], v[72:79], v0
    ds_read_b128 v[72:75], v3 offset:34816
    v_smfmac_f32_16x16x64_bf16 v[28:31], v[16:19], a[80:87], v0
    ds_read_b128 v[76:79], v3 offset:35840
    v_smfmac_f32_16x16x64_bf16 v[36:39], v[16:19], a[224:231], v0
    ds_read_b128 v[12:15], v1 offset:3072
    s_waitcnt lgkmcnt(6)
    v_smfmac_f32_16x16x64_bf16 v[44:47], v[16:19], v[48:55], v0
    s_waitcnt lgkmcnt(5)
    v_smfmac_f32_16x16x64_bf16 v[24:27], v[20:23], a[16:23], v0
    ds_read_b128 v[48:51], v3 offset:49152
    v_smfmac_f32_16x16x64_bf16 v[32:35], v[20:23], a[160:167], v0
    ds_read_b128 v[52:55], v3 offset:50176
    s_waitcnt lgkmcnt(5)
    v_smfmac_f32_16x16x64_bf16 v[40:43], v[20:23], v[56:63], v0
    ds_read_b128 v[56:59], v3 offset:51200
    v_smfmac_f32_16x16x64_bf16 v[28:31], v[20:23], a[88:95], v0
    ds_read_b128 v[60:63], v3 offset:52224
    v_smfmac_f32_16x16x64_bf16 v[36:39], v[20:23], a[232:239], v0
    ds_read_b128 v[16:19], v1 offset:4096
    s_waitcnt lgkmcnt(6)
    v_smfmac_f32_16x16x64_bf16 v[44:47], v[20:23], v[72:79], v0
    s_waitcnt lgkmcnt(5)
    v_smfmac_f32_16x16x64_bf16 v[24:27], v[12:15], a[24:31], v0
    v_add_u32 v3, 0x10000, v3
    ds_read_b128 v[72:75], v3 offset:0
    v_smfmac_f32_16x16x64_bf16 v[32:35], v[12:15], a[168:175], v0
    ds_read_b128 v[76:79], v3 offset:1024
    s_waitcnt lgkmcnt(5)
    v_smfmac_f32_16x16x64_bf16 v[40:43], v[12:15], v[48:55], v0
    ds_read_b128 v[48:51], v3 offset:2048
    v_smfmac_f32_16x16x64_bf16 v[28:31], v[12:15], a[96:103], v0
    ds_read_b128 v[52:55], v3 offset:3072
    v_smfmac_f32_16x16x64_bf16 v[36:39], v[12:15], a[240:247], v0
    ds_read_b128 v[20:23], v1 offset:5120
    s_waitcnt lgkmcnt(6)
    v_smfmac_f32_16x16x64_bf16 v[44:47], v[12:15], v[56:63], v0
    s_waitcnt lgkmcnt(5)
    v_smfmac_f32_16x16x64_bf16 v[24:27], v[16:19], a[32:39], v0
    ds_read_b128 v[56:59], v3 offset:16384
    v_smfmac_f32_16x16x64_bf16 v[32:35], v[16:19], a[176:183], v0
    ds_read_b128 v[60:63], v3 offset:17408
    s_waitcnt lgkmcnt(5)
    v_smfmac_f32_16x16x64_bf16 v[40:43], v[16:19], v[72:79], v0
    ds_read_b128 v[72:75], v3 offset:18432
    v_smfmac_f32_16x16x64_bf16 v[28:31], v[16:19], a[104:111], v0
    ds_read_b128 v[76:79], v3 offset:19456
    v_smfmac_f32_16x16x64_bf16 v[36:39], v[16:19], a[248:255], v0
    ds_read_b128 v[12:15], v1 offset:6144
    s_waitcnt lgkmcnt(6)
    v_smfmac_f32_16x16x64_bf16 v[44:47], v[16:19], v[48:55], v0
    s_waitcnt lgkmcnt(5)
    v_smfmac_f32_16x16x64_bf16 v[24:27], v[20:23], a[40:47], v0
    ds_read_b128 v[48:51], v3 offset:32768
    v_smfmac_f32_16x16x64_bf16 v[32:35], v[20:23], a[184:191], v0
    ds_read_b128 v[52:55], v3 offset:33792
    s_waitcnt lgkmcnt(5)
    v_smfmac_f32_16x16x64_bf16 v[40:43], v[20:23], v[56:63], v0
    ds_read_b128 v[56:59], v3 offset:34816
    v_smfmac_f32_16x16x64_bf16 v[28:31], v[20:23], a[112:119], v0
    ds_read_b128 v[60:63], v3 offset:35840
    v_smfmac_f32_16x16x64_bf16 v[36:39], v[20:23], v[224:231], v0
    ds_read_b128 v[16:19], v1 offset:7168
    s_waitcnt lgkmcnt(6)
    v_smfmac_f32_16x16x64_bf16 v[44:47], v[20:23], v[72:79], v0
    s_waitcnt lgkmcnt(5)
    v_smfmac_f32_16x16x64_bf16 v[24:27], v[12:15], a[48:55], v0
    ds_read_b128 v[72:75], v3 offset:49152
    v_smfmac_f32_16x16x64_bf16 v[32:35], v[12:15], a[192:199], v0
    ds_read_b128 v[76:79], v3 offset:50176
    s_waitcnt lgkmcnt(5)
    v_smfmac_f32_16x16x64_bf16 v[40:43], v[12:15], v[48:55], v0
    ds_read_b128 v[48:51], v3 offset:51200
    v_smfmac_f32_16x16x64_bf16 v[28:31], v[12:15], a[120:127], v0
    ds_read_b128 v[52:55], v3 offset:52224
    v_smfmac_f32_16x16x64_bf16 v[36:39], v[12:15], v[232:239], v0
    ds_read_b128 v[20:23], v1 offset:8192
    s_waitcnt lgkmcnt(6)
    v_smfmac_f32_16x16x64_bf16 v[44:47], v[12:15], v[56:63], v0
    s_waitcnt lgkmcnt(5)
    v_smfmac_f32_16x16x64_bf16 v[24:27], v[16:19], a[56:63], v0
    v_add_u32 v3, 0x10000, v3
    ds_read_b128 v[56:59], v3 offset:0
    v_smfmac_f32_16x16x64_bf16 v[32:35], v[16:19], a[200:207], v0
    ds_read_b128 v[60:63], v3 offset:1024
    s_waitcnt lgkmcnt(5)
    v_smfmac_f32_16x16x64_bf16 v[40:43], v[16:19], v[72:79], v0
    ds_read_b128 v[72:75], v3 offset:2048
    v_smfmac_f32_16x16x64_bf16 v[28:31], v[16:19], a[128:135], v0
    ds_read_b128 v[76:79], v3 offset:3072
    v_smfmac_f32_16x16x64_bf16 v[36:39], v[16:19], v[240:247], v0
    s_waitcnt lgkmcnt(5)
    v_smfmac_f32_16x16x64_bf16 v[44:47], v[16:19], v[48:55], v0
    global_load_dwordx4 v[48:51], v1, s[12:13]
    global_load_dwordx4 v[52:55], v1, s[12:13] offset:1024
    s_waitcnt lgkmcnt(4)
    v_smfmac_f32_16x16x64_bf16 v[24:27], v[20:23], a[64:71], v0
    v_smfmac_f32_16x16x64_bf16 v[28:31], v[20:23], a[136:143], v0
    v_smfmac_f32_16x16x64_bf16 v[32:35], v[20:23], a[208:215], v0
    v_smfmac_f32_16x16x64_bf16 v[36:39], v[20:23], v[248:255], v0
    v_bfe_u32 v12, v1, 4, 2
    v_add_u32 v12, 1, v12
    v_and_b32 v12, 2, v12
    s_waitcnt lgkmcnt(2)
    v_smfmac_f32_16x16x64_bf16 v[40:43], v[20:23], v[56:63], v0
    v_lshlrev_b32 v12, 2, v12
    v_xor_b32 v12, v12, v5
    v_pk_add_f32 v[24:25], v[24:25], v[26:27]
    s_waitcnt lgkmcnt(0)
    v_smfmac_f32_16x16x64_bf16 v[44:47], v[20:23], v[72:79], v0
    v_pk_add_f32 v[28:29], v[28:29], v[30:31]
    v_subrev_u32 v3, 0x20000, v3
    v_cvt_pk_bf16_f32 v26, v24, v25
    v_cvt_pk_bf16_f32 v27, v28, v29
    ds_write2_b32 v4, v26, v27 offset0:0 offset1:64
    v_pk_add_f32 v[32:33], v[32:33], v[34:35]
    v_pk_add_f32 v[36:37], v[36:37], v[38:39]
    ds_read_b64_tr_b16 v[24:25], v5
    ds_read_b64_tr_b16 v[26:27], v5 offset:64
    v_cvt_pk_bf16_f32 v34, v32, v33
    v_cvt_pk_bf16_f32 v35, v36, v37
    ds_write2_b32 v4, v34, v35 offset0:128 offset1:192
    ds_read_b64_tr_b16 v[32:33], v12 offset:512
    ds_read_b64_tr_b16 v[34:35], v12 offset:576
    v_mov_b64 v[56:57], 0
    v_mov_b64 v[58:59], 0
    v_mov_b64 v[60:61], 0
    v_mov_b64 v[62:63], 0
    v_mov_b64 v[72:73], 0
    v_mov_b64 v[74:75], 0
    s_waitcnt vmcnt(2)
    s_waitcnt lgkmcnt(3)
    v_mfma_f32_16x16x32_bf16 v[28:31], v[64:67], v[24:27], 0
    v_mfma_f32_16x16x32_bf16 v[36:39], v[68:71], v[24:27], 0
    v_and_b32 v12, 0x30, v1
    v_bfe_u32 v13, v1, 7, 1
    v_lshl_add_u32 v12, v13, 6, v12
    v_lshrrev_b32 v13, 8, v1
    v_lshl_add_u32 v12, v13, 7, v12
    s_waitcnt lgkmcnt(0)
    v_mfma_f32_16x16x32_bf16 v[20:23], v[32:35], v[24:27], 0
    s_cmp_lt_u32 s74, 54
    s_cbranch_scc1 L_nckF
    v_min_u32 v32, -2, v32
    v_min_u32 v33, -2, v33
    v_min_u32 v34, -2, v34
    v_min_u32 v35, -2, v35
L_nckF:
    s_mov_b64 exec, s[42:43]
    global_store_dwordx4 v12, v[32:35], s[14:15] sc1
    s_mov_b64 exec, -1
    v_cndmask_b32 v28, v36, v28, s[38:39]
    v_cndmask_b32 v29, v37, v29, s[38:39]
    v_cndmask_b32 v30, v38, v30, s[38:39]
    v_cndmask_b32 v31, v39, v31, s[38:39]
    ds_write_b128 v2, v[28:31] offset:9216
    s_lshl_b32 s79, s73, 2
    v_add_u32 v26, s79, v1
    v_xor_b32 v16, 1024, v2
    v_xor_b32 v17, 2048, v2
    v_xor_b32 v18, 3072, v2
    v_cndmask_b32 v24, v21, v20, s[38:39]
    v_cndmask_b32 v25, v23, v22, s[38:39]
    v_cndmask_b32 v24, v25, v24, s[40:41]
    ds_write_b32 v26, v24 offset:13312
    v_pk_add_f32 v[40:41], v[40:41], v[42:43]
    v_pk_add_f32 v[44:45], v[44:45], v[46:47]
    v_cvt_pk_bf16_f32 v40, v40, v41
    v_cvt_pk_bf16_f32 v44, v44, v45
    v_and_b32 v42, 0xf0, v1
    v_lshrrev_b32 v43, 8, v1
    v_lshl_add_u32 v42, v43, 2, v42
    v_min_u32 v40, -2, v40
    v_min_u32 v44, -2, v44
    global_store_dword v42, v40, s[16:17] sc1
    global_store_dword v42, v44, s[16:17] offset:256 sc1
    s_cmp_eq_u32 s74, 63
    s_cbranch_scc1 L_team_doneF
    v_mov_b32 v41, 0
    v_mov_b32 v45, 0
    v_mov_b64 v[46:47], 0
    v_mov_b64 v[76:77], 0
    v_mov_b64 v[78:79], 0
    v_mov_b64 v[64:65], 0
    v_mov_b64 v[66:67], 0
    s_waitcnt lgkmcnt(0)
    s_barrier
    ds_read_b128 v[24:27], v16 offset:9216
    ds_read_b128 v[32:35], v17 offset:9216
    ds_read_b128 v[36:39], v18 offset:9216
    ds_read_b128 v[12:15], v1 offset:13312
    v_mov_b64 v[16:17], 0
    v_mov_b64 v[18:19], 0
    v_mov_b64 v[20:21], 0
    v_mov_b64 v[22:23], 0
    v_mov_b64 v[42:43], 0
    s_waitcnt lgkmcnt(0)
    v_pk_add_f32 v[24:25], v[24:25], v[28:29]
    v_pk_add_f32 v[26:27], v[26:27], v[30:31]
    v_pk_add_f32 v[32:33], v[32:33], v[36:37]
    v_pk_add_f32 v[34:35], v[34:35], v[38:39]
    v_pk_add_f32 v[12:13], v[12:13], v[14:15]
    v_pk_add_f32 v[24:25], v[24:25], v[32:33]
    v_pk_add_f32 v[26:27], v[26:27], v[34:35]
    v_add_f32 v32, v12, v13
    v_max3_f32 v28, v24, v25, v26
    v_max3_f32 v28, v28, v27, v32
    s_nop 1
    v_max_f32_dpp v28, v28, v28 row_ror:8 row_mask:0xf bank_mask:0xf
    v_mov_b32 v29, v28
    s_nop 1
    v_permlane16_swap_b32 v28, v29
    v_max_f32 v28, v28, v29
    v_mov_b32 v29, v28
    s_nop 1
    v_permlane32_swap_b32 v28, v29
    v_max_f32 v28, v28, v29
    v_mul_f32 v28, s46, v28
    v_pk_fma_f32 v[24:25], v[24:25], s[46:47], v[28:29] op_sel_hi:[1,1,0] neg_lo:[0,0,1] neg_hi:[0,0,1]
    v_pk_fma_f32 v[26:27], v[26:27], s[46:47], v[28:29] op_sel_hi:[1,1,0] neg_lo:[0,0,1] neg_hi:[0,0,1]
    v_fma_f32 v32, v32, s46, -v28
    v_exp_f32 v24, v24
    v_exp_f32 v25, v25
    v_exp_f32 v26, v26
    v_exp_f32 v27, v27
    v_exp_f32 v32, v32
    v_cvt_pk_bf16_f32 v28, v24, v25
    v_cvt_pk_bf16_f32 v29, v26, v27
    v_mov_b32_dpp v33, v32 row_ror:8 row_mask:0xf bank_mask:0xf
    v_mov_b32_dpp v30, v28 row_ror:8 row_mask:0xf bank_mask:0xf
    v_mov_b32_dpp v31, v29 row_ror:8 row_mask:0xf bank_mask:0xf
    v_cvt_pk_bf16_f32 v16, v32, v33
    s_waitcnt vmcnt(3)
    v_mfma_f32_16x16x32_bf16 v[12:15], v[8:11], v[28:31], 0
    v_mfma_f32_16x16x32_bf16 v[24:27], v[48:51], v[28:31], 0
    v_mfma_f32_16x16x32_bf16 v[32:35], v[52:55], v[28:31], 0
    v_mfma_f32_16x16x32_bf16 v[12:15], v[8:11], v[16:19], v[12:15]
    v_mfma_f32_16x16x32_bf16 v[24:27], v[40:43], v[16:19], v[24:27]
    v_mfma_f32_16x16x32_bf16 v[32:35], v[44:47], v[16:19], v[32:35]
    s_cmp_lg_u32 s73, 1
    s_cbranch_scc1 L_noprogF
    v_mov_b32 v44, 0
    v_mov_b32 v45, s74
    s_mov_b64 exec, 1
    global_store_dword v44, v45, s[44:45] sc1
    s_mov_b64 exec, -1
L_noprogF:
    v_mov_b64 v[48:49], 0
    v_mov_b64 v[50:51], 0
    v_mov_b64 v[52:53], 0
    v_mov_b64 v[54:55], 0
    v_mov_b32 v16, 0
    v_xor_b32 v39, 32, v6
    v_xor_b32 v40, 128, v7
    v_rcp_f32 v38, v12
    s_nop 0
    v_pk_mul_f32 v[24:25], v[24:25], v[38:39] op_sel_hi:[1,0]
    v_pk_mul_f32 v[26:27], v[26:27], v[38:39] op_sel_hi:[1,0]
    v_pk_mul_f32 v[32:33], v[32:33], v[38:39] op_sel_hi:[1,0]
    v_pk_mul_f32 v[34:35], v[34:35], v[38:39] op_sel_hi:[1,0]
    v_cvt_pk_bf16_f32 v24, v24, v25
    v_cvt_pk_bf16_f32 v25, v26, v27
    v_cvt_pk_bf16_f32 v26, v32, v33
    v_cvt_pk_bf16_f32 v27, v34, v35
    s_mov_b64 exec, s[38:39]
    ds_write_b64 v6, v[24:25]
    ds_write_b64 v39, v[26:27]
    s_mov_b64 exec, -1
    v_and_b32 v13, 0xf0, v1
    v_lshrrev_b32 v12, 8, v1
    v_lshl_add_u32 v12, v12, 13, v13
    v_lshrrev_b32 v14, 8, v1
    v_lshl_add_u32 v13, v14, 2, v13
    v_mov_b32 v41, s75
    s_waitcnt lgkmcnt(0)
    s_barrier
    ds_read_b128 v[32:35], v7
    ds_read_b128 v[36:39], v40
    s_waitcnt lgkmcnt(0)
    v_smfmac_f32_16x16x64_bf16 v[64:67], v[32:35], v[208:215], v0
    v_smfmac_f32_16x16x64_bf16 v[48:51], v[32:35], v[80:87], v0
    v_smfmac_f32_16x16x64_bf16 v[64:67], v[36:39], v[216:223], v0
    v_smfmac_f32_16x16x64_bf16 v[48:51], v[36:39], v[88:95], v0
    v_smfmac_f32_16x16x64_bf16 v[52:55], v[32:35], v[96:103], v0
    v_smfmac_f32_16x16x64_bf16 v[56:59], v[32:35], v[112:119], v0
    s_nop 4
    v_pk_add_f32 v[64:65], v[64:65], v[66:67]
    v_cvt_pk_bf16_f32 v40, v64, v65
    v_smfmac_f32_16x16x64_bf16 v[52:55], v[36:39], v[104:111], v0
    v_and_or_b32 v40, v40, -2, v41
    global_store_dword v13, v40, s[32:33]
    v_smfmac_f32_16x16x64_bf16 v[56:59], v[36:39], v[120:127], v0
    v_pk_add_f32 v[48:49], v[48:49], v[50:51]
    v_cvt_pk_bf16_f32 v24, v48, v49
    v_smfmac_f32_16x16x64_bf16 v[60:63], v[32:35], v[128:135], v0
    v_smfmac_f32_16x16x64_bf16 v[72:75], v[32:35], v[144:151], v0
    s_nop 0
    v_pk_add_f32 v[52:53], v[52:53], v[54:55]
    v_cvt_pk_bf16_f32 v25, v52, v53
    v_smfmac_f32_16x16x64_bf16 v[60:63], v[36:39], v[136:143], v0
    v_pk_add_f32 v[56:57], v[56:57], v[58:59]
    v_cvt_pk_bf16_f32 v26, v56, v57
    v_smfmac_f32_16x16x64_bf16 v[72:75], v[36:39], v[152:159], v0
    v_smfmac_f32_16x16x64_bf16 v[76:79], v[32:35], v[160:167], v0
    v_smfmac_f32_16x16x64_bf16 v[16:19], v[32:35], v[176:183], v0
    s_nop 2
    v_pk_add_f32 v[60:61], v[60:61], v[62:63]
    v_cvt_pk_bf16_f32 v27, v60, v61
    v_smfmac_f32_16x16x64_bf16 v[76:79], v[36:39], v[168:175], v0
    v_and_or_b32 v24, v24, -2, v41
    global_store_dwordx4 v12, v[24:27], s[28:29]
    v_smfmac_f32_16x16x64_bf16 v[16:19], v[36:39], v[184:191], v0
    v_pk_add_f32 v[72:73], v[72:73], v[74:75]
    v_cvt_pk_bf16_f32 v28, v72, v73
    v_smfmac_f32_16x16x64_bf16 v[20:23], v[32:35], v[192:199], v0
    v_smfmac_f32_16x16x64_bf16 v[20:23], v[36:39], v[200:207], v0
    s_nop 0
    v_pk_add_f32 v[76:77], v[76:77], v[78:79]
    v_cvt_pk_bf16_f32 v29, v76, v77
    s_nop 0
    v_pk_add_f32 v[16:17], v[16:17], v[18:19]
    v_cvt_pk_bf16_f32 v30, v16, v17
    s_nop 1
    v_pk_add_f32 v[20:21], v[20:21], v[22:23]
    v_cvt_pk_bf16_f32 v31, v20, v21
    v_and_or_b32 v28, v28, -2, v41
    global_store_dwordx4 v12, v[28:31], s[30:31]
    s_cmp_eq_u32 s78, 0
    s_cbranch_scc1 L_noredF
    v_bfe_u32 v14, v1, 4, 4
    v_and_b32 v15, 1, v14
    v_cmp_eq_u32 vcc, 1, v15
    v_mov_b32 v12, 0x3f80
    v_mov_b32 v13, 0x3f800000
    v_cndmask_b32 v12, v12, v13, vcc
    v_lshrrev_b32 v13, 1, v14
    v_cmp_eq_u32 vcc, 0, v13
    s_nop 1
    v_cndmask_b32 v20, 0, v12, vcc
    v_cmp_eq_u32 vcc, 1, v13
    s_nop 1
    v_cndmask_b32 v21, 0, v12, vcc
    v_cmp_eq_u32 vcc, 2, v13
    s_nop 1
    v_cndmask_b32 v22, 0, v12, vcc
    v_cmp_eq_u32 vcc, 3, v13
    s_nop 1
    v_cndmask_b32 v23, 0, v12, vcc
    v_and_b32 v60, 1, v14
    v_add_u32 v60, s83, v60
    v_bfe_u32 v61, v14, 1, 2
    v_add_u32 v61, s84, v61
    v_and_b32 v62, 7, v14
    v_mov_b32 v63, s84
    s_cmp_eq_u32 s85, 1
    s_cselect_b64 vcc, -1, 0
    v_cndmask_b32 v60, v60, v62, vcc
    v_cndmask_b32 v61, v61, v63, vcc
    v_lshrrev_b32 v62, 1, v60
    v_and_b32 v60, 1, v60
    v_lshl_add_u32 v60, v62, 2, v60
    v_lshlrev_b32 v60, 4, v60
    v_lshrrev_b32 v62, 2, v61
    v_lshl_add_u32 v60, v62, 10, v60
    v_and_b32 v62, 3, v61
    v_lshl_add_u32 v60, v62, 8, v60
    v_bfe_u32 v62, v1, 9, 1
    v_lshl_add_u32 v60, v62, 5, v60
    v_bfe_u32 v62, v1, 8, 1
    v_lshl_add_u32 v62, v62, 3, v60
    v_mov_b32 v63, s75
    s_mov_b32 s81, 0
    s_waitcnt vmcnt(0)
    global_load_dwordx4 v[24:27], v1, s[34:35] offset:0 sc1
    global_load_dwordx4 v[28:31], v1, s[34:35] offset:1024 sc1
    global_load_dwordx4 v[32:35], v1, s[34:35] offset:2048 sc1
    global_load_dwordx4 v[36:39], v1, s[34:35] offset:3072 sc1
    global_load_dwordx4 v[40:43], v1, s[36:37] offset:0 sc1
    global_load_dwordx4 v[48:51], v1, s[36:37] offset:1024 sc1
    global_load_dwordx4 v[52:55], v1, s[36:37] offset:2048 sc1
    global_load_dwordx4 v[56:59], v1, s[36:37] offset:3072 sc1
L_H_chkF:
    v_mov_b32 v15, 0
    s_waitcnt vmcnt(7)
    v_bitop3_b32 v15, v15, v24, v63 bitop3:0xf6
    v_mfma_f32_16x16x32_bf16 v[16:19], v[24:27], v[20:23], 0
    s_waitcnt vmcnt(6)
    v_bitop3_b32 v15, v15, v28, v63 bitop3:0xf6
    v_mfma_f32_16x16x32_bf16 v[16:19], v[28:31], v[20:23], v[16:19]
    s_waitcnt vmcnt(5)
    v_bitop3_b32 v15, v15, v32, v63 bitop3:0xf6
    v_mfma_f32_16x16x32_bf16 v[16:19], v[32:35], v[20:23], v[16:19]
    s_waitcnt vmcnt(4)
    v_bitop3_b32 v15, v15, v36, v63 bitop3:0xf6
    v_mfma_f32_16x16x32_bf16 v[16:19], v[36:39], v[20:23], v[16:19]
    s_waitcnt vmcnt(3)
    v_bitop3_b32 v15, v15, v40, v63 bitop3:0xf6
    v_mfma_f32_16x16x32_bf16 v[16:19], v[40:43], v[20:23], v[16:19]
    s_waitcnt vmcnt(2)
    v_bitop3_b32 v15, v15, v48, v63 bitop3:0xf6
    v_mfma_f32_16x16x32_bf16 v[16:19], v[48:51], v[20:23], v[16:19]
    s_waitcnt vmcnt(1)
    v_bitop3_b32 v15, v15, v52, v63 bitop3:0xf6
    v_mfma_f32_16x16x32_bf16 v[16:19], v[52:55], v[20:23], v[16:19]
    s_waitcnt vmcnt(0)
    v_bitop3_b32 v15, v15, v56, v63 bitop3:0xf6
    v_mfma_f32_16x16x32_bf16 v[16:19], v[56:59], v[20:23], v[16:19]
    v_and_b32 v15, 1, v15
    v_cmp_ne_u32 vcc, 0, v15
    s_cbranch_vccnz L_HrF
    v_mov_b32 v14, -1
    v_mov_b32 v15, -1
    s_nop 2
    v_cvt_pk_bf16_f32 v12, v16, v17
    v_cvt_pk_bf16_f32 v13, v18, v19
    v_min_u32 v12, -2, v12
    v_min_u32 v13, -2, v13
    s_mov_b64 exec, s[38:39]
    global_store_dwordx2 v62, v[12:13], s[20:21]
    global_store_dwordx2 v62, v[14:15], s[22:23]
    s_mov_b64 exec, -1
L_noredF:
L_step_endF:
    s_add_u32 s14, s14, 0x10000
    s_addc_u32 s15, s15, 0
    s_add_u32 s16, s16, 0x10000
    s_addc_u32 s17, s17, 0
    s_mov_b64 s[18:19], s[20:21]
    s_mov_b64 s[20:21], s[22:23]
    s_add_u32 s82, s82, 1
    s_cmp_eq_u32 s82, 3
    s_cselect_b32 s82, 0, s82
    s_mul_i32 s79, s82, 9216
    s_add_u32 s22, s4, 0x5300000
    s_addc_u32 s23, s5, 0
    s_add_u32 s22, s22, s79
    s_addc_u32 s23, s23, 0
    s_add_u32 s10, s10, 0x40000
    s_addc_u32 s11, s11, 0
    s_add_u32 s12, s12, 0x40000
    s_addc_u32 s13, s13, 0
    s_add_u32 s74, s74, 1
    s_add_u32 s75, s74, 1
    s_and_b32 s75, s75, 1
    s_barrier
    s_branch L_stepF
L_HrF:
    global_load_dwordx4 v[24:27], v1, s[34:35] offset:0 sc1
    global_load_dwordx4 v[28:31], v1, s[34:35] offset:1024 sc1
    global_load_dwordx4 v[32:35], v1, s[34:35] offset:2048 sc1
    global_load_dwordx4 v[36:39], v1, s[34:35] offset:3072 sc1
    global_load_dwordx4 v[40:43], v1, s[36:37] offset:0 sc1
    global_load_dwordx4 v[48:51], v1, s[36:37] offset:1024 sc1
    global_load_dwordx4 v[52:55], v1, s[36:37] offset:2048 sc1
    global_load_dwordx4 v[56:59], v1, s[36:37] offset:3072 sc1
    s_add_u32 s81, s81, 1
    s_cmp_gt_u32 s81, 1000000
    s_cbranch_scc1 L_team_failF
    s_branch L_H_chkF
L_Ar3F:
    global_load_dwordx4 v[12:15], v2, s[18:19] offset:0 sc1
    global_load_dwordx4 v[16:19], v2, s[24:25] offset:0 sc1
    global_load_dwordx4 v[20:23], v1, s[26:27] offset:0 sc1
    s_add_u32 s81, s81, 1
    s_cmp_gt_u32 s81, 1000000
    s_cbranch_scc1 L_team_failF
    s_branch L_A_chk3F
L_Ar2F:
    global_load_dwordx4 v[12:15], v2, s[18:19] offset:0 sc1
    global_load_dwordx4 v[16:19], v2, s[24:25] offset:0 sc1
    s_add_u32 s81, s81, 1
    s_cmp_gt_u32 s81, 1000000
    s_cbranch_scc1 L_team_failF
    s_branch L_A_chk2F
L_team_failF:
    v_mov_b32 v32, 160
    v_mov_b32 v33, s74
    v_add_u32 v33, 0x1000, v33
    s_mov_b64 exec, 1
    global_store_dword v32, v33, s[6:7] sc1
    s_mov_b64 exec, -1
L_team_doneF:
    s_waitcnt vmcnt(0)
    s_barrier
    s_cmp_lg_u32 s73, 1
    s_cbranch_scc1 L_nofinF
    v_mov_b32 v12, 0
    v_mov_b32 v13, 64
    s_mov_b64 exec, 1
    global_store_dword v12, v13, s[44:45] sc1
    s_mov_b64 exec, -1
L_nofinF:
    s_waitcnt vmcnt(0)
    s_endpgm
L_team_slow:
    s_mul_i32 s79, s72, 9216
    s_lshl_b32 s80, s73, 10
    s_add_u32 s79, s79, s80
    v_lshlrev_b32 v32, 4, v16
    v_add_u32 v32, s79, v32
    v_mov_b32 v36, 0
    v_mov_b32 v37, 0
    v_mov_b32 v38, 0
    v_mov_b32 v39, 0
    v_mov_b32 v40, -1
    v_mov_b32 v41, -1
    v_mov_b32 v42, -1
    v_mov_b32 v43, -1
    s_add_u32 s50, s4, 0x5200000
    s_addc_u32 s51, s5, 0
    s_add_u32 s52, s4, 0x5300000
    s_addc_u32 s53, s5, 0
    global_store_dwordx4 v32, v[36:39], s[50:51] sc1
    v_add_u32 v33, 4096, v32
    global_store_dwordx4 v33, v[36:39], s[50:51] sc1
    s_cmp_lg_u32 s73, 0
    s_cbranch_scc1 L_clr_skipS
    v_add_u32 v33, 8192, v32
    global_store_dwordx4 v33, v[36:39], s[50:51] sc1
    s_cmp_gt_u32 s72, 26
    s_cbranch_scc1 L_clr_skipS
    s_cmp_gt_u32 s72, 8
    s_cbranch_scc1 L_clr_sentS
    v_lshlrev_b32 v34, 1, v19
    v_and_b32 v35, 1, v17
    v_add_u32 v34, v34, v35
    v_mul_u32_u24 v34, 1152, v34
    v_lshl_add_u32 v34, v18, 5, v34
    v_bfe_u32 v35, v17, 1, 1
    v_lshl_add_u32 v34, v35, 4, v34
    s_min_u32 s79, s72, 8
    s_lshl_b32 s79, s79, 7
    v_add_u32 v34, s79, v34
    global_load_dwordx4 v[48:51], v34, s[8:9]
    s_waitcnt vmcnt(0)
    v_min_u32 v40, -2, v48
    v_min_u32 v41, -2, v49
    v_min_u32 v42, -2, v50
    v_min_u32 v43, -2, v51
L_clr_sentS:
    s_lshl_b32 s79, s72, 10
    v_add_u32 v33, s79, v1
    global_store_dwordx4 v33, v[40:43], s[52:53] sc1
L_clr_skipS:
    s_waitcnt vmcnt(0)
    s_waitcnt vmcnt(0)
    s_barrier
    s_cmp_lg_u32 s73, 3
    s_cbranch_scc1 L_sb_done
    v_mov_b32 v32, 60
    v_mov_b32 v33, 1
    s_mov_b64 exec, 1
    global_atomic_add v32, v33, s[6:7] sc1
    s_mov_b64 exec, -1
    v_mov_b32 v33, 64
    s_mov_b32 s81, 0
L_sb_poll:
    global_load_dword v34, v32, s[6:7] sc1
    global_load_dword v35, v33, s[6:7] sc1
    s_waitcnt vmcnt(0)
    v_lshrrev_b32 v35, 1, v35
    v_min_u32 v34, v34, v35
    s_nop 0
    v_readfirstlane_b32 s79, v34
    s_add_u32 s81, s81, 1
    s_cmp_gt_u32 s81, 1000000
    s_cbranch_scc1 L_team_failS
    s_cmp_lt_u32 s79, 32
    s_cbranch_scc1 L_sb_poll
L_sb_done:
    s_mov_b32 s74, 0
    s_add_u32 s18, s4, 0x5300000
    s_addc_u32 s19, s5, 0
    s_add_u32 s20, s4, 0x5302400
    s_addc_u32 s21, s5, 0
    s_add_u32 s22, s4, 0x5304800
    s_addc_u32 s23, s5, 0
    s_mov_b32 s82, 2
    v_mov_b64 v[24:25], 0
    v_mov_b64 v[26:27], 0
    v_mov_b64 v[28:29], 0
    v_mov_b64 v[30:31], 0
    v_mov_b64 v[32:33], 0
    v_mov_b64 v[34:35], 0
    v_mov_b64 v[36:37], 0
    v_mov_b64 v[38:39], 0
    v_mov_b64 v[40:41], 0
    v_mov_b64 v[42:43], 0
    v_mov_b64 v[44:45], 0
    v_mov_b64 v[46:47], 0
    s_barrier
L_stepS:
    s_cmp_lg_u32 s73, 1
    s_cbranch_scc1 L_nowarmS
    s_add_u32 s77, s74, 2
    s_cmp_gt_u32 s77, 63
    s_cbranch_scc1 L_nowarmS
    s_cmp_lg_u32 s77, 4
    s_cbranch_scc1 L_kvnS
    s_mov_b32 s77, 4294967292
    s_mov_b32 s76, 64
    s_branch L_kvgS
L_kvnS:
    s_mov_b32 s76, 32
    s_and_b32 s79, s77, 7
    s_cmp_lg_u32 s79, 0
    s_cbranch_scc1 L_nowarmS
    s_lshr_b32 s77, s77, 3
L_kvgS:
    s_lshl_b32 s80, s77, 2
    s_add_u32 s80, s80, 64
    v_mov_b32 v21, s80
    s_mov_b32 s81, 0
L_kvbS:
    global_load_dword v20, v21, s[6:7] sc1
    s_waitcnt vmcnt(0)
    v_readfirstlane_b32 s79, v20
    s_add_u32 s81, s81, 1
    s_cmp_gt_u32 s81, 1000000
    s_cbranch_scc1 L_team_failS
    s_cmp_lt_u32 s79, s76
    s_cbranch_scc1 L_kvbS
L_nowarmS:
    s_mov_b32 s81, 0
    ds_read_b128 v[48:51], v3 offset:0
    ds_read_b128 v[52:55], v3 offset:1024
    ds_read_b128 v[56:59], v3 offset:2048
    ds_read_b128 v[60:63], v3 offset:3072
    ds_read_b128 v[72:75], v3 offset:16384
    ds_read_b128 v[76:79], v3 offset:17408
    v_mov_b64 v[24:25], 0
    v_mov_b64 v[26:27], 0
    v_mov_b64 v[28:29], 0
    v_mov_b64 v[30:31], 0
    v_mov_b64 v[32:33], 0
    v_mov_b64 v[34:35], 0
    v_mov_b64 v[36:37], 0
    v_mov_b64 v[38:39], 0
    v_mov_b64 v[40:41], 0
    v_mov_b64 v[42:43], 0
    v_mov_b64 v[44:45], 0
    v_mov_b64 v[46:47], 0
    s_add_u32 s24, s18, 0x1000
    s_addc_u32 s25, s19, 0
    s_add_u32 s26, s18, 0x2000
    s_addc_u32 s27, s19, 0
    s_cmp_lg_u32 s73, 0
    s_cbranch_scc1 L_A_twoS
    global_load_dwordx4 v[12:15], v2, s[18:19] offset:0 sc1
    global_load_dwordx4 v[16:19], v2, s[24:25] offset:0 sc1
    global_load_dwordx4 v[20:23], v1, s[26:27] offset:0 sc1
L_A_chk3S:
    s_waitcnt vmcnt(2)
    ds_write_b128 v2, v[12:15] offset:0
    v_max3_u32 v65, v12, v13, v14
    v_max_u32 v65, v65, v15
    s_waitcnt vmcnt(1)
    ds_write_b128 v2, v[16:19] offset:4096
    v_max3_u32 v65, v65, v16, v17
    v_max3_u32 v65, v65, v18, v19
    s_waitcnt vmcnt(0)
    ds_write_b128 v1, v[20:23] offset:8192
    v_max3_u32 v65, v65, v20, v21
    v_max3_u32 v65, v65, v22, v23
    v_cmp_eq_u32 vcc, -1, v65
    s_cbranch_vccnz L_Ar3S
    s_branch L_A_okS
L_A_twoS:
    global_load_dwordx4 v[12:15], v2, s[18:19] offset:0 sc1
    global_load_dwordx4 v[16:19], v2, s[24:25] offset:0 sc1
L_A_chk2S:
    s_waitcnt vmcnt(1)
    ds_write_b128 v2, v[12:15] offset:0
    v_max3_u32 v65, v12, v13, v14
    v_max_u32 v65, v65, v15
    s_waitcnt vmcnt(0)
    ds_write_b128 v2, v[16:19] offset:4096
    v_max3_u32 v65, v65, v16, v17
    v_max3_u32 v65, v65, v18, v19
    v_cmp_eq_u32 vcc, -1, v65
    s_cbranch_vccnz L_Ar2S
L_A_okS:
    s_waitcnt lgkmcnt(0)
L_A_barS:
    s_barrier
    ds_read_b128 v[12:15], v1 offset:0
    ds_read_b128 v[16:19], v1 offset:1024
    global_load_dwordx4 v[64:67], v1, s[10:11]
    global_load_dwordx4 v[68:71], v1, s[10:11] offset:1024
    s_waitcnt lgkmcnt(1)
    v_smfmac_f32_16x16x64_bf16 v[24:27], v[12:15], a[0:7], v0
    v_smfmac_f32_16x16x64_bf16 v[32:35], v[12:15], a[144:151], v0
    v_smfmac_f32_16x16x64_bf16 v[40:43], v[12:15], v[48:55], v0
    ds_read_b128 v[48:51], v3 offset:18432
    v_smfmac_f32_16x16x64_bf16 v[28:31], v[12:15], a[72:79], v0
    ds_read_b128 v[52:55], v3 offset:19456
    v_smfmac_f32_16x16x64_bf16 v[36:39], v[12:15], a[216:223], v0
    ds_read_b128 v[20:23], v1 offset:2048
    v_smfmac_f32_16x16x64_bf16 v[44:47], v[12:15], v[56:63], v0
    s_waitcnt lgkmcnt(3)
    v_smfmac_f32_16x16x64_bf16 v[24:27], v[16:19], a[8:15], v0
    ds_read_b128 v[56:59], v3 offset:32768
    v_smfmac_f32_16x16x64_bf16 v[32:35], v[16:19], a[152:159], v0
    ds_read_b128 v[60:63], v3 offset:33792
    v_smfmac_f32_16x16x64_bf16 v[40:43], v[16:19], v[72:79], v0
    ds_read_b128 v[72:75], v3 offset:34816
    v_smfmac_f32_16x16x64_bf16 v[28:31], v[16:19], a[80:87], v0
    ds_read_b128 v[76:79], v3 offset:35840
    v_smfmac_f32_16x16x64_bf16 v[36:39], v[16:19], a[224:231], v0
    ds_read_b128 v[12:15], v1 offset:3072
    s_waitcnt lgkmcnt(6)
    v_smfmac_f32_16x16x64_bf16 v[44:47], v[16:19], v[48:55], v0
    s_waitcnt lgkmcnt(5)
    v_smfmac_f32_16x16x64_bf16 v[24:27], v[20:23], a[16:23], v0
    ds_read_b128 v[48:51], v3 offset:49152
    v_smfmac_f32_16x16x64_bf16 v[32:35], v[20:23], a[160:167], v0
    ds_read_b128 v[52:55], v3 offset:50176
    s_waitcnt lgkmcnt(5)
    v_smfmac_f32_16x16x64_bf16 v[40:43], v[20:23], v[56:63], v0
    ds_read_b128 v[56:59], v3 offset:51200
    v_smfmac_f32_16x16x64_bf16 v[28:31], v[20:23], a[88:95], v0
    ds_read_b128 v[60:63], v3 offset:52224
    v_smfmac_f32_16x16x64_bf16 v[36:39], v[20:23], a[232:239], v0
    ds_read_b128 v[16:19], v1 offset:4096
    s_waitcnt lgkmcnt(6)
    v_smfmac_f32_16x16x64_bf16 v[44:47], v[20:23], v[72:79], v0
    s_waitcnt lgkmcnt(5)
    v_smfmac_f32_16x16x64_bf16 v[24:27], v[12:15], a[24:31], v0
    v_add_u32 v3, 0x10000, v3
    ds_read_b128 v[72:75], v3 offset:0
    v_smfmac_f32_16x16x64_bf16 v[32:35], v[12:15], a[168:175], v0
    ds_read_b128 v[76:79], v3 offset:1024
    s_waitcnt lgkmcnt(5)
    v_smfmac_f32_16x16x64_bf16 v[40:43], v[12:15], v[48:55], v0
    ds_read_b128 v[48:51], v3 offset:2048
    v_smfmac_f32_16x16x64_bf16 v[28:31], v[12:15], a[96:103], v0
    ds_read_b128 v[52:55], v3 offset:3072
    v_smfmac_f32_16x16x64_bf16 v[36:39], v[12:15], a[240:247], v0
    ds_read_b128 v[20:23], v1 offset:5120
    s_waitcnt lgkmcnt(6)
    v_smfmac_f32_16x16x64_bf16 v[44:47], v[12:15], v[56:63], v0
    s_waitcnt lgkmcnt(5)
    v_smfmac_f32_16x16x64_bf16 v[24:27], v[16:19], a[32:39], v0
    ds_read_b128 v[56:59], v3 offset:16384
    v_smfmac_f32_16x16x64_bf16 v[32:35], v[16:19], a[176:183], v0
    ds_read_b128 v[60:63], v3 offset:17408
    s_waitcnt lgkmcnt(5)
    v_smfmac_f32_16x16x64_bf16 v[40:43], v[16:19], v[72:79], v0
    ds_read_b128 v[72:75], v3 offset:18432
    v_smfmac_f32_16x16x64_bf16 v[28:31], v[16:19], a[104:111], v0
    ds_read_b128 v[76:79], v3 offset:19456
    v_smfmac_f32_16x16x64_bf16 v[36:39], v[16:19], a[248:255], v0
    ds_read_b128 v[12:15], v1 offset:6144
    s_waitcnt lgkmcnt(6)
    v_smfmac_f32_16x16x64_bf16 v[44:47], v[16:19], v[48:55], v0
    s_waitcnt lgkmcnt(5)
    v_smfmac_f32_16x16x64_bf16 v[24:27], v[20:23], a[40:47], v0
    ds_read_b128 v[48:51], v3 offset:32768
    v_smfmac_f32_16x16x64_bf16 v[32:35], v[20:23], a[184:191], v0
    ds_read_b128 v[52:55], v3 offset:33792
    s_waitcnt lgkmcnt(5)
    v_smfmac_f32_16x16x64_bf16 v[40:43], v[20:23], v[56:63], v0
    ds_read_b128 v[56:59], v3 offset:34816
    v_smfmac_f32_16x16x64_bf16 v[28:31], v[20:23], a[112:119], v0
    ds_read_b128 v[60:63], v3 offset:35840
    v_smfmac_f32_16x16x64_bf16 v[36:39], v[20:23], v[224:231], v0
    ds_read_b128 v[16:19], v1 offset:7168
    s_waitcnt lgkmcnt(6)
    v_smfmac_f32_16x16x64_bf16 v[44:47], v[20:23], v[72:79], v0
    s_waitcnt lgkmcnt(5)
    v_smfmac_f32_16x16x64_bf16 v[24:27], v[12:15], a[48:55], v0
    ds_read_b128 v[72:75], v3 offset:49152
    v_smfmac_f32_16x16x64_bf16 v[32:35], v[12:15], a[192:199], v0
    ds_read_b128 v[76:79], v3 offset:50176
    s_waitcnt lgkmcnt(5)
    v_smfmac_f32_16x16x64_bf16 v[40:43], v[12:15], v[48:55], v0
    ds_read_b128 v[48:51], v3 offset:51200
    v_smfmac_f32_16x16x64_bf16 v[28:31], v[12:15], a[120:127], v0
    ds_read_b128 v[52:55], v3 offset:52224
    v_smfmac_f32_16x16x64_bf16 v[36:39], v[12:15], v[232:239], v0
    ds_read_b128 v[20:23], v1 offset:8192
    s_waitcnt lgkmcnt(6)
    v_smfmac_f32_16x16x64_bf16 v[44:47], v[12:15], v[56:63], v0
    s_waitcnt lgkmcnt(5)
    v_smfmac_f32_16x16x64_bf16 v[24:27], v[16:19], a[56:63], v0
    v_add_u32 v3, 0x10000, v3
    ds_read_b128 v[56:59], v3 offset:0
    v_smfmac_f32_16x16x64_bf16 v[32:35], v[16:19], a[200:207], v0
    ds_read_b128 v[60:63], v3 offset:1024
    s_waitcnt lgkmcnt(5)
    v_smfmac_f32_16x16x64_bf16 v[40:43], v[16:19], v[72:79], v0
    ds_read_b128 v[72:75], v3 offset:2048
    v_smfmac_f32_16x16x64_bf16 v[28:31], v[16:19], a[128:135], v0
    ds_read_b128 v[76:79], v3 offset:3072
    v_smfmac_f32_16x16x64_bf16 v[36:39], v[16:19], v[240:247], v0
    s_waitcnt lgkmcnt(5)
    v_smfmac_f32_16x16x64_bf16 v[44:47], v[16:19], v[48:55], v0
    global_load_dwordx4 v[48:51], v1, s[12:13]
    global_load_dwordx4 v[52:55], v1, s[12:13] offset:1024
    s_waitcnt lgkmcnt(4)
    v_smfmac_f32_16x16x64_bf16 v[24:27], v[20:23], a[64:71], v0
    v_smfmac_f32_16x16x64_bf16 v[28:31], v[20:23], a[136:143], v0
    v_smfmac_f32_16x16x64_bf16 v[32:35], v[20:23], a[208:215], v0
    v_smfmac_f32_16x16x64_bf16 v[36:39], v[20:23], v[248:255], v0
    v_bfe_u32 v12, v1, 4, 2
    v_add_u32 v12, 1, v12
    v_and_b32 v12, 2, v12
    s_waitcnt lgkmcnt(2)
    v_smfmac_f32_16x16x64_bf16 v[40:43], v[20:23], v[56:63], v0
    v_lshlrev_b32 v12, 2, v12
    v_xor_b32 v12, v12, v5
    v_pk_add_f32 v[24:25], v[24:25], v[26:27]
    s_waitcnt lgkmcnt(0)
    v_smfmac_f32_16x16x64_bf16 v[44:47], v[20:23], v[72:79], v0
    v_pk_add_f32 v[28:29], v[28:29], v[30:31]
    v_subrev_u32 v3, 0x20000, v3
    v_cvt_pk_bf16_f32 v26, v24, v25
    v_cvt_pk_bf16_f32 v27, v28, v29
    ds_write2_b32 v4, v26, v27 offset0:0 offset1:64
    v_pk_add_f32 v[32:33], v[32:33], v[34:35]
    v_pk_add_f32 v[36:37], v[36:37], v[38:39]
    ds_read_b64_tr_b16 v[24:25], v5
    ds_read_b64_tr_b16 v[26:27], v5 offset:64
    v_cvt_pk_bf16_f32 v34, v32, v33
    v_cvt_pk_bf16_f32 v35, v36, v37
    ds_write2_b32 v4, v34, v35 offset0:128 offset1:192
    ds_read_b64_tr_b16 v[32:33], v12 offset:512
    ds_read_b64_tr_b16 v[34:35], v12 offset:576
    v_mov_b64 v[56:57], 0
    v_mov_b64 v[58:59], 0
    v_mov_b64 v[60:61], 0
    v_mov_b64 v[62:63], 0
    v_mov_b64 v[72:73], 0
    v_mov_b64 v[74:75], 0
    s_waitcnt vmcnt(2)
    s_waitcnt lgkmcnt(3)
    v_mfma_f32_16x16x32_bf16 v[28:31], v[64:67], v[24:27], 0
    v_mfma_f32_16x16x32_bf16 v[36:39], v[68:71], v[24:27], 0
    v_and_b32 v12, 0x30, v1
    v_bfe_u32 v13, v1, 7, 1
    v_lshl_add_u32 v12, v13, 6, v12
    v_lshrrev_b32 v13, 8, v1
    v_lshl_add_u32 v12, v13, 7, v12
    s_waitcnt lgkmcnt(0)
    v_mfma_f32_16x16x32_bf16 v[20:23], v[32:35], v[24:27], 0
    s_cmp_lt_u32 s74, 54
    s_cbranch_scc1 L_nckS
    v_min_u32 v32, -2, v32
    v_min_u32 v33, -2, v33
    v_min_u32 v34, -2, v34
    v_min_u32 v35, -2, v35
L_nckS:
    s_mov_b64 exec, s[42:43]
    global_store_dwordx4 v12, v[32:35], s[14:15] sc1
    s_mov_b64 exec, -1
    v_cndmask_b32 v28, v36, v28, s[38:39]
    v_cndmask_b32 v29, v37, v29, s[38:39]
    v_cndmask_b32 v30, v38, v30, s[38:39]
    v_cndmask_b32 v31, v39, v31, s[38:39]
    ds_write_b128 v2, v[28:31] offset:9216
    s_lshl_b32 s79, s73, 2
    v_add_u32 v26, s79, v1
    v_xor_b32 v16, 1024, v2
    v_xor_b32 v17, 2048, v2
    v_xor_b32 v18, 3072, v2
    v_cndmask_b32 v24, v21, v20, s[38:39]
    v_cndmask_b32 v25, v23, v22, s[38:39]
    v_cndmask_b32 v24, v25, v24, s[40:41]
    ds_write_b32 v26, v24 offset:13312
    v_pk_add_f32 v[40:41], v[40:41], v[42:43]
    v_pk_add_f32 v[44:45], v[44:45], v[46:47]
    v_cvt_pk_bf16_f32 v40, v40, v41
    v_cvt_pk_bf16_f32 v44, v44, v45
    v_and_b32 v42, 0xf0, v1
    v_lshrrev_b32 v43, 8, v1
    v_lshl_add_u32 v42, v43, 2, v42
    v_min_u32 v40, -2, v40
    v_min_u32 v44, -2, v44
    global_store_dword v42, v40, s[16:17] sc1
    global_store_dword v42, v44, s[16:17] offset:256 sc1
    s_cmp_eq_u32 s74, 63
    s_cbranch_scc1 L_team_doneS
    v_mov_b32 v41, 0
    v_mov_b32 v45, 0
    v_mov_b64 v[46:47], 0
    v_mov_b64 v[76:77], 0
    v_mov_b64 v[78:79], 0
    v_mov_b64 v[64:65], 0
    v_mov_b64 v[66:67], 0
    s_waitcnt lgkmcnt(0)
    s_barrier
    ds_read_b128 v[24:27], v16 offset:9216
    ds_read_b128 v[32:35], v17 offset:9216
    ds_read_b128 v[36:39], v18 offset:9216
    ds_read_b128 v[12:15], v1 offset:13312
    v_mov_b64 v[16:17], 0
    v_mov_b64 v[18:19], 0
    v_mov_b64 v[20:21], 0
    v_mov_b64 v[22:23], 0
    v_mov_b64 v[42:43], 0
    s_waitcnt lgkmcnt(0)
    v_pk_add_f32 v[24:25], v[24:25], v[28:29]
    v_pk_add_f32 v[26:27], v[26:27], v[30:31]
    v_pk_add_f32 v[32:33], v[32:33], v[36:37]
    v_pk_add_f32 v[34:35], v[34:35], v[38:39]
    v_pk_add_f32 v[12:13], v[12:13], v[14:15]
    v_pk_add_f32 v[24:25], v[24:25], v[32:33]
    v_pk_add_f32 v[26:27], v[26:27], v[34:35]
    v_add_f32 v32, v12, v13
    v_max3_f32 v28, v24, v25, v26
    v_max3_f32 v28, v28, v27, v32
    s_nop 1
    v_max_f32_dpp v28, v28, v28 row_ror:8 row_mask:0xf bank_mask:0xf
    v_mov_b32 v29, v28
    s_nop 1
    v_permlane16_swap_b32 v28, v29
    v_max_f32 v28, v28, v29
    v_mov_b32 v29, v28
    s_nop 1
    v_permlane32_swap_b32 v28, v29
    v_max_f32 v28, v28, v29
    v_mul_f32 v28, s46, v28
    v_pk_fma_f32 v[24:25], v[24:25], s[46:47], v[28:29] op_sel_hi:[1,1,0] neg_lo:[0,0,1] neg_hi:[0,0,1]
    v_pk_fma_f32 v[26:27], v[26:27], s[46:47], v[28:29] op_sel_hi:[1,1,0] neg_lo:[0,0,1] neg_hi:[0,0,1]
    v_fma_f32 v32, v32, s46, -v28
    v_exp_f32 v24, v24
    v_exp_f32 v25, v25
    v_exp_f32 v26, v26
    v_exp_f32 v27, v27
    v_exp_f32 v32, v32
    v_cvt_pk_bf16_f32 v28, v24, v25
    v_cvt_pk_bf16_f32 v29, v26, v27
    v_mov_b32_dpp v33, v32 row_ror:8 row_mask:0xf bank_mask:0xf
    v_mov_b32_dpp v30, v28 row_ror:8 row_mask:0xf bank_mask:0xf
    v_mov_b32_dpp v31, v29 row_ror:8 row_mask:0xf bank_mask:0xf
    v_cvt_pk_bf16_f32 v16, v32, v33
    s_waitcnt vmcnt(3)
    v_mfma_f32_16x16x32_bf16 v[12:15], v[8:11], v[28:31], 0
    v_mfma_f32_16x16x32_bf16 v[24:27], v[48:51], v[28:31], 0
    v_mfma_f32_16x16x32_bf16 v[32:35], v[52:55], v[28:31], 0
    v_mfma_f32_16x16x32_bf16 v[12:15], v[8:11], v[16:19], v[12:15]
    v_mfma_f32_16x16x32_bf16 v[24:27], v[40:43], v[16:19], v[24:27]
    v_mfma_f32_16x16x32_bf16 v[32:35], v[44:47], v[16:19], v[32:35]
    s_cmp_lg_u32 s73, 1
    s_cbranch_scc1 L_noprogS
    v_mov_b32 v44, 0
    v_mov_b32 v45, s74
    s_mov_b64 exec, 1
    global_store_dword v44, v45, s[44:45] sc1
    s_mov_b64 exec, -1
L_noprogS:
    v_mov_b64 v[48:49], 0
    v_mov_b64 v[50:51], 0
    v_mov_b64 v[52:53], 0
    v_mov_b64 v[54:55], 0
    v_mov_b32 v16, 0
    v_xor_b32 v39, 32, v6
    v_xor_b32 v40, 128, v7
    v_rcp_f32 v38, v12
    s_nop 0
    v_pk_mul_f32 v[24:25], v[24:25], v[38:39] op_sel_hi:[1,0]
    v_pk_mul_f32 v[26:27], v[26:27], v[38:39] op_sel_hi:[1,0]
    v_pk_mul_f32 v[32:33], v[32:33], v[38:39] op_sel_hi:[1,0]
    v_pk_mul_f32 v[34:35], v[34:35], v[38:39] op_sel_hi:[1,0]
    v_cvt_pk_bf16_f32 v24, v24, v25
    v_cvt_pk_bf16_f32 v25, v26, v27
    v_cvt_pk_bf16_f32 v26, v32, v33
    v_cvt_pk_bf16_f32 v27, v34, v35
    s_mov_b64 exec, s[38:39]
    ds_write_b64 v6, v[24:25]
    ds_write_b64 v39, v[26:27]
    s_mov_b64 exec, -1
    v_and_b32 v13, 0xf0, v1
    v_lshrrev_b32 v12, 8, v1
    v_lshl_add_u32 v12, v12, 13, v13
    v_lshrrev_b32 v14, 8, v1
    v_lshl_add_u32 v13, v14, 2, v13
    v_mov_b32 v41, s75
    s_waitcnt lgkmcnt(0)
    s_barrier
    ds_read_b128 v[32:35], v7
    ds_read_b128 v[36:39], v40
    s_waitcnt lgkmcnt(0)
    v_smfmac_f32_16x16x64_bf16 v[64:67], v[32:35], v[208:215], v0
    v_smfmac_f32_16x16x64_bf16 v[48:51], v[32:35], v[80:87], v0
    v_smfmac_f32_16x16x64_bf16 v[64:67], v[36:39], v[216:223], v0
    v_smfmac_f32_16x16x64_bf16 v[48:51], v[36:39], v[88:95], v0
    v_smfmac_f32_16x16x64_bf16 v[52:55], v[32:35], v[96:103], v0
    v_smfmac_f32_16x16x64_bf16 v[56:59], v[32:35], v[112:119], v0
    s_nop 4
    v_pk_add_f32 v[64:65], v[64:65], v[66:67]
    v_cvt_pk_bf16_f32 v40, v64, v65
    v_smfmac_f32_16x16x64_bf16 v[52:55], v[36:39], v[104:111], v0
    v_and_or_b32 v40, v40, -2, v41
    global_store_dword v13, v40, s[32:33] sc1
    v_smfmac_f32_16x16x64_bf16 v[56:59], v[36:39], v[120:127], v0
    v_pk_add_f32 v[48:49], v[48:49], v[50:51]
    v_cvt_pk_bf16_f32 v24, v48, v49
    v_smfmac_f32_16x16x64_bf16 v[60:63], v[32:35], v[128:135], v0
    v_smfmac_f32_16x16x64_bf16 v[72:75], v[32:35], v[144:151], v0
    s_nop 0
    v_pk_add_f32 v[52:53], v[52:53], v[54:55]
    v_cvt_pk_bf16_f32 v25, v52, v53
    v_smfmac_f32_16x16x64_bf16 v[60:63], v[36:39], v[136:143], v0
    v_pk_add_f32 v[56:57], v[56:57], v[58:59]
    v_cvt_pk_bf16_f32 v26, v56, v57
    v_smfmac_f32_16x16x64_bf16 v[72:75], v[36:39], v[152:159], v0
    v_smfmac_f32_16x16x64_bf16 v[76:79], v[32:35], v[160:167], v0
    v_smfmac_f32_16x16x64_bf16 v[16:19], v[32:35], v[176:183], v0
    s_nop 2
    v_pk_add_f32 v[60:61], v[60:61], v[62:63]
    v_cvt_pk_bf16_f32 v27, v60, v61
    v_smfmac_f32_16x16x64_bf16 v[76:79], v[36:39], v[168:175], v0
    v_and_or_b32 v24, v24, -2, v41
    global_store_dwordx4 v12, v[24:27], s[28:29] sc1
    v_smfmac_f32_16x16x64_bf16 v[16:19], v[36:39], v[184:191], v0
    v_pk_add_f32 v[72:73], v[72:73], v[74:75]
    v_cvt_pk_bf16_f32 v28, v72, v73
    v_smfmac_f32_16x16x64_bf16 v[20:23], v[32:35], v[192:199], v0
    v_smfmac_f32_16x16x64_bf16 v[20:23], v[36:39], v[200:207], v0
    s_nop 0
    v_pk_add_f32 v[76:77], v[76:77], v[78:79]
    v_cvt_pk_bf16_f32 v29, v76, v77
    s_nop 0
    v_pk_add_f32 v[16:17], v[16:17], v[18:19]
    v_cvt_pk_bf16_f32 v30, v16, v17
    s_nop 1
    v_pk_add_f32 v[20:21], v[20:21], v[22:23]
    v_cvt_pk_bf16_f32 v31, v20, v21
    v_and_or_b32 v28, v28, -2, v41
    global_store_dwordx4 v12, v[28:31], s[30:31] sc1
    s_cmp_eq_u32 s78, 0
    s_cbranch_scc1 L_noredS
    v_bfe_u32 v14, v1, 4, 4
    v_and_b32 v15, 1, v14
    v_cmp_eq_u32 vcc, 1, v15
    v_mov_b32 v12, 0x3f80
    v_mov_b32 v13, 0x3f800000
    v_cndmask_b32 v12, v12, v13, vcc
    v_lshrrev_b32 v13, 1, v14
    v_cmp_eq_u32 vcc, 0, v13
    s_nop 1
    v_cndmask_b32 v20, 0, v12, vcc
    v_cmp_eq_u32 vcc, 1, v13
    s_nop 1
    v_cndmask_b32 v21, 0, v12, vcc
    v_cmp_eq_u32 vcc, 2, v13
    s_nop 1
    v_cndmask_b32 v22, 0, v12, vcc
    v_cmp_eq_u32 vcc, 3, v13
    s_nop 1
    v_cndmask_b32 v23, 0, v12, vcc
    v_and_b32 v60, 1, v14
    v_add_u32 v60, s83, v60
    v_bfe_u32 v61, v14, 1, 2
    v_add_u32 v61, s84, v61
    v_and_b32 v62, 7, v14
    v_mov_b32 v63, s84
    s_cmp_eq_u32 s85, 1
    s_cselect_b64 vcc, -1, 0
    v_cndmask_b32 v60, v60, v62, vcc
    v_cndmask_b32 v61, v61, v63, vcc
    v_lshrrev_b32 v62, 1, v60
    v_and_b32 v60, 1, v60
    v_lshl_add_u32 v60, v62, 2, v60
    v_lshlrev_b32 v60, 4, v60
    v_lshrrev_b32 v62, 2, v61
    v_lshl_add_u32 v60, v62, 10, v60
    v_and_b32 v62, 3, v61
    v_lshl_add_u32 v60, v62, 8, v60
    v_bfe_u32 v62, v1, 9, 1
    v_lshl_add_u32 v60, v62, 5, v60
    v_bfe_u32 v62, v1, 8, 1
    v_lshl_add_u32 v62, v62, 3, v60
    v_mov_b32 v63, s75
    s_mov_b32 s81, 0
    s_waitcnt vmcnt(0)
    global_load_dwordx4 v[24:27], v1, s[34:35] offset:0 sc1
    global_load_dwordx4 v[28:31], v1, s[34:35] offset:1024 sc1
    global_load_dwordx4 v[32:35], v1, s[34:35] offset:2048 sc1
    global_load_dwordx4 v[36:39], v1, s[34:35] offset:3072 sc1
    global_load_dwordx4 v[40:43], v1, s[36:37] offset:0 sc1
    global_load_dwordx4 v[48:51], v1, s[36:37] offset:1024 sc1
    global_load_dwordx4 v[52:55], v1, s[36:37] offset:2048 sc1
    global_load_dwordx4 v[56:59], v1, s[36:37] offset:3072 sc1
L_H_chkS:
    v_mov_b32 v15, 0
    s_waitcnt vmcnt(7)
    v_bitop3_b32 v15, v15, v24, v63 bitop3:0xf6
    v_mfma_f32_16x16x32_bf16 v[16:19], v[24:27], v[20:23], 0
    s_waitcnt vmcnt(6)
    v_bitop3_b32 v15, v15, v28, v63 bitop3:0xf6
    v_mfma_f32_16x16x32_bf16 v[16:19], v[28:31], v[20:23], v[16:19]
    s_waitcnt vmcnt(5)
    v_bitop3_b32 v15, v15, v32, v63 bitop3:0xf6
    v_mfma_f32_16x16x32_bf16 v[16:19], v[32:35], v[20:23], v[16:19]
    s_waitcnt vmcnt(4)
    v_bitop3_b32 v15, v15, v36, v63 bitop3:0xf6
    v_mfma_f32_16x16x32_bf16 v[16:19], v[36:39], v[20:23], v[16:19]
    s_waitcnt vmcnt(3)
    v_bitop3_b32 v15, v15, v40, v63 bitop3:0xf6
    v_mfma_f32_16x16x32_bf16 v[16:19], v[40:43], v[20:23], v[16:19]
    s_waitcnt vmcnt(2)
    v_bitop3_b32 v15, v15, v48, v63 bitop3:0xf6
    v_mfma_f32_16x16x32_bf16 v[16:19], v[48:51], v[20:23], v[16:19]
    s_waitcnt vmcnt(1)
    v_bitop3_b32 v15, v15, v52, v63 bitop3:0xf6
    v_mfma_f32_16x16x32_bf16 v[16:19], v[52:55], v[20:23], v[16:19]
    s_waitcnt vmcnt(0)
    v_bitop3_b32 v15, v15, v56, v63 bitop3:0xf6
    v_mfma_f32_16x16x32_bf16 v[16:19], v[56:59], v[20:23], v[16:19]
    v_and_b32 v15, 1, v15
    v_cmp_ne_u32 vcc, 0, v15
    s_cbranch_vccnz L_HrS
    v_mov_b32 v14, -1
    v_mov_b32 v15, -1
    s_nop 2
    v_cvt_pk_bf16_f32 v12, v16, v17
    v_cvt_pk_bf16_f32 v13, v18, v19
    v_min_u32 v12, -2, v12
    v_min_u32 v13, -2, v13
    s_mov_b64 exec, s[38:39]
    global_store_dwordx2 v62, v[12:13], s[20:21] sc1
    global_store_dwordx2 v62, v[14:15], s[22:23] sc1
    s_mov_b64 exec, -1
L_noredS:
L_step_endS:
    s_add_u32 s14, s14, 0x10000
    s_addc_u32 s15, s15, 0
    s_add_u32 s16, s16, 0x10000
    s_addc_u32 s17, s17, 0
    s_mov_b64 s[18:19], s[20:21]
    s_mov_b64 s[20:21], s[22:23]
    s_add_u32 s82, s82, 1
    s_cmp_eq_u32 s82, 3
    s_cselect_b32 s82, 0, s82
    s_mul_i32 s79, s82, 9216
    s_add_u32 s22, s4, 0x5300000
    s_addc_u32 s23, s5, 0
    s_add_u32 s22, s22, s79
    s_addc_u32 s23, s23, 0
    s_add_u32 s10, s10, 0x40000
    s_addc_u32 s11, s11, 0
    s_add_u32 s12, s12, 0x40000
    s_addc_u32 s13, s13, 0
    s_add_u32 s74, s74, 1
    s_add_u32 s75, s74, 1
    s_and_b32 s75, s75, 1
    s_barrier
    s_branch L_stepS
L_HrS:
    global_load_dwordx4 v[24:27], v1, s[34:35] offset:0 sc1
    global_load_dwordx4 v[28:31], v1, s[34:35] offset:1024 sc1
    global_load_dwordx4 v[32:35], v1, s[34:35] offset:2048 sc1
    global_load_dwordx4 v[36:39], v1, s[34:35] offset:3072 sc1
    global_load_dwordx4 v[40:43], v1, s[36:37] offset:0 sc1
    global_load_dwordx4 v[48:51], v1, s[36:37] offset:1024 sc1
    global_load_dwordx4 v[52:55], v1, s[36:37] offset:2048 sc1
    global_load_dwordx4 v[56:59], v1, s[36:37] offset:3072 sc1
    s_add_u32 s81, s81, 1
    s_cmp_gt_u32 s81, 1000000
    s_cbranch_scc1 L_team_failS
    s_branch L_H_chkS
L_Ar3S:
    global_load_dwordx4 v[12:15], v2, s[18:19] offset:0 sc1
    global_load_dwordx4 v[16:19], v2, s[24:25] offset:0 sc1
    global_load_dwordx4 v[20:23], v1, s[26:27] offset:0 sc1
    s_add_u32 s81, s81, 1
    s_cmp_gt_u32 s81, 1000000
    s_cbranch_scc1 L_team_failS
    s_branch L_A_chk3S
L_Ar2S:
    global_load_dwordx4 v[12:15], v2, s[18:19] offset:0 sc1
    global_load_dwordx4 v[16:19], v2, s[24:25] offset:0 sc1
    s_add_u32 s81, s81, 1
    s_cmp_gt_u32 s81, 1000000
    s_cbranch_scc1 L_team_failS
    s_branch L_A_chk2S
L_team_failS:
    v_mov_b32 v32, 160
    v_mov_b32 v33, s74
    v_add_u32 v33, 0x1000, v33
    s_mov_b64 exec, 1
    global_store_dword v32, v33, s[6:7] sc1
    s_mov_b64 exec, -1
L_team_doneS:
    s_waitcnt vmcnt(0)
    s_barrier
    s_cmp_lg_u32 s73, 1
    s_cbranch_scc1 L_nofinS
    v_mov_b32 v12, 0
    v_mov_b32 v13, 64
    s_mov_b64 exec, 1
    global_store_dword v12, v13, s[44:45] sc1
    s_mov_b64 exec, -1
L_nofinS:
    s_waitcnt vmcnt(0)
    s_endpgm
L_worker_entry:
    s_load_dwordx2 s[4:5], s[0:1], 112
    s_load_dwordx2 s[6:7], s[0:1], 104
    s_load_dwordx2 s[8:9], s[0:1], 0
    v_lshrrev_b32 v10, 6, v0
    v_and_b32 v1, 63, v0
    v_readfirstlane_b32 s16, v10
    s_waitcnt lgkmcnt(0)
    s_and_b32 s75, s16, 1
    s_lshr_b32 s76, s16, 1
    v_lshrrev_b32 v10, 2, v1
    v_mul_u32_u24 v2, 1152, v10
    v_and_b32 v10, 3, v1
    v_bfe_u32 v11, v1, 4, 2
    v_xor_b32 v10, v10, v11
    v_lshl_add_u32 v2, v10, 4, v2
    v_and_b32 v10, 31, v1
    v_lshrrev_b32 v11, 5, v1
    v_bfe_u32 v12, v1, 2, 2
    v_xor_b32 v11, v11, v12
    v_lshlrev_b32 v4, 6, v10
    v_lshl_add_u32 v4, v11, 4, v4
    s_lshl_b32 s72, s76, 13
    v_add_u32 v4, s72, v4
    v_xor_b32 v5, 32, v4
    s_lshl_b32 s72, s76, 12
    v_subrev_u32 v16, s72, v4
    v_xor_b32 v17, 32, v16
    v_bfe_u32 v10, v1, 2, 2
    v_lshrrev_b32 v11, 5, v1
    v_lshl_add_u32 v11, v11, 3, v10
    v_lshlrev_b32 v11, 8, v11
    v_bfe_u32 v12, v1, 4, 1
    v_lshlrev_b32 v12, 1, v12
    v_bfe_u32 v13, v1, 1, 1
    v_add_u32 v12, v12, v13
    v_lshl_add_u32 v11, v12, 4, v11
    v_and_b32 v12, 1, v1
    v_lshl_add_u32 v11, v12, 3, v11
    v_add_u32 v11, 16384, v11
    s_lshl_b32 s72, s75, 1
    v_xor_b32 v12, s72, v10
    v_lshl_add_u32 v6, v12, 6, v11
    v_xor_b32 v12, 1, v12
    v_lshl_add_u32 v7, v12, 6, v11
    v_subrev_u32 v18, 8192, v6
    v_subrev_u32 v19, 8192, v7
    v_and_b32 v10, 31, v1
    v_lshrrev_b32 v11, 5, v1
    v_lshrrev_b32 v12, 3, v10
    v_lshlrev_b32 v12, 2, v12
    v_and_b32 v13, 3, v10
    v_add_u32 v12, v12, v13
    v_lshl_add_u32 v12, v11, 4, v12
    v_lshlrev_b32 v12, 4, v12
    v_bfe_u32 v13, v10, 2, 1
    v_lshl_add_u32 v8, v13, 10, v12
    v_and_b32 v12, 15, v10
    v_lshl_add_u32 v12, v11, 4, v12
    v_lshlrev_b32 v12, 4, v12
    v_lshrrev_b32 v13, 4, v10
    v_lshl_add_u32 v9, v13, 10, v12
    v_lshlrev_b32 v14, 4, v1
    s_mov_b32 s24, 0
    s_mov_b32 s27, 0
    s_cmp_eq_u32 s17, -1
    s_cbranch_scc1 L_wk_first
    s_branch L_wk_got
L_wk_next:
    s_cmp_lg_u32 s27, 0
    s_cbranch_scc1 L_wk_first
    s_mov_b32 s27, 1
    s_barrier
    s_cmp_lg_u32 s16, 0
    s_cbranch_scc1 L_wk_pc1
    v_mov_b32 v10, 0
    v_mov_b32 v13, 44
    s_mov_b32 s20, 0
L_wk_pc0:
    global_load_dword v11, v10, s[6:7] sc1
    global_load_dword v12, v13, s[6:7] sc1
    s_waitcnt vmcnt(0)
    v_readfirstlane_b32 s18, v11
    v_readfirstlane_b32 s19, v12
    s_mov_b32 s25, -1
    s_cmp_ge_u32 s18, 32
    s_cbranch_scc1 L_wk_pc2
    s_add_u32 s20, s20, 1
    s_cmp_gt_u32 s20, 600000
    s_cbranch_scc1 L_wk_pc2
    s_cmp_lt_u32 s19, 256
    s_cbranch_scc1 L_wk_pc0
    global_load_dword v11, v10, s[6:7] sc1
    s_waitcnt vmcnt(0)
    v_readfirstlane_b32 s18, v11
    s_cmp_ge_u32 s18, 32
    s_cbranch_scc1 L_wk_pc2
    v_mov_b32 v10, 252
    v_mov_b32 v11, 1
    s_mov_b64 exec, 1
    global_atomic_add v12, v10, v11, s[6:7] sc0 sc1
    s_waitcnt vmcnt(0)
    s_mov_b64 exec, -1
    v_readfirstlane_b32 s19, v12
    s_add_u32 s25, s18, s19
L_wk_pc2:
    v_mov_b32 v10, 163836
    v_mov_b32 v11, s25
    ds_write_b32 v10, v11
    s_waitcnt lgkmcnt(0)
L_wk_pc1:
    s_barrier
    v_mov_b32 v10, 163836
    ds_read_b32 v12, v10
    s_waitcnt lgkmcnt(0)
    v_readfirstlane_b32 s25, v12
    s_cmp_lt_u32 s25, 32
    s_cbranch_scc0 L_wk_first
    s_mov_b32 s72, s25
    v_lshl_add_u32 v0, s16, 6, v1
    s_barrier
    s_branch L_to_team
L_wk_first:
    s_cmp_ge_u32 s24, 7
    s_cbranch_scc1 L_wk_global
    s_add_u32 s21, s23, 56
    s_barrier
    s_cmp_lg_u32 s16, 0
    s_cbranch_scc1 L_wk_t0
    s_lshl_b32 s18, s21, 2
    v_mov_b32 v10, s18
    v_mov_b32 v11, 1
    s_mov_b64 exec, 1
    global_atomic_add v12, v10, v11, s[6:7] sc0 sc1
    s_waitcnt vmcnt(0)
    v_mov_b32 v10, 163836
    ds_write_b32 v10, v12
    s_waitcnt lgkmcnt(0)
    s_mov_b64 exec, -1
L_wk_t0:
    s_barrier
    v_mov_b32 v10, 163836
    ds_read_b32 v12, v10
    s_waitcnt lgkmcnt(0)
    v_readfirstlane_b32 s17, v12
L_wk_got:
    s_sub_u32 s25, 38, s23
    s_mul_i32 s25, s25, 9363
    s_lshr_b32 s25, s25, 16
    s_sub_u32 s26, 74, s23
    s_mul_i32 s26, s26, 9363
    s_lshr_b32 s26, s26, 16
    s_mov_b32 s19, s25
    s_mov_b32 s18, 0
    s_mul_i32 s20, s19, 9
    s_mov_b32 s21, 0
    s_cmp_lt_u32 s17, s20
    s_cbranch_scc1 L_wk_dv
    s_sub_u32 s17, s17, s20
    s_mov_b32 s19, 1
    s_mul_i32 s20, s19, 5
    s_mov_b32 s21, 0
    s_cmp_lt_u32 s17, s20
    s_cbranch_scc1 L_wk_global
    s_sub_u32 s17, s17, s20
    s_mov_b32 s19, s25
    s_mov_b32 s18, 0
    s_mul_i32 s20, s19, 2
    s_mov_b32 s21, 9
    s_cmp_lt_u32 s17, s20
    s_cbranch_scc1 L_wk_dv
    s_sub_u32 s17, s17, s20
    s_sub_u32 s19, 12, s26
    s_mov_b32 s18, s26
    s_mul_i32 s20, s19, 3
    s_mov_b32 s21, 0
    s_cmp_lt_u32 s17, s20
    s_cbranch_scc1 L_wk_dv
    s_sub_u32 s17, s17, s20
    s_sub_u32 s19, s26, s25
    s_mov_b32 s18, s25
    s_mul_i32 s20, s19, 8
    s_mov_b32 s21, 0
    s_cmp_lt_u32 s17, s20
    s_cbranch_scc1 L_wk_dv
    s_sub_u32 s17, s17, s20
    s_sub_u32 s19, 12, s26
    s_mov_b32 s18, s26
    s_mul_i32 s20, s19, 5
    s_mov_b32 s21, 3
    s_cmp_lt_u32 s17, s20
    s_cbranch_scc1 L_wk_dv
    s_sub_u32 s17, s17, s20
    s_cmp_lt_u32 s23, 6
    s_cselect_b32 s19, 1, 0
    s_mul_i32 s20, s19, 16
    s_mov_b32 s21, 0
    s_cmp_lt_u32 s17, s20
    s_cbranch_scc1 L_wk_did
    s_sub_u32 s17, s17, s20
    s_add_u32 s24, s24, 1
    s_add_u32 s23, s23, 1
    s_cmp_eq_u32 s23, 7
    s_cselect_b32 s23, 0, s23
    s_branch L_wk_first
L_wk_dv:
    s_cmp_lt_u32 s17, s19
    s_cbranch_scc1 L_wk_dv2
    s_sub_u32 s17, s17, s19
    s_add_u32 s21, s21, 1
    s_branch L_wk_dv
L_wk_dv2:
    s_add_u32 s18, s18, s17
    s_mul_i32 s18, s18, 7
    s_add_u32 s18, s18, s23
    s_cmp_ge_u32 s18, 68
    s_cbranch_scc1 L_wk_idq
    s_cmp_ge_u32 s18, 32
    s_cbranch_scc1 L_wk_idg
    s_cmp_lt_u32 s21, 4
    s_cbranch_scc1 L_wk_half
    s_sub_u32 s21, s21, 3
    s_lshl_b32 s17, s21, 5
    s_add_u32 s17, s17, s18
    s_branch L_wk_have
L_wk_idg:
    s_mul_i32 s17, s21, 36
    s_add_u32 s17, s17, s18
    s_add_u32 s17, s17, 224
    s_branch L_wk_have
L_wk_idq:
    s_lshl_b32 s17, s21, 4
    s_add_u32 s17, s17, s18
    s_add_u32 s17, s17, 476
    s_branch L_wk_have
L_wk_did:
    s_mul_i32 s17, s17, 6
    s_add_u32 s17, s17, s23
    s_add_u32 s17, s17, 672
    s_branch L_wk_have
L_wk_global:
    s_mov_b32 s21, 9
    s_barrier
    s_cmp_lg_u32 s16, 0
    s_cbranch_scc1 L_wk_t1
    s_lshl_b32 s18, s21, 2
    v_mov_b32 v10, s18
    v_mov_b32 v11, 1
    s_mov_b64 exec, 1
    global_atomic_add v12, v10, v11, s[6:7] sc0 sc1
    s_waitcnt vmcnt(0)
    v_mov_b32 v10, 163836
    ds_write_b32 v10, v12
    s_waitcnt lgkmcnt(0)
    s_mov_b64 exec, -1
L_wk_t1:
    s_barrier
    v_mov_b32 v10, 163836
    ds_read_b32 v12, v10
    s_waitcnt lgkmcnt(0)
    v_readfirstlane_b32 s17, v12
    s_add_u32 s17, s17, 768
L_wk_have:
    s_cmp_ge_u32 s17, 1472
    s_cbranch_scc1 L_wk_exit
    s_cmp_ge_u32 s17, 800
    s_cbranch_scc1 L_wk_att
    s_cmp_ge_u32 s17, 768
    s_cbranch_scc1 L_wk_gate
    s_cmp_ge_u32 s17, 672
    s_cbranch_scc1 L_wk_down
    s_cmp_ge_u32 s17, 544
    s_cbranch_scc1 L_wk_q
    s_cmp_ge_u32 s17, 256
    s_cbranch_scc1 L_wk_gu
    s_and_b32 s75, s16, 1
    s_lshr_b32 s76, s16, 1
    v_lshrrev_b32 v10, 2, v1
    v_mul_u32_u24 v2, 1152, v10
    v_and_b32 v10, 3, v1
    v_bfe_u32 v11, v1, 4, 2
    v_xor_b32 v10, v10, v11
    v_lshl_add_u32 v2, v10, 4, v2
    v_and_b32 v10, 31, v1
    v_lshrrev_b32 v11, 5, v1
    v_bfe_u32 v12, v1, 2, 2
    v_xor_b32 v11, v11, v12
    v_lshlrev_b32 v4, 6, v10
    v_lshl_add_u32 v4, v11, 4, v4
    s_lshl_b32 s72, s76, 13
    v_add_u32 v4, s72, v4
    v_xor_b32 v5, 32, v4
    s_lshl_b32 s72, s76, 12
    v_subrev_u32 v16, s72, v4
    v_xor_b32 v17, 32, v16
    v_bfe_u32 v10, v1, 2, 2
    v_lshrrev_b32 v11, 5, v1
    v_lshl_add_u32 v11, v11, 3, v10
    v_lshlrev_b32 v11, 8, v11
    v_bfe_u32 v12, v1, 4, 1
    v_lshlrev_b32 v12, 1, v12
    v_bfe_u32 v13, v1, 1, 1
    v_add_u32 v12, v12, v13
    v_lshl_add_u32 v11, v12, 4, v11
    v_and_b32 v12, 1, v1
    v_lshl_add_u32 v11, v12, 3, v11
    v_add_u32 v11, 16384, v11
    s_lshl_b32 s72, s75, 1
    v_xor_b32 v12, s72, v10
    v_lshl_add_u32 v6, v12, 6, v11
    v_xor_b32 v12, 1, v12
    v_lshl_add_u32 v7, v12, 6, v11
    v_subrev_u32 v18, 8192, v6
    v_subrev_u32 v19, 8192, v7
    v_and_b32 v10, 31, v1
    v_lshrrev_b32 v11, 5, v1
    v_lshrrev_b32 v12, 3, v10
    v_lshlrev_b32 v12, 2, v12
    v_and_b32 v13, 3, v10
    v_add_u32 v12, v12, v13
    v_lshl_add_u32 v12, v11, 4, v12
    v_lshlrev_b32 v12, 4, v12
    v_bfe_u32 v13, v10, 2, 1
    v_lshl_add_u32 v8, v13, 10, v12
    v_and_b32 v12, 15, v10
    v_lshl_add_u32 v12, v11, 4, v12
    v_lshlrev_b32 v12, 4, v12
    v_lshrrev_b32 v13, 4, v10
    v_lshl_add_u32 v9, v13, 10, v12
    v_lshlrev_b32 v14, 4, v1
    s_lshr_b32 s21, s17, 5
    s_and_b32 s18, s17, 31
    s_cmp_ge_u32 s18, 16
    s_cbranch_scc1 L_wk_v
    s_load_dwordx2 s[10:11], s[0:1], 24
    s_waitcnt lgkmcnt(0)
    s_mov_b32 s48, s8
    s_mov_b32 s49, s9
    s_mov_b32 s50, 2359296
    s_mov_b32 s51, 0x00020000
    s_mov_b32 s52, s10
    s_mov_b32 s53, s11
    s_mov_b32 s54, 4718592
    s_mov_b32 s55, 0x00020000
    s_mov_b32 s56, s10
    s_mov_b32 s57, s11
    s_mov_b32 s58, 4718592
    s_mov_b32 s59, 0x00020000
    s_mov_b32 s65, 8192
    v_lshrrev_b32 v10, 4, v1
    v_mul_lo_u32 v3, v10, s65
    v_lshlrev_b32 v10, 2, v10
    v_and_b32 v11, 15, v1
    v_xor_b32 v10, v10, v11
    v_lshl_add_u32 v3, v10, 4, v3
    s_mul_i32 s68, s21, 294912
    s_lshl_b32 s66, s18, 9
    s_add_u32 s67, s66, 256
    s_lshl_b32 s72, s21, 21
    s_lshl_b32 s73, s18, 14
    s_add_u32 s72, s72, s73
    s_add_u32 s60, s4, 0x0
    s_addc_u32 s61, s5, 0
    s_add_u32 s60, s60, s72
    s_addc_u32 s61, s61, 0
    s_mov_b32 s70, 0
    s_mov_b32 s71, 0
    s_mul_i32 s72, s16, 73728
    s_add_u32 s68, s68, s72
    s_lshl_b32 s80, s65, 2
    s_mul_i32 s72, s16, s80
    s_lshl_b32 s72, s72, 1
    s_add_u32 s66, s66, s72
    s_add_u32 s67, s67, s72
    s_mul_i32 s78, s16, 4096
    s_lshl_b32 s81, s16, 11
    s_add_u32 s81, s81, 16384
    s_lshl_b32 s82, s65, 5
    s_add_u32 s77, s70, s78
    s_add_u32 s79, s70, s81
    s_mov_b32 m0, s77
    s_nop 0
    buffer_load_dwordx4 v2, s[48:51], s68 offen lds
    s_add_u32 m0, s77, 1024
    s_add_u32 s73, s68, 18432
    buffer_load_dwordx4 v2, s[48:51], s73 offen lds
    s_add_u32 m0, s77, 2048
    s_add_u32 s73, s68, 36864
    buffer_load_dwordx4 v2, s[48:51], s73 offen lds
    s_add_u32 m0, s77, 3072
    s_add_u32 s73, s68, 55296
    buffer_load_dwordx4 v2, s[48:51], s73 offen lds
    s_add_u32 m0, s79, 0
    s_nop 0
    buffer_load_dwordx4 v3, s[52:55], s66 offen lds
    s_add_u32 m0, s79, 1024
    s_add_u32 s73, s66, s80
    buffer_load_dwordx4 v3, s[52:55], s73 offen lds
    s_add_u32 m0, s79, 8192
    s_nop 0
    buffer_load_dwordx4 v3, s[56:59], s67 offen lds
    s_add_u32 m0, s79, 9216
    s_add_u32 s73, s67, s80
    buffer_load_dwordx4 v3, s[56:59], s73 offen lds
    s_add_u32 s68, s68, 64
    s_add_u32 s66, s66, s82
    s_add_u32 s67, s67, s82
    s_add_u32 s70, s70, 32768
    s_cmp_eq_u32 s70, 131072
    s_cselect_b32 s70, 0, s70
    s_add_u32 s77, s70, s78
    s_add_u32 s79, s70, s81
    s_mov_b32 m0, s77
    s_nop 0
    buffer_load_dwordx4 v2, s[48:51], s68 offen lds
    s_add_u32 m0, s77, 1024
    s_add_u32 s73, s68, 18432
    buffer_load_dwordx4 v2, s[48:51], s73 offen lds
    s_add_u32 m0, s77, 2048
    s_add_u32 s73, s68, 36864
    buffer_load_dwordx4 v2, s[48:51], s73 offen lds
    s_add_u32 m0, s77, 3072
    s_add_u32 s73, s68, 55296
    buffer_load_dwordx4 v2, s[48:51], s73 offen lds
    s_add_u32 m0, s79, 0
    s_nop 0
    buffer_load_dwordx4 v3, s[52:55], s66 offen lds
    s_add_u32 m0, s79, 1024
    s_add_u32 s73, s66, s80
    buffer_load_dwordx4 v3, s[52:55], s73 offen lds
    s_add_u32 m0, s79, 8192
    s_nop 0
    buffer_load_dwordx4 v3, s[56:59], s67 offen lds
    s_add_u32 m0, s79, 9216
    s_add_u32 s73, s67, s80
    buffer_load_dwordx4 v3, s[56:59], s73 offen lds
    s_add_u32 s68, s68, 64
    s_add_u32 s66, s66, s82
    s_add_u32 s67, s67, s82
    s_add_u32 s70, s70, 32768
    s_cmp_eq_u32 s70, 131072
    s_cselect_b32 s70, 0, s70
    s_add_u32 s77, s70, s78
    s_add_u32 s79, s70, s81
    s_mov_b32 m0, s77
    s_nop 0
    buffer_load_dwordx4 v2, s[48:51], s68 offen lds
    s_add_u32 m0, s77, 1024
    s_add_u32 s73, s68, 18432
    buffer_load_dwordx4 v2, s[48:51], s73 offen lds
    s_add_u32 m0, s77, 2048
    s_add_u32 s73, s68, 36864
    buffer_load_dwordx4 v2, s[48:51], s73 offen lds
    s_add_u32 m0, s77, 3072
    s_add_u32 s73, s68, 55296
    buffer_load_dwordx4 v2, s[48:51], s73 offen lds
    s_add_u32 m0, s79, 0
    s_nop 0
    buffer_load_dwordx4 v3, s[52:55], s66 offen lds
    s_add_u32 m0, s79, 1024
    s_add_u32 s73, s66, s80
    buffer_load_dwordx4 v3, s[52:55], s73 offen lds
    s_add_u32 m0, s79, 8192
    s_nop 0
    buffer_load_dwordx4 v3, s[56:59], s67 offen lds
    s_add_u32 m0, s79, 9216
    s_add_u32 s73, s67, s80
    buffer_load_dwordx4 v3, s[56:59], s73 offen lds
    s_add_u32 s68, s68, 64
    s_add_u32 s66, s66, s82
    s_add_u32 s67, s67, s82
    s_add_u32 s70, s70, 32768
    s_cmp_eq_u32 s70, 131072
    s_cselect_b32 s70, 0, s70
    s_add_u32 s77, s70, s78
    s_add_u32 s79, s70, s81
    s_mov_b32 m0, s77
    s_nop 0
    buffer_load_dwordx4 v2, s[48:51], s68 offen lds
    s_add_u32 m0, s77, 1024
    s_add_u32 s73, s68, 18432
    buffer_load_dwordx4 v2, s[48:51], s73 offen lds
    s_add_u32 m0, s77, 2048
    s_add_u32 s73, s68, 36864
    buffer_load_dwordx4 v2, s[48:51], s73 offen lds
    s_add_u32 m0, s77, 3072
    s_add_u32 s73, s68, 55296
    buffer_load_dwordx4 v2, s[48:51], s73 offen lds
    s_add_u32 m0, s79, 0
    s_nop 0
    buffer_load_dwordx4 v3, s[52:55], s66 offen lds
    s_add_u32 m0, s79, 1024
    s_add_u32 s73, s66, s80
    buffer_load_dwordx4 v3, s[52:55], s73 offen lds
    s_add_u32 m0, s79, 8192
    s_nop 0
    buffer_load_dwordx4 v3, s[56:59], s67 offen lds
    s_add_u32 m0, s79, 9216
    s_add_u32 s73, s67, s80
    buffer_load_dwordx4 v3, s[56:59], s73 offen lds
    s_add_u32 s68, s68, 64
    s_add_u32 s66, s66, s82
    s_add_u32 s67, s67, s82
    s_add_u32 s70, s70, 32768
    s_cmp_eq_u32 s70, 131072
    s_cselect_b32 s70, 0, s70
    v_accvgpr_write_b32 a0, 0
    v_accvgpr_write_b32 a1, 0
    v_accvgpr_write_b32 a2, 0
    v_accvgpr_write_b32 a3, 0
    v_accvgpr_write_b32 a4, 0
    v_accvgpr_write_b32 a5, 0
    v_accvgpr_write_b32 a6, 0
    v_accvgpr_write_b32 a7, 0
    v_accvgpr_write_b32 a8, 0
    v_accvgpr_write_b32 a9, 0
    v_accvgpr_write_b32 a10, 0
    v_accvgpr_write_b32 a11, 0
    v_accvgpr_write_b32 a12, 0
    v_accvgpr_write_b32 a13, 0
    v_accvgpr_write_b32 a14, 0
    v_accvgpr_write_b32 a15, 0
    v_accvgpr_write_b32 a16, 0
    v_accvgpr_write_b32 a17, 0
    v_accvgpr_write_b32 a18, 0
    v_accvgpr_write_b32 a19, 0
    v_accvgpr_write_b32 a20, 0
    v_accvgpr_write_b32 a21, 0
    v_accvgpr_write_b32 a22, 0
    v_accvgpr_write_b32 a23, 0
    v_accvgpr_write_b32 a24, 0
    v_accvgpr_write_b32 a25, 0
    v_accvgpr_write_b32 a26, 0
    v_accvgpr_write_b32 a27, 0
    v_accvgpr_write_b32 a28, 0
    v_accvgpr_write_b32 a29, 0
    v_accvgpr_write_b32 a30, 0
    v_accvgpr_write_b32 a31, 0
    v_accvgpr_write_b32 a32, 0
    v_accvgpr_write_b32 a33, 0
    v_accvgpr_write_b32 a34, 0
    v_accvgpr_write_b32 a35, 0
    v_accvgpr_write_b32 a36, 0
    v_accvgpr_write_b32 a37, 0
    v_accvgpr_write_b32 a38, 0
    v_accvgpr_write_b32 a39, 0
    v_accvgpr_write_b32 a40, 0
    v_accvgpr_write_b32 a41, 0
    v_accvgpr_write_b32 a42, 0
    v_accvgpr_write_b32 a43, 0
    v_accvgpr_write_b32 a44, 0
    v_accvgpr_write_b32 a45, 0
    v_accvgpr_write_b32 a46, 0
    v_accvgpr_write_b32 a47, 0
    v_accvgpr_write_b32 a48, 0
    v_accvgpr_write_b32 a49, 0
    v_accvgpr_write_b32 a50, 0
    v_accvgpr_write_b32 a51, 0
    v_accvgpr_write_b32 a52, 0
    v_accvgpr_write_b32 a53, 0
    v_accvgpr_write_b32 a54, 0
    v_accvgpr_write_b32 a55, 0
    v_accvgpr_write_b32 a56, 0
    v_accvgpr_write_b32 a57, 0
    v_accvgpr_write_b32 a58, 0
    v_accvgpr_write_b32 a59, 0
    v_accvgpr_write_b32 a60, 0
    v_accvgpr_write_b32 a61, 0
    v_accvgpr_write_b32 a62, 0
    v_accvgpr_write_b32 a63, 0
    v_accvgpr_write_b32 a64, 0
    v_accvgpr_write_b32 a65, 0
    v_accvgpr_write_b32 a66, 0
    v_accvgpr_write_b32 a67, 0
    v_accvgpr_write_b32 a68, 0
    v_accvgpr_write_b32 a69, 0
    v_accvgpr_write_b32 a70, 0
    v_accvgpr_write_b32 a71, 0
    v_accvgpr_write_b32 a72, 0
    v_accvgpr_write_b32 a73, 0
    v_accvgpr_write_b32 a74, 0
    v_accvgpr_write_b32 a75, 0
    v_accvgpr_write_b32 a76, 0
    v_accvgpr_write_b32 a77, 0
    v_accvgpr_write_b32 a78, 0
    v_accvgpr_write_b32 a79, 0
    v_accvgpr_write_b32 a80, 0
    v_accvgpr_write_b32 a81, 0
    v_accvgpr_write_b32 a82, 0
    v_accvgpr_write_b32 a83, 0
    v_accvgpr_write_b32 a84, 0
    v_accvgpr_write_b32 a85, 0
    v_accvgpr_write_b32 a86, 0
    v_accvgpr_write_b32 a87, 0
    v_accvgpr_write_b32 a88, 0
    v_accvgpr_write_b32 a89, 0
    v_accvgpr_write_b32 a90, 0
    v_accvgpr_write_b32 a91, 0
    v_accvgpr_write_b32 a92, 0
    v_accvgpr_write_b32 a93, 0
    v_accvgpr_write_b32 a94, 0
    v_accvgpr_write_b32 a95, 0
    v_accvgpr_write_b32 a96, 0
    v_accvgpr_write_b32 a97, 0
    v_accvgpr_write_b32 a98, 0
    v_accvgpr_write_b32 a99, 0
    v_accvgpr_write_b32 a100, 0
    v_accvgpr_write_b32 a101, 0
    v_accvgpr_write_b32 a102, 0
    v_accvgpr_write_b32 a103, 0
    v_accvgpr_write_b32 a104, 0
    v_accvgpr_write_b32 a105, 0
    v_accvgpr_write_b32 a106, 0
    v_accvgpr_write_b32 a107, 0
    v_accvgpr_write_b32 a108, 0
    v_accvgpr_write_b32 a109, 0
    v_accvgpr_write_b32 a110, 0
    v_accvgpr_write_b32 a111, 0
    v_accvgpr_write_b32 a112, 0
    v_accvgpr_write_b32 a113, 0
    v_accvgpr_write_b32 a114, 0
    v_accvgpr_write_b32 a115, 0
    v_accvgpr_write_b32 a116, 0
    v_accvgpr_write_b32 a117, 0
    v_accvgpr_write_b32 a118, 0
    v_accvgpr_write_b32 a119, 0
    v_accvgpr_write_b32 a120, 0
    v_accvgpr_write_b32 a121, 0
    v_accvgpr_write_b32 a122, 0
    v_accvgpr_write_b32 a123, 0
    v_accvgpr_write_b32 a124, 0
    v_accvgpr_write_b32 a125, 0
    v_accvgpr_write_b32 a126, 0
    v_accvgpr_write_b32 a127, 0
    v_accvgpr_write_b32 a128, 0
    v_accvgpr_write_b32 a129, 0
    v_accvgpr_write_b32 a130, 0
    v_accvgpr_write_b32 a131, 0
    v_accvgpr_write_b32 a132, 0
    v_accvgpr_write_b32 a133, 0
    v_accvgpr_write_b32 a134, 0
    v_accvgpr_write_b32 a135, 0
    v_accvgpr_write_b32 a136, 0
    v_accvgpr_write_b32 a137, 0
    v_accvgpr_write_b32 a138, 0
    v_accvgpr_write_b32 a139, 0
    v_accvgpr_write_b32 a140, 0
    v_accvgpr_write_b32 a141, 0
    v_accvgpr_write_b32 a142, 0
    v_accvgpr_write_b32 a143, 0
    v_accvgpr_write_b32 a144, 0
    v_accvgpr_write_b32 a145, 0
    v_accvgpr_write_b32 a146, 0
    v_accvgpr_write_b32 a147, 0
    v_accvgpr_write_b32 a148, 0
    v_accvgpr_write_b32 a149, 0
    v_accvgpr_write_b32 a150, 0
    v_accvgpr_write_b32 a151, 0
    v_accvgpr_write_b32 a152, 0
    v_accvgpr_write_b32 a153, 0
    v_accvgpr_write_b32 a154, 0
    v_accvgpr_write_b32 a155, 0
    v_accvgpr_write_b32 a156, 0
    v_accvgpr_write_b32 a157, 0
    v_accvgpr_write_b32 a158, 0
    v_accvgpr_write_b32 a159, 0
    v_accvgpr_write_b32 a160, 0
    v_accvgpr_write_b32 a161, 0
    v_accvgpr_write_b32 a162, 0
    v_accvgpr_write_b32 a163, 0
    v_accvgpr_write_b32 a164, 0
    v_accvgpr_write_b32 a165, 0
    v_accvgpr_write_b32 a166, 0
    v_accvgpr_write_b32 a167, 0
    v_accvgpr_write_b32 a168, 0
    v_accvgpr_write_b32 a169, 0
    v_accvgpr_write_b32 a170, 0
    v_accvgpr_write_b32 a171, 0
    v_accvgpr_write_b32 a172, 0
    v_accvgpr_write_b32 a173, 0
    v_accvgpr_write_b32 a174, 0
    v_accvgpr_write_b32 a175, 0
    v_accvgpr_write_b32 a176, 0
    v_accvgpr_write_b32 a177, 0
    v_accvgpr_write_b32 a178, 0
    v_accvgpr_write_b32 a179, 0
    v_accvgpr_write_b32 a180, 0
    v_accvgpr_write_b32 a181, 0
    v_accvgpr_write_b32 a182, 0
    v_accvgpr_write_b32 a183, 0
    v_accvgpr_write_b32 a184, 0
    v_accvgpr_write_b32 a185, 0
    v_accvgpr_write_b32 a186, 0
    v_accvgpr_write_b32 a187, 0
    v_accvgpr_write_b32 a188, 0
    v_accvgpr_write_b32 a189, 0
    v_accvgpr_write_b32 a190, 0
    v_accvgpr_write_b32 a191, 0
    v_accvgpr_write_b32 a192, 0
    v_accvgpr_write_b32 a193, 0
    v_accvgpr_write_b32 a194, 0
    v_accvgpr_write_b32 a195, 0
    v_accvgpr_write_b32 a196, 0
    v_accvgpr_write_b32 a197, 0
    v_accvgpr_write_b32 a198, 0
    v_accvgpr_write_b32 a199, 0
    v_accvgpr_write_b32 a200, 0
    v_accvgpr_write_b32 a201, 0
    v_accvgpr_write_b32 a202, 0
    v_accvgpr_write_b32 a203, 0
    v_accvgpr_write_b32 a204, 0
    v_accvgpr_write_b32 a205, 0
    v_accvgpr_write_b32 a206, 0
    v_accvgpr_write_b32 a207, 0
    v_accvgpr_write_b32 a208, 0
    v_accvgpr_write_b32 a209, 0
    v_accvgpr_write_b32 a210, 0
    v_accvgpr_write_b32 a211, 0
    v_accvgpr_write_b32 a212, 0
    v_accvgpr_write_b32 a213, 0
    v_accvgpr_write_b32 a214, 0
    v_accvgpr_write_b32 a215, 0
    v_accvgpr_write_b32 a216, 0
    v_accvgpr_write_b32 a217, 0
    v_accvgpr_write_b32 a218, 0
    v_accvgpr_write_b32 a219, 0
    v_accvgpr_write_b32 a220, 0
    v_accvgpr_write_b32 a221, 0
    v_accvgpr_write_b32 a222, 0
    v_accvgpr_write_b32 a223, 0
    v_accvgpr_write_b32 a224, 0
    v_accvgpr_write_b32 a225, 0
    v_accvgpr_write_b32 a226, 0
    v_accvgpr_write_b32 a227, 0
    v_accvgpr_write_b32 a228, 0
    v_accvgpr_write_b32 a229, 0
    v_accvgpr_write_b32 a230, 0
    v_accvgpr_write_b32 a231, 0
    v_accvgpr_write_b32 a232, 0
    v_accvgpr_write_b32 a233, 0
    v_accvgpr_write_b32 a234, 0
    v_accvgpr_write_b32 a235, 0
    v_accvgpr_write_b32 a236, 0
    v_accvgpr_write_b32 a237, 0
    v_accvgpr_write_b32 a238, 0
    v_accvgpr_write_b32 a239, 0
    v_accvgpr_write_b32 a240, 0
    v_accvgpr_write_b32 a241, 0
    v_accvgpr_write_b32 a242, 0
    v_accvgpr_write_b32 a243, 0
    v_accvgpr_write_b32 a244, 0
    v_accvgpr_write_b32 a245, 0
    v_accvgpr_write_b32 a246, 0
    v_accvgpr_write_b32 a247, 0
    v_accvgpr_write_b32 a248, 0
    v_accvgpr_write_b32 a249, 0
    v_accvgpr_write_b32 a250, 0
    v_accvgpr_write_b32 a251, 0
    v_accvgpr_write_b32 a252, 0
    v_accvgpr_write_b32 a253, 0
    v_accvgpr_write_b32 a254, 0
    v_accvgpr_write_b32 a255, 0
    s_waitcnt vmcnt(24)
    s_barrier
    ds_read_b64_tr_b16 v[64:65], v6 offset:0
    ds_read_b64_tr_b16 v[66:67], v6 offset:1024
    ds_read_b64_tr_b16 v[68:69], v7 offset:0
    ds_read_b64_tr_b16 v[70:71], v7 offset:1024
    ds_read_b64_tr_b16 v[72:73], v6 offset:8192
    ds_read_b64_tr_b16 v[74:75], v6 offset:9216
    ds_read_b64_tr_b16 v[76:77], v7 offset:8192
    ds_read_b64_tr_b16 v[78:79], v7 offset:9216
    ds_read_b128 v[80:83], v4 offset:0
    ds_read_b128 v[84:87], v4 offset:2048
    ds_read_b128 v[88:91], v4 offset:4096
    ds_read_b128 v[92:95], v4 offset:6144
    s_mov_b32 s69, 0
    s_waitcnt lgkmcnt(0)
L_g1_loopk:
    v_mfma_f32_32x32x16_bf16 a[0:15], v[64:67], v[80:83], a[0:15]
    ds_read_b64_tr_b16 v[96:97], v6 offset:4096
    v_mfma_f32_32x32x16_bf16 a[64:79], v[68:71], v[80:83], a[64:79]
    ds_read_b64_tr_b16 v[98:99], v6 offset:5120
    v_mfma_f32_32x32x16_bf16 a[128:143], v[72:75], v[80:83], a[128:143]
    ds_read_b64_tr_b16 v[100:101], v7 offset:4096
    v_mfma_f32_32x32x16_bf16 a[192:207], v[76:79], v[80:83], a[192:207]
    ds_read_b64_tr_b16 v[102:103], v7 offset:5120
    v_mfma_f32_32x32x16_bf16 a[16:31], v[64:67], v[84:87], a[16:31]
    ds_read_b64_tr_b16 v[104:105], v6 offset:12288
    v_mfma_f32_32x32x16_bf16 a[80:95], v[68:71], v[84:87], a[80:95]
    ds_read_b64_tr_b16 v[106:107], v6 offset:13312
    v_mfma_f32_32x32x16_bf16 a[144:159], v[72:75], v[84:87], a[144:159]
    ds_read_b64_tr_b16 v[108:109], v7 offset:12288
    v_mfma_f32_32x32x16_bf16 a[208:223], v[76:79], v[84:87], a[208:223]
    ds_read_b64_tr_b16 v[110:111], v7 offset:13312
    v_mfma_f32_32x32x16_bf16 a[32:47], v[64:67], v[88:91], a[32:47]
    ds_read_b128 v[112:115], v5 offset:0
    v_mfma_f32_32x32x16_bf16 a[96:111], v[68:71], v[88:91], a[96:111]
    ds_read_b128 v[116:119], v5 offset:2048
    v_mfma_f32_32x32x16_bf16 a[160:175], v[72:75], v[88:91], a[160:175]
    ds_read_b128 v[120:123], v5 offset:4096
    v_mfma_f32_32x32x16_bf16 a[224:239], v[76:79], v[88:91], a[224:239]
    ds_read_b128 v[124:127], v5 offset:6144
    v_mfma_f32_32x32x16_bf16 a[48:63], v[64:67], v[92:95], a[48:63]
    v_mfma_f32_32x32x16_bf16 a[112:127], v[68:71], v[92:95], a[112:127]
    v_mfma_f32_32x32x16_bf16 a[176:191], v[72:75], v[92:95], a[176:191]
    v_mfma_f32_32x32x16_bf16 a[240:255], v[76:79], v[92:95], a[240:255]
    s_waitcnt lgkmcnt(0)
    s_cmp_lt_u32 s69, 15
    s_cbranch_scc1 L_g1_w8k
    s_waitcnt vmcnt(0)
    s_branch L_g1_wdk
L_g1_w8k:
    s_waitcnt vmcnt(16)
L_g1_wdk:
    s_barrier
    s_add_u32 s71, s71, 32768
    s_cmp_eq_u32 s71, 131072
    s_mov_b32 s72, 32768
    s_cselect_b32 s72, 0xfffe8000, s72
    s_cselect_b32 s71, 0, s71
    v_add_u32 v4, s72, v4
    v_add_u32 v5, s72, v5
    v_add_u32 v6, s72, v6
    v_add_u32 v7, s72, v7
    s_cmp_lt_u32 s69, 14
    s_cbranch_scc0 L_g1_nodmak
    v_mfma_f32_32x32x16_bf16 a[0:15], v[96:99], v[112:115], a[0:15]
    ds_read_b64_tr_b16 v[64:65], v6 offset:0
    v_mfma_f32_32x32x16_bf16 a[64:79], v[100:103], v[112:115], a[64:79]
    ds_read_b64_tr_b16 v[66:67], v6 offset:1024
    s_add_u32 s77, s70, s78
    s_add_u32 s79, s70, s81
    s_mov_b32 m0, s77
    s_nop 0
    buffer_load_dwordx4 v2, s[48:51], s68 offen lds
    v_mfma_f32_32x32x16_bf16 a[128:143], v[104:107], v[112:115], a[128:143]
    ds_read_b64_tr_b16 v[68:69], v7 offset:0
    v_mfma_f32_32x32x16_bf16 a[192:207], v[108:111], v[112:115], a[192:207]
    ds_read_b64_tr_b16 v[70:71], v7 offset:1024
    s_add_u32 m0, s77, 1024
    s_add_u32 s73, s68, 18432
    buffer_load_dwordx4 v2, s[48:51], s73 offen lds
    v_mfma_f32_32x32x16_bf16 a[16:31], v[96:99], v[116:119], a[16:31]
    ds_read_b64_tr_b16 v[72:73], v6 offset:8192
    v_mfma_f32_32x32x16_bf16 a[80:95], v[100:103], v[116:119], a[80:95]
    ds_read_b64_tr_b16 v[74:75], v6 offset:9216
    s_add_u32 m0, s77, 2048
    s_add_u32 s73, s68, 36864
    buffer_load_dwordx4 v2, s[48:51], s73 offen lds
    v_mfma_f32_32x32x16_bf16 a[144:159], v[104:107], v[116:119], a[144:159]
    ds_read_b64_tr_b16 v[76:77], v7 offset:8192
    v_mfma_f32_32x32x16_bf16 a[208:223], v[108:111], v[116:119], a[208:223]
    ds_read_b64_tr_b16 v[78:79], v7 offset:9216
    s_add_u32 m0, s77, 3072
    s_add_u32 s73, s68, 55296
    buffer_load_dwordx4 v2, s[48:51], s73 offen lds
    v_mfma_f32_32x32x16_bf16 a[32:47], v[96:99], v[120:123], a[32:47]
    ds_read_b128 v[80:83], v4 offset:0
    v_mfma_f32_32x32x16_bf16 a[96:111], v[100:103], v[120:123], a[96:111]
    ds_read_b128 v[84:87], v4 offset:2048
    s_add_u32 m0, s79, 0
    s_nop 0
    buffer_load_dwordx4 v3, s[52:55], s66 offen lds
    v_mfma_f32_32x32x16_bf16 a[160:175], v[104:107], v[120:123], a[160:175]
    ds_read_b128 v[88:91], v4 offset:4096
    v_mfma_f32_32x32x16_bf16 a[224:239], v[108:111], v[120:123], a[224:239]
    ds_read_b128 v[92:95], v4 offset:6144
    s_add_u32 m0, s79, 1024
    s_add_u32 s73, s66, s80
    buffer_load_dwordx4 v3, s[52:55], s73 offen lds
    v_mfma_f32_32x32x16_bf16 a[48:63], v[96:99], v[124:127], a[48:63]
    v_mfma_f32_32x32x16_bf16 a[112:127], v[100:103], v[124:127], a[112:127]
    s_add_u32 m0, s79, 8192
    s_nop 0
    buffer_load_dwordx4 v3, s[56:59], s67 offen lds
    v_mfma_f32_32x32x16_bf16 a[176:191], v[104:107], v[124:127], a[176:191]
    s_add_u32 m0, s79, 9216
    s_add_u32 s73, s67, s80
    buffer_load_dwordx4 v3, s[56:59], s73 offen lds
    v_mfma_f32_32x32x16_bf16 a[240:255], v[108:111], v[124:127], a[240:255]
    s_add_u32 s68, s68, 64
    s_add_u32 s66, s66, s82
    s_add_u32 s67, s67, s82
    s_add_u32 s70, s70, 32768
    s_cmp_eq_u32 s70, 131072
    s_cselect_b32 s70, 0, s70
    s_branch L_g1_jk
L_g1_nodmak:
    v_mfma_f32_32x32x16_bf16 a[0:15], v[96:99], v[112:115], a[0:15]
    ds_read_b64_tr_b16 v[64:65], v6 offset:0
    v_mfma_f32_32x32x16_bf16 a[64:79], v[100:103], v[112:115], a[64:79]
    ds_read_b64_tr_b16 v[66:67], v6 offset:1024
    v_mfma_f32_32x32x16_bf16 a[128:143], v[104:107], v[112:115], a[128:143]
    ds_read_b64_tr_b16 v[68:69], v7 offset:0
    v_mfma_f32_32x32x16_bf16 a[192:207], v[108:111], v[112:115], a[192:207]
    ds_read_b64_tr_b16 v[70:71], v7 offset:1024
    v_mfma_f32_32x32x16_bf16 a[16:31], v[96:99], v[116:119], a[16:31]
    ds_read_b64_tr_b16 v[72:73], v6 offset:8192
    v_mfma_f32_32x32x16_bf16 a[80:95], v[100:103], v[116:119], a[80:95]
    ds_read_b64_tr_b16 v[74:75], v6 offset:9216
    v_mfma_f32_32x32x16_bf16 a[144:159], v[104:107], v[116:119], a[144:159]
    ds_read_b64_tr_b16 v[76:77], v7 offset:8192
    v_mfma_f32_32x32x16_bf16 a[208:223], v[108:111], v[116:119], a[208:223]
    ds_read_b64_tr_b16 v[78:79], v7 offset:9216
    v_mfma_f32_32x32x16_bf16 a[32:47], v[96:99], v[120:123], a[32:47]
    ds_read_b128 v[80:83], v4 offset:0
    v_mfma_f32_32x32x16_bf16 a[96:111], v[100:103], v[120:123], a[96:111]
    ds_read_b128 v[84:87], v4 offset:2048
    v_mfma_f32_32x32x16_bf16 a[160:175], v[104:107], v[120:123], a[160:175]
    ds_read_b128 v[88:91], v4 offset:4096
    v_mfma_f32_32x32x16_bf16 a[224:239], v[108:111], v[120:123], a[224:239]
    ds_read_b128 v[92:95], v4 offset:6144
    v_mfma_f32_32x32x16_bf16 a[48:63], v[96:99], v[124:127], a[48:63]
    v_mfma_f32_32x32x16_bf16 a[112:127], v[100:103], v[124:127], a[112:127]
    v_mfma_f32_32x32x16_bf16 a[176:191], v[104:107], v[124:127], a[176:191]
    v_mfma_f32_32x32x16_bf16 a[240:255], v[108:111], v[124:127], a[240:255]
L_g1_jk:
    s_waitcnt lgkmcnt(0)
    s_add_u32 s69, s69, 1
    s_cmp_lt_u32 s69, 18
    s_cbranch_scc1 L_g1_loopk
    v_subrev_u32 v4, 65536, v4
    v_subrev_u32 v5, 65536, v5
    v_subrev_u32 v6, 65536, v6
    v_subrev_u32 v7, 65536, v7
    s_nop 15
    v_accvgpr_read_b32 v128, a0
    v_accvgpr_read_b32 v129, a1
    v_accvgpr_read_b32 v130, a2
    v_accvgpr_read_b32 v131, a3
    v_accvgpr_read_b32 v132, a4
    v_accvgpr_read_b32 v133, a5
    v_accvgpr_read_b32 v134, a6
    v_accvgpr_read_b32 v135, a7
    v_accvgpr_read_b32 v136, a8
    v_accvgpr_read_b32 v137, a9
    v_accvgpr_read_b32 v138, a10
    v_accvgpr_read_b32 v139, a11
    v_accvgpr_read_b32 v140, a12
    v_accvgpr_read_b32 v141, a13
    v_accvgpr_read_b32 v142, a14
    v_accvgpr_read_b32 v143, a15
    v_cvt_pk_bf16_f32 v144, v128, v129
    v_cvt_pk_bf16_f32 v145, v130, v131
    v_cvt_pk_bf16_f32 v146, v132, v133
    v_cvt_pk_bf16_f32 v147, v134, v135
    v_cvt_pk_bf16_f32 v148, v136, v137
    v_cvt_pk_bf16_f32 v149, v138, v139
    v_cvt_pk_bf16_f32 v150, v140, v141
    v_cvt_pk_bf16_f32 v151, v142, v143
    v_permlane32_swap_b32 v144, v146
    v_permlane32_swap_b32 v145, v147
    v_permlane32_swap_b32 v148, v150
    v_permlane32_swap_b32 v149, v151
    s_mul_i32 s72, s76, 1048576
    s_lshl_b32 s73, s75, 12
    s_add_u32 s72, s72, s73
    s_add_u32 s72, s72, 0
    s_add_u32 s62, s60, s72
    s_addc_u32 s63, s61, 0
    global_store_dwordx4 v8, v[144:147], s[62:63] sc1
    global_store_dwordx4 v8, v[148:151], s[62:63] offset:512 sc1
    v_accvgpr_read_b32 v128, a16
    v_accvgpr_read_b32 v129, a17
    v_accvgpr_read_b32 v130, a18
    v_accvgpr_read_b32 v131, a19
    v_accvgpr_read_b32 v132, a20
    v_accvgpr_read_b32 v133, a21
    v_accvgpr_read_b32 v134, a22
    v_accvgpr_read_b32 v135, a23
    v_accvgpr_read_b32 v136, a24
    v_accvgpr_read_b32 v137, a25
    v_accvgpr_read_b32 v138, a26
    v_accvgpr_read_b32 v139, a27
    v_accvgpr_read_b32 v140, a28
    v_accvgpr_read_b32 v141, a29
    v_accvgpr_read_b32 v142, a30
    v_accvgpr_read_b32 v143, a31
    v_cvt_pk_bf16_f32 v152, v128, v129
    v_cvt_pk_bf16_f32 v153, v130, v131
    v_cvt_pk_bf16_f32 v154, v132, v133
    v_cvt_pk_bf16_f32 v155, v134, v135
    v_cvt_pk_bf16_f32 v156, v136, v137
    v_cvt_pk_bf16_f32 v157, v138, v139
    v_cvt_pk_bf16_f32 v158, v140, v141
    v_cvt_pk_bf16_f32 v159, v142, v143
    v_permlane32_swap_b32 v152, v154
    v_permlane32_swap_b32 v153, v155
    v_permlane32_swap_b32 v156, v158
    v_permlane32_swap_b32 v157, v159
    s_mul_i32 s72, s76, 1048576
    s_lshl_b32 s73, s75, 12
    s_add_u32 s72, s72, s73
    s_add_u32 s72, s72, 262144
    s_add_u32 s62, s60, s72
    s_addc_u32 s63, s61, 0
    global_store_dwordx4 v8, v[152:155], s[62:63] sc1
    global_store_dwordx4 v8, v[156:159], s[62:63] offset:512 sc1
    v_accvgpr_read_b32 v128, a32
    v_accvgpr_read_b32 v129, a33
    v_accvgpr_read_b32 v130, a34
    v_accvgpr_read_b32 v131, a35
    v_accvgpr_read_b32 v132, a36
    v_accvgpr_read_b32 v133, a37
    v_accvgpr_read_b32 v134, a38
    v_accvgpr_read_b32 v135, a39
    v_accvgpr_read_b32 v136, a40
    v_accvgpr_read_b32 v137, a41
    v_accvgpr_read_b32 v138, a42
    v_accvgpr_read_b32 v139, a43
    v_accvgpr_read_b32 v140, a44
    v_accvgpr_read_b32 v141, a45
    v_accvgpr_read_b32 v142, a46
    v_accvgpr_read_b32 v143, a47
    v_cvt_pk_bf16_f32 v144, v128, v129
    v_cvt_pk_bf16_f32 v145, v130, v131
    v_cvt_pk_bf16_f32 v146, v132, v133
    v_cvt_pk_bf16_f32 v147, v134, v135
    v_cvt_pk_bf16_f32 v148, v136, v137
    v_cvt_pk_bf16_f32 v149, v138, v139
    v_cvt_pk_bf16_f32 v150, v140, v141
    v_cvt_pk_bf16_f32 v151, v142, v143
    v_permlane32_swap_b32 v144, v146
    v_permlane32_swap_b32 v145, v147
    v_permlane32_swap_b32 v148, v150
    v_permlane32_swap_b32 v149, v151
    s_mul_i32 s72, s76, 1048576
    s_lshl_b32 s73, s75, 12
    s_add_u32 s72, s72, s73
    s_add_u32 s72, s72, 524288
    s_add_u32 s62, s60, s72
    s_addc_u32 s63, s61, 0
    global_store_dwordx4 v8, v[144:147], s[62:63] sc1
    global_store_dwordx4 v8, v[148:151], s[62:63] offset:512 sc1
    v_accvgpr_read_b32 v128, a48
    v_accvgpr_read_b32 v129, a49
    v_accvgpr_read_b32 v130, a50
    v_accvgpr_read_b32 v131, a51
    v_accvgpr_read_b32 v132, a52
    v_accvgpr_read_b32 v133, a53
    v_accvgpr_read_b32 v134, a54
    v_accvgpr_read_b32 v135, a55
    v_accvgpr_read_b32 v136, a56
    v_accvgpr_read_b32 v137, a57
    v_accvgpr_read_b32 v138, a58
    v_accvgpr_read_b32 v139, a59
    v_accvgpr_read_b32 v140, a60
    v_accvgpr_read_b32 v141, a61
    v_accvgpr_read_b32 v142, a62
    v_accvgpr_read_b32 v143, a63
    v_cvt_pk_bf16_f32 v152, v128, v129
    v_cvt_pk_bf16_f32 v153, v130, v131
    v_cvt_pk_bf16_f32 v154, v132, v133
    v_cvt_pk_bf16_f32 v155, v134, v135
    v_cvt_pk_bf16_f32 v156, v136, v137
    v_cvt_pk_bf16_f32 v157, v138, v139
    v_cvt_pk_bf16_f32 v158, v140, v141
    v_cvt_pk_bf16_f32 v159, v142, v143
    v_permlane32_swap_b32 v152, v154
    v_permlane32_swap_b32 v153, v155
    v_permlane32_swap_b32 v156, v158
    v_permlane32_swap_b32 v157, v159
    s_mul_i32 s72, s76, 1048576
    s_lshl_b32 s73, s75, 12
    s_add_u32 s72, s72, s73
    s_add_u32 s72, s72, 786432
    s_add_u32 s62, s60, s72
    s_addc_u32 s63, s61, 0
    global_store_dwordx4 v8, v[152:155], s[62:63] sc1
    global_store_dwordx4 v8, v[156:159], s[62:63] offset:512 sc1
    v_accvgpr_read_b32 v128, a64
    v_accvgpr_read_b32 v129, a65
    v_accvgpr_read_b32 v130, a66
    v_accvgpr_read_b32 v131, a67
    v_accvgpr_read_b32 v132, a68
    v_accvgpr_read_b32 v133, a69
    v_accvgpr_read_b32 v134, a70
    v_accvgpr_read_b32 v135, a71
    v_accvgpr_read_b32 v136, a72
    v_accvgpr_read_b32 v137, a73
    v_accvgpr_read_b32 v138, a74
    v_accvgpr_read_b32 v139, a75
    v_accvgpr_read_b32 v140, a76
    v_accvgpr_read_b32 v141, a77
    v_accvgpr_read_b32 v142, a78
    v_accvgpr_read_b32 v143, a79
    v_cvt_pk_bf16_f32 v144, v128, v129
    v_cvt_pk_bf16_f32 v145, v130, v131
    v_cvt_pk_bf16_f32 v146, v132, v133
    v_cvt_pk_bf16_f32 v147, v134, v135
    v_cvt_pk_bf16_f32 v148, v136, v137
    v_cvt_pk_bf16_f32 v149, v138, v139
    v_cvt_pk_bf16_f32 v150, v140, v141
    v_cvt_pk_bf16_f32 v151, v142, v143
    v_permlane32_swap_b32 v144, v146
    v_permlane32_swap_b32 v145, v147
    v_permlane32_swap_b32 v148, v150
    v_permlane32_swap_b32 v149, v151
    s_mul_i32 s72, s76, 1048576
    s_lshl_b32 s73, s75, 12
    s_add_u32 s72, s72, s73
    s_add_u32 s72, s72, 2048
    s_add_u32 s62, s60, s72
    s_addc_u32 s63, s61, 0
    global_store_dwordx4 v8, v[144:147], s[62:63] sc1
    global_store_dwordx4 v8, v[148:151], s[62:63] offset:512 sc1
    v_accvgpr_read_b32 v128, a80
    v_accvgpr_read_b32 v129, a81
    v_accvgpr_read_b32 v130, a82
    v_accvgpr_read_b32 v131, a83
    v_accvgpr_read_b32 v132, a84
    v_accvgpr_read_b32 v133, a85
    v_accvgpr_read_b32 v134, a86
    v_accvgpr_read_b32 v135, a87
    v_accvgpr_read_b32 v136, a88
    v_accvgpr_read_b32 v137, a89
    v_accvgpr_read_b32 v138, a90
    v_accvgpr_read_b32 v139, a91
    v_accvgpr_read_b32 v140, a92
    v_accvgpr_read_b32 v141, a93
    v_accvgpr_read_b32 v142, a94
    v_accvgpr_read_b32 v143, a95
    v_cvt_pk_bf16_f32 v152, v128, v129
    v_cvt_pk_bf16_f32 v153, v130, v131
    v_cvt_pk_bf16_f32 v154, v132, v133
    v_cvt_pk_bf16_f32 v155, v134, v135
    v_cvt_pk_bf16_f32 v156, v136, v137
    v_cvt_pk_bf16_f32 v157, v138, v139
    v_cvt_pk_bf16_f32 v158, v140, v141
    v_cvt_pk_bf16_f32 v159, v142, v143
    v_permlane32_swap_b32 v152, v154
    v_permlane32_swap_b32 v153, v155
    v_permlane32_swap_b32 v156, v158
    v_permlane32_swap_b32 v157, v159
    s_mul_i32 s72, s76, 1048576
    s_lshl_b32 s73, s75, 12
    s_add_u32 s72, s72, s73
    s_add_u32 s72, s72, 264192
    s_add_u32 s62, s60, s72
    s_addc_u32 s63, s61, 0
    global_store_dwordx4 v8, v[152:155], s[62:63] sc1
    global_store_dwordx4 v8, v[156:159], s[62:63] offset:512 sc1
    v_accvgpr_read_b32 v128, a96
    v_accvgpr_read_b32 v129, a97
    v_accvgpr_read_b32 v130, a98
    v_accvgpr_read_b32 v131, a99
    v_accvgpr_read_b32 v132, a100
    v_accvgpr_read_b32 v133, a101
    v_accvgpr_read_b32 v134, a102
    v_accvgpr_read_b32 v135, a103
    v_accvgpr_read_b32 v136, a104
    v_accvgpr_read_b32 v137, a105
    v_accvgpr_read_b32 v138, a106
    v_accvgpr_read_b32 v139, a107
    v_accvgpr_read_b32 v140, a108
    v_accvgpr_read_b32 v141, a109
    v_accvgpr_read_b32 v142, a110
    v_accvgpr_read_b32 v143, a111
    v_cvt_pk_bf16_f32 v144, v128, v129
    v_cvt_pk_bf16_f32 v145, v130, v131
    v_cvt_pk_bf16_f32 v146, v132, v133
    v_cvt_pk_bf16_f32 v147, v134, v135
    v_cvt_pk_bf16_f32 v148, v136, v137
    v_cvt_pk_bf16_f32 v149, v138, v139
    v_cvt_pk_bf16_f32 v150, v140, v141
    v_cvt_pk_bf16_f32 v151, v142, v143
    v_permlane32_swap_b32 v144, v146
    v_permlane32_swap_b32 v145, v147
    v_permlane32_swap_b32 v148, v150
    v_permlane32_swap_b32 v149, v151
    s_mul_i32 s72, s76, 1048576
    s_lshl_b32 s73, s75, 12
    s_add_u32 s72, s72, s73
    s_add_u32 s72, s72, 526336
    s_add_u32 s62, s60, s72
    s_addc_u32 s63, s61, 0
    global_store_dwordx4 v8, v[144:147], s[62:63] sc1
    global_store_dwordx4 v8, v[148:151], s[62:63] offset:512 sc1
    v_accvgpr_read_b32 v128, a112
    v_accvgpr_read_b32 v129, a113
    v_accvgpr_read_b32 v130, a114
    v_accvgpr_read_b32 v131, a115
    v_accvgpr_read_b32 v132, a116
    v_accvgpr_read_b32 v133, a117
    v_accvgpr_read_b32 v134, a118
    v_accvgpr_read_b32 v135, a119
    v_accvgpr_read_b32 v136, a120
    v_accvgpr_read_b32 v137, a121
    v_accvgpr_read_b32 v138, a122
    v_accvgpr_read_b32 v139, a123
    v_accvgpr_read_b32 v140, a124
    v_accvgpr_read_b32 v141, a125
    v_accvgpr_read_b32 v142, a126
    v_accvgpr_read_b32 v143, a127
    v_cvt_pk_bf16_f32 v152, v128, v129
    v_cvt_pk_bf16_f32 v153, v130, v131
    v_cvt_pk_bf16_f32 v154, v132, v133
    v_cvt_pk_bf16_f32 v155, v134, v135
    v_cvt_pk_bf16_f32 v156, v136, v137
    v_cvt_pk_bf16_f32 v157, v138, v139
    v_cvt_pk_bf16_f32 v158, v140, v141
    v_cvt_pk_bf16_f32 v159, v142, v143
    v_permlane32_swap_b32 v152, v154
    v_permlane32_swap_b32 v153, v155
    v_permlane32_swap_b32 v156, v158
    v_permlane32_swap_b32 v157, v159
    s_mul_i32 s72, s76, 1048576
    s_lshl_b32 s73, s75, 12
    s_add_u32 s72, s72, s73
    s_add_u32 s72, s72, 788480
    s_add_u32 s62, s60, s72
    s_addc_u32 s63, s61, 0
    global_store_dwordx4 v8, v[152:155], s[62:63] sc1
    global_store_dwordx4 v8, v[156:159], s[62:63] offset:512 sc1
    v_accvgpr_read_b32 v128, a128
    v_accvgpr_read_b32 v129, a129
    v_accvgpr_read_b32 v130, a130
    v_accvgpr_read_b32 v131, a131
    v_accvgpr_read_b32 v132, a132
    v_accvgpr_read_b32 v133, a133
    v_accvgpr_read_b32 v134, a134
    v_accvgpr_read_b32 v135, a135
    v_accvgpr_read_b32 v136, a136
    v_accvgpr_read_b32 v137, a137
    v_accvgpr_read_b32 v138, a138
    v_accvgpr_read_b32 v139, a139
    v_accvgpr_read_b32 v140, a140
    v_accvgpr_read_b32 v141, a141
    v_accvgpr_read_b32 v142, a142
    v_accvgpr_read_b32 v143, a143
    v_cvt_pk_bf16_f32 v144, v128, v129
    v_cvt_pk_bf16_f32 v145, v130, v131
    v_cvt_pk_bf16_f32 v146, v132, v133
    v_cvt_pk_bf16_f32 v147, v134, v135
    v_cvt_pk_bf16_f32 v148, v136, v137
    v_cvt_pk_bf16_f32 v149, v138, v139
    v_cvt_pk_bf16_f32 v150, v140, v141
    v_cvt_pk_bf16_f32 v151, v142, v143
    v_permlane32_swap_b32 v144, v146
    v_permlane32_swap_b32 v145, v147
    v_permlane32_swap_b32 v148, v150
    v_permlane32_swap_b32 v149, v151
    s_mul_i32 s72, s76, 1048576
    s_lshl_b32 s73, s75, 12
    s_add_u32 s72, s72, s73
    s_add_u32 s72, s72, 8192
    s_add_u32 s62, s60, s72
    s_addc_u32 s63, s61, 0
    global_store_dwordx4 v8, v[144:147], s[62:63] sc1
    global_store_dwordx4 v8, v[148:151], s[62:63] offset:512 sc1
    v_accvgpr_read_b32 v128, a144
    v_accvgpr_read_b32 v129, a145
    v_accvgpr_read_b32 v130, a146
    v_accvgpr_read_b32 v131, a147
    v_accvgpr_read_b32 v132, a148
    v_accvgpr_read_b32 v133, a149
    v_accvgpr_read_b32 v134, a150
    v_accvgpr_read_b32 v135, a151
    v_accvgpr_read_b32 v136, a152
    v_accvgpr_read_b32 v137, a153
    v_accvgpr_read_b32 v138, a154
    v_accvgpr_read_b32 v139, a155
    v_accvgpr_read_b32 v140, a156
    v_accvgpr_read_b32 v141, a157
    v_accvgpr_read_b32 v142, a158
    v_accvgpr_read_b32 v143, a159
    v_cvt_pk_bf16_f32 v152, v128, v129
    v_cvt_pk_bf16_f32 v153, v130, v131
    v_cvt_pk_bf16_f32 v154, v132, v133
    v_cvt_pk_bf16_f32 v155, v134, v135
    v_cvt_pk_bf16_f32 v156, v136, v137
    v_cvt_pk_bf16_f32 v157, v138, v139
    v_cvt_pk_bf16_f32 v158, v140, v141
    v_cvt_pk_bf16_f32 v159, v142, v143
    v_permlane32_swap_b32 v152, v154
    v_permlane32_swap_b32 v153, v155
    v_permlane32_swap_b32 v156, v158
    v_permlane32_swap_b32 v157, v159
    s_mul_i32 s72, s76, 1048576
    s_lshl_b32 s73, s75, 12
    s_add_u32 s72, s72, s73
    s_add_u32 s72, s72, 270336
    s_add_u32 s62, s60, s72
    s_addc_u32 s63, s61, 0
    global_store_dwordx4 v8, v[152:155], s[62:63] sc1
    global_store_dwordx4 v8, v[156:159], s[62:63] offset:512 sc1
    v_accvgpr_read_b32 v128, a160
    v_accvgpr_read_b32 v129, a161
    v_accvgpr_read_b32 v130, a162
    v_accvgpr_read_b32 v131, a163
    v_accvgpr_read_b32 v132, a164
    v_accvgpr_read_b32 v133, a165
    v_accvgpr_read_b32 v134, a166
    v_accvgpr_read_b32 v135, a167
    v_accvgpr_read_b32 v136, a168
    v_accvgpr_read_b32 v137, a169
    v_accvgpr_read_b32 v138, a170
    v_accvgpr_read_b32 v139, a171
    v_accvgpr_read_b32 v140, a172
    v_accvgpr_read_b32 v141, a173
    v_accvgpr_read_b32 v142, a174
    v_accvgpr_read_b32 v143, a175
    v_cvt_pk_bf16_f32 v144, v128, v129
    v_cvt_pk_bf16_f32 v145, v130, v131
    v_cvt_pk_bf16_f32 v146, v132, v133
    v_cvt_pk_bf16_f32 v147, v134, v135
    v_cvt_pk_bf16_f32 v148, v136, v137
    v_cvt_pk_bf16_f32 v149, v138, v139
    v_cvt_pk_bf16_f32 v150, v140, v141
    v_cvt_pk_bf16_f32 v151, v142, v143
    v_permlane32_swap_b32 v144, v146
    v_permlane32_swap_b32 v145, v147
    v_permlane32_swap_b32 v148, v150
    v_permlane32_swap_b32 v149, v151
    s_mul_i32 s72, s76, 1048576
    s_lshl_b32 s73, s75, 12
    s_add_u32 s72, s72, s73
    s_add_u32 s72, s72, 532480
    s_add_u32 s62, s60, s72
    s_addc_u32 s63, s61, 0
    global_store_dwordx4 v8, v[144:147], s[62:63] sc1
    global_store_dwordx4 v8, v[148:151], s[62:63] offset:512 sc1
    v_accvgpr_read_b32 v128, a176
    v_accvgpr_read_b32 v129, a177
    v_accvgpr_read_b32 v130, a178
    v_accvgpr_read_b32 v131, a179
    v_accvgpr_read_b32 v132, a180
    v_accvgpr_read_b32 v133, a181
    v_accvgpr_read_b32 v134, a182
    v_accvgpr_read_b32 v135, a183
    v_accvgpr_read_b32 v136, a184
    v_accvgpr_read_b32 v137, a185
    v_accvgpr_read_b32 v138, a186
    v_accvgpr_read_b32 v139, a187
    v_accvgpr_read_b32 v140, a188
    v_accvgpr_read_b32 v141, a189
    v_accvgpr_read_b32 v142, a190
    v_accvgpr_read_b32 v143, a191
    v_cvt_pk_bf16_f32 v152, v128, v129
    v_cvt_pk_bf16_f32 v153, v130, v131
    v_cvt_pk_bf16_f32 v154, v132, v133
    v_cvt_pk_bf16_f32 v155, v134, v135
    v_cvt_pk_bf16_f32 v156, v136, v137
    v_cvt_pk_bf16_f32 v157, v138, v139
    v_cvt_pk_bf16_f32 v158, v140, v141
    v_cvt_pk_bf16_f32 v159, v142, v143
    v_permlane32_swap_b32 v152, v154
    v_permlane32_swap_b32 v153, v155
    v_permlane32_swap_b32 v156, v158
    v_permlane32_swap_b32 v157, v159
    s_mul_i32 s72, s76, 1048576
    s_lshl_b32 s73, s75, 12
    s_add_u32 s72, s72, s73
    s_add_u32 s72, s72, 794624
    s_add_u32 s62, s60, s72
    s_addc_u32 s63, s61, 0
    global_store_dwordx4 v8, v[152:155], s[62:63] sc1
    global_store_dwordx4 v8, v[156:159], s[62:63] offset:512 sc1
    v_accvgpr_read_b32 v128, a192
    v_accvgpr_read_b32 v129, a193
    v_accvgpr_read_b32 v130, a194
    v_accvgpr_read_b32 v131, a195
    v_accvgpr_read_b32 v132, a196
    v_accvgpr_read_b32 v133, a197
    v_accvgpr_read_b32 v134, a198
    v_accvgpr_read_b32 v135, a199
    v_accvgpr_read_b32 v136, a200
    v_accvgpr_read_b32 v137, a201
    v_accvgpr_read_b32 v138, a202
    v_accvgpr_read_b32 v139, a203
    v_accvgpr_read_b32 v140, a204
    v_accvgpr_read_b32 v141, a205
    v_accvgpr_read_b32 v142, a206
    v_accvgpr_read_b32 v143, a207
    v_cvt_pk_bf16_f32 v144, v128, v129
    v_cvt_pk_bf16_f32 v145, v130, v131
    v_cvt_pk_bf16_f32 v146, v132, v133
    v_cvt_pk_bf16_f32 v147, v134, v135
    v_cvt_pk_bf16_f32 v148, v136, v137
    v_cvt_pk_bf16_f32 v149, v138, v139
    v_cvt_pk_bf16_f32 v150, v140, v141
    v_cvt_pk_bf16_f32 v151, v142, v143
    v_permlane32_swap_b32 v144, v146
    v_permlane32_swap_b32 v145, v147
    v_permlane32_swap_b32 v148, v150
    v_permlane32_swap_b32 v149, v151
    s_mul_i32 s72, s76, 1048576
    s_lshl_b32 s73, s75, 12
    s_add_u32 s72, s72, s73
    s_add_u32 s72, s72, 10240
    s_add_u32 s62, s60, s72
    s_addc_u32 s63, s61, 0
    global_store_dwordx4 v8, v[144:147], s[62:63] sc1
    global_store_dwordx4 v8, v[148:151], s[62:63] offset:512 sc1
    v_accvgpr_read_b32 v128, a208
    v_accvgpr_read_b32 v129, a209
    v_accvgpr_read_b32 v130, a210
    v_accvgpr_read_b32 v131, a211
    v_accvgpr_read_b32 v132, a212
    v_accvgpr_read_b32 v133, a213
    v_accvgpr_read_b32 v134, a214
    v_accvgpr_read_b32 v135, a215
    v_accvgpr_read_b32 v136, a216
    v_accvgpr_read_b32 v137, a217
    v_accvgpr_read_b32 v138, a218
    v_accvgpr_read_b32 v139, a219
    v_accvgpr_read_b32 v140, a220
    v_accvgpr_read_b32 v141, a221
    v_accvgpr_read_b32 v142, a222
    v_accvgpr_read_b32 v143, a223
    v_cvt_pk_bf16_f32 v152, v128, v129
    v_cvt_pk_bf16_f32 v153, v130, v131
    v_cvt_pk_bf16_f32 v154, v132, v133
    v_cvt_pk_bf16_f32 v155, v134, v135
    v_cvt_pk_bf16_f32 v156, v136, v137
    v_cvt_pk_bf16_f32 v157, v138, v139
    v_cvt_pk_bf16_f32 v158, v140, v141
    v_cvt_pk_bf16_f32 v159, v142, v143
    v_permlane32_swap_b32 v152, v154
    v_permlane32_swap_b32 v153, v155
    v_permlane32_swap_b32 v156, v158
    v_permlane32_swap_b32 v157, v159
    s_mul_i32 s72, s76, 1048576
    s_lshl_b32 s73, s75, 12
    s_add_u32 s72, s72, s73
    s_add_u32 s72, s72, 272384
    s_add_u32 s62, s60, s72
    s_addc_u32 s63, s61, 0
    global_store_dwordx4 v8, v[152:155], s[62:63] sc1
    global_store_dwordx4 v8, v[156:159], s[62:63] offset:512 sc1
    v_accvgpr_read_b32 v128, a224
    v_accvgpr_read_b32 v129, a225
    v_accvgpr_read_b32 v130, a226
    v_accvgpr_read_b32 v131, a227
    v_accvgpr_read_b32 v132, a228
    v_accvgpr_read_b32 v133, a229
    v_accvgpr_read_b32 v134, a230
    v_accvgpr_read_b32 v135, a231
    v_accvgpr_read_b32 v136, a232
    v_accvgpr_read_b32 v137, a233
    v_accvgpr_read_b32 v138, a234
    v_accvgpr_read_b32 v139, a235
    v_accvgpr_read_b32 v140, a236
    v_accvgpr_read_b32 v141, a237
    v_accvgpr_read_b32 v142, a238
    v_accvgpr_read_b32 v143, a239
    v_cvt_pk_bf16_f32 v144, v128, v129
    v_cvt_pk_bf16_f32 v145, v130, v131
    v_cvt_pk_bf16_f32 v146, v132, v133
    v_cvt_pk_bf16_f32 v147, v134, v135
    v_cvt_pk_bf16_f32 v148, v136, v137
    v_cvt_pk_bf16_f32 v149, v138, v139
    v_cvt_pk_bf16_f32 v150, v140, v141
    v_cvt_pk_bf16_f32 v151, v142, v143
    v_permlane32_swap_b32 v144, v146
    v_permlane32_swap_b32 v145, v147
    v_permlane32_swap_b32 v148, v150
    v_permlane32_swap_b32 v149, v151
    s_mul_i32 s72, s76, 1048576
    s_lshl_b32 s73, s75, 12
    s_add_u32 s72, s72, s73
    s_add_u32 s72, s72, 534528
    s_add_u32 s62, s60, s72
    s_addc_u32 s63, s61, 0
    global_store_dwordx4 v8, v[144:147], s[62:63] sc1
    global_store_dwordx4 v8, v[148:151], s[62:63] offset:512 sc1
    v_accvgpr_read_b32 v128, a240
    v_accvgpr_read_b32 v129, a241
    v_accvgpr_read_b32 v130, a242
    v_accvgpr_read_b32 v131, a243
    v_accvgpr_read_b32 v132, a244
    v_accvgpr_read_b32 v133, a245
    v_accvgpr_read_b32 v134, a246
    v_accvgpr_read_b32 v135, a247
    v_accvgpr_read_b32 v136, a248
    v_accvgpr_read_b32 v137, a249
    v_accvgpr_read_b32 v138, a250
    v_accvgpr_read_b32 v139, a251
    v_accvgpr_read_b32 v140, a252
    v_accvgpr_read_b32 v141, a253
    v_accvgpr_read_b32 v142, a254
    v_accvgpr_read_b32 v143, a255
    v_cvt_pk_bf16_f32 v152, v128, v129
    v_cvt_pk_bf16_f32 v153, v130, v131
    v_cvt_pk_bf16_f32 v154, v132, v133
    v_cvt_pk_bf16_f32 v155, v134, v135
    v_cvt_pk_bf16_f32 v156, v136, v137
    v_cvt_pk_bf16_f32 v157, v138, v139
    v_cvt_pk_bf16_f32 v158, v140, v141
    v_cvt_pk_bf16_f32 v159, v142, v143
    v_permlane32_swap_b32 v152, v154
    v_permlane32_swap_b32 v153, v155
    v_permlane32_swap_b32 v156, v158
    v_permlane32_swap_b32 v157, v159
    s_mul_i32 s72, s76, 1048576
    s_lshl_b32 s73, s75, 12
    s_add_u32 s72, s72, s73
    s_add_u32 s72, s72, 796672
    s_add_u32 s62, s60, s72
    s_addc_u32 s63, s61, 0
    global_store_dwordx4 v8, v[152:155], s[62:63] sc1
    global_store_dwordx4 v8, v[156:159], s[62:63] offset:512 sc1
    s_waitcnt vmcnt(0)
    s_barrier
    s_cmp_lg_u32 s16, 0
    s_cbranch_scc1 L_wk_ks
    s_lshl_b32 s18, s21, 2
    s_add_u32 s18, s18, 64
    v_mov_b32 v10, s18
    v_mov_b32 v11, 1
    s_mov_b64 exec, 1
    global_atomic_add v10, v11, s[6:7] sc1
    s_mov_b64 exec, -1
L_wk_ks:
    s_branch L_wk_next
L_wk_v:
    s_sub_u32 s18, s18, 16
    s_load_dwordx2 s[10:11], s[0:1], 32
    s_waitcnt lgkmcnt(0)
    s_mov_b32 s48, s8
    s_mov_b32 s49, s9
    s_mov_b32 s50, 2359296
    s_mov_b32 s51, 0x00020000
    s_mov_b32 s52, s10
    s_mov_b32 s53, s11
    s_mov_b32 s54, 4718592
    s_mov_b32 s55, 0x00020000
    s_mov_b32 s56, s10
    s_mov_b32 s57, s11
    s_mov_b32 s58, 4718592
    s_mov_b32 s59, 0x00020000
    s_mov_b32 s65, 8192
    v_lshrrev_b32 v10, 4, v1
    v_mul_lo_u32 v3, v10, s65
    v_lshlrev_b32 v10, 2, v10
    v_and_b32 v11, 15, v1
    v_xor_b32 v10, v10, v11
    v_lshl_add_u32 v3, v10, 4, v3
    s_mul_i32 s68, s21, 294912
    s_lshl_b32 s66, s18, 9
    s_add_u32 s67, s66, 256
    s_lshl_b32 s72, s21, 21
    s_lshl_b32 s73, s18, 14
    s_add_u32 s72, s72, s73
    s_add_u32 s60, s4, 0x1000000
    s_addc_u32 s61, s5, 0
    s_add_u32 s60, s60, s72
    s_addc_u32 s61, s61, 0
    s_mov_b32 s70, 0
    s_mov_b32 s71, 0
    s_mul_i32 s72, s16, 73728
    s_add_u32 s68, s68, s72
    s_lshl_b32 s80, s65, 2
    s_mul_i32 s72, s16, s80
    s_lshl_b32 s72, s72, 1
    s_add_u32 s66, s66, s72
    s_add_u32 s67, s67, s72
    s_mul_i32 s78, s16, 4096
    s_lshl_b32 s81, s16, 11
    s_add_u32 s81, s81, 16384
    s_lshl_b32 s82, s65, 5
    s_add_u32 s77, s70, s78
    s_add_u32 s79, s70, s81
    s_mov_b32 m0, s77
    s_nop 0
    buffer_load_dwordx4 v2, s[48:51], s68 offen lds
    s_add_u32 m0, s77, 1024
    s_add_u32 s73, s68, 18432
    buffer_load_dwordx4 v2, s[48:51], s73 offen lds
    s_add_u32 m0, s77, 2048
    s_add_u32 s73, s68, 36864
    buffer_load_dwordx4 v2, s[48:51], s73 offen lds
    s_add_u32 m0, s77, 3072
    s_add_u32 s73, s68, 55296
    buffer_load_dwordx4 v2, s[48:51], s73 offen lds
    s_add_u32 m0, s79, 0
    s_nop 0
    buffer_load_dwordx4 v3, s[52:55], s66 offen lds
    s_add_u32 m0, s79, 1024
    s_add_u32 s73, s66, s80
    buffer_load_dwordx4 v3, s[52:55], s73 offen lds
    s_add_u32 m0, s79, 8192
    s_nop 0
    buffer_load_dwordx4 v3, s[56:59], s67 offen lds
    s_add_u32 m0, s79, 9216
    s_add_u32 s73, s67, s80
    buffer_load_dwordx4 v3, s[56:59], s73 offen lds
    s_add_u32 s68, s68, 64
    s_add_u32 s66, s66, s82
    s_add_u32 s67, s67, s82
    s_add_u32 s70, s70, 32768
    s_cmp_eq_u32 s70, 131072
    s_cselect_b32 s70, 0, s70
    s_add_u32 s77, s70, s78
    s_add_u32 s79, s70, s81
    s_mov_b32 m0, s77
    s_nop 0
    buffer_load_dwordx4 v2, s[48:51], s68 offen lds
    s_add_u32 m0, s77, 1024
    s_add_u32 s73, s68, 18432
    buffer_load_dwordx4 v2, s[48:51], s73 offen lds
    s_add_u32 m0, s77, 2048
    s_add_u32 s73, s68, 36864
    buffer_load_dwordx4 v2, s[48:51], s73 offen lds
    s_add_u32 m0, s77, 3072
    s_add_u32 s73, s68, 55296
    buffer_load_dwordx4 v2, s[48:51], s73 offen lds
    s_add_u32 m0, s79, 0
    s_nop 0
    buffer_load_dwordx4 v3, s[52:55], s66 offen lds
    s_add_u32 m0, s79, 1024
    s_add_u32 s73, s66, s80
    buffer_load_dwordx4 v3, s[52:55], s73 offen lds
    s_add_u32 m0, s79, 8192
    s_nop 0
    buffer_load_dwordx4 v3, s[56:59], s67 offen lds
    s_add_u32 m0, s79, 9216
    s_add_u32 s73, s67, s80
    buffer_load_dwordx4 v3, s[56:59], s73 offen lds
    s_add_u32 s68, s68, 64
    s_add_u32 s66, s66, s82
    s_add_u32 s67, s67, s82
    s_add_u32 s70, s70, 32768
    s_cmp_eq_u32 s70, 131072
    s_cselect_b32 s70, 0, s70
    s_add_u32 s77, s70, s78
    s_add_u32 s79, s70, s81
    s_mov_b32 m0, s77
    s_nop 0
    buffer_load_dwordx4 v2, s[48:51], s68 offen lds
    s_add_u32 m0, s77, 1024
    s_add_u32 s73, s68, 18432
    buffer_load_dwordx4 v2, s[48:51], s73 offen lds
    s_add_u32 m0, s77, 2048
    s_add_u32 s73, s68, 36864
    buffer_load_dwordx4 v2, s[48:51], s73 offen lds
    s_add_u32 m0, s77, 3072
    s_add_u32 s73, s68, 55296
    buffer_load_dwordx4 v2, s[48:51], s73 offen lds
    s_add_u32 m0, s79, 0
    s_nop 0
    buffer_load_dwordx4 v3, s[52:55], s66 offen lds
    s_add_u32 m0, s79, 1024
    s_add_u32 s73, s66, s80
    buffer_load_dwordx4 v3, s[52:55], s73 offen lds
    s_add_u32 m0, s79, 8192
    s_nop 0
    buffer_load_dwordx4 v3, s[56:59], s67 offen lds
    s_add_u32 m0, s79, 9216
    s_add_u32 s73, s67, s80
    buffer_load_dwordx4 v3, s[56:59], s73 offen lds
    s_add_u32 s68, s68, 64
    s_add_u32 s66, s66, s82
    s_add_u32 s67, s67, s82
    s_add_u32 s70, s70, 32768
    s_cmp_eq_u32 s70, 131072
    s_cselect_b32 s70, 0, s70
    s_add_u32 s77, s70, s78
    s_add_u32 s79, s70, s81
    s_mov_b32 m0, s77
    s_nop 0
    buffer_load_dwordx4 v2, s[48:51], s68 offen lds
    s_add_u32 m0, s77, 1024
    s_add_u32 s73, s68, 18432
    buffer_load_dwordx4 v2, s[48:51], s73 offen lds
    s_add_u32 m0, s77, 2048
    s_add_u32 s73, s68, 36864
    buffer_load_dwordx4 v2, s[48:51], s73 offen lds
    s_add_u32 m0, s77, 3072
    s_add_u32 s73, s68, 55296
    buffer_load_dwordx4 v2, s[48:51], s73 offen lds
    s_add_u32 m0, s79, 0
    s_nop 0
    buffer_load_dwordx4 v3, s[52:55], s66 offen lds
    s_add_u32 m0, s79, 1024
    s_add_u32 s73, s66, s80
    buffer_load_dwordx4 v3, s[52:55], s73 offen lds
    s_add_u32 m0, s79, 8192
    s_nop 0
    buffer_load_dwordx4 v3, s[56:59], s67 offen lds
    s_add_u32 m0, s79, 9216
    s_add_u32 s73, s67, s80
    buffer_load_dwordx4 v3, s[56:59], s73 offen lds
    s_add_u32 s68, s68, 64
    s_add_u32 s66, s66, s82
    s_add_u32 s67, s67, s82
    s_add_u32 s70, s70, 32768
    s_cmp_eq_u32 s70, 131072
    s_cselect_b32 s70, 0, s70
    v_accvgpr_write_b32 a0, 0
    v_accvgpr_write_b32 a1, 0
    v_accvgpr_write_b32 a2, 0
    v_accvgpr_write_b32 a3, 0
    v_accvgpr_write_b32 a4, 0
    v_accvgpr_write_b32 a5, 0
    v_accvgpr_write_b32 a6, 0
    v_accvgpr_write_b32 a7, 0
    v_accvgpr_write_b32 a8, 0
    v_accvgpr_write_b32 a9, 0
    v_accvgpr_write_b32 a10, 0
    v_accvgpr_write_b32 a11, 0
    v_accvgpr_write_b32 a12, 0
    v_accvgpr_write_b32 a13, 0
    v_accvgpr_write_b32 a14, 0
    v_accvgpr_write_b32 a15, 0
    v_accvgpr_write_b32 a16, 0
    v_accvgpr_write_b32 a17, 0
    v_accvgpr_write_b32 a18, 0
    v_accvgpr_write_b32 a19, 0
    v_accvgpr_write_b32 a20, 0
    v_accvgpr_write_b32 a21, 0
    v_accvgpr_write_b32 a22, 0
    v_accvgpr_write_b32 a23, 0
    v_accvgpr_write_b32 a24, 0
    v_accvgpr_write_b32 a25, 0
    v_accvgpr_write_b32 a26, 0
    v_accvgpr_write_b32 a27, 0
    v_accvgpr_write_b32 a28, 0
    v_accvgpr_write_b32 a29, 0
    v_accvgpr_write_b32 a30, 0
    v_accvgpr_write_b32 a31, 0
    v_accvgpr_write_b32 a32, 0
    v_accvgpr_write_b32 a33, 0
    v_accvgpr_write_b32 a34, 0
    v_accvgpr_write_b32 a35, 0
    v_accvgpr_write_b32 a36, 0
    v_accvgpr_write_b32 a37, 0
    v_accvgpr_write_b32 a38, 0
    v_accvgpr_write_b32 a39, 0
    v_accvgpr_write_b32 a40, 0
    v_accvgpr_write_b32 a41, 0
    v_accvgpr_write_b32 a42, 0
    v_accvgpr_write_b32 a43, 0
    v_accvgpr_write_b32 a44, 0
    v_accvgpr_write_b32 a45, 0
    v_accvgpr_write_b32 a46, 0
    v_accvgpr_write_b32 a47, 0
    v_accvgpr_write_b32 a48, 0
    v_accvgpr_write_b32 a49, 0
    v_accvgpr_write_b32 a50, 0
    v_accvgpr_write_b32 a51, 0
    v_accvgpr_write_b32 a52, 0
    v_accvgpr_write_b32 a53, 0
    v_accvgpr_write_b32 a54, 0
    v_accvgpr_write_b32 a55, 0
    v_accvgpr_write_b32 a56, 0
    v_accvgpr_write_b32 a57, 0
    v_accvgpr_write_b32 a58, 0
    v_accvgpr_write_b32 a59, 0
    v_accvgpr_write_b32 a60, 0
    v_accvgpr_write_b32 a61, 0
    v_accvgpr_write_b32 a62, 0
    v_accvgpr_write_b32 a63, 0
    v_accvgpr_write_b32 a64, 0
    v_accvgpr_write_b32 a65, 0
    v_accvgpr_write_b32 a66, 0
    v_accvgpr_write_b32 a67, 0
    v_accvgpr_write_b32 a68, 0
    v_accvgpr_write_b32 a69, 0
    v_accvgpr_write_b32 a70, 0
    v_accvgpr_write_b32 a71, 0
    v_accvgpr_write_b32 a72, 0
    v_accvgpr_write_b32 a73, 0
    v_accvgpr_write_b32 a74, 0
    v_accvgpr_write_b32 a75, 0
    v_accvgpr_write_b32 a76, 0
    v_accvgpr_write_b32 a77, 0
    v_accvgpr_write_b32 a78, 0
    v_accvgpr_write_b32 a79, 0
    v_accvgpr_write_b32 a80, 0
    v_accvgpr_write_b32 a81, 0
    v_accvgpr_write_b32 a82, 0
    v_accvgpr_write_b32 a83, 0
    v_accvgpr_write_b32 a84, 0
    v_accvgpr_write_b32 a85, 0
    v_accvgpr_write_b32 a86, 0
    v_accvgpr_write_b32 a87, 0
    v_accvgpr_write_b32 a88, 0
    v_accvgpr_write_b32 a89, 0
    v_accvgpr_write_b32 a90, 0
    v_accvgpr_write_b32 a91, 0
    v_accvgpr_write_b32 a92, 0
    v_accvgpr_write_b32 a93, 0
    v_accvgpr_write_b32 a94, 0
    v_accvgpr_write_b32 a95, 0
    v_accvgpr_write_b32 a96, 0
    v_accvgpr_write_b32 a97, 0
    v_accvgpr_write_b32 a98, 0
    v_accvgpr_write_b32 a99, 0
    v_accvgpr_write_b32 a100, 0
    v_accvgpr_write_b32 a101, 0
    v_accvgpr_write_b32 a102, 0
    v_accvgpr_write_b32 a103, 0
    v_accvgpr_write_b32 a104, 0
    v_accvgpr_write_b32 a105, 0
    v_accvgpr_write_b32 a106, 0
    v_accvgpr_write_b32 a107, 0
    v_accvgpr_write_b32 a108, 0
    v_accvgpr_write_b32 a109, 0
    v_accvgpr_write_b32 a110, 0
    v_accvgpr_write_b32 a111, 0
    v_accvgpr_write_b32 a112, 0
    v_accvgpr_write_b32 a113, 0
    v_accvgpr_write_b32 a114, 0
    v_accvgpr_write_b32 a115, 0
    v_accvgpr_write_b32 a116, 0
    v_accvgpr_write_b32 a117, 0
    v_accvgpr_write_b32 a118, 0
    v_accvgpr_write_b32 a119, 0
    v_accvgpr_write_b32 a120, 0
    v_accvgpr_write_b32 a121, 0
    v_accvgpr_write_b32 a122, 0
    v_accvgpr_write_b32 a123, 0
    v_accvgpr_write_b32 a124, 0
    v_accvgpr_write_b32 a125, 0
    v_accvgpr_write_b32 a126, 0
    v_accvgpr_write_b32 a127, 0
    v_accvgpr_write_b32 a128, 0
    v_accvgpr_write_b32 a129, 0
    v_accvgpr_write_b32 a130, 0
    v_accvgpr_write_b32 a131, 0
    v_accvgpr_write_b32 a132, 0
    v_accvgpr_write_b32 a133, 0
    v_accvgpr_write_b32 a134, 0
    v_accvgpr_write_b32 a135, 0
    v_accvgpr_write_b32 a136, 0
    v_accvgpr_write_b32 a137, 0
    v_accvgpr_write_b32 a138, 0
    v_accvgpr_write_b32 a139, 0
    v_accvgpr_write_b32 a140, 0
    v_accvgpr_write_b32 a141, 0
    v_accvgpr_write_b32 a142, 0
    v_accvgpr_write_b32 a143, 0
    v_accvgpr_write_b32 a144, 0
    v_accvgpr_write_b32 a145, 0
    v_accvgpr_write_b32 a146, 0
    v_accvgpr_write_b32 a147, 0
    v_accvgpr_write_b32 a148, 0
    v_accvgpr_write_b32 a149, 0
    v_accvgpr_write_b32 a150, 0
    v_accvgpr_write_b32 a151, 0
    v_accvgpr_write_b32 a152, 0
    v_accvgpr_write_b32 a153, 0
    v_accvgpr_write_b32 a154, 0
    v_accvgpr_write_b32 a155, 0
    v_accvgpr_write_b32 a156, 0
    v_accvgpr_write_b32 a157, 0
    v_accvgpr_write_b32 a158, 0
    v_accvgpr_write_b32 a159, 0
    v_accvgpr_write_b32 a160, 0
    v_accvgpr_write_b32 a161, 0
    v_accvgpr_write_b32 a162, 0
    v_accvgpr_write_b32 a163, 0
    v_accvgpr_write_b32 a164, 0
    v_accvgpr_write_b32 a165, 0
    v_accvgpr_write_b32 a166, 0
    v_accvgpr_write_b32 a167, 0
    v_accvgpr_write_b32 a168, 0
    v_accvgpr_write_b32 a169, 0
    v_accvgpr_write_b32 a170, 0
    v_accvgpr_write_b32 a171, 0
    v_accvgpr_write_b32 a172, 0
    v_accvgpr_write_b32 a173, 0
    v_accvgpr_write_b32 a174, 0
    v_accvgpr_write_b32 a175, 0
    v_accvgpr_write_b32 a176, 0
    v_accvgpr_write_b32 a177, 0
    v_accvgpr_write_b32 a178, 0
    v_accvgpr_write_b32 a179, 0
    v_accvgpr_write_b32 a180, 0
    v_accvgpr_write_b32 a181, 0
    v_accvgpr_write_b32 a182, 0
    v_accvgpr_write_b32 a183, 0
    v_accvgpr_write_b32 a184, 0
    v_accvgpr_write_b32 a185, 0
    v_accvgpr_write_b32 a186, 0
    v_accvgpr_write_b32 a187, 0
    v_accvgpr_write_b32 a188, 0
    v_accvgpr_write_b32 a189, 0
    v_accvgpr_write_b32 a190, 0
    v_accvgpr_write_b32 a191, 0
    v_accvgpr_write_b32 a192, 0
    v_accvgpr_write_b32 a193, 0
    v_accvgpr_write_b32 a194, 0
    v_accvgpr_write_b32 a195, 0
    v_accvgpr_write_b32 a196, 0
    v_accvgpr_write_b32 a197, 0
    v_accvgpr_write_b32 a198, 0
    v_accvgpr_write_b32 a199, 0
    v_accvgpr_write_b32 a200, 0
    v_accvgpr_write_b32 a201, 0
    v_accvgpr_write_b32 a202, 0
    v_accvgpr_write_b32 a203, 0
    v_accvgpr_write_b32 a204, 0
    v_accvgpr_write_b32 a205, 0
    v_accvgpr_write_b32 a206, 0
    v_accvgpr_write_b32 a207, 0
    v_accvgpr_write_b32 a208, 0
    v_accvgpr_write_b32 a209, 0
    v_accvgpr_write_b32 a210, 0
    v_accvgpr_write_b32 a211, 0
    v_accvgpr_write_b32 a212, 0
    v_accvgpr_write_b32 a213, 0
    v_accvgpr_write_b32 a214, 0
    v_accvgpr_write_b32 a215, 0
    v_accvgpr_write_b32 a216, 0
    v_accvgpr_write_b32 a217, 0
    v_accvgpr_write_b32 a218, 0
    v_accvgpr_write_b32 a219, 0
    v_accvgpr_write_b32 a220, 0
    v_accvgpr_write_b32 a221, 0
    v_accvgpr_write_b32 a222, 0
    v_accvgpr_write_b32 a223, 0
    v_accvgpr_write_b32 a224, 0
    v_accvgpr_write_b32 a225, 0
    v_accvgpr_write_b32 a226, 0
    v_accvgpr_write_b32 a227, 0
    v_accvgpr_write_b32 a228, 0
    v_accvgpr_write_b32 a229, 0
    v_accvgpr_write_b32 a230, 0
    v_accvgpr_write_b32 a231, 0
    v_accvgpr_write_b32 a232, 0
    v_accvgpr_write_b32 a233, 0
    v_accvgpr_write_b32 a234, 0
    v_accvgpr_write_b32 a235, 0
    v_accvgpr_write_b32 a236, 0
    v_accvgpr_write_b32 a237, 0
    v_accvgpr_write_b32 a238, 0
    v_accvgpr_write_b32 a239, 0
    v_accvgpr_write_b32 a240, 0
    v_accvgpr_write_b32 a241, 0
    v_accvgpr_write_b32 a242, 0
    v_accvgpr_write_b32 a243, 0
    v_accvgpr_write_b32 a244, 0
    v_accvgpr_write_b32 a245, 0
    v_accvgpr_write_b32 a246, 0
    v_accvgpr_write_b32 a247, 0
    v_accvgpr_write_b32 a248, 0
    v_accvgpr_write_b32 a249, 0
    v_accvgpr_write_b32 a250, 0
    v_accvgpr_write_b32 a251, 0
    v_accvgpr_write_b32 a252, 0
    v_accvgpr_write_b32 a253, 0
    v_accvgpr_write_b32 a254, 0
    v_accvgpr_write_b32 a255, 0
    s_waitcnt vmcnt(24)
    s_barrier
    ds_read_b64_tr_b16 v[64:65], v6 offset:0
    ds_read_b64_tr_b16 v[66:67], v6 offset:1024
    ds_read_b64_tr_b16 v[68:69], v7 offset:0
    ds_read_b64_tr_b16 v[70:71], v7 offset:1024
    ds_read_b64_tr_b16 v[72:73], v6 offset:8192
    ds_read_b64_tr_b16 v[74:75], v6 offset:9216
    ds_read_b64_tr_b16 v[76:77], v7 offset:8192
    ds_read_b64_tr_b16 v[78:79], v7 offset:9216
    ds_read_b128 v[80:83], v4 offset:0
    ds_read_b128 v[84:87], v4 offset:2048
    ds_read_b128 v[88:91], v4 offset:4096
    ds_read_b128 v[92:95], v4 offset:6144
    s_mov_b32 s69, 0
    s_waitcnt lgkmcnt(0)
L_g1_loopv:
    v_mfma_f32_32x32x16_bf16 a[0:15], v[80:83], v[64:67], a[0:15]
    ds_read_b64_tr_b16 v[96:97], v6 offset:4096
    v_mfma_f32_32x32x16_bf16 a[64:79], v[80:83], v[68:71], a[64:79]
    ds_read_b64_tr_b16 v[98:99], v6 offset:5120
    v_mfma_f32_32x32x16_bf16 a[128:143], v[80:83], v[72:75], a[128:143]
    ds_read_b64_tr_b16 v[100:101], v7 offset:4096
    v_mfma_f32_32x32x16_bf16 a[192:207], v[80:83], v[76:79], a[192:207]
    ds_read_b64_tr_b16 v[102:103], v7 offset:5120
    v_mfma_f32_32x32x16_bf16 a[16:31], v[84:87], v[64:67], a[16:31]
    ds_read_b64_tr_b16 v[104:105], v6 offset:12288
    v_mfma_f32_32x32x16_bf16 a[80:95], v[84:87], v[68:71], a[80:95]
    ds_read_b64_tr_b16 v[106:107], v6 offset:13312
    v_mfma_f32_32x32x16_bf16 a[144:159], v[84:87], v[72:75], a[144:159]
    ds_read_b64_tr_b16 v[108:109], v7 offset:12288
    v_mfma_f32_32x32x16_bf16 a[208:223], v[84:87], v[76:79], a[208:223]
    ds_read_b64_tr_b16 v[110:111], v7 offset:13312
    v_mfma_f32_32x32x16_bf16 a[32:47], v[88:91], v[64:67], a[32:47]
    ds_read_b128 v[112:115], v5 offset:0
    v_mfma_f32_32x32x16_bf16 a[96:111], v[88:91], v[68:71], a[96:111]
    ds_read_b128 v[116:119], v5 offset:2048
    v_mfma_f32_32x32x16_bf16 a[160:175], v[88:91], v[72:75], a[160:175]
    ds_read_b128 v[120:123], v5 offset:4096
    v_mfma_f32_32x32x16_bf16 a[224:239], v[88:91], v[76:79], a[224:239]
    ds_read_b128 v[124:127], v5 offset:6144
    v_mfma_f32_32x32x16_bf16 a[48:63], v[92:95], v[64:67], a[48:63]
    v_mfma_f32_32x32x16_bf16 a[112:127], v[92:95], v[68:71], a[112:127]
    v_mfma_f32_32x32x16_bf16 a[176:191], v[92:95], v[72:75], a[176:191]
    v_mfma_f32_32x32x16_bf16 a[240:255], v[92:95], v[76:79], a[240:255]
    s_waitcnt lgkmcnt(0)
    s_cmp_lt_u32 s69, 15
    s_cbranch_scc1 L_g1_w8v
    s_waitcnt vmcnt(0)
    s_branch L_g1_wdv
L_g1_w8v:
    s_waitcnt vmcnt(16)
L_g1_wdv:
    s_barrier
    s_add_u32 s71, s71, 32768
    s_cmp_eq_u32 s71, 131072
    s_mov_b32 s72, 32768
    s_cselect_b32 s72, 0xfffe8000, s72
    s_cselect_b32 s71, 0, s71
    v_add_u32 v4, s72, v4
    v_add_u32 v5, s72, v5
    v_add_u32 v6, s72, v6
    v_add_u32 v7, s72, v7
    s_cmp_lt_u32 s69, 14
    s_cbranch_scc0 L_g1_nodmav
    v_mfma_f32_32x32x16_bf16 a[0:15], v[112:115], v[96:99], a[0:15]
    ds_read_b64_tr_b16 v[64:65], v6 offset:0
    v_mfma_f32_32x32x16_bf16 a[64:79], v[112:115], v[100:103], a[64:79]
    ds_read_b64_tr_b16 v[66:67], v6 offset:1024
    s_add_u32 s77, s70, s78
    s_add_u32 s79, s70, s81
    s_mov_b32 m0, s77
    s_nop 0
    buffer_load_dwordx4 v2, s[48:51], s68 offen lds
    v_mfma_f32_32x32x16_bf16 a[128:143], v[112:115], v[104:107], a[128:143]
    ds_read_b64_tr_b16 v[68:69], v7 offset:0
    v_mfma_f32_32x32x16_bf16 a[192:207], v[112:115], v[108:111], a[192:207]
    ds_read_b64_tr_b16 v[70:71], v7 offset:1024
    s_add_u32 m0, s77, 1024
    s_add_u32 s73, s68, 18432
    buffer_load_dwordx4 v2, s[48:51], s73 offen lds
    v_mfma_f32_32x32x16_bf16 a[16:31], v[116:119], v[96:99], a[16:31]
    ds_read_b64_tr_b16 v[72:73], v6 offset:8192
    v_mfma_f32_32x32x16_bf16 a[80:95], v[116:119], v[100:103], a[80:95]
    ds_read_b64_tr_b16 v[74:75], v6 offset:9216
    s_add_u32 m0, s77, 2048
    s_add_u32 s73, s68, 36864
    buffer_load_dwordx4 v2, s[48:51], s73 offen lds
    v_mfma_f32_32x32x16_bf16 a[144:159], v[116:119], v[104:107], a[144:159]
    ds_read_b64_tr_b16 v[76:77], v7 offset:8192
    v_mfma_f32_32x32x16_bf16 a[208:223], v[116:119], v[108:111], a[208:223]
    ds_read_b64_tr_b16 v[78:79], v7 offset:9216
    s_add_u32 m0, s77, 3072
    s_add_u32 s73, s68, 55296
    buffer_load_dwordx4 v2, s[48:51], s73 offen lds
    v_mfma_f32_32x32x16_bf16 a[32:47], v[120:123], v[96:99], a[32:47]
    ds_read_b128 v[80:83], v4 offset:0
    v_mfma_f32_32x32x16_bf16 a[96:111], v[120:123], v[100:103], a[96:111]
    ds_read_b128 v[84:87], v4 offset:2048
    s_add_u32 m0, s79, 0
    s_nop 0
    buffer_load_dwordx4 v3, s[52:55], s66 offen lds
    v_mfma_f32_32x32x16_bf16 a[160:175], v[120:123], v[104:107], a[160:175]
    ds_read_b128 v[88:91], v4 offset:4096
    v_mfma_f32_32x32x16_bf16 a[224:239], v[120:123], v[108:111], a[224:239]
    ds_read_b128 v[92:95], v4 offset:6144
    s_add_u32 m0, s79, 1024
    s_add_u32 s73, s66, s80
    buffer_load_dwordx4 v3, s[52:55], s73 offen lds
    v_mfma_f32_32x32x16_bf16 a[48:63], v[124:127], v[96:99], a[48:63]
    v_mfma_f32_32x32x16_bf16 a[112:127], v[124:127], v[100:103], a[112:127]
    s_add_u32 m0, s79, 8192
    s_nop 0
    buffer_load_dwordx4 v3, s[56:59], s67 offen lds
    v_mfma_f32_32x32x16_bf16 a[176:191], v[124:127], v[104:107], a[176:191]
    s_add_u32 m0, s79, 9216
    s_add_u32 s73, s67, s80
    buffer_load_dwordx4 v3, s[56:59], s73 offen lds
    v_mfma_f32_32x32x16_bf16 a[240:255], v[124:127], v[108:111], a[240:255]
    s_add_u32 s68, s68, 64
    s_add_u32 s66, s66, s82
    s_add_u32 s67, s67, s82
    s_add_u32 s70, s70, 32768
    s_cmp_eq_u32 s70, 131072
    s_cselect_b32 s70, 0, s70
    s_branch L_g1_jv
L_g1_nodmav:
    v_mfma_f32_32x32x16_bf16 a[0:15], v[112:115], v[96:99], a[0:15]
    ds_read_b64_tr_b16 v[64:65], v6 offset:0
    v_mfma_f32_32x32x16_bf16 a[64:79], v[112:115], v[100:103], a[64:79]
    ds_read_b64_tr_b16 v[66:67], v6 offset:1024
    v_mfma_f32_32x32x16_bf16 a[128:143], v[112:115], v[104:107], a[128:143]
    ds_read_b64_tr_b16 v[68:69], v7 offset:0
    v_mfma_f32_32x32x16_bf16 a[192:207], v[112:115], v[108:111], a[192:207]
    ds_read_b64_tr_b16 v[70:71], v7 offset:1024
    v_mfma_f32_32x32x16_bf16 a[16:31], v[116:119], v[96:99], a[16:31]
    ds_read_b64_tr_b16 v[72:73], v6 offset:8192
    v_mfma_f32_32x32x16_bf16 a[80:95], v[116:119], v[100:103], a[80:95]
    ds_read_b64_tr_b16 v[74:75], v6 offset:9216
    v_mfma_f32_32x32x16_bf16 a[144:159], v[116:119], v[104:107], a[144:159]
    ds_read_b64_tr_b16 v[76:77], v7 offset:8192
    v_mfma_f32_32x32x16_bf16 a[208:223], v[116:119], v[108:111], a[208:223]
    ds_read_b64_tr_b16 v[78:79], v7 offset:9216
    v_mfma_f32_32x32x16_bf16 a[32:47], v[120:123], v[96:99], a[32:47]
    ds_read_b128 v[80:83], v4 offset:0
    v_mfma_f32_32x32x16_bf16 a[96:111], v[120:123], v[100:103], a[96:111]
    ds_read_b128 v[84:87], v4 offset:2048
    v_mfma_f32_32x32x16_bf16 a[160:175], v[120:123], v[104:107], a[160:175]
    ds_read_b128 v[88:91], v4 offset:4096
    v_mfma_f32_32x32x16_bf16 a[224:239], v[120:123], v[108:111], a[224:239]
    ds_read_b128 v[92:95], v4 offset:6144
    v_mfma_f32_32x32x16_bf16 a[48:63], v[124:127], v[96:99], a[48:63]
    v_mfma_f32_32x32x16_bf16 a[112:127], v[124:127], v[100:103], a[112:127]
    v_mfma_f32_32x32x16_bf16 a[176:191], v[124:127], v[104:107], a[176:191]
    v_mfma_f32_32x32x16_bf16 a[240:255], v[124:127], v[108:111], a[240:255]
L_g1_jv:
    s_waitcnt lgkmcnt(0)
    s_add_u32 s69, s69, 1
    s_cmp_lt_u32 s69, 18
    s_cbranch_scc1 L_g1_loopv
    v_subrev_u32 v4, 65536, v4
    v_subrev_u32 v5, 65536, v5
    v_subrev_u32 v6, 65536, v6
    v_subrev_u32 v7, 65536, v7
    s_nop 15
    v_accvgpr_read_b32 v128, a0
    v_accvgpr_read_b32 v129, a1
    v_accvgpr_read_b32 v130, a2
    v_accvgpr_read_b32 v131, a3
    v_accvgpr_read_b32 v132, a4
    v_accvgpr_read_b32 v133, a5
    v_accvgpr_read_b32 v134, a6
    v_accvgpr_read_b32 v135, a7
    v_accvgpr_read_b32 v136, a8
    v_accvgpr_read_b32 v137, a9
    v_accvgpr_read_b32 v138, a10
    v_accvgpr_read_b32 v139, a11
    v_accvgpr_read_b32 v140, a12
    v_accvgpr_read_b32 v141, a13
    v_accvgpr_read_b32 v142, a14
    v_accvgpr_read_b32 v143, a15
    v_cvt_pk_bf16_f32 v144, v128, v129
    v_cvt_pk_bf16_f32 v145, v130, v131
    v_cvt_pk_bf16_f32 v146, v132, v133
    v_cvt_pk_bf16_f32 v147, v134, v135
    v_cvt_pk_bf16_f32 v148, v136, v137
    v_cvt_pk_bf16_f32 v149, v138, v139
    v_cvt_pk_bf16_f32 v150, v140, v141
    v_cvt_pk_bf16_f32 v151, v142, v143
    v_permlane32_swap_b32 v144, v146
    v_permlane32_swap_b32 v145, v147
    v_permlane32_swap_b32 v148, v150
    v_permlane32_swap_b32 v149, v151
    s_mul_i32 s72, s76, 1048576
    s_lshl_b32 s73, s75, 12
    s_add_u32 s72, s72, s73
    s_add_u32 s72, s72, 0
    s_add_u32 s62, s60, s72
    s_addc_u32 s63, s61, 0
    global_store_dwordx4 v9, v[144:147], s[62:63] sc1
    global_store_dwordx4 v9, v[148:151], s[62:63] offset:512 sc1
    v_accvgpr_read_b32 v128, a16
    v_accvgpr_read_b32 v129, a17
    v_accvgpr_read_b32 v130, a18
    v_accvgpr_read_b32 v131, a19
    v_accvgpr_read_b32 v132, a20
    v_accvgpr_read_b32 v133, a21
    v_accvgpr_read_b32 v134, a22
    v_accvgpr_read_b32 v135, a23
    v_accvgpr_read_b32 v136, a24
    v_accvgpr_read_b32 v137, a25
    v_accvgpr_read_b32 v138, a26
    v_accvgpr_read_b32 v139, a27
    v_accvgpr_read_b32 v140, a28
    v_accvgpr_read_b32 v141, a29
    v_accvgpr_read_b32 v142, a30
    v_accvgpr_read_b32 v143, a31
    v_cvt_pk_bf16_f32 v152, v128, v129
    v_cvt_pk_bf16_f32 v153, v130, v131
    v_cvt_pk_bf16_f32 v154, v132, v133
    v_cvt_pk_bf16_f32 v155, v134, v135
    v_cvt_pk_bf16_f32 v156, v136, v137
    v_cvt_pk_bf16_f32 v157, v138, v139
    v_cvt_pk_bf16_f32 v158, v140, v141
    v_cvt_pk_bf16_f32 v159, v142, v143
    v_permlane32_swap_b32 v152, v154
    v_permlane32_swap_b32 v153, v155
    v_permlane32_swap_b32 v156, v158
    v_permlane32_swap_b32 v157, v159
    s_mul_i32 s72, s76, 1048576
    s_lshl_b32 s73, s75, 12
    s_add_u32 s72, s72, s73
    s_add_u32 s72, s72, 262144
    s_add_u32 s62, s60, s72
    s_addc_u32 s63, s61, 0
    global_store_dwordx4 v9, v[152:155], s[62:63] sc1
    global_store_dwordx4 v9, v[156:159], s[62:63] offset:512 sc1
    v_accvgpr_read_b32 v128, a32
    v_accvgpr_read_b32 v129, a33
    v_accvgpr_read_b32 v130, a34
    v_accvgpr_read_b32 v131, a35
    v_accvgpr_read_b32 v132, a36
    v_accvgpr_read_b32 v133, a37
    v_accvgpr_read_b32 v134, a38
    v_accvgpr_read_b32 v135, a39
    v_accvgpr_read_b32 v136, a40
    v_accvgpr_read_b32 v137, a41
    v_accvgpr_read_b32 v138, a42
    v_accvgpr_read_b32 v139, a43
    v_accvgpr_read_b32 v140, a44
    v_accvgpr_read_b32 v141, a45
    v_accvgpr_read_b32 v142, a46
    v_accvgpr_read_b32 v143, a47
    v_cvt_pk_bf16_f32 v144, v128, v129
    v_cvt_pk_bf16_f32 v145, v130, v131
    v_cvt_pk_bf16_f32 v146, v132, v133
    v_cvt_pk_bf16_f32 v147, v134, v135
    v_cvt_pk_bf16_f32 v148, v136, v137
    v_cvt_pk_bf16_f32 v149, v138, v139
    v_cvt_pk_bf16_f32 v150, v140, v141
    v_cvt_pk_bf16_f32 v151, v142, v143
    v_permlane32_swap_b32 v144, v146
    v_permlane32_swap_b32 v145, v147
    v_permlane32_swap_b32 v148, v150
    v_permlane32_swap_b32 v149, v151
    s_mul_i32 s72, s76, 1048576
    s_lshl_b32 s73, s75, 12
    s_add_u32 s72, s72, s73
    s_add_u32 s72, s72, 524288
    s_add_u32 s62, s60, s72
    s_addc_u32 s63, s61, 0
    global_store_dwordx4 v9, v[144:147], s[62:63] sc1
    global_store_dwordx4 v9, v[148:151], s[62:63] offset:512 sc1
    v_accvgpr_read_b32 v128, a48
    v_accvgpr_read_b32 v129, a49
    v_accvgpr_read_b32 v130, a50
    v_accvgpr_read_b32 v131, a51
    v_accvgpr_read_b32 v132, a52
    v_accvgpr_read_b32 v133, a53
    v_accvgpr_read_b32 v134, a54
    v_accvgpr_read_b32 v135, a55
    v_accvgpr_read_b32 v136, a56
    v_accvgpr_read_b32 v137, a57
    v_accvgpr_read_b32 v138, a58
    v_accvgpr_read_b32 v139, a59
    v_accvgpr_read_b32 v140, a60
    v_accvgpr_read_b32 v141, a61
    v_accvgpr_read_b32 v142, a62
    v_accvgpr_read_b32 v143, a63
    v_cvt_pk_bf16_f32 v152, v128, v129
    v_cvt_pk_bf16_f32 v153, v130, v131
    v_cvt_pk_bf16_f32 v154, v132, v133
    v_cvt_pk_bf16_f32 v155, v134, v135
    v_cvt_pk_bf16_f32 v156, v136, v137
    v_cvt_pk_bf16_f32 v157, v138, v139
    v_cvt_pk_bf16_f32 v158, v140, v141
    v_cvt_pk_bf16_f32 v159, v142, v143
    v_permlane32_swap_b32 v152, v154
    v_permlane32_swap_b32 v153, v155
    v_permlane32_swap_b32 v156, v158
    v_permlane32_swap_b32 v157, v159
    s_mul_i32 s72, s76, 1048576
    s_lshl_b32 s73, s75, 12
    s_add_u32 s72, s72, s73
    s_add_u32 s72, s72, 786432
    s_add_u32 s62, s60, s72
    s_addc_u32 s63, s61, 0
    global_store_dwordx4 v9, v[152:155], s[62:63] sc1
    global_store_dwordx4 v9, v[156:159], s[62:63] offset:512 sc1
    v_accvgpr_read_b32 v128, a64
    v_accvgpr_read_b32 v129, a65
    v_accvgpr_read_b32 v130, a66
    v_accvgpr_read_b32 v131, a67
    v_accvgpr_read_b32 v132, a68
    v_accvgpr_read_b32 v133, a69
    v_accvgpr_read_b32 v134, a70
    v_accvgpr_read_b32 v135, a71
    v_accvgpr_read_b32 v136, a72
    v_accvgpr_read_b32 v137, a73
    v_accvgpr_read_b32 v138, a74
    v_accvgpr_read_b32 v139, a75
    v_accvgpr_read_b32 v140, a76
    v_accvgpr_read_b32 v141, a77
    v_accvgpr_read_b32 v142, a78
    v_accvgpr_read_b32 v143, a79
    v_cvt_pk_bf16_f32 v144, v128, v129
    v_cvt_pk_bf16_f32 v145, v130, v131
    v_cvt_pk_bf16_f32 v146, v132, v133
    v_cvt_pk_bf16_f32 v147, v134, v135
    v_cvt_pk_bf16_f32 v148, v136, v137
    v_cvt_pk_bf16_f32 v149, v138, v139
    v_cvt_pk_bf16_f32 v150, v140, v141
    v_cvt_pk_bf16_f32 v151, v142, v143
    v_permlane32_swap_b32 v144, v146
    v_permlane32_swap_b32 v145, v147
    v_permlane32_swap_b32 v148, v150
    v_permlane32_swap_b32 v149, v151
    s_mul_i32 s72, s76, 1048576
    s_lshl_b32 s73, s75, 12
    s_add_u32 s72, s72, s73
    s_add_u32 s72, s72, 2048
    s_add_u32 s62, s60, s72
    s_addc_u32 s63, s61, 0
    global_store_dwordx4 v9, v[144:147], s[62:63] sc1
    global_store_dwordx4 v9, v[148:151], s[62:63] offset:512 sc1
    v_accvgpr_read_b32 v128, a80
    v_accvgpr_read_b32 v129, a81
    v_accvgpr_read_b32 v130, a82
    v_accvgpr_read_b32 v131, a83
    v_accvgpr_read_b32 v132, a84
    v_accvgpr_read_b32 v133, a85
    v_accvgpr_read_b32 v134, a86
    v_accvgpr_read_b32 v135, a87
    v_accvgpr_read_b32 v136, a88
    v_accvgpr_read_b32 v137, a89
    v_accvgpr_read_b32 v138, a90
    v_accvgpr_read_b32 v139, a91
    v_accvgpr_read_b32 v140, a92
    v_accvgpr_read_b32 v141, a93
    v_accvgpr_read_b32 v142, a94
    v_accvgpr_read_b32 v143, a95
    v_cvt_pk_bf16_f32 v152, v128, v129
    v_cvt_pk_bf16_f32 v153, v130, v131
    v_cvt_pk_bf16_f32 v154, v132, v133
    v_cvt_pk_bf16_f32 v155, v134, v135
    v_cvt_pk_bf16_f32 v156, v136, v137
    v_cvt_pk_bf16_f32 v157, v138, v139
    v_cvt_pk_bf16_f32 v158, v140, v141
    v_cvt_pk_bf16_f32 v159, v142, v143
    v_permlane32_swap_b32 v152, v154
    v_permlane32_swap_b32 v153, v155
    v_permlane32_swap_b32 v156, v158
    v_permlane32_swap_b32 v157, v159
    s_mul_i32 s72, s76, 1048576
    s_lshl_b32 s73, s75, 12
    s_add_u32 s72, s72, s73
    s_add_u32 s72, s72, 264192
    s_add_u32 s62, s60, s72
    s_addc_u32 s63, s61, 0
    global_store_dwordx4 v9, v[152:155], s[62:63] sc1
    global_store_dwordx4 v9, v[156:159], s[62:63] offset:512 sc1
    v_accvgpr_read_b32 v128, a96
    v_accvgpr_read_b32 v129, a97
    v_accvgpr_read_b32 v130, a98
    v_accvgpr_read_b32 v131, a99
    v_accvgpr_read_b32 v132, a100
    v_accvgpr_read_b32 v133, a101
    v_accvgpr_read_b32 v134, a102
    v_accvgpr_read_b32 v135, a103
    v_accvgpr_read_b32 v136, a104
    v_accvgpr_read_b32 v137, a105
    v_accvgpr_read_b32 v138, a106
    v_accvgpr_read_b32 v139, a107
    v_accvgpr_read_b32 v140, a108
    v_accvgpr_read_b32 v141, a109
    v_accvgpr_read_b32 v142, a110
    v_accvgpr_read_b32 v143, a111
    v_cvt_pk_bf16_f32 v144, v128, v129
    v_cvt_pk_bf16_f32 v145, v130, v131
    v_cvt_pk_bf16_f32 v146, v132, v133
    v_cvt_pk_bf16_f32 v147, v134, v135
    v_cvt_pk_bf16_f32 v148, v136, v137
    v_cvt_pk_bf16_f32 v149, v138, v139
    v_cvt_pk_bf16_f32 v150, v140, v141
    v_cvt_pk_bf16_f32 v151, v142, v143
    v_permlane32_swap_b32 v144, v146
    v_permlane32_swap_b32 v145, v147
    v_permlane32_swap_b32 v148, v150
    v_permlane32_swap_b32 v149, v151
    s_mul_i32 s72, s76, 1048576
    s_lshl_b32 s73, s75, 12
    s_add_u32 s72, s72, s73
    s_add_u32 s72, s72, 526336
    s_add_u32 s62, s60, s72
    s_addc_u32 s63, s61, 0
    global_store_dwordx4 v9, v[144:147], s[62:63] sc1
    global_store_dwordx4 v9, v[148:151], s[62:63] offset:512 sc1
    v_accvgpr_read_b32 v128, a112
    v_accvgpr_read_b32 v129, a113
    v_accvgpr_read_b32 v130, a114
    v_accvgpr_read_b32 v131, a115
    v_accvgpr_read_b32 v132, a116
    v_accvgpr_read_b32 v133, a117
    v_accvgpr_read_b32 v134, a118
    v_accvgpr_read_b32 v135, a119
    v_accvgpr_read_b32 v136, a120
    v_accvgpr_read_b32 v137, a121
    v_accvgpr_read_b32 v138, a122
    v_accvgpr_read_b32 v139, a123
    v_accvgpr_read_b32 v140, a124
    v_accvgpr_read_b32 v141, a125
    v_accvgpr_read_b32 v142, a126
    v_accvgpr_read_b32 v143, a127
    v_cvt_pk_bf16_f32 v152, v128, v129
    v_cvt_pk_bf16_f32 v153, v130, v131
    v_cvt_pk_bf16_f32 v154, v132, v133
    v_cvt_pk_bf16_f32 v155, v134, v135
    v_cvt_pk_bf16_f32 v156, v136, v137
    v_cvt_pk_bf16_f32 v157, v138, v139
    v_cvt_pk_bf16_f32 v158, v140, v141
    v_cvt_pk_bf16_f32 v159, v142, v143
    v_permlane32_swap_b32 v152, v154
    v_permlane32_swap_b32 v153, v155
    v_permlane32_swap_b32 v156, v158
    v_permlane32_swap_b32 v157, v159
    s_mul_i32 s72, s76, 1048576
    s_lshl_b32 s73, s75, 12
    s_add_u32 s72, s72, s73
    s_add_u32 s72, s72, 788480
    s_add_u32 s62, s60, s72
    s_addc_u32 s63, s61, 0
    global_store_dwordx4 v9, v[152:155], s[62:63] sc1
    global_store_dwordx4 v9, v[156:159], s[62:63] offset:512 sc1
    v_accvgpr_read_b32 v128, a128
    v_accvgpr_read_b32 v129, a129
    v_accvgpr_read_b32 v130, a130
    v_accvgpr_read_b32 v131, a131
    v_accvgpr_read_b32 v132, a132
    v_accvgpr_read_b32 v133, a133
    v_accvgpr_read_b32 v134, a134
    v_accvgpr_read_b32 v135, a135
    v_accvgpr_read_b32 v136, a136
    v_accvgpr_read_b32 v137, a137
    v_accvgpr_read_b32 v138, a138
    v_accvgpr_read_b32 v139, a139
    v_accvgpr_read_b32 v140, a140
    v_accvgpr_read_b32 v141, a141
    v_accvgpr_read_b32 v142, a142
    v_accvgpr_read_b32 v143, a143
    v_cvt_pk_bf16_f32 v144, v128, v129
    v_cvt_pk_bf16_f32 v145, v130, v131
    v_cvt_pk_bf16_f32 v146, v132, v133
    v_cvt_pk_bf16_f32 v147, v134, v135
    v_cvt_pk_bf16_f32 v148, v136, v137
    v_cvt_pk_bf16_f32 v149, v138, v139
    v_cvt_pk_bf16_f32 v150, v140, v141
    v_cvt_pk_bf16_f32 v151, v142, v143
    v_permlane32_swap_b32 v144, v146
    v_permlane32_swap_b32 v145, v147
    v_permlane32_swap_b32 v148, v150
    v_permlane32_swap_b32 v149, v151
    s_mul_i32 s72, s76, 1048576
    s_lshl_b32 s73, s75, 12
    s_add_u32 s72, s72, s73
    s_add_u32 s72, s72, 8192
    s_add_u32 s62, s60, s72
    s_addc_u32 s63, s61, 0
    global_store_dwordx4 v9, v[144:147], s[62:63] sc1
    global_store_dwordx4 v9, v[148:151], s[62:63] offset:512 sc1
    v_accvgpr_read_b32 v128, a144
    v_accvgpr_read_b32 v129, a145
    v_accvgpr_read_b32 v130, a146
    v_accvgpr_read_b32 v131, a147
    v_accvgpr_read_b32 v132, a148
    v_accvgpr_read_b32 v133, a149
    v_accvgpr_read_b32 v134, a150
    v_accvgpr_read_b32 v135, a151
    v_accvgpr_read_b32 v136, a152
    v_accvgpr_read_b32 v137, a153
    v_accvgpr_read_b32 v138, a154
    v_accvgpr_read_b32 v139, a155
    v_accvgpr_read_b32 v140, a156
    v_accvgpr_read_b32 v141, a157
    v_accvgpr_read_b32 v142, a158
    v_accvgpr_read_b32 v143, a159
    v_cvt_pk_bf16_f32 v152, v128, v129
    v_cvt_pk_bf16_f32 v153, v130, v131
    v_cvt_pk_bf16_f32 v154, v132, v133
    v_cvt_pk_bf16_f32 v155, v134, v135
    v_cvt_pk_bf16_f32 v156, v136, v137
    v_cvt_pk_bf16_f32 v157, v138, v139
    v_cvt_pk_bf16_f32 v158, v140, v141
    v_cvt_pk_bf16_f32 v159, v142, v143
    v_permlane32_swap_b32 v152, v154
    v_permlane32_swap_b32 v153, v155
    v_permlane32_swap_b32 v156, v158
    v_permlane32_swap_b32 v157, v159
    s_mul_i32 s72, s76, 1048576
    s_lshl_b32 s73, s75, 12
    s_add_u32 s72, s72, s73
    s_add_u32 s72, s72, 270336
    s_add_u32 s62, s60, s72
    s_addc_u32 s63, s61, 0
    global_store_dwordx4 v9, v[152:155], s[62:63] sc1
    global_store_dwordx4 v9, v[156:159], s[62:63] offset:512 sc1
    v_accvgpr_read_b32 v128, a160
    v_accvgpr_read_b32 v129, a161
    v_accvgpr_read_b32 v130, a162
    v_accvgpr_read_b32 v131, a163
    v_accvgpr_read_b32 v132, a164
    v_accvgpr_read_b32 v133, a165
    v_accvgpr_read_b32 v134, a166
    v_accvgpr_read_b32 v135, a167
    v_accvgpr_read_b32 v136, a168
    v_accvgpr_read_b32 v137, a169
    v_accvgpr_read_b32 v138, a170
    v_accvgpr_read_b32 v139, a171
    v_accvgpr_read_b32 v140, a172
    v_accvgpr_read_b32 v141, a173
    v_accvgpr_read_b32 v142, a174
    v_accvgpr_read_b32 v143, a175
    v_cvt_pk_bf16_f32 v144, v128, v129
    v_cvt_pk_bf16_f32 v145, v130, v131
    v_cvt_pk_bf16_f32 v146, v132, v133
    v_cvt_pk_bf16_f32 v147, v134, v135
    v_cvt_pk_bf16_f32 v148, v136, v137
    v_cvt_pk_bf16_f32 v149, v138, v139
    v_cvt_pk_bf16_f32 v150, v140, v141
    v_cvt_pk_bf16_f32 v151, v142, v143
    v_permlane32_swap_b32 v144, v146
    v_permlane32_swap_b32 v145, v147
    v_permlane32_swap_b32 v148, v150
    v_permlane32_swap_b32 v149, v151
    s_mul_i32 s72, s76, 1048576
    s_lshl_b32 s73, s75, 12
    s_add_u32 s72, s72, s73
    s_add_u32 s72, s72, 532480
    s_add_u32 s62, s60, s72
    s_addc_u32 s63, s61, 0
    global_store_dwordx4 v9, v[144:147], s[62:63] sc1
    global_store_dwordx4 v9, v[148:151], s[62:63] offset:512 sc1
    v_accvgpr_read_b32 v128, a176
    v_accvgpr_read_b32 v129, a177
    v_accvgpr_read_b32 v130, a178
    v_accvgpr_read_b32 v131, a179
    v_accvgpr_read_b32 v132, a180
    v_accvgpr_read_b32 v133, a181
    v_accvgpr_read_b32 v134, a182
    v_accvgpr_read_b32 v135, a183
    v_accvgpr_read_b32 v136, a184
    v_accvgpr_read_b32 v137, a185
    v_accvgpr_read_b32 v138, a186
    v_accvgpr_read_b32 v139, a187
    v_accvgpr_read_b32 v140, a188
    v_accvgpr_read_b32 v141, a189
    v_accvgpr_read_b32 v142, a190
    v_accvgpr_read_b32 v143, a191
    v_cvt_pk_bf16_f32 v152, v128, v129
    v_cvt_pk_bf16_f32 v153, v130, v131
    v_cvt_pk_bf16_f32 v154, v132, v133
    v_cvt_pk_bf16_f32 v155, v134, v135
    v_cvt_pk_bf16_f32 v156, v136, v137
    v_cvt_pk_bf16_f32 v157, v138, v139
    v_cvt_pk_bf16_f32 v158, v140, v141
    v_cvt_pk_bf16_f32 v159, v142, v143
    v_permlane32_swap_b32 v152, v154
    v_permlane32_swap_b32 v153, v155
    v_permlane32_swap_b32 v156, v158
    v_permlane32_swap_b32 v157, v159
    s_mul_i32 s72, s76, 1048576
    s_lshl_b32 s73, s75, 12
    s_add_u32 s72, s72, s73
    s_add_u32 s72, s72, 794624
    s_add_u32 s62, s60, s72
    s_addc_u32 s63, s61, 0
    global_store_dwordx4 v9, v[152:155], s[62:63] sc1
    global_store_dwordx4 v9, v[156:159], s[62:63] offset:512 sc1
    v_accvgpr_read_b32 v128, a192
    v_accvgpr_read_b32 v129, a193
    v_accvgpr_read_b32 v130, a194
    v_accvgpr_read_b32 v131, a195
    v_accvgpr_read_b32 v132, a196
    v_accvgpr_read_b32 v133, a197
    v_accvgpr_read_b32 v134, a198
    v_accvgpr_read_b32 v135, a199
    v_accvgpr_read_b32 v136, a200
    v_accvgpr_read_b32 v137, a201
    v_accvgpr_read_b32 v138, a202
    v_accvgpr_read_b32 v139, a203
    v_accvgpr_read_b32 v140, a204
    v_accvgpr_read_b32 v141, a205
    v_accvgpr_read_b32 v142, a206
    v_accvgpr_read_b32 v143, a207
    v_cvt_pk_bf16_f32 v144, v128, v129
    v_cvt_pk_bf16_f32 v145, v130, v131
    v_cvt_pk_bf16_f32 v146, v132, v133
    v_cvt_pk_bf16_f32 v147, v134, v135
    v_cvt_pk_bf16_f32 v148, v136, v137
    v_cvt_pk_bf16_f32 v149, v138, v139
    v_cvt_pk_bf16_f32 v150, v140, v141
    v_cvt_pk_bf16_f32 v151, v142, v143
    v_permlane32_swap_b32 v144, v146
    v_permlane32_swap_b32 v145, v147
    v_permlane32_swap_b32 v148, v150
    v_permlane32_swap_b32 v149, v151
    s_mul_i32 s72, s76, 1048576
    s_lshl_b32 s73, s75, 12
    s_add_u32 s72, s72, s73
    s_add_u32 s72, s72, 10240
    s_add_u32 s62, s60, s72
    s_addc_u32 s63, s61, 0
    global_store_dwordx4 v9, v[144:147], s[62:63] sc1
    global_store_dwordx4 v9, v[148:151], s[62:63] offset:512 sc1
    v_accvgpr_read_b32 v128, a208
    v_accvgpr_read_b32 v129, a209
    v_accvgpr_read_b32 v130, a210
    v_accvgpr_read_b32 v131, a211
    v_accvgpr_read_b32 v132, a212
    v_accvgpr_read_b32 v133, a213
    v_accvgpr_read_b32 v134, a214
    v_accvgpr_read_b32 v135, a215
    v_accvgpr_read_b32 v136, a216
    v_accvgpr_read_b32 v137, a217
    v_accvgpr_read_b32 v138, a218
    v_accvgpr_read_b32 v139, a219
    v_accvgpr_read_b32 v140, a220
    v_accvgpr_read_b32 v141, a221
    v_accvgpr_read_b32 v142, a222
    v_accvgpr_read_b32 v143, a223
    v_cvt_pk_bf16_f32 v152, v128, v129
    v_cvt_pk_bf16_f32 v153, v130, v131
    v_cvt_pk_bf16_f32 v154, v132, v133
    v_cvt_pk_bf16_f32 v155, v134, v135
    v_cvt_pk_bf16_f32 v156, v136, v137
    v_cvt_pk_bf16_f32 v157, v138, v139
    v_cvt_pk_bf16_f32 v158, v140, v141
    v_cvt_pk_bf16_f32 v159, v142, v143
    v_permlane32_swap_b32 v152, v154
    v_permlane32_swap_b32 v153, v155
    v_permlane32_swap_b32 v156, v158
    v_permlane32_swap_b32 v157, v159
    s_mul_i32 s72, s76, 1048576
    s_lshl_b32 s73, s75, 12
    s_add_u32 s72, s72, s73
    s_add_u32 s72, s72, 272384
    s_add_u32 s62, s60, s72
    s_addc_u32 s63, s61, 0
    global_store_dwordx4 v9, v[152:155], s[62:63] sc1
    global_store_dwordx4 v9, v[156:159], s[62:63] offset:512 sc1
    v_accvgpr_read_b32 v128, a224
    v_accvgpr_read_b32 v129, a225
    v_accvgpr_read_b32 v130, a226
    v_accvgpr_read_b32 v131, a227
    v_accvgpr_read_b32 v132, a228
    v_accvgpr_read_b32 v133, a229
    v_accvgpr_read_b32 v134, a230
    v_accvgpr_read_b32 v135, a231
    v_accvgpr_read_b32 v136, a232
    v_accvgpr_read_b32 v137, a233
    v_accvgpr_read_b32 v138, a234
    v_accvgpr_read_b32 v139, a235
    v_accvgpr_read_b32 v140, a236
    v_accvgpr_read_b32 v141, a237
    v_accvgpr_read_b32 v142, a238
    v_accvgpr_read_b32 v143, a239
    v_cvt_pk_bf16_f32 v144, v128, v129
    v_cvt_pk_bf16_f32 v145, v130, v131
    v_cvt_pk_bf16_f32 v146, v132, v133
    v_cvt_pk_bf16_f32 v147, v134, v135
    v_cvt_pk_bf16_f32 v148, v136, v137
    v_cvt_pk_bf16_f32 v149, v138, v139
    v_cvt_pk_bf16_f32 v150, v140, v141
    v_cvt_pk_bf16_f32 v151, v142, v143
    v_permlane32_swap_b32 v144, v146
    v_permlane32_swap_b32 v145, v147
    v_permlane32_swap_b32 v148, v150
    v_permlane32_swap_b32 v149, v151
    s_mul_i32 s72, s76, 1048576
    s_lshl_b32 s73, s75, 12
    s_add_u32 s72, s72, s73
    s_add_u32 s72, s72, 534528
    s_add_u32 s62, s60, s72
    s_addc_u32 s63, s61, 0
    global_store_dwordx4 v9, v[144:147], s[62:63] sc1
    global_store_dwordx4 v9, v[148:151], s[62:63] offset:512 sc1
    v_accvgpr_read_b32 v128, a240
    v_accvgpr_read_b32 v129, a241
    v_accvgpr_read_b32 v130, a242
    v_accvgpr_read_b32 v131, a243
    v_accvgpr_read_b32 v132, a244
    v_accvgpr_read_b32 v133, a245
    v_accvgpr_read_b32 v134, a246
    v_accvgpr_read_b32 v135, a247
    v_accvgpr_read_b32 v136, a248
    v_accvgpr_read_b32 v137, a249
    v_accvgpr_read_b32 v138, a250
    v_accvgpr_read_b32 v139, a251
    v_accvgpr_read_b32 v140, a252
    v_accvgpr_read_b32 v141, a253
    v_accvgpr_read_b32 v142, a254
    v_accvgpr_read_b32 v143, a255
    v_cvt_pk_bf16_f32 v152, v128, v129
    v_cvt_pk_bf16_f32 v153, v130, v131
    v_cvt_pk_bf16_f32 v154, v132, v133
    v_cvt_pk_bf16_f32 v155, v134, v135
    v_cvt_pk_bf16_f32 v156, v136, v137
    v_cvt_pk_bf16_f32 v157, v138, v139
    v_cvt_pk_bf16_f32 v158, v140, v141
    v_cvt_pk_bf16_f32 v159, v142, v143
    v_permlane32_swap_b32 v152, v154
    v_permlane32_swap_b32 v153, v155
    v_permlane32_swap_b32 v156, v158
    v_permlane32_swap_b32 v157, v159
    s_mul_i32 s72, s76, 1048576
    s_lshl_b32 s73, s75, 12
    s_add_u32 s72, s72, s73
    s_add_u32 s72, s72, 796672
    s_add_u32 s62, s60, s72
    s_addc_u32 s63, s61, 0
    global_store_dwordx4 v9, v[152:155], s[62:63] sc1
    global_store_dwordx4 v9, v[156:159], s[62:63] offset:512 sc1
    s_waitcnt vmcnt(0)
    s_barrier
    s_cmp_lg_u32 s16, 0
    s_cbranch_scc1 L_wk_vs
    s_lshl_b32 s18, s21, 2
    s_add_u32 s18, s18, 64
    v_mov_b32 v10, s18
    v_mov_b32 v11, 1
    s_mov_b64 exec, 1
    global_atomic_add v10, v11, s[6:7] sc1
    s_mov_b64 exec, -1
L_wk_vs:
    s_branch L_wk_next
L_wk_half:
    s_and_b32 s75, s16, 1
    s_lshr_b32 s76, s16, 1
    v_lshrrev_b32 v10, 2, v1
    v_mul_u32_u24 v2, 1152, v10
    v_and_b32 v10, 3, v1
    v_bfe_u32 v11, v1, 4, 2
    v_xor_b32 v10, v10, v11
    v_lshl_add_u32 v2, v10, 4, v2
    v_and_b32 v10, 31, v1
    v_lshrrev_b32 v11, 5, v1
    v_bfe_u32 v12, v1, 2, 2
    v_xor_b32 v11, v11, v12
    v_lshlrev_b32 v4, 6, v10
    v_lshl_add_u32 v4, v11, 4, v4
    s_lshl_b32 s72, s76, 13
    v_add_u32 v4, s72, v4
    v_xor_b32 v5, 32, v4
    s_lshl_b32 s72, s76, 12
    v_subrev_u32 v16, s72, v4
    v_xor_b32 v17, 32, v16
    v_bfe_u32 v10, v1, 2, 2
    v_lshrrev_b32 v11, 5, v1
    v_lshl_add_u32 v11, v11, 3, v10
    v_lshlrev_b32 v11, 8, v11
    v_bfe_u32 v12, v1, 4, 1
    v_lshlrev_b32 v12, 1, v12
    v_bfe_u32 v13, v1, 1, 1
    v_add_u32 v12, v12, v13
    v_lshl_add_u32 v11, v12, 4, v11
    v_and_b32 v12, 1, v1
    v_lshl_add_u32 v11, v12, 3, v11
    v_add_u32 v11, 16384, v11
    s_lshl_b32 s72, s75, 1
    v_xor_b32 v12, s72, v10
    v_lshl_add_u32 v6, v12, 6, v11
    v_xor_b32 v12, 1, v12
    v_lshl_add_u32 v7, v12, 6, v11
    v_subrev_u32 v18, 8192, v6
    v_subrev_u32 v19, 8192, v7
    v_and_b32 v10, 31, v1
    v_lshrrev_b32 v11, 5, v1
    v_lshrrev_b32 v12, 3, v10
    v_lshlrev_b32 v12, 2, v12
    v_and_b32 v13, 3, v10
    v_add_u32 v12, v12, v13
    v_lshl_add_u32 v12, v11, 4, v12
    v_lshlrev_b32 v12, 4, v12
    v_bfe_u32 v13, v10, 2, 1
    v_lshl_add_u32 v8, v13, 10, v12
    v_and_b32 v12, 15, v10
    v_lshl_add_u32 v12, v11, 4, v12
    v_lshlrev_b32 v12, 4, v12
    v_lshrrev_b32 v13, 4, v10
    v_lshl_add_u32 v9, v13, 10, v12
    v_lshlrev_b32 v14, 4, v1
    s_and_b32 s25, s21, 1
    s_lshr_b32 s21, s21, 1
    s_cmp_ge_u32 s18, 16
    s_cbranch_scc1 L_wk_vh
    s_load_dwordx2 s[10:11], s[0:1], 24
    s_waitcnt lgkmcnt(0)
    s_mov_b32 s48, s8
    s_mov_b32 s49, s9
    s_mov_b32 s50, 2359296
    s_mov_b32 s51, 0x00020000
    s_mov_b32 s52, s10
    s_mov_b32 s53, s11
    s_mov_b32 s54, 4718592
    s_mov_b32 s55, 0x00020000
    s_mov_b32 s56, s10
    s_mov_b32 s57, s11
    s_mov_b32 s58, 4718592
    s_mov_b32 s59, 0x00020000
    s_mov_b32 s65, 8192
    v_lshrrev_b32 v10, 4, v1
    v_mul_lo_u32 v3, v10, s65
    v_lshlrev_b32 v10, 2, v10
    v_and_b32 v11, 15, v1
    v_xor_b32 v10, v10, v11
    v_lshl_add_u32 v3, v10, 4, v3
    s_mul_i32 s68, s21, 147456
    s_lshl_b32 s66, s18, 9
    s_add_u32 s67, s66, 256
    s_lshl_b32 s72, s21, 20
    s_lshl_b32 s73, s18, 14
    s_add_u32 s72, s72, s73
    s_lshl_b32 s73, s25, 8
    s_add_u32 s66, s66, s73
    s_lshl_b32 s73, s25, 13
    s_add_u32 s72, s72, s73
    s_add_u32 s60, s4, 0x0
    s_addc_u32 s61, s5, 0
    s_add_u32 s60, s60, s72
    s_addc_u32 s61, s61, 0
    s_mov_b32 s70, 0
    s_mov_b32 s71, 0
    s_mul_i32 s72, s16, 36864
    s_add_u32 s68, s68, s72
    s_lshl_b32 s80, s65, 2
    s_mul_i32 s72, s16, s80
    s_lshl_b32 s72, s72, 1
    s_add_u32 s66, s66, s72
    s_add_u32 s67, s67, s72
    s_mul_i32 s78, s16, 2048
    s_lshl_b32 s81, s16, 11
    s_add_u32 s81, s81, 8192
    s_lshl_b32 s82, s65, 5
    s_add_u32 s77, s70, s78
    s_add_u32 s79, s70, s81
    s_mov_b32 m0, s77
    s_nop 0
    buffer_load_dwordx4 v2, s[48:51], s68 offen lds
    s_add_u32 m0, s77, 1024
    s_add_u32 s73, s68, 18432
    buffer_load_dwordx4 v2, s[48:51], s73 offen lds
    s_add_u32 m0, s79, 0
    s_nop 0
    buffer_load_dwordx4 v3, s[52:55], s66 offen lds
    s_add_u32 m0, s79, 1024
    s_add_u32 s73, s66, s80
    buffer_load_dwordx4 v3, s[52:55], s73 offen lds
    s_add_u32 s68, s68, 64
    s_add_u32 s66, s66, s82
    s_add_u32 s67, s67, s82
    s_add_u32 s70, s70, 16384
    s_cmp_eq_u32 s70, 147456
    s_cselect_b32 s70, 0, s70
    s_add_u32 s77, s70, s78
    s_add_u32 s79, s70, s81
    s_mov_b32 m0, s77
    s_nop 0
    buffer_load_dwordx4 v2, s[48:51], s68 offen lds
    s_add_u32 m0, s77, 1024
    s_add_u32 s73, s68, 18432
    buffer_load_dwordx4 v2, s[48:51], s73 offen lds
    s_add_u32 m0, s79, 0
    s_nop 0
    buffer_load_dwordx4 v3, s[52:55], s66 offen lds
    s_add_u32 m0, s79, 1024
    s_add_u32 s73, s66, s80
    buffer_load_dwordx4 v3, s[52:55], s73 offen lds
    s_add_u32 s68, s68, 64
    s_add_u32 s66, s66, s82
    s_add_u32 s67, s67, s82
    s_add_u32 s70, s70, 16384
    s_cmp_eq_u32 s70, 147456
    s_cselect_b32 s70, 0, s70
    s_add_u32 s77, s70, s78
    s_add_u32 s79, s70, s81
    s_mov_b32 m0, s77
    s_nop 0
    buffer_load_dwordx4 v2, s[48:51], s68 offen lds
    s_add_u32 m0, s77, 1024
    s_add_u32 s73, s68, 18432
    buffer_load_dwordx4 v2, s[48:51], s73 offen lds
    s_add_u32 m0, s79, 0
    s_nop 0
    buffer_load_dwordx4 v3, s[52:55], s66 offen lds
    s_add_u32 m0, s79, 1024
    s_add_u32 s73, s66, s80
    buffer_load_dwordx4 v3, s[52:55], s73 offen lds
    s_add_u32 s68, s68, 64
    s_add_u32 s66, s66, s82
    s_add_u32 s67, s67, s82
    s_add_u32 s70, s70, 16384
    s_cmp_eq_u32 s70, 147456
    s_cselect_b32 s70, 0, s70
    s_add_u32 s77, s70, s78
    s_add_u32 s79, s70, s81
    s_mov_b32 m0, s77
    s_nop 0
    buffer_load_dwordx4 v2, s[48:51], s68 offen lds
    s_add_u32 m0, s77, 1024
    s_add_u32 s73, s68, 18432
    buffer_load_dwordx4 v2, s[48:51], s73 offen lds
    s_add_u32 m0, s79, 0
    s_nop 0
    buffer_load_dwordx4 v3, s[52:55], s66 offen lds
    s_add_u32 m0, s79, 1024
    s_add_u32 s73, s66, s80
    buffer_load_dwordx4 v3, s[52:55], s73 offen lds
    s_add_u32 s68, s68, 64
    s_add_u32 s66, s66, s82
    s_add_u32 s67, s67, s82
    s_add_u32 s70, s70, 16384
    s_cmp_eq_u32 s70, 147456
    s_cselect_b32 s70, 0, s70
    s_add_u32 s77, s70, s78
    s_add_u32 s79, s70, s81
    s_mov_b32 m0, s77
    s_nop 0
    buffer_load_dwordx4 v2, s[48:51], s68 offen lds
    s_add_u32 m0, s77, 1024
    s_add_u32 s73, s68, 18432
    buffer_load_dwordx4 v2, s[48:51], s73 offen lds
    s_add_u32 m0, s79, 0
    s_nop 0
    buffer_load_dwordx4 v3, s[52:55], s66 offen lds
    s_add_u32 m0, s79, 1024
    s_add_u32 s73, s66, s80
    buffer_load_dwordx4 v3, s[52:55], s73 offen lds
    s_add_u32 s68, s68, 64
    s_add_u32 s66, s66, s82
    s_add_u32 s67, s67, s82
    s_add_u32 s70, s70, 16384
    s_cmp_eq_u32 s70, 147456
    s_cselect_b32 s70, 0, s70
    s_add_u32 s77, s70, s78
    s_add_u32 s79, s70, s81
    s_mov_b32 m0, s77
    s_nop 0
    buffer_load_dwordx4 v2, s[48:51], s68 offen lds
    s_add_u32 m0, s77, 1024
    s_add_u32 s73, s68, 18432
    buffer_load_dwordx4 v2, s[48:51], s73 offen lds
    s_add_u32 m0, s79, 0
    s_nop 0
    buffer_load_dwordx4 v3, s[52:55], s66 offen lds
    s_add_u32 m0, s79, 1024
    s_add_u32 s73, s66, s80
    buffer_load_dwordx4 v3, s[52:55], s73 offen lds
    s_add_u32 s68, s68, 64
    s_add_u32 s66, s66, s82
    s_add_u32 s67, s67, s82
    s_add_u32 s70, s70, 16384
    s_cmp_eq_u32 s70, 147456
    s_cselect_b32 s70, 0, s70
    s_add_u32 s77, s70, s78
    s_add_u32 s79, s70, s81
    s_mov_b32 m0, s77
    s_nop 0
    buffer_load_dwordx4 v2, s[48:51], s68 offen lds
    s_add_u32 m0, s77, 1024
    s_add_u32 s73, s68, 18432
    buffer_load_dwordx4 v2, s[48:51], s73 offen lds
    s_add_u32 m0, s79, 0
    s_nop 0
    buffer_load_dwordx4 v3, s[52:55], s66 offen lds
    s_add_u32 m0, s79, 1024
    s_add_u32 s73, s66, s80
    buffer_load_dwordx4 v3, s[52:55], s73 offen lds
    s_add_u32 s68, s68, 64
    s_add_u32 s66, s66, s82
    s_add_u32 s67, s67, s82
    s_add_u32 s70, s70, 16384
    s_cmp_eq_u32 s70, 147456
    s_cselect_b32 s70, 0, s70
    s_add_u32 s77, s70, s78
    s_add_u32 s79, s70, s81
    s_mov_b32 m0, s77
    s_nop 0
    buffer_load_dwordx4 v2, s[48:51], s68 offen lds
    s_add_u32 m0, s77, 1024
    s_add_u32 s73, s68, 18432
    buffer_load_dwordx4 v2, s[48:51], s73 offen lds
    s_add_u32 m0, s79, 0
    s_nop 0
    buffer_load_dwordx4 v3, s[52:55], s66 offen lds
    s_add_u32 m0, s79, 1024
    s_add_u32 s73, s66, s80
    buffer_load_dwordx4 v3, s[52:55], s73 offen lds
    s_add_u32 s68, s68, 64
    s_add_u32 s66, s66, s82
    s_add_u32 s67, s67, s82
    s_add_u32 s70, s70, 16384
    s_cmp_eq_u32 s70, 147456
    s_cselect_b32 s70, 0, s70
    s_add_u32 s77, s70, s78
    s_add_u32 s79, s70, s81
    s_mov_b32 m0, s77
    s_nop 0
    buffer_load_dwordx4 v2, s[48:51], s68 offen lds
    s_add_u32 m0, s77, 1024
    s_add_u32 s73, s68, 18432
    buffer_load_dwordx4 v2, s[48:51], s73 offen lds
    s_add_u32 m0, s79, 0
    s_nop 0
    buffer_load_dwordx4 v3, s[52:55], s66 offen lds
    s_add_u32 m0, s79, 1024
    s_add_u32 s73, s66, s80
    buffer_load_dwordx4 v3, s[52:55], s73 offen lds
    s_add_u32 s68, s68, 64
    s_add_u32 s66, s66, s82
    s_add_u32 s67, s67, s82
    s_add_u32 s70, s70, 16384
    s_cmp_eq_u32 s70, 147456
    s_cselect_b32 s70, 0, s70
    v_accvgpr_write_b32 a0, 0
    v_accvgpr_write_b32 a1, 0
    v_accvgpr_write_b32 a2, 0
    v_accvgpr_write_b32 a3, 0
    v_accvgpr_write_b32 a4, 0
    v_accvgpr_write_b32 a5, 0
    v_accvgpr_write_b32 a6, 0
    v_accvgpr_write_b32 a7, 0
    v_accvgpr_write_b32 a8, 0
    v_accvgpr_write_b32 a9, 0
    v_accvgpr_write_b32 a10, 0
    v_accvgpr_write_b32 a11, 0
    v_accvgpr_write_b32 a12, 0
    v_accvgpr_write_b32 a13, 0
    v_accvgpr_write_b32 a14, 0
    v_accvgpr_write_b32 a15, 0
    v_accvgpr_write_b32 a16, 0
    v_accvgpr_write_b32 a17, 0
    v_accvgpr_write_b32 a18, 0
    v_accvgpr_write_b32 a19, 0
    v_accvgpr_write_b32 a20, 0
    v_accvgpr_write_b32 a21, 0
    v_accvgpr_write_b32 a22, 0
    v_accvgpr_write_b32 a23, 0
    v_accvgpr_write_b32 a24, 0
    v_accvgpr_write_b32 a25, 0
    v_accvgpr_write_b32 a26, 0
    v_accvgpr_write_b32 a27, 0
    v_accvgpr_write_b32 a28, 0
    v_accvgpr_write_b32 a29, 0
    v_accvgpr_write_b32 a30, 0
    v_accvgpr_write_b32 a31, 0
    v_accvgpr_write_b32 a64, 0
    v_accvgpr_write_b32 a65, 0
    v_accvgpr_write_b32 a66, 0
    v_accvgpr_write_b32 a67, 0
    v_accvgpr_write_b32 a68, 0
    v_accvgpr_write_b32 a69, 0
    v_accvgpr_write_b32 a70, 0
    v_accvgpr_write_b32 a71, 0
    v_accvgpr_write_b32 a72, 0
    v_accvgpr_write_b32 a73, 0
    v_accvgpr_write_b32 a74, 0
    v_accvgpr_write_b32 a75, 0
    v_accvgpr_write_b32 a76, 0
    v_accvgpr_write_b32 a77, 0
    v_accvgpr_write_b32 a78, 0
    v_accvgpr_write_b32 a79, 0
    v_accvgpr_write_b32 a80, 0
    v_accvgpr_write_b32 a81, 0
    v_accvgpr_write_b32 a82, 0
    v_accvgpr_write_b32 a83, 0
    v_accvgpr_write_b32 a84, 0
    v_accvgpr_write_b32 a85, 0
    v_accvgpr_write_b32 a86, 0
    v_accvgpr_write_b32 a87, 0
    v_accvgpr_write_b32 a88, 0
    v_accvgpr_write_b32 a89, 0
    v_accvgpr_write_b32 a90, 0
    v_accvgpr_write_b32 a91, 0
    v_accvgpr_write_b32 a92, 0
    v_accvgpr_write_b32 a93, 0
    v_accvgpr_write_b32 a94, 0
    v_accvgpr_write_b32 a95, 0
    s_waitcnt vmcnt(32)
    s_barrier
    ds_read_b64_tr_b16 v[64:65], v18 offset:0
    ds_read_b64_tr_b16 v[66:67], v18 offset:1024
    ds_read_b64_tr_b16 v[68:69], v19 offset:0
    ds_read_b64_tr_b16 v[70:71], v19 offset:1024
    ds_read_b128 v[80:83], v16 offset:0
    ds_read_b128 v[84:87], v16 offset:2048
    s_mov_b32 s69, 0
    s_waitcnt lgkmcnt(0)
L_g1_loopkh:
    v_mfma_f32_32x32x16_bf16 a[0:15], v[64:67], v[80:83], a[0:15]
    ds_read_b64_tr_b16 v[96:97], v18 offset:4096
    v_mfma_f32_32x32x16_bf16 a[64:79], v[68:71], v[80:83], a[64:79]
    ds_read_b64_tr_b16 v[98:99], v18 offset:5120
    v_mfma_f32_32x32x16_bf16 a[16:31], v[64:67], v[84:87], a[16:31]
    ds_read_b64_tr_b16 v[100:101], v19 offset:4096
    v_mfma_f32_32x32x16_bf16 a[80:95], v[68:71], v[84:87], a[80:95]
    ds_read_b64_tr_b16 v[102:103], v19 offset:5120
    ds_read_b128 v[112:115], v17 offset:0
    ds_read_b128 v[116:119], v17 offset:2048
    s_waitcnt lgkmcnt(0)
    s_cmp_lt_u32 s69, 10
    s_cbranch_scc1 L_g1_w8kh
    s_waitcnt vmcnt(0)
    s_branch L_g1_wdkh
L_g1_w8kh:
    s_waitcnt vmcnt(28)
L_g1_wdkh:
    s_barrier
    s_add_u32 s71, s71, 16384
    s_cmp_eq_u32 s71, 147456
    s_mov_b32 s72, 16384
    s_cselect_b32 s72, 0xfffe0000, s72
    s_cselect_b32 s71, 0, s71
    v_add_u32 v16, s72, v16
    v_add_u32 v17, s72, v17
    v_add_u32 v18, s72, v18
    v_add_u32 v19, s72, v19
    s_cmp_lt_u32 s69, 9
    s_cbranch_scc0 L_g1_nodmakh
    v_mfma_f32_32x32x16_bf16 a[0:15], v[96:99], v[112:115], a[0:15]
    ds_read_b64_tr_b16 v[64:65], v18 offset:0
    s_add_u32 s77, s70, s78
    s_add_u32 s79, s70, s81
    s_mov_b32 m0, s77
    s_nop 0
    buffer_load_dwordx4 v2, s[48:51], s68 offen lds
    v_mfma_f32_32x32x16_bf16 a[64:79], v[100:103], v[112:115], a[64:79]
    ds_read_b64_tr_b16 v[66:67], v18 offset:1024
    s_add_u32 m0, s77, 1024
    s_add_u32 s73, s68, 18432
    buffer_load_dwordx4 v2, s[48:51], s73 offen lds
    v_mfma_f32_32x32x16_bf16 a[16:31], v[96:99], v[116:119], a[16:31]
    ds_read_b64_tr_b16 v[68:69], v19 offset:0
    s_add_u32 m0, s79, 0
    s_nop 0
    buffer_load_dwordx4 v3, s[52:55], s66 offen lds
    v_mfma_f32_32x32x16_bf16 a[80:95], v[100:103], v[116:119], a[80:95]
    ds_read_b64_tr_b16 v[70:71], v19 offset:1024
    s_add_u32 m0, s79, 1024
    s_add_u32 s73, s66, s80
    buffer_load_dwordx4 v3, s[52:55], s73 offen lds
    ds_read_b128 v[80:83], v16 offset:0
    ds_read_b128 v[84:87], v16 offset:2048
    s_add_u32 s68, s68, 64
    s_add_u32 s66, s66, s82
    s_add_u32 s67, s67, s82
    s_add_u32 s70, s70, 16384
    s_cmp_eq_u32 s70, 147456
    s_cselect_b32 s70, 0, s70
    s_branch L_g1_jkh
L_g1_nodmakh:
    v_mfma_f32_32x32x16_bf16 a[0:15], v[96:99], v[112:115], a[0:15]
    ds_read_b64_tr_b16 v[64:65], v18 offset:0
    v_mfma_f32_32x32x16_bf16 a[64:79], v[100:103], v[112:115], a[64:79]
    ds_read_b64_tr_b16 v[66:67], v18 offset:1024
    v_mfma_f32_32x32x16_bf16 a[16:31], v[96:99], v[116:119], a[16:31]
    ds_read_b64_tr_b16 v[68:69], v19 offset:0
    v_mfma_f32_32x32x16_bf16 a[80:95], v[100:103], v[116:119], a[80:95]
    ds_read_b64_tr_b16 v[70:71], v19 offset:1024
    ds_read_b128 v[80:83], v16 offset:0
    ds_read_b128 v[84:87], v16 offset:2048
L_g1_jkh:
    s_waitcnt lgkmcnt(0)
    s_add_u32 s69, s69, 1
    s_cmp_lt_u32 s69, 18
    s_cbranch_scc1 L_g1_loopkh
    s_nop 15
    v_accvgpr_read_b32 v128, a0
    v_accvgpr_read_b32 v129, a1
    v_accvgpr_read_b32 v130, a2
    v_accvgpr_read_b32 v131, a3
    v_accvgpr_read_b32 v132, a4
    v_accvgpr_read_b32 v133, a5
    v_accvgpr_read_b32 v134, a6
    v_accvgpr_read_b32 v135, a7
    v_accvgpr_read_b32 v136, a8
    v_accvgpr_read_b32 v137, a9
    v_accvgpr_read_b32 v138, a10
    v_accvgpr_read_b32 v139, a11
    v_accvgpr_read_b32 v140, a12
    v_accvgpr_read_b32 v141, a13
    v_accvgpr_read_b32 v142, a14
    v_accvgpr_read_b32 v143, a15
    v_cvt_pk_bf16_f32 v144, v128, v129
    v_cvt_pk_bf16_f32 v145, v130, v131
    v_cvt_pk_bf16_f32 v146, v132, v133
    v_cvt_pk_bf16_f32 v147, v134, v135
    v_cvt_pk_bf16_f32 v148, v136, v137
    v_cvt_pk_bf16_f32 v149, v138, v139
    v_cvt_pk_bf16_f32 v150, v140, v141
    v_cvt_pk_bf16_f32 v151, v142, v143
    v_permlane32_swap_b32 v144, v146
    v_permlane32_swap_b32 v145, v147
    v_permlane32_swap_b32 v148, v150
    v_permlane32_swap_b32 v149, v151
    s_mul_i32 s72, s76, 524288
    s_lshl_b32 s73, s75, 12
    s_add_u32 s72, s72, s73
    s_add_u32 s72, s72, 0
    s_add_u32 s62, s60, s72
    s_addc_u32 s63, s61, 0
    global_store_dwordx4 v8, v[144:147], s[62:63] sc1
    global_store_dwordx4 v8, v[148:151], s[62:63] offset:512 sc1
    v_accvgpr_read_b32 v128, a16
    v_accvgpr_read_b32 v129, a17
    v_accvgpr_read_b32 v130, a18
    v_accvgpr_read_b32 v131, a19
    v_accvgpr_read_b32 v132, a20
    v_accvgpr_read_b32 v133, a21
    v_accvgpr_read_b32 v134, a22
    v_accvgpr_read_b32 v135, a23
    v_accvgpr_read_b32 v136, a24
    v_accvgpr_read_b32 v137, a25
    v_accvgpr_read_b32 v138, a26
    v_accvgpr_read_b32 v139, a27
    v_accvgpr_read_b32 v140, a28
    v_accvgpr_read_b32 v141, a29
    v_accvgpr_read_b32 v142, a30
    v_accvgpr_read_b32 v143, a31
    v_cvt_pk_bf16_f32 v152, v128, v129
    v_cvt_pk_bf16_f32 v153, v130, v131
    v_cvt_pk_bf16_f32 v154, v132, v133
    v_cvt_pk_bf16_f32 v155, v134, v135
    v_cvt_pk_bf16_f32 v156, v136, v137
    v_cvt_pk_bf16_f32 v157, v138, v139
    v_cvt_pk_bf16_f32 v158, v140, v141
    v_cvt_pk_bf16_f32 v159, v142, v143
    v_permlane32_swap_b32 v152, v154
    v_permlane32_swap_b32 v153, v155
    v_permlane32_swap_b32 v156, v158
    v_permlane32_swap_b32 v157, v159
    s_mul_i32 s72, s76, 524288
    s_lshl_b32 s73, s75, 12
    s_add_u32 s72, s72, s73
    s_add_u32 s72, s72, 262144
    s_add_u32 s62, s60, s72
    s_addc_u32 s63, s61, 0
    global_store_dwordx4 v8, v[152:155], s[62:63] sc1
    global_store_dwordx4 v8, v[156:159], s[62:63] offset:512 sc1
    v_accvgpr_read_b32 v128, a64
    v_accvgpr_read_b32 v129, a65
    v_accvgpr_read_b32 v130, a66
    v_accvgpr_read_b32 v131, a67
    v_accvgpr_read_b32 v132, a68
    v_accvgpr_read_b32 v133, a69
    v_accvgpr_read_b32 v134, a70
    v_accvgpr_read_b32 v135, a71
    v_accvgpr_read_b32 v136, a72
    v_accvgpr_read_b32 v137, a73
    v_accvgpr_read_b32 v138, a74
    v_accvgpr_read_b32 v139, a75
    v_accvgpr_read_b32 v140, a76
    v_accvgpr_read_b32 v141, a77
    v_accvgpr_read_b32 v142, a78
    v_accvgpr_read_b32 v143, a79
    v_cvt_pk_bf16_f32 v144, v128, v129
    v_cvt_pk_bf16_f32 v145, v130, v131
    v_cvt_pk_bf16_f32 v146, v132, v133
    v_cvt_pk_bf16_f32 v147, v134, v135
    v_cvt_pk_bf16_f32 v148, v136, v137
    v_cvt_pk_bf16_f32 v149, v138, v139
    v_cvt_pk_bf16_f32 v150, v140, v141
    v_cvt_pk_bf16_f32 v151, v142, v143
    v_permlane32_swap_b32 v144, v146
    v_permlane32_swap_b32 v145, v147
    v_permlane32_swap_b32 v148, v150
    v_permlane32_swap_b32 v149, v151
    s_mul_i32 s72, s76, 524288
    s_lshl_b32 s73, s75, 12
    s_add_u32 s72, s72, s73
    s_add_u32 s72, s72, 2048
    s_add_u32 s62, s60, s72
    s_addc_u32 s63, s61, 0
    global_store_dwordx4 v8, v[144:147], s[62:63] sc1
    global_store_dwordx4 v8, v[148:151], s[62:63] offset:512 sc1
    v_accvgpr_read_b32 v128, a80
    v_accvgpr_read_b32 v129, a81
    v_accvgpr_read_b32 v130, a82
    v_accvgpr_read_b32 v131, a83
    v_accvgpr_read_b32 v132, a84
    v_accvgpr_read_b32 v133, a85
    v_accvgpr_read_b32 v134, a86
    v_accvgpr_read_b32 v135, a87
    v_accvgpr_read_b32 v136, a88
    v_accvgpr_read_b32 v137, a89
    v_accvgpr_read_b32 v138, a90
    v_accvgpr_read_b32 v139, a91
    v_accvgpr_read_b32 v140, a92
    v_accvgpr_read_b32 v141, a93
    v_accvgpr_read_b32 v142, a94
    v_accvgpr_read_b32 v143, a95
    v_cvt_pk_bf16_f32 v152, v128, v129
    v_cvt_pk_bf16_f32 v153, v130, v131
    v_cvt_pk_bf16_f32 v154, v132, v133
    v_cvt_pk_bf16_f32 v155, v134, v135
    v_cvt_pk_bf16_f32 v156, v136, v137
    v_cvt_pk_bf16_f32 v157, v138, v139
    v_cvt_pk_bf16_f32 v158, v140, v141
    v_cvt_pk_bf16_f32 v159, v142, v143
    v_permlane32_swap_b32 v152, v154
    v_permlane32_swap_b32 v153, v155
    v_permlane32_swap_b32 v156, v158
    v_permlane32_swap_b32 v157, v159
    s_mul_i32 s72, s76, 524288
    s_lshl_b32 s73, s75, 12
    s_add_u32 s72, s72, s73
    s_add_u32 s72, s72, 264192
    s_add_u32 s62, s60, s72
    s_addc_u32 s63, s61, 0
    global_store_dwordx4 v8, v[152:155], s[62:63] sc1
    global_store_dwordx4 v8, v[156:159], s[62:63] offset:512 sc1
    s_branch L_wk_hs
L_wk_vh:
    s_sub_u32 s18, s18, 16
    s_load_dwordx2 s[10:11], s[0:1], 32
    s_waitcnt lgkmcnt(0)
    s_mov_b32 s48, s8
    s_mov_b32 s49, s9
    s_mov_b32 s50, 2359296
    s_mov_b32 s51, 0x00020000
    s_mov_b32 s52, s10
    s_mov_b32 s53, s11
    s_mov_b32 s54, 4718592
    s_mov_b32 s55, 0x00020000
    s_mov_b32 s56, s10
    s_mov_b32 s57, s11
    s_mov_b32 s58, 4718592
    s_mov_b32 s59, 0x00020000
    s_mov_b32 s65, 8192
    v_lshrrev_b32 v10, 4, v1
    v_mul_lo_u32 v3, v10, s65
    v_lshlrev_b32 v10, 2, v10
    v_and_b32 v11, 15, v1
    v_xor_b32 v10, v10, v11
    v_lshl_add_u32 v3, v10, 4, v3
    s_mul_i32 s68, s21, 147456
    s_lshl_b32 s66, s18, 9
    s_add_u32 s67, s66, 256
    s_lshl_b32 s72, s21, 20
    s_lshl_b32 s73, s18, 14
    s_add_u32 s72, s72, s73
    s_lshl_b32 s73, s25, 8
    s_add_u32 s66, s66, s73
    s_lshl_b32 s73, s25, 13
    s_add_u32 s72, s72, s73
    s_add_u32 s60, s4, 0x1000000
    s_addc_u32 s61, s5, 0
    s_add_u32 s60, s60, s72
    s_addc_u32 s61, s61, 0
    s_mov_b32 s70, 0
    s_mov_b32 s71, 0
    s_mul_i32 s72, s16, 36864
    s_add_u32 s68, s68, s72
    s_lshl_b32 s80, s65, 2
    s_mul_i32 s72, s16, s80
    s_lshl_b32 s72, s72, 1
    s_add_u32 s66, s66, s72
    s_add_u32 s67, s67, s72
    s_mul_i32 s78, s16, 2048
    s_lshl_b32 s81, s16, 11
    s_add_u32 s81, s81, 8192
    s_lshl_b32 s82, s65, 5
    s_add_u32 s77, s70, s78
    s_add_u32 s79, s70, s81
    s_mov_b32 m0, s77
    s_nop 0
    buffer_load_dwordx4 v2, s[48:51], s68 offen lds
    s_add_u32 m0, s77, 1024
    s_add_u32 s73, s68, 18432
    buffer_load_dwordx4 v2, s[48:51], s73 offen lds
    s_add_u32 m0, s79, 0
    s_nop 0
    buffer_load_dwordx4 v3, s[52:55], s66 offen lds
    s_add_u32 m0, s79, 1024
    s_add_u32 s73, s66, s80
    buffer_load_dwordx4 v3, s[52:55], s73 offen lds
    s_add_u32 s68, s68, 64
    s_add_u32 s66, s66, s82
    s_add_u32 s67, s67, s82
    s_add_u32 s70, s70, 16384
    s_cmp_eq_u32 s70, 147456
    s_cselect_b32 s70, 0, s70
    s_add_u32 s77, s70, s78
    s_add_u32 s79, s70, s81
    s_mov_b32 m0, s77
    s_nop 0
    buffer_load_dwordx4 v2, s[48:51], s68 offen lds
    s_add_u32 m0, s77, 1024
    s_add_u32 s73, s68, 18432
    buffer_load_dwordx4 v2, s[48:51], s73 offen lds
    s_add_u32 m0, s79, 0
    s_nop 0
    buffer_load_dwordx4 v3, s[52:55], s66 offen lds
    s_add_u32 m0, s79, 1024
    s_add_u32 s73, s66, s80
    buffer_load_dwordx4 v3, s[52:55], s73 offen lds
    s_add_u32 s68, s68, 64
    s_add_u32 s66, s66, s82
    s_add_u32 s67, s67, s82
    s_add_u32 s70, s70, 16384
    s_cmp_eq_u32 s70, 147456
    s_cselect_b32 s70, 0, s70
    s_add_u32 s77, s70, s78
    s_add_u32 s79, s70, s81
    s_mov_b32 m0, s77
    s_nop 0
    buffer_load_dwordx4 v2, s[48:51], s68 offen lds
    s_add_u32 m0, s77, 1024
    s_add_u32 s73, s68, 18432
    buffer_load_dwordx4 v2, s[48:51], s73 offen lds
    s_add_u32 m0, s79, 0
    s_nop 0
    buffer_load_dwordx4 v3, s[52:55], s66 offen lds
    s_add_u32 m0, s79, 1024
    s_add_u32 s73, s66, s80
    buffer_load_dwordx4 v3, s[52:55], s73 offen lds
    s_add_u32 s68, s68, 64
    s_add_u32 s66, s66, s82
    s_add_u32 s67, s67, s82
    s_add_u32 s70, s70, 16384
    s_cmp_eq_u32 s70, 147456
    s_cselect_b32 s70, 0, s70
    s_add_u32 s77, s70, s78
    s_add_u32 s79, s70, s81
    s_mov_b32 m0, s77
    s_nop 0
    buffer_load_dwordx4 v2, s[48:51], s68 offen lds
    s_add_u32 m0, s77, 1024
    s_add_u32 s73, s68, 18432
    buffer_load_dwordx4 v2, s[48:51], s73 offen lds
    s_add_u32 m0, s79, 0
    s_nop 0
    buffer_load_dwordx4 v3, s[52:55], s66 offen lds
    s_add_u32 m0, s79, 1024
    s_add_u32 s73, s66, s80
    buffer_load_dwordx4 v3, s[52:55], s73 offen lds
    s_add_u32 s68, s68, 64
    s_add_u32 s66, s66, s82
    s_add_u32 s67, s67, s82
    s_add_u32 s70, s70, 16384
    s_cmp_eq_u32 s70, 147456
    s_cselect_b32 s70, 0, s70
    s_add_u32 s77, s70, s78
    s_add_u32 s79, s70, s81
    s_mov_b32 m0, s77
    s_nop 0
    buffer_load_dwordx4 v2, s[48:51], s68 offen lds
    s_add_u32 m0, s77, 1024
    s_add_u32 s73, s68, 18432
    buffer_load_dwordx4 v2, s[48:51], s73 offen lds
    s_add_u32 m0, s79, 0
    s_nop 0
    buffer_load_dwordx4 v3, s[52:55], s66 offen lds
    s_add_u32 m0, s79, 1024
    s_add_u32 s73, s66, s80
    buffer_load_dwordx4 v3, s[52:55], s73 offen lds
    s_add_u32 s68, s68, 64
    s_add_u32 s66, s66, s82
    s_add_u32 s67, s67, s82
    s_add_u32 s70, s70, 16384
    s_cmp_eq_u32 s70, 147456
    s_cselect_b32 s70, 0, s70
    s_add_u32 s77, s70, s78
    s_add_u32 s79, s70, s81
    s_mov_b32 m0, s77
    s_nop 0
    buffer_load_dwordx4 v2, s[48:51], s68 offen lds
    s_add_u32 m0, s77, 1024
    s_add_u32 s73, s68, 18432
    buffer_load_dwordx4 v2, s[48:51], s73 offen lds
    s_add_u32 m0, s79, 0
    s_nop 0
    buffer_load_dwordx4 v3, s[52:55], s66 offen lds
    s_add_u32 m0, s79, 1024
    s_add_u32 s73, s66, s80
    buffer_load_dwordx4 v3, s[52:55], s73 offen lds
    s_add_u32 s68, s68, 64
    s_add_u32 s66, s66, s82
    s_add_u32 s67, s67, s82
    s_add_u32 s70, s70, 16384
    s_cmp_eq_u32 s70, 147456
    s_cselect_b32 s70, 0, s70
    s_add_u32 s77, s70, s78
    s_add_u32 s79, s70, s81
    s_mov_b32 m0, s77
    s_nop 0
    buffer_load_dwordx4 v2, s[48:51], s68 offen lds
    s_add_u32 m0, s77, 1024
    s_add_u32 s73, s68, 18432
    buffer_load_dwordx4 v2, s[48:51], s73 offen lds
    s_add_u32 m0, s79, 0
    s_nop 0
    buffer_load_dwordx4 v3, s[52:55], s66 offen lds
    s_add_u32 m0, s79, 1024
    s_add_u32 s73, s66, s80
    buffer_load_dwordx4 v3, s[52:55], s73 offen lds
    s_add_u32 s68, s68, 64
    s_add_u32 s66, s66, s82
    s_add_u32 s67, s67, s82
    s_add_u32 s70, s70, 16384
    s_cmp_eq_u32 s70, 147456
    s_cselect_b32 s70, 0, s70
    s_add_u32 s77, s70, s78
    s_add_u32 s79, s70, s81
    s_mov_b32 m0, s77
    s_nop 0
    buffer_load_dwordx4 v2, s[48:51], s68 offen lds
    s_add_u32 m0, s77, 1024
    s_add_u32 s73, s68, 18432
    buffer_load_dwordx4 v2, s[48:51], s73 offen lds
    s_add_u32 m0, s79, 0
    s_nop 0
    buffer_load_dwordx4 v3, s[52:55], s66 offen lds
    s_add_u32 m0, s79, 1024
    s_add_u32 s73, s66, s80
    buffer_load_dwordx4 v3, s[52:55], s73 offen lds
    s_add_u32 s68, s68, 64
    s_add_u32 s66, s66, s82
    s_add_u32 s67, s67, s82
    s_add_u32 s70, s70, 16384
    s_cmp_eq_u32 s70, 147456
    s_cselect_b32 s70, 0, s70
    s_add_u32 s77, s70, s78
    s_add_u32 s79, s70, s81
    s_mov_b32 m0, s77
    s_nop 0
    buffer_load_dwordx4 v2, s[48:51], s68 offen lds
    s_add_u32 m0, s77, 1024
    s_add_u32 s73, s68, 18432
    buffer_load_dwordx4 v2, s[48:51], s73 offen lds
    s_add_u32 m0, s79, 0
    s_nop 0
    buffer_load_dwordx4 v3, s[52:55], s66 offen lds
    s_add_u32 m0, s79, 1024
    s_add_u32 s73, s66, s80
    buffer_load_dwordx4 v3, s[52:55], s73 offen lds
    s_add_u32 s68, s68, 64
    s_add_u32 s66, s66, s82
    s_add_u32 s67, s67, s82
    s_add_u32 s70, s70, 16384
    s_cmp_eq_u32 s70, 147456
    s_cselect_b32 s70, 0, s70
    v_accvgpr_write_b32 a0, 0
    v_accvgpr_write_b32 a1, 0
    v_accvgpr_write_b32 a2, 0
    v_accvgpr_write_b32 a3, 0
    v_accvgpr_write_b32 a4, 0
    v_accvgpr_write_b32 a5, 0
    v_accvgpr_write_b32 a6, 0
    v_accvgpr_write_b32 a7, 0
    v_accvgpr_write_b32 a8, 0
    v_accvgpr_write_b32 a9, 0
    v_accvgpr_write_b32 a10, 0
    v_accvgpr_write_b32 a11, 0
    v_accvgpr_write_b32 a12, 0
    v_accvgpr_write_b32 a13, 0
    v_accvgpr_write_b32 a14, 0
    v_accvgpr_write_b32 a15, 0
    v_accvgpr_write_b32 a16, 0
    v_accvgpr_write_b32 a17, 0
    v_accvgpr_write_b32 a18, 0
    v_accvgpr_write_b32 a19, 0
    v_accvgpr_write_b32 a20, 0
    v_accvgpr_write_b32 a21, 0
    v_accvgpr_write_b32 a22, 0
    v_accvgpr_write_b32 a23, 0
    v_accvgpr_write_b32 a24, 0
    v_accvgpr_write_b32 a25, 0
    v_accvgpr_write_b32 a26, 0
    v_accvgpr_write_b32 a27, 0
    v_accvgpr_write_b32 a28, 0
    v_accvgpr_write_b32 a29, 0
    v_accvgpr_write_b32 a30, 0
    v_accvgpr_write_b32 a31, 0
    v_accvgpr_write_b32 a64, 0
    v_accvgpr_write_b32 a65, 0
    v_accvgpr_write_b32 a66, 0
    v_accvgpr_write_b32 a67, 0
    v_accvgpr_write_b32 a68, 0
    v_accvgpr_write_b32 a69, 0
    v_accvgpr_write_b32 a70, 0
    v_accvgpr_write_b32 a71, 0
    v_accvgpr_write_b32 a72, 0
    v_accvgpr_write_b32 a73, 0
    v_accvgpr_write_b32 a74, 0
    v_accvgpr_write_b32 a75, 0
    v_accvgpr_write_b32 a76, 0
    v_accvgpr_write_b32 a77, 0
    v_accvgpr_write_b32 a78, 0
    v_accvgpr_write_b32 a79, 0
    v_accvgpr_write_b32 a80, 0
    v_accvgpr_write_b32 a81, 0
    v_accvgpr_write_b32 a82, 0
    v_accvgpr_write_b32 a83, 0
    v_accvgpr_write_b32 a84, 0
    v_accvgpr_write_b32 a85, 0
    v_accvgpr_write_b32 a86, 0
    v_accvgpr_write_b32 a87, 0
    v_accvgpr_write_b32 a88, 0
    v_accvgpr_write_b32 a89, 0
    v_accvgpr_write_b32 a90, 0
    v_accvgpr_write_b32 a91, 0
    v_accvgpr_write_b32 a92, 0
    v_accvgpr_write_b32 a93, 0
    v_accvgpr_write_b32 a94, 0
    v_accvgpr_write_b32 a95, 0
    s_waitcnt vmcnt(32)
    s_barrier
    ds_read_b64_tr_b16 v[64:65], v18 offset:0
    ds_read_b64_tr_b16 v[66:67], v18 offset:1024
    ds_read_b64_tr_b16 v[68:69], v19 offset:0
    ds_read_b64_tr_b16 v[70:71], v19 offset:1024
    ds_read_b128 v[80:83], v16 offset:0
    ds_read_b128 v[84:87], v16 offset:2048
    s_mov_b32 s69, 0
    s_waitcnt lgkmcnt(0)
L_g1_loopvh:
    v_mfma_f32_32x32x16_bf16 a[0:15], v[80:83], v[64:67], a[0:15]
    ds_read_b64_tr_b16 v[96:97], v18 offset:4096
    v_mfma_f32_32x32x16_bf16 a[64:79], v[80:83], v[68:71], a[64:79]
    ds_read_b64_tr_b16 v[98:99], v18 offset:5120
    v_mfma_f32_32x32x16_bf16 a[16:31], v[84:87], v[64:67], a[16:31]
    ds_read_b64_tr_b16 v[100:101], v19 offset:4096
    v_mfma_f32_32x32x16_bf16 a[80:95], v[84:87], v[68:71], a[80:95]
    ds_read_b64_tr_b16 v[102:103], v19 offset:5120
    ds_read_b128 v[112:115], v17 offset:0
    ds_read_b128 v[116:119], v17 offset:2048
    s_waitcnt lgkmcnt(0)
    s_cmp_lt_u32 s69, 10
    s_cbranch_scc1 L_g1_w8vh
    s_waitcnt vmcnt(0)
    s_branch L_g1_wdvh
L_g1_w8vh:
    s_waitcnt vmcnt(28)
L_g1_wdvh:
    s_barrier
    s_add_u32 s71, s71, 16384
    s_cmp_eq_u32 s71, 147456
    s_mov_b32 s72, 16384
    s_cselect_b32 s72, 0xfffe0000, s72
    s_cselect_b32 s71, 0, s71
    v_add_u32 v16, s72, v16
    v_add_u32 v17, s72, v17
    v_add_u32 v18, s72, v18
    v_add_u32 v19, s72, v19
    s_cmp_lt_u32 s69, 9
    s_cbranch_scc0 L_g1_nodmavh
    v_mfma_f32_32x32x16_bf16 a[0:15], v[112:115], v[96:99], a[0:15]
    ds_read_b64_tr_b16 v[64:65], v18 offset:0
    s_add_u32 s77, s70, s78
    s_add_u32 s79, s70, s81
    s_mov_b32 m0, s77
    s_nop 0
    buffer_load_dwordx4 v2, s[48:51], s68 offen lds
    v_mfma_f32_32x32x16_bf16 a[64:79], v[112:115], v[100:103], a[64:79]
    ds_read_b64_tr_b16 v[66:67], v18 offset:1024
    s_add_u32 m0, s77, 1024
    s_add_u32 s73, s68, 18432
    buffer_load_dwordx4 v2, s[48:51], s73 offen lds
    v_mfma_f32_32x32x16_bf16 a[16:31], v[116:119], v[96:99], a[16:31]
    ds_read_b64_tr_b16 v[68:69], v19 offset:0
    s_add_u32 m0, s79, 0
    s_nop 0
    buffer_load_dwordx4 v3, s[52:55], s66 offen lds
    v_mfma_f32_32x32x16_bf16 a[80:95], v[116:119], v[100:103], a[80:95]
    ds_read_b64_tr_b16 v[70:71], v19 offset:1024
    s_add_u32 m0, s79, 1024
    s_add_u32 s73, s66, s80
    buffer_load_dwordx4 v3, s[52:55], s73 offen lds
    ds_read_b128 v[80:83], v16 offset:0
    ds_read_b128 v[84:87], v16 offset:2048
    s_add_u32 s68, s68, 64
    s_add_u32 s66, s66, s82
    s_add_u32 s67, s67, s82
    s_add_u32 s70, s70, 16384
    s_cmp_eq_u32 s70, 147456
    s_cselect_b32 s70, 0, s70
    s_branch L_g1_jvh
L_g1_nodmavh:
    v_mfma_f32_32x32x16_bf16 a[0:15], v[112:115], v[96:99], a[0:15]
    ds_read_b64_tr_b16 v[64:65], v18 offset:0
    v_mfma_f32_32x32x16_bf16 a[64:79], v[112:115], v[100:103], a[64:79]
    ds_read_b64_tr_b16 v[66:67], v18 offset:1024
    v_mfma_f32_32x32x16_bf16 a[16:31], v[116:119], v[96:99], a[16:31]
    ds_read_b64_tr_b16 v[68:69], v19 offset:0
    v_mfma_f32_32x32x16_bf16 a[80:95], v[116:119], v[100:103], a[80:95]
    ds_read_b64_tr_b16 v[70:71], v19 offset:1024
    ds_read_b128 v[80:83], v16 offset:0
    ds_read_b128 v[84:87], v16 offset:2048
L_g1_jvh:
    s_waitcnt lgkmcnt(0)
    s_add_u32 s69, s69, 1
    s_cmp_lt_u32 s69, 18
    s_cbranch_scc1 L_g1_loopvh
    s_nop 15
    v_accvgpr_read_b32 v128, a0
    v_accvgpr_read_b32 v129, a1
    v_accvgpr_read_b32 v130, a2
    v_accvgpr_read_b32 v131, a3
    v_accvgpr_read_b32 v132, a4
    v_accvgpr_read_b32 v133, a5
    v_accvgpr_read_b32 v134, a6
    v_accvgpr_read_b32 v135, a7
    v_accvgpr_read_b32 v136, a8
    v_accvgpr_read_b32 v137, a9
    v_accvgpr_read_b32 v138, a10
    v_accvgpr_read_b32 v139, a11
    v_accvgpr_read_b32 v140, a12
    v_accvgpr_read_b32 v141, a13
    v_accvgpr_read_b32 v142, a14
    v_accvgpr_read_b32 v143, a15
    v_cvt_pk_bf16_f32 v144, v128, v129
    v_cvt_pk_bf16_f32 v145, v130, v131
    v_cvt_pk_bf16_f32 v146, v132, v133
    v_cvt_pk_bf16_f32 v147, v134, v135
    v_cvt_pk_bf16_f32 v148, v136, v137
    v_cvt_pk_bf16_f32 v149, v138, v139
    v_cvt_pk_bf16_f32 v150, v140, v141
    v_cvt_pk_bf16_f32 v151, v142, v143
    v_permlane32_swap_b32 v144, v146
    v_permlane32_swap_b32 v145, v147
    v_permlane32_swap_b32 v148, v150
    v_permlane32_swap_b32 v149, v151
    s_mul_i32 s72, s76, 524288
    s_lshl_b32 s73, s75, 12
    s_add_u32 s72, s72, s73
    s_add_u32 s72, s72, 0
    s_add_u32 s62, s60, s72
    s_addc_u32 s63, s61, 0
    global_store_dwordx4 v9, v[144:147], s[62:63] sc1
    global_store_dwordx4 v9, v[148:151], s[62:63] offset:512 sc1
    v_accvgpr_read_b32 v128, a16
    v_accvgpr_read_b32 v129, a17
    v_accvgpr_read_b32 v130, a18
    v_accvgpr_read_b32 v131, a19
    v_accvgpr_read_b32 v132, a20
    v_accvgpr_read_b32 v133, a21
    v_accvgpr_read_b32 v134, a22
    v_accvgpr_read_b32 v135, a23
    v_accvgpr_read_b32 v136, a24
    v_accvgpr_read_b32 v137, a25
    v_accvgpr_read_b32 v138, a26
    v_accvgpr_read_b32 v139, a27
    v_accvgpr_read_b32 v140, a28
    v_accvgpr_read_b32 v141, a29
    v_accvgpr_read_b32 v142, a30
    v_accvgpr_read_b32 v143, a31
    v_cvt_pk_bf16_f32 v152, v128, v129
    v_cvt_pk_bf16_f32 v153, v130, v131
    v_cvt_pk_bf16_f32 v154, v132, v133
    v_cvt_pk_bf16_f32 v155, v134, v135
    v_cvt_pk_bf16_f32 v156, v136, v137
    v_cvt_pk_bf16_f32 v157, v138, v139
    v_cvt_pk_bf16_f32 v158, v140, v141
    v_cvt_pk_bf16_f32 v159, v142, v143
    v_permlane32_swap_b32 v152, v154
    v_permlane32_swap_b32 v153, v155
    v_permlane32_swap_b32 v156, v158
    v_permlane32_swap_b32 v157, v159
    s_mul_i32 s72, s76, 524288
    s_lshl_b32 s73, s75, 12
    s_add_u32 s72, s72, s73
    s_add_u32 s72, s72, 262144
    s_add_u32 s62, s60, s72
    s_addc_u32 s63, s61, 0
    global_store_dwordx4 v9, v[152:155], s[62:63] sc1
    global_store_dwordx4 v9, v[156:159], s[62:63] offset:512 sc1
    v_accvgpr_read_b32 v128, a64
    v_accvgpr_read_b32 v129, a65
    v_accvgpr_read_b32 v130, a66
    v_accvgpr_read_b32 v131, a67
    v_accvgpr_read_b32 v132, a68
    v_accvgpr_read_b32 v133, a69
    v_accvgpr_read_b32 v134, a70
    v_accvgpr_read_b32 v135, a71
    v_accvgpr_read_b32 v136, a72
    v_accvgpr_read_b32 v137, a73
    v_accvgpr_read_b32 v138, a74
    v_accvgpr_read_b32 v139, a75
    v_accvgpr_read_b32 v140, a76
    v_accvgpr_read_b32 v141, a77
    v_accvgpr_read_b32 v142, a78
    v_accvgpr_read_b32 v143, a79
    v_cvt_pk_bf16_f32 v144, v128, v129
    v_cvt_pk_bf16_f32 v145, v130, v131
    v_cvt_pk_bf16_f32 v146, v132, v133
    v_cvt_pk_bf16_f32 v147, v134, v135
    v_cvt_pk_bf16_f32 v148, v136, v137
    v_cvt_pk_bf16_f32 v149, v138, v139
    v_cvt_pk_bf16_f32 v150, v140, v141
    v_cvt_pk_bf16_f32 v151, v142, v143
    v_permlane32_swap_b32 v144, v146
    v_permlane32_swap_b32 v145, v147
    v_permlane32_swap_b32 v148, v150
    v_permlane32_swap_b32 v149, v151
    s_mul_i32 s72, s76, 524288
    s_lshl_b32 s73, s75, 12
    s_add_u32 s72, s72, s73
    s_add_u32 s72, s72, 2048
    s_add_u32 s62, s60, s72
    s_addc_u32 s63, s61, 0
    global_store_dwordx4 v9, v[144:147], s[62:63] sc1
    global_store_dwordx4 v9, v[148:151], s[62:63] offset:512 sc1
    v_accvgpr_read_b32 v128, a80
    v_accvgpr_read_b32 v129, a81
    v_accvgpr_read_b32 v130, a82
    v_accvgpr_read_b32 v131, a83
    v_accvgpr_read_b32 v132, a84
    v_accvgpr_read_b32 v133, a85
    v_accvgpr_read_b32 v134, a86
    v_accvgpr_read_b32 v135, a87
    v_accvgpr_read_b32 v136, a88
    v_accvgpr_read_b32 v137, a89
    v_accvgpr_read_b32 v138, a90
    v_accvgpr_read_b32 v139, a91
    v_accvgpr_read_b32 v140, a92
    v_accvgpr_read_b32 v141, a93
    v_accvgpr_read_b32 v142, a94
    v_accvgpr_read_b32 v143, a95
    v_cvt_pk_bf16_f32 v152, v128, v129
    v_cvt_pk_bf16_f32 v153, v130, v131
    v_cvt_pk_bf16_f32 v154, v132, v133
    v_cvt_pk_bf16_f32 v155, v134, v135
    v_cvt_pk_bf16_f32 v156, v136, v137
    v_cvt_pk_bf16_f32 v157, v138, v139
    v_cvt_pk_bf16_f32 v158, v140, v141
    v_cvt_pk_bf16_f32 v159, v142, v143
    v_permlane32_swap_b32 v152, v154
    v_permlane32_swap_b32 v153, v155
    v_permlane32_swap_b32 v156, v158
    v_permlane32_swap_b32 v157, v159
    s_mul_i32 s72, s76, 524288
    s_lshl_b32 s73, s75, 12
    s_add_u32 s72, s72, s73
    s_add_u32 s72, s72, 264192
    s_add_u32 s62, s60, s72
    s_addc_u32 s63, s61, 0
    global_store_dwordx4 v9, v[152:155], s[62:63] sc1
    global_store_dwordx4 v9, v[156:159], s[62:63] offset:512 sc1
L_wk_hs:
    s_mul_i32 s21, s21, 4294967292
    s_waitcnt vmcnt(0)
    s_barrier
    s_cmp_lg_u32 s16, 0
    s_cbranch_scc1 L_wk_hsg
    s_lshl_b32 s18, s21, 2
    s_add_u32 s18, s18, 64
    v_mov_b32 v10, s18
    v_mov_b32 v11, 1
    s_mov_b64 exec, 1
    global_atomic_add v10, v11, s[6:7] sc1
    s_mov_b64 exec, -1
L_wk_hsg:
    s_branch L_wk_next
L_wk_q:
    s_and_b32 s75, s16, 1
    s_lshr_b32 s76, s16, 1
    v_lshrrev_b32 v10, 2, v1
    v_mul_u32_u24 v2, 1152, v10
    v_and_b32 v10, 3, v1
    v_bfe_u32 v11, v1, 4, 2
    v_xor_b32 v10, v10, v11
    v_lshl_add_u32 v2, v10, 4, v2
    v_and_b32 v10, 31, v1
    v_lshrrev_b32 v11, 5, v1
    v_bfe_u32 v12, v1, 2, 2
    v_xor_b32 v11, v11, v12
    v_lshlrev_b32 v4, 6, v10
    v_lshl_add_u32 v4, v11, 4, v4
    s_lshl_b32 s72, s76, 13
    v_add_u32 v4, s72, v4
    v_xor_b32 v5, 32, v4
    s_lshl_b32 s72, s76, 12
    v_subrev_u32 v16, s72, v4
    v_xor_b32 v17, 32, v16
    v_bfe_u32 v10, v1, 2, 2
    v_lshrrev_b32 v11, 5, v1
    v_lshl_add_u32 v11, v11, 3, v10
    v_lshlrev_b32 v11, 8, v11
    v_bfe_u32 v12, v1, 4, 1
    v_lshlrev_b32 v12, 1, v12
    v_bfe_u32 v13, v1, 1, 1
    v_add_u32 v12, v12, v13
    v_lshl_add_u32 v11, v12, 4, v11
    v_and_b32 v12, 1, v1
    v_lshl_add_u32 v11, v12, 3, v11
    v_add_u32 v11, 16384, v11
    s_lshl_b32 s72, s75, 1
    v_xor_b32 v12, s72, v10
    v_lshl_add_u32 v6, v12, 6, v11
    v_xor_b32 v12, 1, v12
    v_lshl_add_u32 v7, v12, 6, v11
    v_subrev_u32 v18, 8192, v6
    v_subrev_u32 v19, 8192, v7
    v_and_b32 v10, 31, v1
    v_lshrrev_b32 v11, 5, v1
    v_lshrrev_b32 v12, 3, v10
    v_lshlrev_b32 v12, 2, v12
    v_and_b32 v13, 3, v10
    v_add_u32 v12, v12, v13
    v_lshl_add_u32 v12, v11, 4, v12
    v_lshlrev_b32 v12, 4, v12
    v_bfe_u32 v13, v10, 2, 1
    v_lshl_add_u32 v8, v13, 10, v12
    v_and_b32 v12, 15, v10
    v_lshl_add_u32 v12, v11, 4, v12
    v_lshlrev_b32 v12, 4, v12
    v_lshrrev_b32 v13, 4, v10
    v_lshl_add_u32 v9, v13, 10, v12
    v_lshlrev_b32 v14, 4, v1
    s_sub_u32 s18, s17, 544
    s_lshr_b32 s21, s18, 4
    s_and_b32 s18, s18, 15
    s_load_dwordx2 s[10:11], s[0:1], 16
    s_waitcnt lgkmcnt(0)
    s_mov_b32 s48, s8
    s_mov_b32 s49, s9
    s_mov_b32 s50, 2359296
    s_mov_b32 s51, 0x00020000
    s_mov_b32 s52, s10
    s_mov_b32 s53, s11
    s_mov_b32 s54, 4718592
    s_mov_b32 s55, 0x00020000
    s_mov_b32 s56, s10
    s_mov_b32 s57, s11
    s_mov_b32 s58, 4718592
    s_mov_b32 s59, 0x00020000
    s_mov_b32 s65, 8192
    v_lshrrev_b32 v10, 4, v1
    v_mul_lo_u32 v3, v10, s65
    v_lshlrev_b32 v10, 2, v10
    v_and_b32 v11, 15, v1
    v_xor_b32 v10, v10, v11
    v_lshl_add_u32 v3, v10, 4, v3
    s_mul_i32 s68, s21, 294912
    s_lshl_b32 s66, s18, 9
    s_add_u32 s67, s66, 256
    s_lshl_b32 s72, s21, 21
    s_lshl_b32 s73, s18, 14
    s_add_u32 s72, s72, s73
    s_add_u32 s60, s4, 0x2000000
    s_addc_u32 s61, s5, 0
    s_add_u32 s60, s60, s72
    s_addc_u32 s61, s61, 0
    s_mov_b32 s70, 0
    s_mov_b32 s71, 0
    s_mul_i32 s72, s16, 73728
    s_add_u32 s68, s68, s72
    s_lshl_b32 s80, s65, 2
    s_mul_i32 s72, s16, s80
    s_lshl_b32 s72, s72, 1
    s_add_u32 s66, s66, s72
    s_add_u32 s67, s67, s72
    s_mul_i32 s78, s16, 4096
    s_lshl_b32 s81, s16, 11
    s_add_u32 s81, s81, 16384
    s_lshl_b32 s82, s65, 5
    s_add_u32 s77, s70, s78
    s_add_u32 s79, s70, s81
    s_mov_b32 m0, s77
    s_nop 0
    buffer_load_dwordx4 v2, s[48:51], s68 offen lds
    s_add_u32 m0, s77, 1024
    s_add_u32 s73, s68, 18432
    buffer_load_dwordx4 v2, s[48:51], s73 offen lds
    s_add_u32 m0, s77, 2048
    s_add_u32 s73, s68, 36864
    buffer_load_dwordx4 v2, s[48:51], s73 offen lds
    s_add_u32 m0, s77, 3072
    s_add_u32 s73, s68, 55296
    buffer_load_dwordx4 v2, s[48:51], s73 offen lds
    s_add_u32 m0, s79, 0
    s_nop 0
    buffer_load_dwordx4 v3, s[52:55], s66 offen lds
    s_add_u32 m0, s79, 1024
    s_add_u32 s73, s66, s80
    buffer_load_dwordx4 v3, s[52:55], s73 offen lds
    s_add_u32 m0, s79, 8192
    s_nop 0
    buffer_load_dwordx4 v3, s[56:59], s67 offen lds
    s_add_u32 m0, s79, 9216
    s_add_u32 s73, s67, s80
    buffer_load_dwordx4 v3, s[56:59], s73 offen lds
    s_add_u32 s68, s68, 64
    s_add_u32 s66, s66, s82
    s_add_u32 s67, s67, s82
    s_add_u32 s70, s70, 32768
    s_cmp_eq_u32 s70, 131072
    s_cselect_b32 s70, 0, s70
    s_add_u32 s77, s70, s78
    s_add_u32 s79, s70, s81
    s_mov_b32 m0, s77
    s_nop 0
    buffer_load_dwordx4 v2, s[48:51], s68 offen lds
    s_add_u32 m0, s77, 1024
    s_add_u32 s73, s68, 18432
    buffer_load_dwordx4 v2, s[48:51], s73 offen lds
    s_add_u32 m0, s77, 2048
    s_add_u32 s73, s68, 36864
    buffer_load_dwordx4 v2, s[48:51], s73 offen lds
    s_add_u32 m0, s77, 3072
    s_add_u32 s73, s68, 55296
    buffer_load_dwordx4 v2, s[48:51], s73 offen lds
    s_add_u32 m0, s79, 0
    s_nop 0
    buffer_load_dwordx4 v3, s[52:55], s66 offen lds
    s_add_u32 m0, s79, 1024
    s_add_u32 s73, s66, s80
    buffer_load_dwordx4 v3, s[52:55], s73 offen lds
    s_add_u32 m0, s79, 8192
    s_nop 0
    buffer_load_dwordx4 v3, s[56:59], s67 offen lds
    s_add_u32 m0, s79, 9216
    s_add_u32 s73, s67, s80
    buffer_load_dwordx4 v3, s[56:59], s73 offen lds
    s_add_u32 s68, s68, 64
    s_add_u32 s66, s66, s82
    s_add_u32 s67, s67, s82
    s_add_u32 s70, s70, 32768
    s_cmp_eq_u32 s70, 131072
    s_cselect_b32 s70, 0, s70
    s_add_u32 s77, s70, s78
    s_add_u32 s79, s70, s81
    s_mov_b32 m0, s77
    s_nop 0
    buffer_load_dwordx4 v2, s[48:51], s68 offen lds
    s_add_u32 m0, s77, 1024
    s_add_u32 s73, s68, 18432
    buffer_load_dwordx4 v2, s[48:51], s73 offen lds
    s_add_u32 m0, s77, 2048
    s_add_u32 s73, s68, 36864
    buffer_load_dwordx4 v2, s[48:51], s73 offen lds
    s_add_u32 m0, s77, 3072
    s_add_u32 s73, s68, 55296
    buffer_load_dwordx4 v2, s[48:51], s73 offen lds
    s_add_u32 m0, s79, 0
    s_nop 0
    buffer_load_dwordx4 v3, s[52:55], s66 offen lds
    s_add_u32 m0, s79, 1024
    s_add_u32 s73, s66, s80
    buffer_load_dwordx4 v3, s[52:55], s73 offen lds
    s_add_u32 m0, s79, 8192
    s_nop 0
    buffer_load_dwordx4 v3, s[56:59], s67 offen lds
    s_add_u32 m0, s79, 9216
    s_add_u32 s73, s67, s80
    buffer_load_dwordx4 v3, s[56:59], s73 offen lds
    s_add_u32 s68, s68, 64
    s_add_u32 s66, s66, s82
    s_add_u32 s67, s67, s82
    s_add_u32 s70, s70, 32768
    s_cmp_eq_u32 s70, 131072
    s_cselect_b32 s70, 0, s70
    s_add_u32 s77, s70, s78
    s_add_u32 s79, s70, s81
    s_mov_b32 m0, s77
    s_nop 0
    buffer_load_dwordx4 v2, s[48:51], s68 offen lds
    s_add_u32 m0, s77, 1024
    s_add_u32 s73, s68, 18432
    buffer_load_dwordx4 v2, s[48:51], s73 offen lds
    s_add_u32 m0, s77, 2048
    s_add_u32 s73, s68, 36864
    buffer_load_dwordx4 v2, s[48:51], s73 offen lds
    s_add_u32 m0, s77, 3072
    s_add_u32 s73, s68, 55296
    buffer_load_dwordx4 v2, s[48:51], s73 offen lds
    s_add_u32 m0, s79, 0
    s_nop 0
    buffer_load_dwordx4 v3, s[52:55], s66 offen lds
    s_add_u32 m0, s79, 1024
    s_add_u32 s73, s66, s80
    buffer_load_dwordx4 v3, s[52:55], s73 offen lds
    s_add_u32 m0, s79, 8192
    s_nop 0
    buffer_load_dwordx4 v3, s[56:59], s67 offen lds
    s_add_u32 m0, s79, 9216
    s_add_u32 s73, s67, s80
    buffer_load_dwordx4 v3, s[56:59], s73 offen lds
    s_add_u32 s68, s68, 64
    s_add_u32 s66, s66, s82
    s_add_u32 s67, s67, s82
    s_add_u32 s70, s70, 32768
    s_cmp_eq_u32 s70, 131072
    s_cselect_b32 s70, 0, s70
    v_accvgpr_write_b32 a0, 0
    v_accvgpr_write_b32 a1, 0
    v_accvgpr_write_b32 a2, 0
    v_accvgpr_write_b32 a3, 0
    v_accvgpr_write_b32 a4, 0
    v_accvgpr_write_b32 a5, 0
    v_accvgpr_write_b32 a6, 0
    v_accvgpr_write_b32 a7, 0
    v_accvgpr_write_b32 a8, 0
    v_accvgpr_write_b32 a9, 0
    v_accvgpr_write_b32 a10, 0
    v_accvgpr_write_b32 a11, 0
    v_accvgpr_write_b32 a12, 0
    v_accvgpr_write_b32 a13, 0
    v_accvgpr_write_b32 a14, 0
    v_accvgpr_write_b32 a15, 0
    v_accvgpr_write_b32 a16, 0
    v_accvgpr_write_b32 a17, 0
    v_accvgpr_write_b32 a18, 0
    v_accvgpr_write_b32 a19, 0
    v_accvgpr_write_b32 a20, 0
    v_accvgpr_write_b32 a21, 0
    v_accvgpr_write_b32 a22, 0
    v_accvgpr_write_b32 a23, 0
    v_accvgpr_write_b32 a24, 0
    v_accvgpr_write_b32 a25, 0
    v_accvgpr_write_b32 a26, 0
    v_accvgpr_write_b32 a27, 0
    v_accvgpr_write_b32 a28, 0
    v_accvgpr_write_b32 a29, 0
    v_accvgpr_write_b32 a30, 0
    v_accvgpr_write_b32 a31, 0
    v_accvgpr_write_b32 a32, 0
    v_accvgpr_write_b32 a33, 0
    v_accvgpr_write_b32 a34, 0
    v_accvgpr_write_b32 a35, 0
    v_accvgpr_write_b32 a36, 0
    v_accvgpr_write_b32 a37, 0
    v_accvgpr_write_b32 a38, 0
    v_accvgpr_write_b32 a39, 0
    v_accvgpr_write_b32 a40, 0
    v_accvgpr_write_b32 a41, 0
    v_accvgpr_write_b32 a42, 0
    v_accvgpr_write_b32 a43, 0
    v_accvgpr_write_b32 a44, 0
    v_accvgpr_write_b32 a45, 0
    v_accvgpr_write_b32 a46, 0
    v_accvgpr_write_b32 a47, 0
    v_accvgpr_write_b32 a48, 0
    v_accvgpr_write_b32 a49, 0
    v_accvgpr_write_b32 a50, 0
    v_accvgpr_write_b32 a51, 0
    v_accvgpr_write_b32 a52, 0
    v_accvgpr_write_b32 a53, 0
    v_accvgpr_write_b32 a54, 0
    v_accvgpr_write_b32 a55, 0
    v_accvgpr_write_b32 a56, 0
    v_accvgpr_write_b32 a57, 0
    v_accvgpr_write_b32 a58, 0
    v_accvgpr_write_b32 a59, 0
    v_accvgpr_write_b32 a60, 0
    v_accvgpr_write_b32 a61, 0
    v_accvgpr_write_b32 a62, 0
    v_accvgpr_write_b32 a63, 0
    v_accvgpr_write_b32 a64, 0
    v_accvgpr_write_b32 a65, 0
    v_accvgpr_write_b32 a66, 0
    v_accvgpr_write_b32 a67, 0
    v_accvgpr_write_b32 a68, 0
    v_accvgpr_write_b32 a69, 0
    v_accvgpr_write_b32 a70, 0
    v_accvgpr_write_b32 a71, 0
    v_accvgpr_write_b32 a72, 0
    v_accvgpr_write_b32 a73, 0
    v_accvgpr_write_b32 a74, 0
    v_accvgpr_write_b32 a75, 0
    v_accvgpr_write_b32 a76, 0
    v_accvgpr_write_b32 a77, 0
    v_accvgpr_write_b32 a78, 0
    v_accvgpr_write_b32 a79, 0
    v_accvgpr_write_b32 a80, 0
    v_accvgpr_write_b32 a81, 0
    v_accvgpr_write_b32 a82, 0
    v_accvgpr_write_b32 a83, 0
    v_accvgpr_write_b32 a84, 0
    v_accvgpr_write_b32 a85, 0
    v_accvgpr_write_b32 a86, 0
    v_accvgpr_write_b32 a87, 0
    v_accvgpr_write_b32 a88, 0
    v_accvgpr_write_b32 a89, 0
    v_accvgpr_write_b32 a90, 0
    v_accvgpr_write_b32 a91, 0
    v_accvgpr_write_b32 a92, 0
    v_accvgpr_write_b32 a93, 0
    v_accvgpr_write_b32 a94, 0
    v_accvgpr_write_b32 a95, 0
    v_accvgpr_write_b32 a96, 0
    v_accvgpr_write_b32 a97, 0
    v_accvgpr_write_b32 a98, 0
    v_accvgpr_write_b32 a99, 0
    v_accvgpr_write_b32 a100, 0
    v_accvgpr_write_b32 a101, 0
    v_accvgpr_write_b32 a102, 0
    v_accvgpr_write_b32 a103, 0
    v_accvgpr_write_b32 a104, 0
    v_accvgpr_write_b32 a105, 0
    v_accvgpr_write_b32 a106, 0
    v_accvgpr_write_b32 a107, 0
    v_accvgpr_write_b32 a108, 0
    v_accvgpr_write_b32 a109, 0
    v_accvgpr_write_b32 a110, 0
    v_accvgpr_write_b32 a111, 0
    v_accvgpr_write_b32 a112, 0
    v_accvgpr_write_b32 a113, 0
    v_accvgpr_write_b32 a114, 0
    v_accvgpr_write_b32 a115, 0
    v_accvgpr_write_b32 a116, 0
    v_accvgpr_write_b32 a117, 0
    v_accvgpr_write_b32 a118, 0
    v_accvgpr_write_b32 a119, 0
    v_accvgpr_write_b32 a120, 0
    v_accvgpr_write_b32 a121, 0
    v_accvgpr_write_b32 a122, 0
    v_accvgpr_write_b32 a123, 0
    v_accvgpr_write_b32 a124, 0
    v_accvgpr_write_b32 a125, 0
    v_accvgpr_write_b32 a126, 0
    v_accvgpr_write_b32 a127, 0
    v_accvgpr_write_b32 a128, 0
    v_accvgpr_write_b32 a129, 0
    v_accvgpr_write_b32 a130, 0
    v_accvgpr_write_b32 a131, 0
    v_accvgpr_write_b32 a132, 0
    v_accvgpr_write_b32 a133, 0
    v_accvgpr_write_b32 a134, 0
    v_accvgpr_write_b32 a135, 0
    v_accvgpr_write_b32 a136, 0
    v_accvgpr_write_b32 a137, 0
    v_accvgpr_write_b32 a138, 0
    v_accvgpr_write_b32 a139, 0
    v_accvgpr_write_b32 a140, 0
    v_accvgpr_write_b32 a141, 0
    v_accvgpr_write_b32 a142, 0
    v_accvgpr_write_b32 a143, 0
    v_accvgpr_write_b32 a144, 0
    v_accvgpr_write_b32 a145, 0
    v_accvgpr_write_b32 a146, 0
    v_accvgpr_write_b32 a147, 0
    v_accvgpr_write_b32 a148, 0
    v_accvgpr_write_b32 a149, 0
    v_accvgpr_write_b32 a150, 0
    v_accvgpr_write_b32 a151, 0
    v_accvgpr_write_b32 a152, 0
    v_accvgpr_write_b32 a153, 0
    v_accvgpr_write_b32 a154, 0
    v_accvgpr_write_b32 a155, 0
    v_accvgpr_write_b32 a156, 0
    v_accvgpr_write_b32 a157, 0
    v_accvgpr_write_b32 a158, 0
    v_accvgpr_write_b32 a159, 0
    v_accvgpr_write_b32 a160, 0
    v_accvgpr_write_b32 a161, 0
    v_accvgpr_write_b32 a162, 0
    v_accvgpr_write_b32 a163, 0
    v_accvgpr_write_b32 a164, 0
    v_accvgpr_write_b32 a165, 0
    v_accvgpr_write_b32 a166, 0
    v_accvgpr_write_b32 a167, 0
    v_accvgpr_write_b32 a168, 0
    v_accvgpr_write_b32 a169, 0
    v_accvgpr_write_b32 a170, 0
    v_accvgpr_write_b32 a171, 0
    v_accvgpr_write_b32 a172, 0
    v_accvgpr_write_b32 a173, 0
    v_accvgpr_write_b32 a174, 0
    v_accvgpr_write_b32 a175, 0
    v_accvgpr_write_b32 a176, 0
    v_accvgpr_write_b32 a177, 0
    v_accvgpr_write_b32 a178, 0
    v_accvgpr_write_b32 a179, 0
    v_accvgpr_write_b32 a180, 0
    v_accvgpr_write_b32 a181, 0
    v_accvgpr_write_b32 a182, 0
    v_accvgpr_write_b32 a183, 0
    v_accvgpr_write_b32 a184, 0
    v_accvgpr_write_b32 a185, 0
    v_accvgpr_write_b32 a186, 0
    v_accvgpr_write_b32 a187, 0
    v_accvgpr_write_b32 a188, 0
    v_accvgpr_write_b32 a189, 0
    v_accvgpr_write_b32 a190, 0
    v_accvgpr_write_b32 a191, 0
    v_accvgpr_write_b32 a192, 0
    v_accvgpr_write_b32 a193, 0
    v_accvgpr_write_b32 a194, 0
    v_accvgpr_write_b32 a195, 0
    v_accvgpr_write_b32 a196, 0
    v_accvgpr_write_b32 a197, 0
    v_accvgpr_write_b32 a198, 0
    v_accvgpr_write_b32 a199, 0
    v_accvgpr_write_b32 a200, 0
    v_accvgpr_write_b32 a201, 0
    v_accvgpr_write_b32 a202, 0
    v_accvgpr_write_b32 a203, 0
    v_accvgpr_write_b32 a204, 0
    v_accvgpr_write_b32 a205, 0
    v_accvgpr_write_b32 a206, 0
    v_accvgpr_write_b32 a207, 0
    v_accvgpr_write_b32 a208, 0
    v_accvgpr_write_b32 a209, 0
    v_accvgpr_write_b32 a210, 0
    v_accvgpr_write_b32 a211, 0
    v_accvgpr_write_b32 a212, 0
    v_accvgpr_write_b32 a213, 0
    v_accvgpr_write_b32 a214, 0
    v_accvgpr_write_b32 a215, 0
    v_accvgpr_write_b32 a216, 0
    v_accvgpr_write_b32 a217, 0
    v_accvgpr_write_b32 a218, 0
    v_accvgpr_write_b32 a219, 0
    v_accvgpr_write_b32 a220, 0
    v_accvgpr_write_b32 a221, 0
    v_accvgpr_write_b32 a222, 0
    v_accvgpr_write_b32 a223, 0
    v_accvgpr_write_b32 a224, 0
    v_accvgpr_write_b32 a225, 0
    v_accvgpr_write_b32 a226, 0
    v_accvgpr_write_b32 a227, 0
    v_accvgpr_write_b32 a228, 0
    v_accvgpr_write_b32 a229, 0
    v_accvgpr_write_b32 a230, 0
    v_accvgpr_write_b32 a231, 0
    v_accvgpr_write_b32 a232, 0
    v_accvgpr_write_b32 a233, 0
    v_accvgpr_write_b32 a234, 0
    v_accvgpr_write_b32 a235, 0
    v_accvgpr_write_b32 a236, 0
    v_accvgpr_write_b32 a237, 0
    v_accvgpr_write_b32 a238, 0
    v_accvgpr_write_b32 a239, 0
    v_accvgpr_write_b32 a240, 0
    v_accvgpr_write_b32 a241, 0
    v_accvgpr_write_b32 a242, 0
    v_accvgpr_write_b32 a243, 0
    v_accvgpr_write_b32 a244, 0
    v_accvgpr_write_b32 a245, 0
    v_accvgpr_write_b32 a246, 0
    v_accvgpr_write_b32 a247, 0
    v_accvgpr_write_b32 a248, 0
    v_accvgpr_write_b32 a249, 0
    v_accvgpr_write_b32 a250, 0
    v_accvgpr_write_b32 a251, 0
    v_accvgpr_write_b32 a252, 0
    v_accvgpr_write_b32 a253, 0
    v_accvgpr_write_b32 a254, 0
    v_accvgpr_write_b32 a255, 0
    s_waitcnt vmcnt(24)
    s_barrier
    ds_read_b64_tr_b16 v[64:65], v6 offset:0
    ds_read_b64_tr_b16 v[66:67], v6 offset:1024
    ds_read_b64_tr_b16 v[68:69], v7 offset:0
    ds_read_b64_tr_b16 v[70:71], v7 offset:1024
    ds_read_b64_tr_b16 v[72:73], v6 offset:8192
    ds_read_b64_tr_b16 v[74:75], v6 offset:9216
    ds_read_b64_tr_b16 v[76:77], v7 offset:8192
    ds_read_b64_tr_b16 v[78:79], v7 offset:9216
    ds_read_b128 v[80:83], v4 offset:0
    ds_read_b128 v[84:87], v4 offset:2048
    ds_read_b128 v[88:91], v4 offset:4096
    ds_read_b128 v[92:95], v4 offset:6144
    s_mov_b32 s69, 0
    s_waitcnt lgkmcnt(0)
L_g1_loopq:
    v_mfma_f32_32x32x16_bf16 a[0:15], v[64:67], v[80:83], a[0:15]
    ds_read_b64_tr_b16 v[96:97], v6 offset:4096
    v_mfma_f32_32x32x16_bf16 a[64:79], v[68:71], v[80:83], a[64:79]
    ds_read_b64_tr_b16 v[98:99], v6 offset:5120
    v_mfma_f32_32x32x16_bf16 a[128:143], v[72:75], v[80:83], a[128:143]
    ds_read_b64_tr_b16 v[100:101], v7 offset:4096
    v_mfma_f32_32x32x16_bf16 a[192:207], v[76:79], v[80:83], a[192:207]
    ds_read_b64_tr_b16 v[102:103], v7 offset:5120
    v_mfma_f32_32x32x16_bf16 a[16:31], v[64:67], v[84:87], a[16:31]
    ds_read_b64_tr_b16 v[104:105], v6 offset:12288
    v_mfma_f32_32x32x16_bf16 a[80:95], v[68:71], v[84:87], a[80:95]
    ds_read_b64_tr_b16 v[106:107], v6 offset:13312
    v_mfma_f32_32x32x16_bf16 a[144:159], v[72:75], v[84:87], a[144:159]
    ds_read_b64_tr_b16 v[108:109], v7 offset:12288
    v_mfma_f32_32x32x16_bf16 a[208:223], v[76:79], v[84:87], a[208:223]
    ds_read_b64_tr_b16 v[110:111], v7 offset:13312
    v_mfma_f32_32x32x16_bf16 a[32:47], v[64:67], v[88:91], a[32:47]
    ds_read_b128 v[112:115], v5 offset:0
    v_mfma_f32_32x32x16_bf16 a[96:111], v[68:71], v[88:91], a[96:111]
    ds_read_b128 v[116:119], v5 offset:2048
    v_mfma_f32_32x32x16_bf16 a[160:175], v[72:75], v[88:91], a[160:175]
    ds_read_b128 v[120:123], v5 offset:4096
    v_mfma_f32_32x32x16_bf16 a[224:239], v[76:79], v[88:91], a[224:239]
    ds_read_b128 v[124:127], v5 offset:6144
    v_mfma_f32_32x32x16_bf16 a[48:63], v[64:67], v[92:95], a[48:63]
    v_mfma_f32_32x32x16_bf16 a[112:127], v[68:71], v[92:95], a[112:127]
    v_mfma_f32_32x32x16_bf16 a[176:191], v[72:75], v[92:95], a[176:191]
    v_mfma_f32_32x32x16_bf16 a[240:255], v[76:79], v[92:95], a[240:255]
    s_waitcnt lgkmcnt(0)
    s_cmp_lt_u32 s69, 15
    s_cbranch_scc1 L_g1_w8q
    s_waitcnt vmcnt(0)
    s_branch L_g1_wdq
L_g1_w8q:
    s_waitcnt vmcnt(16)
L_g1_wdq:
    s_barrier
    s_add_u32 s71, s71, 32768
    s_cmp_eq_u32 s71, 131072
    s_mov_b32 s72, 32768
    s_cselect_b32 s72, 0xfffe8000, s72
    s_cselect_b32 s71, 0, s71
    v_add_u32 v4, s72, v4
    v_add_u32 v5, s72, v5
    v_add_u32 v6, s72, v6
    v_add_u32 v7, s72, v7
    s_cmp_lt_u32 s69, 14
    s_cbranch_scc0 L_g1_nodmaq
    v_mfma_f32_32x32x16_bf16 a[0:15], v[96:99], v[112:115], a[0:15]
    ds_read_b64_tr_b16 v[64:65], v6 offset:0
    v_mfma_f32_32x32x16_bf16 a[64:79], v[100:103], v[112:115], a[64:79]
    ds_read_b64_tr_b16 v[66:67], v6 offset:1024
    s_add_u32 s77, s70, s78
    s_add_u32 s79, s70, s81
    s_mov_b32 m0, s77
    s_nop 0
    buffer_load_dwordx4 v2, s[48:51], s68 offen lds
    v_mfma_f32_32x32x16_bf16 a[128:143], v[104:107], v[112:115], a[128:143]
    ds_read_b64_tr_b16 v[68:69], v7 offset:0
    v_mfma_f32_32x32x16_bf16 a[192:207], v[108:111], v[112:115], a[192:207]
    ds_read_b64_tr_b16 v[70:71], v7 offset:1024
    s_add_u32 m0, s77, 1024
    s_add_u32 s73, s68, 18432
    buffer_load_dwordx4 v2, s[48:51], s73 offen lds
    v_mfma_f32_32x32x16_bf16 a[16:31], v[96:99], v[116:119], a[16:31]
    ds_read_b64_tr_b16 v[72:73], v6 offset:8192
    v_mfma_f32_32x32x16_bf16 a[80:95], v[100:103], v[116:119], a[80:95]
    ds_read_b64_tr_b16 v[74:75], v6 offset:9216
    s_add_u32 m0, s77, 2048
    s_add_u32 s73, s68, 36864
    buffer_load_dwordx4 v2, s[48:51], s73 offen lds
    v_mfma_f32_32x32x16_bf16 a[144:159], v[104:107], v[116:119], a[144:159]
    ds_read_b64_tr_b16 v[76:77], v7 offset:8192
    v_mfma_f32_32x32x16_bf16 a[208:223], v[108:111], v[116:119], a[208:223]
    ds_read_b64_tr_b16 v[78:79], v7 offset:9216
    s_add_u32 m0, s77, 3072
    s_add_u32 s73, s68, 55296
    buffer_load_dwordx4 v2, s[48:51], s73 offen lds
    v_mfma_f32_32x32x16_bf16 a[32:47], v[96:99], v[120:123], a[32:47]
    ds_read_b128 v[80:83], v4 offset:0
    v_mfma_f32_32x32x16_bf16 a[96:111], v[100:103], v[120:123], a[96:111]
    ds_read_b128 v[84:87], v4 offset:2048
    s_add_u32 m0, s79, 0
    s_nop 0
    buffer_load_dwordx4 v3, s[52:55], s66 offen lds
    v_mfma_f32_32x32x16_bf16 a[160:175], v[104:107], v[120:123], a[160:175]
    ds_read_b128 v[88:91], v4 offset:4096
    v_mfma_f32_32x32x16_bf16 a[224:239], v[108:111], v[120:123], a[224:239]
    ds_read_b128 v[92:95], v4 offset:6144
    s_add_u32 m0, s79, 1024
    s_add_u32 s73, s66, s80
    buffer_load_dwordx4 v3, s[52:55], s73 offen lds
    v_mfma_f32_32x32x16_bf16 a[48:63], v[96:99], v[124:127], a[48:63]
    v_mfma_f32_32x32x16_bf16 a[112:127], v[100:103], v[124:127], a[112:127]
    s_add_u32 m0, s79, 8192
    s_nop 0
    buffer_load_dwordx4 v3, s[56:59], s67 offen lds
    v_mfma_f32_32x32x16_bf16 a[176:191], v[104:107], v[124:127], a[176:191]
    s_add_u32 m0, s79, 9216
    s_add_u32 s73, s67, s80
    buffer_load_dwordx4 v3, s[56:59], s73 offen lds
    v_mfma_f32_32x32x16_bf16 a[240:255], v[108:111], v[124:127], a[240:255]
    s_add_u32 s68, s68, 64
    s_add_u32 s66, s66, s82
    s_add_u32 s67, s67, s82
    s_add_u32 s70, s70, 32768
    s_cmp_eq_u32 s70, 131072
    s_cselect_b32 s70, 0, s70
    s_branch L_g1_jq
L_g1_nodmaq:
    v_mfma_f32_32x32x16_bf16 a[0:15], v[96:99], v[112:115], a[0:15]
    ds_read_b64_tr_b16 v[64:65], v6 offset:0
    v_mfma_f32_32x32x16_bf16 a[64:79], v[100:103], v[112:115], a[64:79]
    ds_read_b64_tr_b16 v[66:67], v6 offset:1024
    v_mfma_f32_32x32x16_bf16 a[128:143], v[104:107], v[112:115], a[128:143]
    ds_read_b64_tr_b16 v[68:69], v7 offset:0
    v_mfma_f32_32x32x16_bf16 a[192:207], v[108:111], v[112:115], a[192:207]
    ds_read_b64_tr_b16 v[70:71], v7 offset:1024
    v_mfma_f32_32x32x16_bf16 a[16:31], v[96:99], v[116:119], a[16:31]
    ds_read_b64_tr_b16 v[72:73], v6 offset:8192
    v_mfma_f32_32x32x16_bf16 a[80:95], v[100:103], v[116:119], a[80:95]
    ds_read_b64_tr_b16 v[74:75], v6 offset:9216
    v_mfma_f32_32x32x16_bf16 a[144:159], v[104:107], v[116:119], a[144:159]
    ds_read_b64_tr_b16 v[76:77], v7 offset:8192
    v_mfma_f32_32x32x16_bf16 a[208:223], v[108:111], v[116:119], a[208:223]
    ds_read_b64_tr_b16 v[78:79], v7 offset:9216
    v_mfma_f32_32x32x16_bf16 a[32:47], v[96:99], v[120:123], a[32:47]
    ds_read_b128 v[80:83], v4 offset:0
    v_mfma_f32_32x32x16_bf16 a[96:111], v[100:103], v[120:123], a[96:111]
    ds_read_b128 v[84:87], v4 offset:2048
    v_mfma_f32_32x32x16_bf16 a[160:175], v[104:107], v[120:123], a[160:175]
    ds_read_b128 v[88:91], v4 offset:4096
    v_mfma_f32_32x32x16_bf16 a[224:239], v[108:111], v[120:123], a[224:239]
    ds_read_b128 v[92:95], v4 offset:6144
    v_mfma_f32_32x32x16_bf16 a[48:63], v[96:99], v[124:127], a[48:63]
    v_mfma_f32_32x32x16_bf16 a[112:127], v[100:103], v[124:127], a[112:127]
    v_mfma_f32_32x32x16_bf16 a[176:191], v[104:107], v[124:127], a[176:191]
    v_mfma_f32_32x32x16_bf16 a[240:255], v[108:111], v[124:127], a[240:255]
L_g1_jq:
    s_waitcnt lgkmcnt(0)
    s_add_u32 s69, s69, 1
    s_cmp_lt_u32 s69, 18
    s_cbranch_scc1 L_g1_loopq
    v_subrev_u32 v4, 65536, v4
    v_subrev_u32 v5, 65536, v5
    v_subrev_u32 v6, 65536, v6
    v_subrev_u32 v7, 65536, v7
    s_nop 15
    v_accvgpr_read_b32 v128, a0
    v_accvgpr_read_b32 v129, a1
    v_accvgpr_read_b32 v130, a2
    v_accvgpr_read_b32 v131, a3
    v_accvgpr_read_b32 v132, a4
    v_accvgpr_read_b32 v133, a5
    v_accvgpr_read_b32 v134, a6
    v_accvgpr_read_b32 v135, a7
    v_accvgpr_read_b32 v136, a8
    v_accvgpr_read_b32 v137, a9
    v_accvgpr_read_b32 v138, a10
    v_accvgpr_read_b32 v139, a11
    v_accvgpr_read_b32 v140, a12
    v_accvgpr_read_b32 v141, a13
    v_accvgpr_read_b32 v142, a14
    v_accvgpr_read_b32 v143, a15
    v_cvt_pk_bf16_f32 v144, v128, v129
    v_cvt_pk_bf16_f32 v145, v130, v131
    v_cvt_pk_bf16_f32 v146, v132, v133
    v_cvt_pk_bf16_f32 v147, v134, v135
    v_cvt_pk_bf16_f32 v148, v136, v137
    v_cvt_pk_bf16_f32 v149, v138, v139
    v_cvt_pk_bf16_f32 v150, v140, v141
    v_cvt_pk_bf16_f32 v151, v142, v143
    v_permlane32_swap_b32 v144, v146
    v_permlane32_swap_b32 v145, v147
    v_permlane32_swap_b32 v148, v150
    v_permlane32_swap_b32 v149, v151
    s_mul_i32 s72, s76, 1048576
    s_lshl_b32 s73, s75, 12
    s_add_u32 s72, s72, s73
    s_add_u32 s72, s72, 0
    s_add_u32 s62, s60, s72
    s_addc_u32 s63, s61, 0
    global_store_dwordx4 v9, v[144:147], s[62:63] sc1
    global_store_dwordx4 v9, v[148:151], s[62:63] offset:512 sc1
    v_accvgpr_read_b32 v128, a16
    v_accvgpr_read_b32 v129, a17
    v_accvgpr_read_b32 v130, a18
    v_accvgpr_read_b32 v131, a19
    v_accvgpr_read_b32 v132, a20
    v_accvgpr_read_b32 v133, a21
    v_accvgpr_read_b32 v134, a22
    v_accvgpr_read_b32 v135, a23
    v_accvgpr_read_b32 v136, a24
    v_accvgpr_read_b32 v137, a25
    v_accvgpr_read_b32 v138, a26
    v_accvgpr_read_b32 v139, a27
    v_accvgpr_read_b32 v140, a28
    v_accvgpr_read_b32 v141, a29
    v_accvgpr_read_b32 v142, a30
    v_accvgpr_read_b32 v143, a31
    v_cvt_pk_bf16_f32 v152, v128, v129
    v_cvt_pk_bf16_f32 v153, v130, v131
    v_cvt_pk_bf16_f32 v154, v132, v133
    v_cvt_pk_bf16_f32 v155, v134, v135
    v_cvt_pk_bf16_f32 v156, v136, v137
    v_cvt_pk_bf16_f32 v157, v138, v139
    v_cvt_pk_bf16_f32 v158, v140, v141
    v_cvt_pk_bf16_f32 v159, v142, v143
    v_permlane32_swap_b32 v152, v154
    v_permlane32_swap_b32 v153, v155
    v_permlane32_swap_b32 v156, v158
    v_permlane32_swap_b32 v157, v159
    s_mul_i32 s72, s76, 1048576
    s_lshl_b32 s73, s75, 12
    s_add_u32 s72, s72, s73
    s_add_u32 s72, s72, 262144
    s_add_u32 s62, s60, s72
    s_addc_u32 s63, s61, 0
    global_store_dwordx4 v9, v[152:155], s[62:63] sc1
    global_store_dwordx4 v9, v[156:159], s[62:63] offset:512 sc1
    v_accvgpr_read_b32 v128, a32
    v_accvgpr_read_b32 v129, a33
    v_accvgpr_read_b32 v130, a34
    v_accvgpr_read_b32 v131, a35
    v_accvgpr_read_b32 v132, a36
    v_accvgpr_read_b32 v133, a37
    v_accvgpr_read_b32 v134, a38
    v_accvgpr_read_b32 v135, a39
    v_accvgpr_read_b32 v136, a40
    v_accvgpr_read_b32 v137, a41
    v_accvgpr_read_b32 v138, a42
    v_accvgpr_read_b32 v139, a43
    v_accvgpr_read_b32 v140, a44
    v_accvgpr_read_b32 v141, a45
    v_accvgpr_read_b32 v142, a46
    v_accvgpr_read_b32 v143, a47
    v_cvt_pk_bf16_f32 v144, v128, v129
    v_cvt_pk_bf16_f32 v145, v130, v131
    v_cvt_pk_bf16_f32 v146, v132, v133
    v_cvt_pk_bf16_f32 v147, v134, v135
    v_cvt_pk_bf16_f32 v148, v136, v137
    v_cvt_pk_bf16_f32 v149, v138, v139
    v_cvt_pk_bf16_f32 v150, v140, v141
    v_cvt_pk_bf16_f32 v151, v142, v143
    v_permlane32_swap_b32 v144, v146
    v_permlane32_swap_b32 v145, v147
    v_permlane32_swap_b32 v148, v150
    v_permlane32_swap_b32 v149, v151
    s_mul_i32 s72, s76, 1048576
    s_lshl_b32 s73, s75, 12
    s_add_u32 s72, s72, s73
    s_add_u32 s72, s72, 524288
    s_add_u32 s62, s60, s72
    s_addc_u32 s63, s61, 0
    global_store_dwordx4 v9, v[144:147], s[62:63] sc1
    global_store_dwordx4 v9, v[148:151], s[62:63] offset:512 sc1
    v_accvgpr_read_b32 v128, a48
    v_accvgpr_read_b32 v129, a49
    v_accvgpr_read_b32 v130, a50
    v_accvgpr_read_b32 v131, a51
    v_accvgpr_read_b32 v132, a52
    v_accvgpr_read_b32 v133, a53
    v_accvgpr_read_b32 v134, a54
    v_accvgpr_read_b32 v135, a55
    v_accvgpr_read_b32 v136, a56
    v_accvgpr_read_b32 v137, a57
    v_accvgpr_read_b32 v138, a58
    v_accvgpr_read_b32 v139, a59
    v_accvgpr_read_b32 v140, a60
    v_accvgpr_read_b32 v141, a61
    v_accvgpr_read_b32 v142, a62
    v_accvgpr_read_b32 v143, a63
    v_cvt_pk_bf16_f32 v152, v128, v129
    v_cvt_pk_bf16_f32 v153, v130, v131
    v_cvt_pk_bf16_f32 v154, v132, v133
    v_cvt_pk_bf16_f32 v155, v134, v135
    v_cvt_pk_bf16_f32 v156, v136, v137
    v_cvt_pk_bf16_f32 v157, v138, v139
    v_cvt_pk_bf16_f32 v158, v140, v141
    v_cvt_pk_bf16_f32 v159, v142, v143
    v_permlane32_swap_b32 v152, v154
    v_permlane32_swap_b32 v153, v155
    v_permlane32_swap_b32 v156, v158
    v_permlane32_swap_b32 v157, v159
    s_mul_i32 s72, s76, 1048576
    s_lshl_b32 s73, s75, 12
    s_add_u32 s72, s72, s73
    s_add_u32 s72, s72, 786432
    s_add_u32 s62, s60, s72
    s_addc_u32 s63, s61, 0
    global_store_dwordx4 v9, v[152:155], s[62:63] sc1
    global_store_dwordx4 v9, v[156:159], s[62:63] offset:512 sc1
    v_accvgpr_read_b32 v128, a64
    v_accvgpr_read_b32 v129, a65
    v_accvgpr_read_b32 v130, a66
    v_accvgpr_read_b32 v131, a67
    v_accvgpr_read_b32 v132, a68
    v_accvgpr_read_b32 v133, a69
    v_accvgpr_read_b32 v134, a70
    v_accvgpr_read_b32 v135, a71
    v_accvgpr_read_b32 v136, a72
    v_accvgpr_read_b32 v137, a73
    v_accvgpr_read_b32 v138, a74
    v_accvgpr_read_b32 v139, a75
    v_accvgpr_read_b32 v140, a76
    v_accvgpr_read_b32 v141, a77
    v_accvgpr_read_b32 v142, a78
    v_accvgpr_read_b32 v143, a79
    v_cvt_pk_bf16_f32 v144, v128, v129
    v_cvt_pk_bf16_f32 v145, v130, v131
    v_cvt_pk_bf16_f32 v146, v132, v133
    v_cvt_pk_bf16_f32 v147, v134, v135
    v_cvt_pk_bf16_f32 v148, v136, v137
    v_cvt_pk_bf16_f32 v149, v138, v139
    v_cvt_pk_bf16_f32 v150, v140, v141
    v_cvt_pk_bf16_f32 v151, v142, v143
    v_permlane32_swap_b32 v144, v146
    v_permlane32_swap_b32 v145, v147
    v_permlane32_swap_b32 v148, v150
    v_permlane32_swap_b32 v149, v151
    s_mul_i32 s72, s76, 1048576
    s_lshl_b32 s73, s75, 12
    s_add_u32 s72, s72, s73
    s_add_u32 s72, s72, 2048
    s_add_u32 s62, s60, s72
    s_addc_u32 s63, s61, 0
    global_store_dwordx4 v9, v[144:147], s[62:63] sc1
    global_store_dwordx4 v9, v[148:151], s[62:63] offset:512 sc1
    v_accvgpr_read_b32 v128, a80
    v_accvgpr_read_b32 v129, a81
    v_accvgpr_read_b32 v130, a82
    v_accvgpr_read_b32 v131, a83
    v_accvgpr_read_b32 v132, a84
    v_accvgpr_read_b32 v133, a85
    v_accvgpr_read_b32 v134, a86
    v_accvgpr_read_b32 v135, a87
    v_accvgpr_read_b32 v136, a88
    v_accvgpr_read_b32 v137, a89
    v_accvgpr_read_b32 v138, a90
    v_accvgpr_read_b32 v139, a91
    v_accvgpr_read_b32 v140, a92
    v_accvgpr_read_b32 v141, a93
    v_accvgpr_read_b32 v142, a94
    v_accvgpr_read_b32 v143, a95
    v_cvt_pk_bf16_f32 v152, v128, v129
    v_cvt_pk_bf16_f32 v153, v130, v131
    v_cvt_pk_bf16_f32 v154, v132, v133
    v_cvt_pk_bf16_f32 v155, v134, v135
    v_cvt_pk_bf16_f32 v156, v136, v137
    v_cvt_pk_bf16_f32 v157, v138, v139
    v_cvt_pk_bf16_f32 v158, v140, v141
    v_cvt_pk_bf16_f32 v159, v142, v143
    v_permlane32_swap_b32 v152, v154
    v_permlane32_swap_b32 v153, v155
    v_permlane32_swap_b32 v156, v158
    v_permlane32_swap_b32 v157, v159
    s_mul_i32 s72, s76, 1048576
    s_lshl_b32 s73, s75, 12
    s_add_u32 s72, s72, s73
    s_add_u32 s72, s72, 264192
    s_add_u32 s62, s60, s72
    s_addc_u32 s63, s61, 0
    global_store_dwordx4 v9, v[152:155], s[62:63] sc1
    global_store_dwordx4 v9, v[156:159], s[62:63] offset:512 sc1
    v_accvgpr_read_b32 v128, a96
    v_accvgpr_read_b32 v129, a97
    v_accvgpr_read_b32 v130, a98
    v_accvgpr_read_b32 v131, a99
    v_accvgpr_read_b32 v132, a100
    v_accvgpr_read_b32 v133, a101
    v_accvgpr_read_b32 v134, a102
    v_accvgpr_read_b32 v135, a103
    v_accvgpr_read_b32 v136, a104
    v_accvgpr_read_b32 v137, a105
    v_accvgpr_read_b32 v138, a106
    v_accvgpr_read_b32 v139, a107
    v_accvgpr_read_b32 v140, a108
    v_accvgpr_read_b32 v141, a109
    v_accvgpr_read_b32 v142, a110
    v_accvgpr_read_b32 v143, a111
    v_cvt_pk_bf16_f32 v144, v128, v129
    v_cvt_pk_bf16_f32 v145, v130, v131
    v_cvt_pk_bf16_f32 v146, v132, v133
    v_cvt_pk_bf16_f32 v147, v134, v135
    v_cvt_pk_bf16_f32 v148, v136, v137
    v_cvt_pk_bf16_f32 v149, v138, v139
    v_cvt_pk_bf16_f32 v150, v140, v141
    v_cvt_pk_bf16_f32 v151, v142, v143
    v_permlane32_swap_b32 v144, v146
    v_permlane32_swap_b32 v145, v147
    v_permlane32_swap_b32 v148, v150
    v_permlane32_swap_b32 v149, v151
    s_mul_i32 s72, s76, 1048576
    s_lshl_b32 s73, s75, 12
    s_add_u32 s72, s72, s73
    s_add_u32 s72, s72, 526336
    s_add_u32 s62, s60, s72
    s_addc_u32 s63, s61, 0
    global_store_dwordx4 v9, v[144:147], s[62:63] sc1
    global_store_dwordx4 v9, v[148:151], s[62:63] offset:512 sc1
    v_accvgpr_read_b32 v128, a112
    v_accvgpr_read_b32 v129, a113
    v_accvgpr_read_b32 v130, a114
    v_accvgpr_read_b32 v131, a115
    v_accvgpr_read_b32 v132, a116
    v_accvgpr_read_b32 v133, a117
    v_accvgpr_read_b32 v134, a118
    v_accvgpr_read_b32 v135, a119
    v_accvgpr_read_b32 v136, a120
    v_accvgpr_read_b32 v137, a121
    v_accvgpr_read_b32 v138, a122
    v_accvgpr_read_b32 v139, a123
    v_accvgpr_read_b32 v140, a124
    v_accvgpr_read_b32 v141, a125
    v_accvgpr_read_b32 v142, a126
    v_accvgpr_read_b32 v143, a127
    v_cvt_pk_bf16_f32 v152, v128, v129
    v_cvt_pk_bf16_f32 v153, v130, v131
    v_cvt_pk_bf16_f32 v154, v132, v133
    v_cvt_pk_bf16_f32 v155, v134, v135
    v_cvt_pk_bf16_f32 v156, v136, v137
    v_cvt_pk_bf16_f32 v157, v138, v139
    v_cvt_pk_bf16_f32 v158, v140, v141
    v_cvt_pk_bf16_f32 v159, v142, v143
    v_permlane32_swap_b32 v152, v154
    v_permlane32_swap_b32 v153, v155
    v_permlane32_swap_b32 v156, v158
    v_permlane32_swap_b32 v157, v159
    s_mul_i32 s72, s76, 1048576
    s_lshl_b32 s73, s75, 12
    s_add_u32 s72, s72, s73
    s_add_u32 s72, s72, 788480
    s_add_u32 s62, s60, s72
    s_addc_u32 s63, s61, 0
    global_store_dwordx4 v9, v[152:155], s[62:63] sc1
    global_store_dwordx4 v9, v[156:159], s[62:63] offset:512 sc1
    v_accvgpr_read_b32 v128, a128
    v_accvgpr_read_b32 v129, a129
    v_accvgpr_read_b32 v130, a130
    v_accvgpr_read_b32 v131, a131
    v_accvgpr_read_b32 v132, a132
    v_accvgpr_read_b32 v133, a133
    v_accvgpr_read_b32 v134, a134
    v_accvgpr_read_b32 v135, a135
    v_accvgpr_read_b32 v136, a136
    v_accvgpr_read_b32 v137, a137
    v_accvgpr_read_b32 v138, a138
    v_accvgpr_read_b32 v139, a139
    v_accvgpr_read_b32 v140, a140
    v_accvgpr_read_b32 v141, a141
    v_accvgpr_read_b32 v142, a142
    v_accvgpr_read_b32 v143, a143
    v_cvt_pk_bf16_f32 v144, v128, v129
    v_cvt_pk_bf16_f32 v145, v130, v131
    v_cvt_pk_bf16_f32 v146, v132, v133
    v_cvt_pk_bf16_f32 v147, v134, v135
    v_cvt_pk_bf16_f32 v148, v136, v137
    v_cvt_pk_bf16_f32 v149, v138, v139
    v_cvt_pk_bf16_f32 v150, v140, v141
    v_cvt_pk_bf16_f32 v151, v142, v143
    v_permlane32_swap_b32 v144, v146
    v_permlane32_swap_b32 v145, v147
    v_permlane32_swap_b32 v148, v150
    v_permlane32_swap_b32 v149, v151
    s_mul_i32 s72, s76, 1048576
    s_lshl_b32 s73, s75, 12
    s_add_u32 s72, s72, s73
    s_add_u32 s72, s72, 8192
    s_add_u32 s62, s60, s72
    s_addc_u32 s63, s61, 0
    global_store_dwordx4 v9, v[144:147], s[62:63] sc1
    global_store_dwordx4 v9, v[148:151], s[62:63] offset:512 sc1
    v_accvgpr_read_b32 v128, a144
    v_accvgpr_read_b32 v129, a145
    v_accvgpr_read_b32 v130, a146
    v_accvgpr_read_b32 v131, a147
    v_accvgpr_read_b32 v132, a148
    v_accvgpr_read_b32 v133, a149
    v_accvgpr_read_b32 v134, a150
    v_accvgpr_read_b32 v135, a151
    v_accvgpr_read_b32 v136, a152
    v_accvgpr_read_b32 v137, a153
    v_accvgpr_read_b32 v138, a154
    v_accvgpr_read_b32 v139, a155
    v_accvgpr_read_b32 v140, a156
    v_accvgpr_read_b32 v141, a157
    v_accvgpr_read_b32 v142, a158
    v_accvgpr_read_b32 v143, a159
    v_cvt_pk_bf16_f32 v152, v128, v129
    v_cvt_pk_bf16_f32 v153, v130, v131
    v_cvt_pk_bf16_f32 v154, v132, v133
    v_cvt_pk_bf16_f32 v155, v134, v135
    v_cvt_pk_bf16_f32 v156, v136, v137
    v_cvt_pk_bf16_f32 v157, v138, v139
    v_cvt_pk_bf16_f32 v158, v140, v141
    v_cvt_pk_bf16_f32 v159, v142, v143
    v_permlane32_swap_b32 v152, v154
    v_permlane32_swap_b32 v153, v155
    v_permlane32_swap_b32 v156, v158
    v_permlane32_swap_b32 v157, v159
    s_mul_i32 s72, s76, 1048576
    s_lshl_b32 s73, s75, 12
    s_add_u32 s72, s72, s73
    s_add_u32 s72, s72, 270336
    s_add_u32 s62, s60, s72
    s_addc_u32 s63, s61, 0
    global_store_dwordx4 v9, v[152:155], s[62:63] sc1
    global_store_dwordx4 v9, v[156:159], s[62:63] offset:512 sc1
    v_accvgpr_read_b32 v128, a160
    v_accvgpr_read_b32 v129, a161
    v_accvgpr_read_b32 v130, a162
    v_accvgpr_read_b32 v131, a163
    v_accvgpr_read_b32 v132, a164
    v_accvgpr_read_b32 v133, a165
    v_accvgpr_read_b32 v134, a166
    v_accvgpr_read_b32 v135, a167
    v_accvgpr_read_b32 v136, a168
    v_accvgpr_read_b32 v137, a169
    v_accvgpr_read_b32 v138, a170
    v_accvgpr_read_b32 v139, a171
    v_accvgpr_read_b32 v140, a172
    v_accvgpr_read_b32 v141, a173
    v_accvgpr_read_b32 v142, a174
    v_accvgpr_read_b32 v143, a175
    v_cvt_pk_bf16_f32 v144, v128, v129
    v_cvt_pk_bf16_f32 v145, v130, v131
    v_cvt_pk_bf16_f32 v146, v132, v133
    v_cvt_pk_bf16_f32 v147, v134, v135
    v_cvt_pk_bf16_f32 v148, v136, v137
    v_cvt_pk_bf16_f32 v149, v138, v139
    v_cvt_pk_bf16_f32 v150, v140, v141
    v_cvt_pk_bf16_f32 v151, v142, v143
    v_permlane32_swap_b32 v144, v146
    v_permlane32_swap_b32 v145, v147
    v_permlane32_swap_b32 v148, v150
    v_permlane32_swap_b32 v149, v151
    s_mul_i32 s72, s76, 1048576
    s_lshl_b32 s73, s75, 12
    s_add_u32 s72, s72, s73
    s_add_u32 s72, s72, 532480
    s_add_u32 s62, s60, s72
    s_addc_u32 s63, s61, 0
    global_store_dwordx4 v9, v[144:147], s[62:63] sc1
    global_store_dwordx4 v9, v[148:151], s[62:63] offset:512 sc1
    v_accvgpr_read_b32 v128, a176
    v_accvgpr_read_b32 v129, a177
    v_accvgpr_read_b32 v130, a178
    v_accvgpr_read_b32 v131, a179
    v_accvgpr_read_b32 v132, a180
    v_accvgpr_read_b32 v133, a181
    v_accvgpr_read_b32 v134, a182
    v_accvgpr_read_b32 v135, a183
    v_accvgpr_read_b32 v136, a184
    v_accvgpr_read_b32 v137, a185
    v_accvgpr_read_b32 v138, a186
    v_accvgpr_read_b32 v139, a187
    v_accvgpr_read_b32 v140, a188
    v_accvgpr_read_b32 v141, a189
    v_accvgpr_read_b32 v142, a190
    v_accvgpr_read_b32 v143, a191
    v_cvt_pk_bf16_f32 v152, v128, v129
    v_cvt_pk_bf16_f32 v153, v130, v131
    v_cvt_pk_bf16_f32 v154, v132, v133
    v_cvt_pk_bf16_f32 v155, v134, v135
    v_cvt_pk_bf16_f32 v156, v136, v137
    v_cvt_pk_bf16_f32 v157, v138, v139
    v_cvt_pk_bf16_f32 v158, v140, v141
    v_cvt_pk_bf16_f32 v159, v142, v143
    v_permlane32_swap_b32 v152, v154
    v_permlane32_swap_b32 v153, v155
    v_permlane32_swap_b32 v156, v158
    v_permlane32_swap_b32 v157, v159
    s_mul_i32 s72, s76, 1048576
    s_lshl_b32 s73, s75, 12
    s_add_u32 s72, s72, s73
    s_add_u32 s72, s72, 794624
    s_add_u32 s62, s60, s72
    s_addc_u32 s63, s61, 0
    global_store_dwordx4 v9, v[152:155], s[62:63] sc1
    global_store_dwordx4 v9, v[156:159], s[62:63] offset:512 sc1
    v_accvgpr_read_b32 v128, a192
    v_accvgpr_read_b32 v129, a193
    v_accvgpr_read_b32 v130, a194
    v_accvgpr_read_b32 v131, a195
    v_accvgpr_read_b32 v132, a196
    v_accvgpr_read_b32 v133, a197
    v_accvgpr_read_b32 v134, a198
    v_accvgpr_read_b32 v135, a199
    v_accvgpr_read_b32 v136, a200
    v_accvgpr_read_b32 v137, a201
    v_accvgpr_read_b32 v138, a202
    v_accvgpr_read_b32 v139, a203
    v_accvgpr_read_b32 v140, a204
    v_accvgpr_read_b32 v141, a205
    v_accvgpr_read_b32 v142, a206
    v_accvgpr_read_b32 v143, a207
    v_cvt_pk_bf16_f32 v144, v128, v129
    v_cvt_pk_bf16_f32 v145, v130, v131
    v_cvt_pk_bf16_f32 v146, v132, v133
    v_cvt_pk_bf16_f32 v147, v134, v135
    v_cvt_pk_bf16_f32 v148, v136, v137
    v_cvt_pk_bf16_f32 v149, v138, v139
    v_cvt_pk_bf16_f32 v150, v140, v141
    v_cvt_pk_bf16_f32 v151, v142, v143
    v_permlane32_swap_b32 v144, v146
    v_permlane32_swap_b32 v145, v147
    v_permlane32_swap_b32 v148, v150
    v_permlane32_swap_b32 v149, v151
    s_mul_i32 s72, s76, 1048576
    s_lshl_b32 s73, s75, 12
    s_add_u32 s72, s72, s73
    s_add_u32 s72, s72, 10240
    s_add_u32 s62, s60, s72
    s_addc_u32 s63, s61, 0
    global_store_dwordx4 v9, v[144:147], s[62:63] sc1
    global_store_dwordx4 v9, v[148:151], s[62:63] offset:512 sc1
    v_accvgpr_read_b32 v128, a208
    v_accvgpr_read_b32 v129, a209
    v_accvgpr_read_b32 v130, a210
    v_accvgpr_read_b32 v131, a211
    v_accvgpr_read_b32 v132, a212
    v_accvgpr_read_b32 v133, a213
    v_accvgpr_read_b32 v134, a214
    v_accvgpr_read_b32 v135, a215
    v_accvgpr_read_b32 v136, a216
    v_accvgpr_read_b32 v137, a217
    v_accvgpr_read_b32 v138, a218
    v_accvgpr_read_b32 v139, a219
    v_accvgpr_read_b32 v140, a220
    v_accvgpr_read_b32 v141, a221
    v_accvgpr_read_b32 v142, a222
    v_accvgpr_read_b32 v143, a223
    v_cvt_pk_bf16_f32 v152, v128, v129
    v_cvt_pk_bf16_f32 v153, v130, v131
    v_cvt_pk_bf16_f32 v154, v132, v133
    v_cvt_pk_bf16_f32 v155, v134, v135
    v_cvt_pk_bf16_f32 v156, v136, v137
    v_cvt_pk_bf16_f32 v157, v138, v139
    v_cvt_pk_bf16_f32 v158, v140, v141
    v_cvt_pk_bf16_f32 v159, v142, v143
    v_permlane32_swap_b32 v152, v154
    v_permlane32_swap_b32 v153, v155
    v_permlane32_swap_b32 v156, v158
    v_permlane32_swap_b32 v157, v159
    s_mul_i32 s72, s76, 1048576
    s_lshl_b32 s73, s75, 12
    s_add_u32 s72, s72, s73
    s_add_u32 s72, s72, 272384
    s_add_u32 s62, s60, s72
    s_addc_u32 s63, s61, 0
    global_store_dwordx4 v9, v[152:155], s[62:63] sc1
    global_store_dwordx4 v9, v[156:159], s[62:63] offset:512 sc1
    v_accvgpr_read_b32 v128, a224
    v_accvgpr_read_b32 v129, a225
    v_accvgpr_read_b32 v130, a226
    v_accvgpr_read_b32 v131, a227
    v_accvgpr_read_b32 v132, a228
    v_accvgpr_read_b32 v133, a229
    v_accvgpr_read_b32 v134, a230
    v_accvgpr_read_b32 v135, a231
    v_accvgpr_read_b32 v136, a232
    v_accvgpr_read_b32 v137, a233
    v_accvgpr_read_b32 v138, a234
    v_accvgpr_read_b32 v139, a235
    v_accvgpr_read_b32 v140, a236
    v_accvgpr_read_b32 v141, a237
    v_accvgpr_read_b32 v142, a238
    v_accvgpr_read_b32 v143, a239
    v_cvt_pk_bf16_f32 v144, v128, v129
    v_cvt_pk_bf16_f32 v145, v130, v131
    v_cvt_pk_bf16_f32 v146, v132, v133
    v_cvt_pk_bf16_f32 v147, v134, v135
    v_cvt_pk_bf16_f32 v148, v136, v137
    v_cvt_pk_bf16_f32 v149, v138, v139
    v_cvt_pk_bf16_f32 v150, v140, v141
    v_cvt_pk_bf16_f32 v151, v142, v143
    v_permlane32_swap_b32 v144, v146
    v_permlane32_swap_b32 v145, v147
    v_permlane32_swap_b32 v148, v150
    v_permlane32_swap_b32 v149, v151
    s_mul_i32 s72, s76, 1048576
    s_lshl_b32 s73, s75, 12
    s_add_u32 s72, s72, s73
    s_add_u32 s72, s72, 534528
    s_add_u32 s62, s60, s72
    s_addc_u32 s63, s61, 0
    global_store_dwordx4 v9, v[144:147], s[62:63] sc1
    global_store_dwordx4 v9, v[148:151], s[62:63] offset:512 sc1
    v_accvgpr_read_b32 v128, a240
    v_accvgpr_read_b32 v129, a241
    v_accvgpr_read_b32 v130, a242
    v_accvgpr_read_b32 v131, a243
    v_accvgpr_read_b32 v132, a244
    v_accvgpr_read_b32 v133, a245
    v_accvgpr_read_b32 v134, a246
    v_accvgpr_read_b32 v135, a247
    v_accvgpr_read_b32 v136, a248
    v_accvgpr_read_b32 v137, a249
    v_accvgpr_read_b32 v138, a250
    v_accvgpr_read_b32 v139, a251
    v_accvgpr_read_b32 v140, a252
    v_accvgpr_read_b32 v141, a253
    v_accvgpr_read_b32 v142, a254
    v_accvgpr_read_b32 v143, a255
    v_cvt_pk_bf16_f32 v152, v128, v129
    v_cvt_pk_bf16_f32 v153, v130, v131
    v_cvt_pk_bf16_f32 v154, v132, v133
    v_cvt_pk_bf16_f32 v155, v134, v135
    v_cvt_pk_bf16_f32 v156, v136, v137
    v_cvt_pk_bf16_f32 v157, v138, v139
    v_cvt_pk_bf16_f32 v158, v140, v141
    v_cvt_pk_bf16_f32 v159, v142, v143
    v_permlane32_swap_b32 v152, v154
    v_permlane32_swap_b32 v153, v155
    v_permlane32_swap_b32 v156, v158
    v_permlane32_swap_b32 v157, v159
    s_mul_i32 s72, s76, 1048576
    s_lshl_b32 s73, s75, 12
    s_add_u32 s72, s72, s73
    s_add_u32 s72, s72, 796672
    s_add_u32 s62, s60, s72
    s_addc_u32 s63, s61, 0
    global_store_dwordx4 v9, v[152:155], s[62:63] sc1
    global_store_dwordx4 v9, v[156:159], s[62:63] offset:512 sc1
    s_waitcnt vmcnt(0)
    s_barrier
    s_cmp_lg_u32 s16, 0
    s_cbranch_scc1 L_wk_qs
    s_lshl_b32 s18, s21, 2
    s_add_u32 s18, s18, 128
    v_mov_b32 v10, s18
    v_mov_b32 v11, 1
    s_mov_b64 exec, 1
    global_atomic_add v10, v11, s[6:7] sc1
    s_mov_b64 exec, -1
L_wk_qs:
    s_branch L_wk_next
L_wk_gu:
    s_and_b32 s75, s16, 1
    s_lshr_b32 s76, s16, 1
    v_lshrrev_b32 v10, 2, v1
    v_mul_u32_u24 v2, 1152, v10
    v_and_b32 v10, 3, v1
    v_bfe_u32 v11, v1, 4, 2
    v_xor_b32 v10, v10, v11
    v_lshl_add_u32 v2, v10, 4, v2
    v_and_b32 v10, 31, v1
    v_lshrrev_b32 v11, 5, v1
    v_bfe_u32 v12, v1, 2, 2
    v_xor_b32 v11, v11, v12
    v_lshlrev_b32 v4, 6, v10
    v_lshl_add_u32 v4, v11, 4, v4
    s_lshl_b32 s72, s76, 13
    v_add_u32 v4, s72, v4
    v_xor_b32 v5, 32, v4
    s_lshl_b32 s72, s76, 12
    v_subrev_u32 v16, s72, v4
    v_xor_b32 v17, 32, v16
    v_bfe_u32 v10, v1, 2, 2
    v_lshrrev_b32 v11, 5, v1
    v_lshl_add_u32 v11, v11, 3, v10
    v_lshlrev_b32 v11, 8, v11
    v_bfe_u32 v12, v1, 4, 1
    v_lshlrev_b32 v12, 1, v12
    v_bfe_u32 v13, v1, 1, 1
    v_add_u32 v12, v12, v13
    v_lshl_add_u32 v11, v12, 4, v11
    v_and_b32 v12, 1, v1
    v_lshl_add_u32 v11, v12, 3, v11
    v_add_u32 v11, 16384, v11
    s_lshl_b32 s72, s75, 1
    v_xor_b32 v12, s72, v10
    v_lshl_add_u32 v6, v12, 6, v11
    v_xor_b32 v12, 1, v12
    v_lshl_add_u32 v7, v12, 6, v11
    v_subrev_u32 v18, 8192, v6
    v_subrev_u32 v19, 8192, v7
    v_and_b32 v10, 31, v1
    v_lshrrev_b32 v11, 5, v1
    v_lshrrev_b32 v12, 3, v10
    v_lshlrev_b32 v12, 2, v12
    v_and_b32 v13, 3, v10
    v_add_u32 v12, v12, v13
    v_lshl_add_u32 v12, v11, 4, v12
    v_lshlrev_b32 v12, 4, v12
    v_bfe_u32 v13, v10, 2, 1
    v_lshl_add_u32 v8, v13, 10, v12
    v_and_b32 v12, 15, v10
    v_lshl_add_u32 v12, v11, 4, v12
    v_lshlrev_b32 v12, 4, v12
    v_lshrrev_b32 v13, 4, v10
    v_lshl_add_u32 v9, v13, 10, v12
    v_lshlrev_b32 v14, 4, v1
    s_sub_u32 s18, s17, 256
    s_mul_i32 s21, s18, 1821
    s_lshr_b32 s21, s21, 16
    s_mul_i32 s19, s21, 36
    s_sub_u32 s18, s18, s19
    s_load_dwordx2 s[10:11], s[0:1], 64
    s_load_dwordx2 s[12:13], s[0:1], 72
    s_waitcnt lgkmcnt(0)
    s_mov_b32 s48, s8
    s_mov_b32 s49, s9
    s_mov_b32 s50, 2359296
    s_mov_b32 s51, 0x00020000
    s_mov_b32 s52, s10
    s_mov_b32 s53, s11
    s_mov_b32 s54, 5308416
    s_mov_b32 s55, 0x00020000
    s_mov_b32 s56, s12
    s_mov_b32 s57, s13
    s_mov_b32 s58, 5308416
    s_mov_b32 s59, 0x00020000
    s_mov_b32 s65, 9216
    v_lshrrev_b32 v10, 4, v1
    v_mul_lo_u32 v3, v10, s65
    v_lshlrev_b32 v10, 2, v10
    v_and_b32 v11, 15, v1
    v_xor_b32 v10, v10, v11
    v_lshl_add_u32 v3, v10, 4, v3
    s_mul_i32 s68, s21, 294912
    s_lshl_b32 s66, s18, 8
    s_mov_b32 s67, s66
    s_mul_i32 s72, s21, 2359296
    s_lshl_b32 s73, s18, 13
    s_add_u32 s72, s72, s73
    s_add_u32 s60, s4, 0x3000000
    s_addc_u32 s61, s5, 0
    s_add_u32 s60, s60, s72
    s_addc_u32 s61, s61, 0
    s_mov_b32 s70, 0
    s_mov_b32 s71, 0
    s_mul_i32 s72, s16, 73728
    s_add_u32 s68, s68, s72
    s_lshl_b32 s80, s65, 2
    s_mul_i32 s72, s16, s80
    s_lshl_b32 s72, s72, 1
    s_add_u32 s66, s66, s72
    s_add_u32 s67, s67, s72
    s_mul_i32 s78, s16, 4096
    s_lshl_b32 s81, s16, 11
    s_add_u32 s81, s81, 16384
    s_lshl_b32 s82, s65, 5
    s_add_u32 s77, s70, s78
    s_add_u32 s79, s70, s81
    s_mov_b32 m0, s77
    s_nop 0
    buffer_load_dwordx4 v2, s[48:51], s68 offen lds
    s_add_u32 m0, s77, 1024
    s_add_u32 s73, s68, 18432
    buffer_load_dwordx4 v2, s[48:51], s73 offen lds
    s_add_u32 m0, s77, 2048
    s_add_u32 s73, s68, 36864
    buffer_load_dwordx4 v2, s[48:51], s73 offen lds
    s_add_u32 m0, s77, 3072
    s_add_u32 s73, s68, 55296
    buffer_load_dwordx4 v2, s[48:51], s73 offen lds
    s_add_u32 m0, s79, 0
    s_nop 0
    buffer_load_dwordx4 v3, s[52:55], s66 offen lds
    s_add_u32 m0, s79, 1024
    s_add_u32 s73, s66, s80
    buffer_load_dwordx4 v3, s[52:55], s73 offen lds
    s_add_u32 m0, s79, 8192
    s_nop 0
    buffer_load_dwordx4 v3, s[56:59], s67 offen lds
    s_add_u32 m0, s79, 9216
    s_add_u32 s73, s67, s80
    buffer_load_dwordx4 v3, s[56:59], s73 offen lds
    s_add_u32 s68, s68, 64
    s_add_u32 s66, s66, s82
    s_add_u32 s67, s67, s82
    s_add_u32 s70, s70, 32768
    s_cmp_eq_u32 s70, 131072
    s_cselect_b32 s70, 0, s70
    s_add_u32 s77, s70, s78
    s_add_u32 s79, s70, s81
    s_mov_b32 m0, s77
    s_nop 0
    buffer_load_dwordx4 v2, s[48:51], s68 offen lds
    s_add_u32 m0, s77, 1024
    s_add_u32 s73, s68, 18432
    buffer_load_dwordx4 v2, s[48:51], s73 offen lds
    s_add_u32 m0, s77, 2048
    s_add_u32 s73, s68, 36864
    buffer_load_dwordx4 v2, s[48:51], s73 offen lds
    s_add_u32 m0, s77, 3072
    s_add_u32 s73, s68, 55296
    buffer_load_dwordx4 v2, s[48:51], s73 offen lds
    s_add_u32 m0, s79, 0
    s_nop 0
    buffer_load_dwordx4 v3, s[52:55], s66 offen lds
    s_add_u32 m0, s79, 1024
    s_add_u32 s73, s66, s80
    buffer_load_dwordx4 v3, s[52:55], s73 offen lds
    s_add_u32 m0, s79, 8192
    s_nop 0
    buffer_load_dwordx4 v3, s[56:59], s67 offen lds
    s_add_u32 m0, s79, 9216
    s_add_u32 s73, s67, s80
    buffer_load_dwordx4 v3, s[56:59], s73 offen lds
    s_add_u32 s68, s68, 64
    s_add_u32 s66, s66, s82
    s_add_u32 s67, s67, s82
    s_add_u32 s70, s70, 32768
    s_cmp_eq_u32 s70, 131072
    s_cselect_b32 s70, 0, s70
    s_add_u32 s77, s70, s78
    s_add_u32 s79, s70, s81
    s_mov_b32 m0, s77
    s_nop 0
    buffer_load_dwordx4 v2, s[48:51], s68 offen lds
    s_add_u32 m0, s77, 1024
    s_add_u32 s73, s68, 18432
    buffer_load_dwordx4 v2, s[48:51], s73 offen lds
    s_add_u32 m0, s77, 2048
    s_add_u32 s73, s68, 36864
    buffer_load_dwordx4 v2, s[48:51], s73 offen lds
    s_add_u32 m0, s77, 3072
    s_add_u32 s73, s68, 55296
    buffer_load_dwordx4 v2, s[48:51], s73 offen lds
    s_add_u32 m0, s79, 0
    s_nop 0
    buffer_load_dwordx4 v3, s[52:55], s66 offen lds
    s_add_u32 m0, s79, 1024
    s_add_u32 s73, s66, s80
    buffer_load_dwordx4 v3, s[52:55], s73 offen lds
    s_add_u32 m0, s79, 8192
    s_nop 0
    buffer_load_dwordx4 v3, s[56:59], s67 offen lds
    s_add_u32 m0, s79, 9216
    s_add_u32 s73, s67, s80
    buffer_load_dwordx4 v3, s[56:59], s73 offen lds
    s_add_u32 s68, s68, 64
    s_add_u32 s66, s66, s82
    s_add_u32 s67, s67, s82
    s_add_u32 s70, s70, 32768
    s_cmp_eq_u32 s70, 131072
    s_cselect_b32 s70, 0, s70
    s_add_u32 s77, s70, s78
    s_add_u32 s79, s70, s81
    s_mov_b32 m0, s77
    s_nop 0
    buffer_load_dwordx4 v2, s[48:51], s68 offen lds
    s_add_u32 m0, s77, 1024
    s_add_u32 s73, s68, 18432
    buffer_load_dwordx4 v2, s[48:51], s73 offen lds
    s_add_u32 m0, s77, 2048
    s_add_u32 s73, s68, 36864
    buffer_load_dwordx4 v2, s[48:51], s73 offen lds
    s_add_u32 m0, s77, 3072
    s_add_u32 s73, s68, 55296
    buffer_load_dwordx4 v2, s[48:51], s73 offen lds
    s_add_u32 m0, s79, 0
    s_nop 0
    buffer_load_dwordx4 v3, s[52:55], s66 offen lds
    s_add_u32 m0, s79, 1024
    s_add_u32 s73, s66, s80
    buffer_load_dwordx4 v3, s[52:55], s73 offen lds
    s_add_u32 m0, s79, 8192
    s_nop 0
    buffer_load_dwordx4 v3, s[56:59], s67 offen lds
    s_add_u32 m0, s79, 9216
    s_add_u32 s73, s67, s80
    buffer_load_dwordx4 v3, s[56:59], s73 offen lds
    s_add_u32 s68, s68, 64
    s_add_u32 s66, s66, s82
    s_add_u32 s67, s67, s82
    s_add_u32 s70, s70, 32768
    s_cmp_eq_u32 s70, 131072
    s_cselect_b32 s70, 0, s70
    v_accvgpr_write_b32 a0, 0
    v_accvgpr_write_b32 a1, 0
    v_accvgpr_write_b32 a2, 0
    v_accvgpr_write_b32 a3, 0
    v_accvgpr_write_b32 a4, 0
    v_accvgpr_write_b32 a5, 0
    v_accvgpr_write_b32 a6, 0
    v_accvgpr_write_b32 a7, 0
    v_accvgpr_write_b32 a8, 0
    v_accvgpr_write_b32 a9, 0
    v_accvgpr_write_b32 a10, 0
    v_accvgpr_write_b32 a11, 0
    v_accvgpr_write_b32 a12, 0
    v_accvgpr_write_b32 a13, 0
    v_accvgpr_write_b32 a14, 0
    v_accvgpr_write_b32 a15, 0
    v_accvgpr_write_b32 a16, 0
    v_accvgpr_write_b32 a17, 0
    v_accvgpr_write_b32 a18, 0
    v_accvgpr_write_b32 a19, 0
    v_accvgpr_write_b32 a20, 0
    v_accvgpr_write_b32 a21, 0
    v_accvgpr_write_b32 a22, 0
    v_accvgpr_write_b32 a23, 0
    v_accvgpr_write_b32 a24, 0
    v_accvgpr_write_b32 a25, 0
    v_accvgpr_write_b32 a26, 0
    v_accvgpr_write_b32 a27, 0
    v_accvgpr_write_b32 a28, 0
    v_accvgpr_write_b32 a29, 0
    v_accvgpr_write_b32 a30, 0
    v_accvgpr_write_b32 a31, 0
    v_accvgpr_write_b32 a32, 0
    v_accvgpr_write_b32 a33, 0
    v_accvgpr_write_b32 a34, 0
    v_accvgpr_write_b32 a35, 0
    v_accvgpr_write_b32 a36, 0
    v_accvgpr_write_b32 a37, 0
    v_accvgpr_write_b32 a38, 0
    v_accvgpr_write_b32 a39, 0
    v_accvgpr_write_b32 a40, 0
    v_accvgpr_write_b32 a41, 0
    v_accvgpr_write_b32 a42, 0
    v_accvgpr_write_b32 a43, 0
    v_accvgpr_write_b32 a44, 0
    v_accvgpr_write_b32 a45, 0
    v_accvgpr_write_b32 a46, 0
    v_accvgpr_write_b32 a47, 0
    v_accvgpr_write_b32 a48, 0
    v_accvgpr_write_b32 a49, 0
    v_accvgpr_write_b32 a50, 0
    v_accvgpr_write_b32 a51, 0
    v_accvgpr_write_b32 a52, 0
    v_accvgpr_write_b32 a53, 0
    v_accvgpr_write_b32 a54, 0
    v_accvgpr_write_b32 a55, 0
    v_accvgpr_write_b32 a56, 0
    v_accvgpr_write_b32 a57, 0
    v_accvgpr_write_b32 a58, 0
    v_accvgpr_write_b32 a59, 0
    v_accvgpr_write_b32 a60, 0
    v_accvgpr_write_b32 a61, 0
    v_accvgpr_write_b32 a62, 0
    v_accvgpr_write_b32 a63, 0
    v_accvgpr_write_b32 a64, 0
    v_accvgpr_write_b32 a65, 0
    v_accvgpr_write_b32 a66, 0
    v_accvgpr_write_b32 a67, 0
    v_accvgpr_write_b32 a68, 0
    v_accvgpr_write_b32 a69, 0
    v_accvgpr_write_b32 a70, 0
    v_accvgpr_write_b32 a71, 0
    v_accvgpr_write_b32 a72, 0
    v_accvgpr_write_b32 a73, 0
    v_accvgpr_write_b32 a74, 0
    v_accvgpr_write_b32 a75, 0
    v_accvgpr_write_b32 a76, 0
    v_accvgpr_write_b32 a77, 0
    v_accvgpr_write_b32 a78, 0
    v_accvgpr_write_b32 a79, 0
    v_accvgpr_write_b32 a80, 0
    v_accvgpr_write_b32 a81, 0
    v_accvgpr_write_b32 a82, 0
    v_accvgpr_write_b32 a83, 0
    v_accvgpr_write_b32 a84, 0
    v_accvgpr_write_b32 a85, 0
    v_accvgpr_write_b32 a86, 0
    v_accvgpr_write_b32 a87, 0
    v_accvgpr_write_b32 a88, 0
    v_accvgpr_write_b32 a89, 0
    v_accvgpr_write_b32 a90, 0
    v_accvgpr_write_b32 a91, 0
    v_accvgpr_write_b32 a92, 0
    v_accvgpr_write_b32 a93, 0
    v_accvgpr_write_b32 a94, 0
    v_accvgpr_write_b32 a95, 0
    v_accvgpr_write_b32 a96, 0
    v_accvgpr_write_b32 a97, 0
    v_accvgpr_write_b32 a98, 0
    v_accvgpr_write_b32 a99, 0
    v_accvgpr_write_b32 a100, 0
    v_accvgpr_write_b32 a101, 0
    v_accvgpr_write_b32 a102, 0
    v_accvgpr_write_b32 a103, 0
    v_accvgpr_write_b32 a104, 0
    v_accvgpr_write_b32 a105, 0
    v_accvgpr_write_b32 a106, 0
    v_accvgpr_write_b32 a107, 0
    v_accvgpr_write_b32 a108, 0
    v_accvgpr_write_b32 a109, 0
    v_accvgpr_write_b32 a110, 0
    v_accvgpr_write_b32 a111, 0
    v_accvgpr_write_b32 a112, 0
    v_accvgpr_write_b32 a113, 0
    v_accvgpr_write_b32 a114, 0
    v_accvgpr_write_b32 a115, 0
    v_accvgpr_write_b32 a116, 0
    v_accvgpr_write_b32 a117, 0
    v_accvgpr_write_b32 a118, 0
    v_accvgpr_write_b32 a119, 0
    v_accvgpr_write_b32 a120, 0
    v_accvgpr_write_b32 a121, 0
    v_accvgpr_write_b32 a122, 0
    v_accvgpr_write_b32 a123, 0
    v_accvgpr_write_b32 a124, 0
    v_accvgpr_write_b32 a125, 0
    v_accvgpr_write_b32 a126, 0
    v_accvgpr_write_b32 a127, 0
    v_accvgpr_write_b32 a128, 0
    v_accvgpr_write_b32 a129, 0
    v_accvgpr_write_b32 a130, 0
    v_accvgpr_write_b32 a131, 0
    v_accvgpr_write_b32 a132, 0
    v_accvgpr_write_b32 a133, 0
    v_accvgpr_write_b32 a134, 0
    v_accvgpr_write_b32 a135, 0
    v_accvgpr_write_b32 a136, 0
    v_accvgpr_write_b32 a137, 0
    v_accvgpr_write_b32 a138, 0
    v_accvgpr_write_b32 a139, 0
    v_accvgpr_write_b32 a140, 0
    v_accvgpr_write_b32 a141, 0
    v_accvgpr_write_b32 a142, 0
    v_accvgpr_write_b32 a143, 0
    v_accvgpr_write_b32 a144, 0
    v_accvgpr_write_b32 a145, 0
    v_accvgpr_write_b32 a146, 0
    v_accvgpr_write_b32 a147, 0
    v_accvgpr_write_b32 a148, 0
    v_accvgpr_write_b32 a149, 0
    v_accvgpr_write_b32 a150, 0
    v_accvgpr_write_b32 a151, 0
    v_accvgpr_write_b32 a152, 0
    v_accvgpr_write_b32 a153, 0
    v_accvgpr_write_b32 a154, 0
    v_accvgpr_write_b32 a155, 0
    v_accvgpr_write_b32 a156, 0
    v_accvgpr_write_b32 a157, 0
    v_accvgpr_write_b32 a158, 0
    v_accvgpr_write_b32 a159, 0
    v_accvgpr_write_b32 a160, 0
    v_accvgpr_write_b32 a161, 0
    v_accvgpr_write_b32 a162, 0
    v_accvgpr_write_b32 a163, 0
    v_accvgpr_write_b32 a164, 0
    v_accvgpr_write_b32 a165, 0
    v_accvgpr_write_b32 a166, 0
    v_accvgpr_write_b32 a167, 0
    v_accvgpr_write_b32 a168, 0
    v_accvgpr_write_b32 a169, 0
    v_accvgpr_write_b32 a170, 0
    v_accvgpr_write_b32 a171, 0
    v_accvgpr_write_b32 a172, 0
    v_accvgpr_write_b32 a173, 0
    v_accvgpr_write_b32 a174, 0
    v_accvgpr_write_b32 a175, 0
    v_accvgpr_write_b32 a176, 0
    v_accvgpr_write_b32 a177, 0
    v_accvgpr_write_b32 a178, 0
    v_accvgpr_write_b32 a179, 0
    v_accvgpr_write_b32 a180, 0
    v_accvgpr_write_b32 a181, 0
    v_accvgpr_write_b32 a182, 0
    v_accvgpr_write_b32 a183, 0
    v_accvgpr_write_b32 a184, 0
    v_accvgpr_write_b32 a185, 0
    v_accvgpr_write_b32 a186, 0
    v_accvgpr_write_b32 a187, 0
    v_accvgpr_write_b32 a188, 0
    v_accvgpr_write_b32 a189, 0
    v_accvgpr_write_b32 a190, 0
    v_accvgpr_write_b32 a191, 0
    v_accvgpr_write_b32 a192, 0
    v_accvgpr_write_b32 a193, 0
    v_accvgpr_write_b32 a194, 0
    v_accvgpr_write_b32 a195, 0
    v_accvgpr_write_b32 a196, 0
    v_accvgpr_write_b32 a197, 0
    v_accvgpr_write_b32 a198, 0
    v_accvgpr_write_b32 a199, 0
    v_accvgpr_write_b32 a200, 0
    v_accvgpr_write_b32 a201, 0
    v_accvgpr_write_b32 a202, 0
    v_accvgpr_write_b32 a203, 0
    v_accvgpr_write_b32 a204, 0
    v_accvgpr_write_b32 a205, 0
    v_accvgpr_write_b32 a206, 0
    v_accvgpr_write_b32 a207, 0
    v_accvgpr_write_b32 a208, 0
    v_accvgpr_write_b32 a209, 0
    v_accvgpr_write_b32 a210, 0
    v_accvgpr_write_b32 a211, 0
    v_accvgpr_write_b32 a212, 0
    v_accvgpr_write_b32 a213, 0
    v_accvgpr_write_b32 a214, 0
    v_accvgpr_write_b32 a215, 0
    v_accvgpr_write_b32 a216, 0
    v_accvgpr_write_b32 a217, 0
    v_accvgpr_write_b32 a218, 0
    v_accvgpr_write_b32 a219, 0
    v_accvgpr_write_b32 a220, 0
    v_accvgpr_write_b32 a221, 0
    v_accvgpr_write_b32 a222, 0
    v_accvgpr_write_b32 a223, 0
    v_accvgpr_write_b32 a224, 0
    v_accvgpr_write_b32 a225, 0
    v_accvgpr_write_b32 a226, 0
    v_accvgpr_write_b32 a227, 0
    v_accvgpr_write_b32 a228, 0
    v_accvgpr_write_b32 a229, 0
    v_accvgpr_write_b32 a230, 0
    v_accvgpr_write_b32 a231, 0
    v_accvgpr_write_b32 a232, 0
    v_accvgpr_write_b32 a233, 0
    v_accvgpr_write_b32 a234, 0
    v_accvgpr_write_b32 a235, 0
    v_accvgpr_write_b32 a236, 0
    v_accvgpr_write_b32 a237, 0
    v_accvgpr_write_b32 a238, 0
    v_accvgpr_write_b32 a239, 0
    v_accvgpr_write_b32 a240, 0
    v_accvgpr_write_b32 a241, 0
    v_accvgpr_write_b32 a242, 0
    v_accvgpr_write_b32 a243, 0
    v_accvgpr_write_b32 a244, 0
    v_accvgpr_write_b32 a245, 0
    v_accvgpr_write_b32 a246, 0
    v_accvgpr_write_b32 a247, 0
    v_accvgpr_write_b32 a248, 0
    v_accvgpr_write_b32 a249, 0
    v_accvgpr_write_b32 a250, 0
    v_accvgpr_write_b32 a251, 0
    v_accvgpr_write_b32 a252, 0
    v_accvgpr_write_b32 a253, 0
    v_accvgpr_write_b32 a254, 0
    v_accvgpr_write_b32 a255, 0
    s_waitcnt vmcnt(24)
    s_barrier
    ds_read_b64_tr_b16 v[64:65], v6 offset:0
    ds_read_b64_tr_b16 v[66:67], v6 offset:1024
    ds_read_b64_tr_b16 v[68:69], v7 offset:0
    ds_read_b64_tr_b16 v[70:71], v7 offset:1024
    ds_read_b64_tr_b16 v[72:73], v6 offset:8192
    ds_read_b64_tr_b16 v[74:75], v6 offset:9216
    ds_read_b64_tr_b16 v[76:77], v7 offset:8192
    ds_read_b64_tr_b16 v[78:79], v7 offset:9216
    ds_read_b128 v[80:83], v4 offset:0
    ds_read_b128 v[84:87], v4 offset:2048
    ds_read_b128 v[88:91], v4 offset:4096
    ds_read_b128 v[92:95], v4 offset:6144
    s_mov_b32 s69, 0
    s_waitcnt lgkmcnt(0)
L_g1_loopg:
    v_mfma_f32_32x32x16_bf16 a[0:15], v[64:67], v[80:83], a[0:15]
    ds_read_b64_tr_b16 v[96:97], v6 offset:4096
    v_mfma_f32_32x32x16_bf16 a[64:79], v[68:71], v[80:83], a[64:79]
    ds_read_b64_tr_b16 v[98:99], v6 offset:5120
    v_mfma_f32_32x32x16_bf16 a[128:143], v[72:75], v[80:83], a[128:143]
    ds_read_b64_tr_b16 v[100:101], v7 offset:4096
    v_mfma_f32_32x32x16_bf16 a[192:207], v[76:79], v[80:83], a[192:207]
    ds_read_b64_tr_b16 v[102:103], v7 offset:5120
    v_mfma_f32_32x32x16_bf16 a[16:31], v[64:67], v[84:87], a[16:31]
    ds_read_b64_tr_b16 v[104:105], v6 offset:12288
    v_mfma_f32_32x32x16_bf16 a[80:95], v[68:71], v[84:87], a[80:95]
    ds_read_b64_tr_b16 v[106:107], v6 offset:13312
    v_mfma_f32_32x32x16_bf16 a[144:159], v[72:75], v[84:87], a[144:159]
    ds_read_b64_tr_b16 v[108:109], v7 offset:12288
    v_mfma_f32_32x32x16_bf16 a[208:223], v[76:79], v[84:87], a[208:223]
    ds_read_b64_tr_b16 v[110:111], v7 offset:13312
    v_mfma_f32_32x32x16_bf16 a[32:47], v[64:67], v[88:91], a[32:47]
    ds_read_b128 v[112:115], v5 offset:0
    v_mfma_f32_32x32x16_bf16 a[96:111], v[68:71], v[88:91], a[96:111]
    ds_read_b128 v[116:119], v5 offset:2048
    v_mfma_f32_32x32x16_bf16 a[160:175], v[72:75], v[88:91], a[160:175]
    ds_read_b128 v[120:123], v5 offset:4096
    v_mfma_f32_32x32x16_bf16 a[224:239], v[76:79], v[88:91], a[224:239]
    ds_read_b128 v[124:127], v5 offset:6144
    v_mfma_f32_32x32x16_bf16 a[48:63], v[64:67], v[92:95], a[48:63]
    v_mfma_f32_32x32x16_bf16 a[112:127], v[68:71], v[92:95], a[112:127]
    v_mfma_f32_32x32x16_bf16 a[176:191], v[72:75], v[92:95], a[176:191]
    v_mfma_f32_32x32x16_bf16 a[240:255], v[76:79], v[92:95], a[240:255]
    s_waitcnt lgkmcnt(0)
    s_cmp_lt_u32 s69, 15
    s_cbranch_scc1 L_g1_w8g
    s_waitcnt vmcnt(0)
    s_branch L_g1_wdg
L_g1_w8g:
    s_waitcnt vmcnt(16)
L_g1_wdg:
    s_barrier
    s_add_u32 s71, s71, 32768
    s_cmp_eq_u32 s71, 131072
    s_mov_b32 s72, 32768
    s_cselect_b32 s72, 0xfffe8000, s72
    s_cselect_b32 s71, 0, s71
    v_add_u32 v4, s72, v4
    v_add_u32 v5, s72, v5
    v_add_u32 v6, s72, v6
    v_add_u32 v7, s72, v7
    s_cmp_lt_u32 s69, 14
    s_cbranch_scc0 L_g1_nodmag
    v_mfma_f32_32x32x16_bf16 a[0:15], v[96:99], v[112:115], a[0:15]
    ds_read_b64_tr_b16 v[64:65], v6 offset:0
    v_mfma_f32_32x32x16_bf16 a[64:79], v[100:103], v[112:115], a[64:79]
    ds_read_b64_tr_b16 v[66:67], v6 offset:1024
    s_add_u32 s77, s70, s78
    s_add_u32 s79, s70, s81
    s_mov_b32 m0, s77
    s_nop 0
    buffer_load_dwordx4 v2, s[48:51], s68 offen lds
    v_mfma_f32_32x32x16_bf16 a[128:143], v[104:107], v[112:115], a[128:143]
    ds_read_b64_tr_b16 v[68:69], v7 offset:0
    v_mfma_f32_32x32x16_bf16 a[192:207], v[108:111], v[112:115], a[192:207]
    ds_read_b64_tr_b16 v[70:71], v7 offset:1024
    s_add_u32 m0, s77, 1024
    s_add_u32 s73, s68, 18432
    buffer_load_dwordx4 v2, s[48:51], s73 offen lds
    v_mfma_f32_32x32x16_bf16 a[16:31], v[96:99], v[116:119], a[16:31]
    ds_read_b64_tr_b16 v[72:73], v6 offset:8192
    v_mfma_f32_32x32x16_bf16 a[80:95], v[100:103], v[116:119], a[80:95]
    ds_read_b64_tr_b16 v[74:75], v6 offset:9216
    s_add_u32 m0, s77, 2048
    s_add_u32 s73, s68, 36864
    buffer_load_dwordx4 v2, s[48:51], s73 offen lds
    v_mfma_f32_32x32x16_bf16 a[144:159], v[104:107], v[116:119], a[144:159]
    ds_read_b64_tr_b16 v[76:77], v7 offset:8192
    v_mfma_f32_32x32x16_bf16 a[208:223], v[108:111], v[116:119], a[208:223]
    ds_read_b64_tr_b16 v[78:79], v7 offset:9216
    s_add_u32 m0, s77, 3072
    s_add_u32 s73, s68, 55296
    buffer_load_dwordx4 v2, s[48:51], s73 offen lds
    v_mfma_f32_32x32x16_bf16 a[32:47], v[96:99], v[120:123], a[32:47]
    ds_read_b128 v[80:83], v4 offset:0
    v_mfma_f32_32x32x16_bf16 a[96:111], v[100:103], v[120:123], a[96:111]
    ds_read_b128 v[84:87], v4 offset:2048
    s_add_u32 m0, s79, 0
    s_nop 0
    buffer_load_dwordx4 v3, s[52:55], s66 offen lds
    v_mfma_f32_32x32x16_bf16 a[160:175], v[104:107], v[120:123], a[160:175]
    ds_read_b128 v[88:91], v4 offset:4096
    v_mfma_f32_32x32x16_bf16 a[224:239], v[108:111], v[120:123], a[224:239]
    ds_read_b128 v[92:95], v4 offset:6144
    s_add_u32 m0, s79, 1024
    s_add_u32 s73, s66, s80
    buffer_load_dwordx4 v3, s[52:55], s73 offen lds
    v_mfma_f32_32x32x16_bf16 a[48:63], v[96:99], v[124:127], a[48:63]
    v_mfma_f32_32x32x16_bf16 a[112:127], v[100:103], v[124:127], a[112:127]
    s_add_u32 m0, s79, 8192
    s_nop 0
    buffer_load_dwordx4 v3, s[56:59], s67 offen lds
    v_mfma_f32_32x32x16_bf16 a[176:191], v[104:107], v[124:127], a[176:191]
    s_add_u32 m0, s79, 9216
    s_add_u32 s73, s67, s80
    buffer_load_dwordx4 v3, s[56:59], s73 offen lds
    v_mfma_f32_32x32x16_bf16 a[240:255], v[108:111], v[124:127], a[240:255]
    s_add_u32 s68, s68, 64
    s_add_u32 s66, s66, s82
    s_add_u32 s67, s67, s82
    s_add_u32 s70, s70, 32768
    s_cmp_eq_u32 s70, 131072
    s_cselect_b32 s70, 0, s70
    s_branch L_g1_jg
L_g1_nodmag:
    v_mfma_f32_32x32x16_bf16 a[0:15], v[96:99], v[112:115], a[0:15]
    ds_read_b64_tr_b16 v[64:65], v6 offset:0
    v_mfma_f32_32x32x16_bf16 a[64:79], v[100:103], v[112:115], a[64:79]
    ds_read_b64_tr_b16 v[66:67], v6 offset:1024
    v_mfma_f32_32x32x16_bf16 a[128:143], v[104:107], v[112:115], a[128:143]
    ds_read_b64_tr_b16 v[68:69], v7 offset:0
    v_mfma_f32_32x32x16_bf16 a[192:207], v[108:111], v[112:115], a[192:207]
    ds_read_b64_tr_b16 v[70:71], v7 offset:1024
    v_mfma_f32_32x32x16_bf16 a[16:31], v[96:99], v[116:119], a[16:31]
    ds_read_b64_tr_b16 v[72:73], v6 offset:8192
    v_mfma_f32_32x32x16_bf16 a[80:95], v[100:103], v[116:119], a[80:95]
    ds_read_b64_tr_b16 v[74:75], v6 offset:9216
    v_mfma_f32_32x32x16_bf16 a[144:159], v[104:107], v[116:119], a[144:159]
    ds_read_b64_tr_b16 v[76:77], v7 offset:8192
    v_mfma_f32_32x32x16_bf16 a[208:223], v[108:111], v[116:119], a[208:223]
    ds_read_b64_tr_b16 v[78:79], v7 offset:9216
    v_mfma_f32_32x32x16_bf16 a[32:47], v[96:99], v[120:123], a[32:47]
    ds_read_b128 v[80:83], v4 offset:0
    v_mfma_f32_32x32x16_bf16 a[96:111], v[100:103], v[120:123], a[96:111]
    ds_read_b128 v[84:87], v4 offset:2048
    v_mfma_f32_32x32x16_bf16 a[160:175], v[104:107], v[120:123], a[160:175]
    ds_read_b128 v[88:91], v4 offset:4096
    v_mfma_f32_32x32x16_bf16 a[224:239], v[108:111], v[120:123], a[224:239]
    ds_read_b128 v[92:95], v4 offset:6144
    v_mfma_f32_32x32x16_bf16 a[48:63], v[96:99], v[124:127], a[48:63]
    v_mfma_f32_32x32x16_bf16 a[112:127], v[100:103], v[124:127], a[112:127]
    v_mfma_f32_32x32x16_bf16 a[176:191], v[104:107], v[124:127], a[176:191]
    v_mfma_f32_32x32x16_bf16 a[240:255], v[108:111], v[124:127], a[240:255]
L_g1_jg:
    s_waitcnt lgkmcnt(0)
    s_add_u32 s69, s69, 1
    s_cmp_lt_u32 s69, 18
    s_cbranch_scc1 L_g1_loopg
    v_subrev_u32 v4, 65536, v4
    v_subrev_u32 v5, 65536, v5
    v_subrev_u32 v6, 65536, v6
    v_subrev_u32 v7, 65536, v7
    s_nop 15
    s_mov_b32 s74, 0xbdd2d3e8
    v_mov_b32 v15, 0xc0135761
    v_accvgpr_read_b32 v128, a0
    v_accvgpr_read_b32 v129, a1
    v_accvgpr_read_b32 v130, a2
    v_accvgpr_read_b32 v131, a3
    v_accvgpr_read_b32 v132, a4
    v_accvgpr_read_b32 v133, a5
    v_accvgpr_read_b32 v134, a6
    v_accvgpr_read_b32 v135, a7
    v_accvgpr_read_b32 v136, a8
    v_accvgpr_read_b32 v137, a9
    v_accvgpr_read_b32 v138, a10
    v_accvgpr_read_b32 v139, a11
    v_accvgpr_read_b32 v140, a12
    v_accvgpr_read_b32 v141, a13
    v_accvgpr_read_b32 v142, a14
    v_accvgpr_read_b32 v143, a15
    v_mul_f32 v160, v128, v128
    v_mul_f32 v161, v129, v129
    v_mul_f32 v162, v130, v130
    v_mul_f32 v163, v131, v131
    v_mul_f32 v164, v132, v132
    v_mul_f32 v165, v133, v133
    v_mul_f32 v166, v134, v134
    v_mul_f32 v167, v135, v135
    v_mul_f32 v168, v136, v136
    v_mul_f32 v169, v137, v137
    v_mul_f32 v170, v138, v138
    v_mul_f32 v171, v139, v139
    v_mul_f32 v172, v140, v140
    v_mul_f32 v173, v141, v141
    v_mul_f32 v174, v142, v142
    v_mul_f32 v175, v143, v143
    v_fma_f32 v160, v160, s74, v15
    v_fma_f32 v161, v161, s74, v15
    v_fma_f32 v162, v162, s74, v15
    v_fma_f32 v163, v163, s74, v15
    v_fma_f32 v164, v164, s74, v15
    v_fma_f32 v165, v165, s74, v15
    v_fma_f32 v166, v166, s74, v15
    v_fma_f32 v167, v167, s74, v15
    v_fma_f32 v168, v168, s74, v15
    v_fma_f32 v169, v169, s74, v15
    v_fma_f32 v170, v170, s74, v15
    v_fma_f32 v171, v171, s74, v15
    v_fma_f32 v172, v172, s74, v15
    v_fma_f32 v173, v173, s74, v15
    v_fma_f32 v174, v174, s74, v15
    v_fma_f32 v175, v175, s74, v15
    v_mul_f32 v160, v160, v128
    v_mul_f32 v161, v161, v129
    v_mul_f32 v162, v162, v130
    v_mul_f32 v163, v163, v131
    v_mul_f32 v164, v164, v132
    v_mul_f32 v165, v165, v133
    v_mul_f32 v166, v166, v134
    v_mul_f32 v167, v167, v135
    v_mul_f32 v168, v168, v136
    v_mul_f32 v169, v169, v137
    v_mul_f32 v170, v170, v138
    v_mul_f32 v171, v171, v139
    v_mul_f32 v172, v172, v140
    v_mul_f32 v173, v173, v141
    v_mul_f32 v174, v174, v142
    v_mul_f32 v175, v175, v143
    v_exp_f32 v160, v160
    v_exp_f32 v161, v161
    v_exp_f32 v162, v162
    v_exp_f32 v163, v163
    v_exp_f32 v164, v164
    v_exp_f32 v165, v165
    v_exp_f32 v166, v166
    v_exp_f32 v167, v167
    v_exp_f32 v168, v168
    v_exp_f32 v169, v169
    v_exp_f32 v170, v170
    v_exp_f32 v171, v171
    v_exp_f32 v172, v172
    v_exp_f32 v173, v173
    v_exp_f32 v174, v174
    v_exp_f32 v175, v175
    v_add_f32 v160, 1.0, v160
    v_add_f32 v161, 1.0, v161
    v_add_f32 v162, 1.0, v162
    v_add_f32 v163, 1.0, v163
    v_add_f32 v164, 1.0, v164
    v_add_f32 v165, 1.0, v165
    v_add_f32 v166, 1.0, v166
    v_add_f32 v167, 1.0, v167
    v_add_f32 v168, 1.0, v168
    v_add_f32 v169, 1.0, v169
    v_add_f32 v170, 1.0, v170
    v_add_f32 v171, 1.0, v171
    v_add_f32 v172, 1.0, v172
    v_add_f32 v173, 1.0, v173
    v_add_f32 v174, 1.0, v174
    v_add_f32 v175, 1.0, v175
    v_rcp_f32 v160, v160
    v_rcp_f32 v161, v161
    v_rcp_f32 v162, v162
    v_rcp_f32 v163, v163
    v_rcp_f32 v164, v164
    v_rcp_f32 v165, v165
    v_rcp_f32 v166, v166
    v_rcp_f32 v167, v167
    v_rcp_f32 v168, v168
    v_rcp_f32 v169, v169
    v_rcp_f32 v170, v170
    v_rcp_f32 v171, v171
    v_rcp_f32 v172, v172
    v_rcp_f32 v173, v173
    v_rcp_f32 v174, v174
    v_rcp_f32 v175, v175
    v_mul_f32 v128, v128, v160
    v_mul_f32 v129, v129, v161
    v_mul_f32 v130, v130, v162
    v_mul_f32 v131, v131, v163
    v_mul_f32 v132, v132, v164
    v_mul_f32 v133, v133, v165
    v_mul_f32 v134, v134, v166
    v_mul_f32 v135, v135, v167
    v_mul_f32 v136, v136, v168
    v_mul_f32 v137, v137, v169
    v_mul_f32 v138, v138, v170
    v_mul_f32 v139, v139, v171
    v_mul_f32 v140, v140, v172
    v_mul_f32 v141, v141, v173
    v_mul_f32 v142, v142, v174
    v_mul_f32 v143, v143, v175
    v_accvgpr_read_b32 v160, a128
    v_accvgpr_read_b32 v161, a129
    v_accvgpr_read_b32 v162, a130
    v_accvgpr_read_b32 v163, a131
    v_accvgpr_read_b32 v164, a132
    v_accvgpr_read_b32 v165, a133
    v_accvgpr_read_b32 v166, a134
    v_accvgpr_read_b32 v167, a135
    v_accvgpr_read_b32 v168, a136
    v_accvgpr_read_b32 v169, a137
    v_accvgpr_read_b32 v170, a138
    v_accvgpr_read_b32 v171, a139
    v_accvgpr_read_b32 v172, a140
    v_accvgpr_read_b32 v173, a141
    v_accvgpr_read_b32 v174, a142
    v_accvgpr_read_b32 v175, a143
    v_mul_f32 v128, v128, v160
    v_mul_f32 v129, v129, v161
    v_mul_f32 v130, v130, v162
    v_mul_f32 v131, v131, v163
    v_mul_f32 v132, v132, v164
    v_mul_f32 v133, v133, v165
    v_mul_f32 v134, v134, v166
    v_mul_f32 v135, v135, v167
    v_mul_f32 v136, v136, v168
    v_mul_f32 v137, v137, v169
    v_mul_f32 v138, v138, v170
    v_mul_f32 v139, v139, v171
    v_mul_f32 v140, v140, v172
    v_mul_f32 v141, v141, v173
    v_mul_f32 v142, v142, v174
    v_mul_f32 v143, v143, v175
    v_cvt_pk_bf16_f32 v144, v128, v129
    v_cvt_pk_bf16_f32 v145, v130, v131
    v_cvt_pk_bf16_f32 v146, v132, v133
    v_cvt_pk_bf16_f32 v147, v134, v135
    v_cvt_pk_bf16_f32 v148, v136, v137
    v_cvt_pk_bf16_f32 v149, v138, v139
    v_cvt_pk_bf16_f32 v150, v140, v141
    v_cvt_pk_bf16_f32 v151, v142, v143
    v_permlane32_swap_b32 v144, v146
    v_permlane32_swap_b32 v145, v147
    v_permlane32_swap_b32 v148, v150
    v_permlane32_swap_b32 v149, v151
    s_mul_i32 s72, s76, 1179648
    s_lshl_b32 s73, s75, 12
    s_add_u32 s72, s72, s73
    s_add_u32 s72, s72, 0
    s_add_u32 s62, s60, s72
    s_addc_u32 s63, s61, 0
    global_store_dwordx4 v14, v[144:147], s[62:63] sc1
    global_store_dwordx4 v14, v[148:151], s[62:63] offset:1024 sc1
    v_accvgpr_read_b32 v128, a16
    v_accvgpr_read_b32 v129, a17
    v_accvgpr_read_b32 v130, a18
    v_accvgpr_read_b32 v131, a19
    v_accvgpr_read_b32 v132, a20
    v_accvgpr_read_b32 v133, a21
    v_accvgpr_read_b32 v134, a22
    v_accvgpr_read_b32 v135, a23
    v_accvgpr_read_b32 v136, a24
    v_accvgpr_read_b32 v137, a25
    v_accvgpr_read_b32 v138, a26
    v_accvgpr_read_b32 v139, a27
    v_accvgpr_read_b32 v140, a28
    v_accvgpr_read_b32 v141, a29
    v_accvgpr_read_b32 v142, a30
    v_accvgpr_read_b32 v143, a31
    v_mul_f32 v160, v128, v128
    v_mul_f32 v161, v129, v129
    v_mul_f32 v162, v130, v130
    v_mul_f32 v163, v131, v131
    v_mul_f32 v164, v132, v132
    v_mul_f32 v165, v133, v133
    v_mul_f32 v166, v134, v134
    v_mul_f32 v167, v135, v135
    v_mul_f32 v168, v136, v136
    v_mul_f32 v169, v137, v137
    v_mul_f32 v170, v138, v138
    v_mul_f32 v171, v139, v139
    v_mul_f32 v172, v140, v140
    v_mul_f32 v173, v141, v141
    v_mul_f32 v174, v142, v142
    v_mul_f32 v175, v143, v143
    v_fma_f32 v160, v160, s74, v15
    v_fma_f32 v161, v161, s74, v15
    v_fma_f32 v162, v162, s74, v15
    v_fma_f32 v163, v163, s74, v15
    v_fma_f32 v164, v164, s74, v15
    v_fma_f32 v165, v165, s74, v15
    v_fma_f32 v166, v166, s74, v15
    v_fma_f32 v167, v167, s74, v15
    v_fma_f32 v168, v168, s74, v15
    v_fma_f32 v169, v169, s74, v15
    v_fma_f32 v170, v170, s74, v15
    v_fma_f32 v171, v171, s74, v15
    v_fma_f32 v172, v172, s74, v15
    v_fma_f32 v173, v173, s74, v15
    v_fma_f32 v174, v174, s74, v15
    v_fma_f32 v175, v175, s74, v15
    v_mul_f32 v160, v160, v128
    v_mul_f32 v161, v161, v129
    v_mul_f32 v162, v162, v130
    v_mul_f32 v163, v163, v131
    v_mul_f32 v164, v164, v132
    v_mul_f32 v165, v165, v133
    v_mul_f32 v166, v166, v134
    v_mul_f32 v167, v167, v135
    v_mul_f32 v168, v168, v136
    v_mul_f32 v169, v169, v137
    v_mul_f32 v170, v170, v138
    v_mul_f32 v171, v171, v139
    v_mul_f32 v172, v172, v140
    v_mul_f32 v173, v173, v141
    v_mul_f32 v174, v174, v142
    v_mul_f32 v175, v175, v143
    v_exp_f32 v160, v160
    v_exp_f32 v161, v161
    v_exp_f32 v162, v162
    v_exp_f32 v163, v163
    v_exp_f32 v164, v164
    v_exp_f32 v165, v165
    v_exp_f32 v166, v166
    v_exp_f32 v167, v167
    v_exp_f32 v168, v168
    v_exp_f32 v169, v169
    v_exp_f32 v170, v170
    v_exp_f32 v171, v171
    v_exp_f32 v172, v172
    v_exp_f32 v173, v173
    v_exp_f32 v174, v174
    v_exp_f32 v175, v175
    v_add_f32 v160, 1.0, v160
    v_add_f32 v161, 1.0, v161
    v_add_f32 v162, 1.0, v162
    v_add_f32 v163, 1.0, v163
    v_add_f32 v164, 1.0, v164
    v_add_f32 v165, 1.0, v165
    v_add_f32 v166, 1.0, v166
    v_add_f32 v167, 1.0, v167
    v_add_f32 v168, 1.0, v168
    v_add_f32 v169, 1.0, v169
    v_add_f32 v170, 1.0, v170
    v_add_f32 v171, 1.0, v171
    v_add_f32 v172, 1.0, v172
    v_add_f32 v173, 1.0, v173
    v_add_f32 v174, 1.0, v174
    v_add_f32 v175, 1.0, v175
    v_rcp_f32 v160, v160
    v_rcp_f32 v161, v161
    v_rcp_f32 v162, v162
    v_rcp_f32 v163, v163
    v_rcp_f32 v164, v164
    v_rcp_f32 v165, v165
    v_rcp_f32 v166, v166
    v_rcp_f32 v167, v167
    v_rcp_f32 v168, v168
    v_rcp_f32 v169, v169
    v_rcp_f32 v170, v170
    v_rcp_f32 v171, v171
    v_rcp_f32 v172, v172
    v_rcp_f32 v173, v173
    v_rcp_f32 v174, v174
    v_rcp_f32 v175, v175
    v_mul_f32 v128, v128, v160
    v_mul_f32 v129, v129, v161
    v_mul_f32 v130, v130, v162
    v_mul_f32 v131, v131, v163
    v_mul_f32 v132, v132, v164
    v_mul_f32 v133, v133, v165
    v_mul_f32 v134, v134, v166
    v_mul_f32 v135, v135, v167
    v_mul_f32 v136, v136, v168
    v_mul_f32 v137, v137, v169
    v_mul_f32 v138, v138, v170
    v_mul_f32 v139, v139, v171
    v_mul_f32 v140, v140, v172
    v_mul_f32 v141, v141, v173
    v_mul_f32 v142, v142, v174
    v_mul_f32 v143, v143, v175
    v_accvgpr_read_b32 v160, a144
    v_accvgpr_read_b32 v161, a145
    v_accvgpr_read_b32 v162, a146
    v_accvgpr_read_b32 v163, a147
    v_accvgpr_read_b32 v164, a148
    v_accvgpr_read_b32 v165, a149
    v_accvgpr_read_b32 v166, a150
    v_accvgpr_read_b32 v167, a151
    v_accvgpr_read_b32 v168, a152
    v_accvgpr_read_b32 v169, a153
    v_accvgpr_read_b32 v170, a154
    v_accvgpr_read_b32 v171, a155
    v_accvgpr_read_b32 v172, a156
    v_accvgpr_read_b32 v173, a157
    v_accvgpr_read_b32 v174, a158
    v_accvgpr_read_b32 v175, a159
    v_mul_f32 v128, v128, v160
    v_mul_f32 v129, v129, v161
    v_mul_f32 v130, v130, v162
    v_mul_f32 v131, v131, v163
    v_mul_f32 v132, v132, v164
    v_mul_f32 v133, v133, v165
    v_mul_f32 v134, v134, v166
    v_mul_f32 v135, v135, v167
    v_mul_f32 v136, v136, v168
    v_mul_f32 v137, v137, v169
    v_mul_f32 v138, v138, v170
    v_mul_f32 v139, v139, v171
    v_mul_f32 v140, v140, v172
    v_mul_f32 v141, v141, v173
    v_mul_f32 v142, v142, v174
    v_mul_f32 v143, v143, v175
    v_cvt_pk_bf16_f32 v152, v128, v129
    v_cvt_pk_bf16_f32 v153, v130, v131
    v_cvt_pk_bf16_f32 v154, v132, v133
    v_cvt_pk_bf16_f32 v155, v134, v135
    v_cvt_pk_bf16_f32 v156, v136, v137
    v_cvt_pk_bf16_f32 v157, v138, v139
    v_cvt_pk_bf16_f32 v158, v140, v141
    v_cvt_pk_bf16_f32 v159, v142, v143
    v_permlane32_swap_b32 v152, v154
    v_permlane32_swap_b32 v153, v155
    v_permlane32_swap_b32 v156, v158
    v_permlane32_swap_b32 v157, v159
    s_mul_i32 s72, s76, 1179648
    s_lshl_b32 s73, s75, 12
    s_add_u32 s72, s72, s73
    s_add_u32 s72, s72, 294912
    s_add_u32 s62, s60, s72
    s_addc_u32 s63, s61, 0
    global_store_dwordx4 v14, v[152:155], s[62:63] sc1
    global_store_dwordx4 v14, v[156:159], s[62:63] offset:1024 sc1
    v_accvgpr_read_b32 v128, a32
    v_accvgpr_read_b32 v129, a33
    v_accvgpr_read_b32 v130, a34
    v_accvgpr_read_b32 v131, a35
    v_accvgpr_read_b32 v132, a36
    v_accvgpr_read_b32 v133, a37
    v_accvgpr_read_b32 v134, a38
    v_accvgpr_read_b32 v135, a39
    v_accvgpr_read_b32 v136, a40
    v_accvgpr_read_b32 v137, a41
    v_accvgpr_read_b32 v138, a42
    v_accvgpr_read_b32 v139, a43
    v_accvgpr_read_b32 v140, a44
    v_accvgpr_read_b32 v141, a45
    v_accvgpr_read_b32 v142, a46
    v_accvgpr_read_b32 v143, a47
    v_mul_f32 v160, v128, v128
    v_mul_f32 v161, v129, v129
    v_mul_f32 v162, v130, v130
    v_mul_f32 v163, v131, v131
    v_mul_f32 v164, v132, v132
    v_mul_f32 v165, v133, v133
    v_mul_f32 v166, v134, v134
    v_mul_f32 v167, v135, v135
    v_mul_f32 v168, v136, v136
    v_mul_f32 v169, v137, v137
    v_mul_f32 v170, v138, v138
    v_mul_f32 v171, v139, v139
    v_mul_f32 v172, v140, v140
    v_mul_f32 v173, v141, v141
    v_mul_f32 v174, v142, v142
    v_mul_f32 v175, v143, v143
    v_fma_f32 v160, v160, s74, v15
    v_fma_f32 v161, v161, s74, v15
    v_fma_f32 v162, v162, s74, v15
    v_fma_f32 v163, v163, s74, v15
    v_fma_f32 v164, v164, s74, v15
    v_fma_f32 v165, v165, s74, v15
    v_fma_f32 v166, v166, s74, v15
    v_fma_f32 v167, v167, s74, v15
    v_fma_f32 v168, v168, s74, v15
    v_fma_f32 v169, v169, s74, v15
    v_fma_f32 v170, v170, s74, v15
    v_fma_f32 v171, v171, s74, v15
    v_fma_f32 v172, v172, s74, v15
    v_fma_f32 v173, v173, s74, v15
    v_fma_f32 v174, v174, s74, v15
    v_fma_f32 v175, v175, s74, v15
    v_mul_f32 v160, v160, v128
    v_mul_f32 v161, v161, v129
    v_mul_f32 v162, v162, v130
    v_mul_f32 v163, v163, v131
    v_mul_f32 v164, v164, v132
    v_mul_f32 v165, v165, v133
    v_mul_f32 v166, v166, v134
    v_mul_f32 v167, v167, v135
    v_mul_f32 v168, v168, v136
    v_mul_f32 v169, v169, v137
    v_mul_f32 v170, v170, v138
    v_mul_f32 v171, v171, v139
    v_mul_f32 v172, v172, v140
    v_mul_f32 v173, v173, v141
    v_mul_f32 v174, v174, v142
    v_mul_f32 v175, v175, v143
    v_exp_f32 v160, v160
    v_exp_f32 v161, v161
    v_exp_f32 v162, v162
    v_exp_f32 v163, v163
    v_exp_f32 v164, v164
    v_exp_f32 v165, v165
    v_exp_f32 v166, v166
    v_exp_f32 v167, v167
    v_exp_f32 v168, v168
    v_exp_f32 v169, v169
    v_exp_f32 v170, v170
    v_exp_f32 v171, v171
    v_exp_f32 v172, v172
    v_exp_f32 v173, v173
    v_exp_f32 v174, v174
    v_exp_f32 v175, v175
    v_add_f32 v160, 1.0, v160
    v_add_f32 v161, 1.0, v161
    v_add_f32 v162, 1.0, v162
    v_add_f32 v163, 1.0, v163
    v_add_f32 v164, 1.0, v164
    v_add_f32 v165, 1.0, v165
    v_add_f32 v166, 1.0, v166
    v_add_f32 v167, 1.0, v167
    v_add_f32 v168, 1.0, v168
    v_add_f32 v169, 1.0, v169
    v_add_f32 v170, 1.0, v170
    v_add_f32 v171, 1.0, v171
    v_add_f32 v172, 1.0, v172
    v_add_f32 v173, 1.0, v173
    v_add_f32 v174, 1.0, v174
    v_add_f32 v175, 1.0, v175
    v_rcp_f32 v160, v160
    v_rcp_f32 v161, v161
    v_rcp_f32 v162, v162
    v_rcp_f32 v163, v163
    v_rcp_f32 v164, v164
    v_rcp_f32 v165, v165
    v_rcp_f32 v166, v166
    v_rcp_f32 v167, v167
    v_rcp_f32 v168, v168
    v_rcp_f32 v169, v169
    v_rcp_f32 v170, v170
    v_rcp_f32 v171, v171
    v_rcp_f32 v172, v172
    v_rcp_f32 v173, v173
    v_rcp_f32 v174, v174
    v_rcp_f32 v175, v175
    v_mul_f32 v128, v128, v160
    v_mul_f32 v129, v129, v161
    v_mul_f32 v130, v130, v162
    v_mul_f32 v131, v131, v163
    v_mul_f32 v132, v132, v164
    v_mul_f32 v133, v133, v165
    v_mul_f32 v134, v134, v166
    v_mul_f32 v135, v135, v167
    v_mul_f32 v136, v136, v168
    v_mul_f32 v137, v137, v169
    v_mul_f32 v138, v138, v170
    v_mul_f32 v139, v139, v171
    v_mul_f32 v140, v140, v172
    v_mul_f32 v141, v141, v173
    v_mul_f32 v142, v142, v174
    v_mul_f32 v143, v143, v175
    v_accvgpr_read_b32 v160, a160
    v_accvgpr_read_b32 v161, a161
    v_accvgpr_read_b32 v162, a162
    v_accvgpr_read_b32 v163, a163
    v_accvgpr_read_b32 v164, a164
    v_accvgpr_read_b32 v165, a165
    v_accvgpr_read_b32 v166, a166
    v_accvgpr_read_b32 v167, a167
    v_accvgpr_read_b32 v168, a168
    v_accvgpr_read_b32 v169, a169
    v_accvgpr_read_b32 v170, a170
    v_accvgpr_read_b32 v171, a171
    v_accvgpr_read_b32 v172, a172
    v_accvgpr_read_b32 v173, a173
    v_accvgpr_read_b32 v174, a174
    v_accvgpr_read_b32 v175, a175
    v_mul_f32 v128, v128, v160
    v_mul_f32 v129, v129, v161
    v_mul_f32 v130, v130, v162
    v_mul_f32 v131, v131, v163
    v_mul_f32 v132, v132, v164
    v_mul_f32 v133, v133, v165
    v_mul_f32 v134, v134, v166
    v_mul_f32 v135, v135, v167
    v_mul_f32 v136, v136, v168
    v_mul_f32 v137, v137, v169
    v_mul_f32 v138, v138, v170
    v_mul_f32 v139, v139, v171
    v_mul_f32 v140, v140, v172
    v_mul_f32 v141, v141, v173
    v_mul_f32 v142, v142, v174
    v_mul_f32 v143, v143, v175
    v_cvt_pk_bf16_f32 v144, v128, v129
    v_cvt_pk_bf16_f32 v145, v130, v131
    v_cvt_pk_bf16_f32 v146, v132, v133
    v_cvt_pk_bf16_f32 v147, v134, v135
    v_cvt_pk_bf16_f32 v148, v136, v137
    v_cvt_pk_bf16_f32 v149, v138, v139
    v_cvt_pk_bf16_f32 v150, v140, v141
    v_cvt_pk_bf16_f32 v151, v142, v143
    v_permlane32_swap_b32 v144, v146
    v_permlane32_swap_b32 v145, v147
    v_permlane32_swap_b32 v148, v150
    v_permlane32_swap_b32 v149, v151
    s_mul_i32 s72, s76, 1179648
    s_lshl_b32 s73, s75, 12
    s_add_u32 s72, s72, s73
    s_add_u32 s72, s72, 589824
    s_add_u32 s62, s60, s72
    s_addc_u32 s63, s61, 0
    global_store_dwordx4 v14, v[144:147], s[62:63] sc1
    global_store_dwordx4 v14, v[148:151], s[62:63] offset:1024 sc1
    v_accvgpr_read_b32 v128, a48
    v_accvgpr_read_b32 v129, a49
    v_accvgpr_read_b32 v130, a50
    v_accvgpr_read_b32 v131, a51
    v_accvgpr_read_b32 v132, a52
    v_accvgpr_read_b32 v133, a53
    v_accvgpr_read_b32 v134, a54
    v_accvgpr_read_b32 v135, a55
    v_accvgpr_read_b32 v136, a56
    v_accvgpr_read_b32 v137, a57
    v_accvgpr_read_b32 v138, a58
    v_accvgpr_read_b32 v139, a59
    v_accvgpr_read_b32 v140, a60
    v_accvgpr_read_b32 v141, a61
    v_accvgpr_read_b32 v142, a62
    v_accvgpr_read_b32 v143, a63
    v_mul_f32 v160, v128, v128
    v_mul_f32 v161, v129, v129
    v_mul_f32 v162, v130, v130
    v_mul_f32 v163, v131, v131
    v_mul_f32 v164, v132, v132
    v_mul_f32 v165, v133, v133
    v_mul_f32 v166, v134, v134
    v_mul_f32 v167, v135, v135
    v_mul_f32 v168, v136, v136
    v_mul_f32 v169, v137, v137
    v_mul_f32 v170, v138, v138
    v_mul_f32 v171, v139, v139
    v_mul_f32 v172, v140, v140
    v_mul_f32 v173, v141, v141
    v_mul_f32 v174, v142, v142
    v_mul_f32 v175, v143, v143
    v_fma_f32 v160, v160, s74, v15
    v_fma_f32 v161, v161, s74, v15
    v_fma_f32 v162, v162, s74, v15
    v_fma_f32 v163, v163, s74, v15
    v_fma_f32 v164, v164, s74, v15
    v_fma_f32 v165, v165, s74, v15
    v_fma_f32 v166, v166, s74, v15
    v_fma_f32 v167, v167, s74, v15
    v_fma_f32 v168, v168, s74, v15
    v_fma_f32 v169, v169, s74, v15
    v_fma_f32 v170, v170, s74, v15
    v_fma_f32 v171, v171, s74, v15
    v_fma_f32 v172, v172, s74, v15
    v_fma_f32 v173, v173, s74, v15
    v_fma_f32 v174, v174, s74, v15
    v_fma_f32 v175, v175, s74, v15
    v_mul_f32 v160, v160, v128
    v_mul_f32 v161, v161, v129
    v_mul_f32 v162, v162, v130
    v_mul_f32 v163, v163, v131
    v_mul_f32 v164, v164, v132
    v_mul_f32 v165, v165, v133
    v_mul_f32 v166, v166, v134
    v_mul_f32 v167, v167, v135
    v_mul_f32 v168, v168, v136
    v_mul_f32 v169, v169, v137
    v_mul_f32 v170, v170, v138
    v_mul_f32 v171, v171, v139
    v_mul_f32 v172, v172, v140
    v_mul_f32 v173, v173, v141
    v_mul_f32 v174, v174, v142
    v_mul_f32 v175, v175, v143
    v_exp_f32 v160, v160
    v_exp_f32 v161, v161
    v_exp_f32 v162, v162
    v_exp_f32 v163, v163
    v_exp_f32 v164, v164
    v_exp_f32 v165, v165
    v_exp_f32 v166, v166
    v_exp_f32 v167, v167
    v_exp_f32 v168, v168
    v_exp_f32 v169, v169
    v_exp_f32 v170, v170
    v_exp_f32 v171, v171
    v_exp_f32 v172, v172
    v_exp_f32 v173, v173
    v_exp_f32 v174, v174
    v_exp_f32 v175, v175
    v_add_f32 v160, 1.0, v160
    v_add_f32 v161, 1.0, v161
    v_add_f32 v162, 1.0, v162
    v_add_f32 v163, 1.0, v163
    v_add_f32 v164, 1.0, v164
    v_add_f32 v165, 1.0, v165
    v_add_f32 v166, 1.0, v166
    v_add_f32 v167, 1.0, v167
    v_add_f32 v168, 1.0, v168
    v_add_f32 v169, 1.0, v169
    v_add_f32 v170, 1.0, v170
    v_add_f32 v171, 1.0, v171
    v_add_f32 v172, 1.0, v172
    v_add_f32 v173, 1.0, v173
    v_add_f32 v174, 1.0, v174
    v_add_f32 v175, 1.0, v175
    v_rcp_f32 v160, v160
    v_rcp_f32 v161, v161
    v_rcp_f32 v162, v162
    v_rcp_f32 v163, v163
    v_rcp_f32 v164, v164
    v_rcp_f32 v165, v165
    v_rcp_f32 v166, v166
    v_rcp_f32 v167, v167
    v_rcp_f32 v168, v168
    v_rcp_f32 v169, v169
    v_rcp_f32 v170, v170
    v_rcp_f32 v171, v171
    v_rcp_f32 v172, v172
    v_rcp_f32 v173, v173
    v_rcp_f32 v174, v174
    v_rcp_f32 v175, v175
    v_mul_f32 v128, v128, v160
    v_mul_f32 v129, v129, v161
    v_mul_f32 v130, v130, v162
    v_mul_f32 v131, v131, v163
    v_mul_f32 v132, v132, v164
    v_mul_f32 v133, v133, v165
    v_mul_f32 v134, v134, v166
    v_mul_f32 v135, v135, v167
    v_mul_f32 v136, v136, v168
    v_mul_f32 v137, v137, v169
    v_mul_f32 v138, v138, v170
    v_mul_f32 v139, v139, v171
    v_mul_f32 v140, v140, v172
    v_mul_f32 v141, v141, v173
    v_mul_f32 v142, v142, v174
    v_mul_f32 v143, v143, v175
    v_accvgpr_read_b32 v160, a176
    v_accvgpr_read_b32 v161, a177
    v_accvgpr_read_b32 v162, a178
    v_accvgpr_read_b32 v163, a179
    v_accvgpr_read_b32 v164, a180
    v_accvgpr_read_b32 v165, a181
    v_accvgpr_read_b32 v166, a182
    v_accvgpr_read_b32 v167, a183
    v_accvgpr_read_b32 v168, a184
    v_accvgpr_read_b32 v169, a185
    v_accvgpr_read_b32 v170, a186
    v_accvgpr_read_b32 v171, a187
    v_accvgpr_read_b32 v172, a188
    v_accvgpr_read_b32 v173, a189
    v_accvgpr_read_b32 v174, a190
    v_accvgpr_read_b32 v175, a191
    v_mul_f32 v128, v128, v160
    v_mul_f32 v129, v129, v161
    v_mul_f32 v130, v130, v162
    v_mul_f32 v131, v131, v163
    v_mul_f32 v132, v132, v164
    v_mul_f32 v133, v133, v165
    v_mul_f32 v134, v134, v166
    v_mul_f32 v135, v135, v167
    v_mul_f32 v136, v136, v168
    v_mul_f32 v137, v137, v169
    v_mul_f32 v138, v138, v170
    v_mul_f32 v139, v139, v171
    v_mul_f32 v140, v140, v172
    v_mul_f32 v141, v141, v173
    v_mul_f32 v142, v142, v174
    v_mul_f32 v143, v143, v175
    v_cvt_pk_bf16_f32 v152, v128, v129
    v_cvt_pk_bf16_f32 v153, v130, v131
    v_cvt_pk_bf16_f32 v154, v132, v133
    v_cvt_pk_bf16_f32 v155, v134, v135
    v_cvt_pk_bf16_f32 v156, v136, v137
    v_cvt_pk_bf16_f32 v157, v138, v139
    v_cvt_pk_bf16_f32 v158, v140, v141
    v_cvt_pk_bf16_f32 v159, v142, v143
    v_permlane32_swap_b32 v152, v154
    v_permlane32_swap_b32 v153, v155
    v_permlane32_swap_b32 v156, v158
    v_permlane32_swap_b32 v157, v159
    s_mul_i32 s72, s76, 1179648
    s_lshl_b32 s73, s75, 12
    s_add_u32 s72, s72, s73
    s_add_u32 s72, s72, 884736
    s_add_u32 s62, s60, s72
    s_addc_u32 s63, s61, 0
    global_store_dwordx4 v14, v[152:155], s[62:63] sc1
    global_store_dwordx4 v14, v[156:159], s[62:63] offset:1024 sc1
    v_accvgpr_read_b32 v128, a64
    v_accvgpr_read_b32 v129, a65
    v_accvgpr_read_b32 v130, a66
    v_accvgpr_read_b32 v131, a67
    v_accvgpr_read_b32 v132, a68
    v_accvgpr_read_b32 v133, a69
    v_accvgpr_read_b32 v134, a70
    v_accvgpr_read_b32 v135, a71
    v_accvgpr_read_b32 v136, a72
    v_accvgpr_read_b32 v137, a73
    v_accvgpr_read_b32 v138, a74
    v_accvgpr_read_b32 v139, a75
    v_accvgpr_read_b32 v140, a76
    v_accvgpr_read_b32 v141, a77
    v_accvgpr_read_b32 v142, a78
    v_accvgpr_read_b32 v143, a79
    v_mul_f32 v160, v128, v128
    v_mul_f32 v161, v129, v129
    v_mul_f32 v162, v130, v130
    v_mul_f32 v163, v131, v131
    v_mul_f32 v164, v132, v132
    v_mul_f32 v165, v133, v133
    v_mul_f32 v166, v134, v134
    v_mul_f32 v167, v135, v135
    v_mul_f32 v168, v136, v136
    v_mul_f32 v169, v137, v137
    v_mul_f32 v170, v138, v138
    v_mul_f32 v171, v139, v139
    v_mul_f32 v172, v140, v140
    v_mul_f32 v173, v141, v141
    v_mul_f32 v174, v142, v142
    v_mul_f32 v175, v143, v143
    v_fma_f32 v160, v160, s74, v15
    v_fma_f32 v161, v161, s74, v15
    v_fma_f32 v162, v162, s74, v15
    v_fma_f32 v163, v163, s74, v15
    v_fma_f32 v164, v164, s74, v15
    v_fma_f32 v165, v165, s74, v15
    v_fma_f32 v166, v166, s74, v15
    v_fma_f32 v167, v167, s74, v15
    v_fma_f32 v168, v168, s74, v15
    v_fma_f32 v169, v169, s74, v15
    v_fma_f32 v170, v170, s74, v15
    v_fma_f32 v171, v171, s74, v15
    v_fma_f32 v172, v172, s74, v15
    v_fma_f32 v173, v173, s74, v15
    v_fma_f32 v174, v174, s74, v15
    v_fma_f32 v175, v175, s74, v15
    v_mul_f32 v160, v160, v128
    v_mul_f32 v161, v161, v129
    v_mul_f32 v162, v162, v130
    v_mul_f32 v163, v163, v131
    v_mul_f32 v164, v164, v132
    v_mul_f32 v165, v165, v133
    v_mul_f32 v166, v166, v134
    v_mul_f32 v167, v167, v135
    v_mul_f32 v168, v168, v136
    v_mul_f32 v169, v169, v137
    v_mul_f32 v170, v170, v138
    v_mul_f32 v171, v171, v139
    v_mul_f32 v172, v172, v140
    v_mul_f32 v173, v173, v141
    v_mul_f32 v174, v174, v142
    v_mul_f32 v175, v175, v143
    v_exp_f32 v160, v160
    v_exp_f32 v161, v161
    v_exp_f32 v162, v162
    v_exp_f32 v163, v163
    v_exp_f32 v164, v164
    v_exp_f32 v165, v165
    v_exp_f32 v166, v166
    v_exp_f32 v167, v167
    v_exp_f32 v168, v168
    v_exp_f32 v169, v169
    v_exp_f32 v170, v170
    v_exp_f32 v171, v171
    v_exp_f32 v172, v172
    v_exp_f32 v173, v173
    v_exp_f32 v174, v174
    v_exp_f32 v175, v175
    v_add_f32 v160, 1.0, v160
    v_add_f32 v161, 1.0, v161
    v_add_f32 v162, 1.0, v162
    v_add_f32 v163, 1.0, v163
    v_add_f32 v164, 1.0, v164
    v_add_f32 v165, 1.0, v165
    v_add_f32 v166, 1.0, v166
    v_add_f32 v167, 1.0, v167
    v_add_f32 v168, 1.0, v168
    v_add_f32 v169, 1.0, v169
    v_add_f32 v170, 1.0, v170
    v_add_f32 v171, 1.0, v171
    v_add_f32 v172, 1.0, v172
    v_add_f32 v173, 1.0, v173
    v_add_f32 v174, 1.0, v174
    v_add_f32 v175, 1.0, v175
    v_rcp_f32 v160, v160
    v_rcp_f32 v161, v161
    v_rcp_f32 v162, v162
    v_rcp_f32 v163, v163
    v_rcp_f32 v164, v164
    v_rcp_f32 v165, v165
    v_rcp_f32 v166, v166
    v_rcp_f32 v167, v167
    v_rcp_f32 v168, v168
    v_rcp_f32 v169, v169
    v_rcp_f32 v170, v170
    v_rcp_f32 v171, v171
    v_rcp_f32 v172, v172
    v_rcp_f32 v173, v173
    v_rcp_f32 v174, v174
    v_rcp_f32 v175, v175
    v_mul_f32 v128, v128, v160
    v_mul_f32 v129, v129, v161
    v_mul_f32 v130, v130, v162
    v_mul_f32 v131, v131, v163
    v_mul_f32 v132, v132, v164
    v_mul_f32 v133, v133, v165
    v_mul_f32 v134, v134, v166
    v_mul_f32 v135, v135, v167
    v_mul_f32 v136, v136, v168
    v_mul_f32 v137, v137, v169
    v_mul_f32 v138, v138, v170
    v_mul_f32 v139, v139, v171
    v_mul_f32 v140, v140, v172
    v_mul_f32 v141, v141, v173
    v_mul_f32 v142, v142, v174
    v_mul_f32 v143, v143, v175
    v_accvgpr_read_b32 v160, a192
    v_accvgpr_read_b32 v161, a193
    v_accvgpr_read_b32 v162, a194
    v_accvgpr_read_b32 v163, a195
    v_accvgpr_read_b32 v164, a196
    v_accvgpr_read_b32 v165, a197
    v_accvgpr_read_b32 v166, a198
    v_accvgpr_read_b32 v167, a199
    v_accvgpr_read_b32 v168, a200
    v_accvgpr_read_b32 v169, a201
    v_accvgpr_read_b32 v170, a202
    v_accvgpr_read_b32 v171, a203
    v_accvgpr_read_b32 v172, a204
    v_accvgpr_read_b32 v173, a205
    v_accvgpr_read_b32 v174, a206
    v_accvgpr_read_b32 v175, a207
    v_mul_f32 v128, v128, v160
    v_mul_f32 v129, v129, v161
    v_mul_f32 v130, v130, v162
    v_mul_f32 v131, v131, v163
    v_mul_f32 v132, v132, v164
    v_mul_f32 v133, v133, v165
    v_mul_f32 v134, v134, v166
    v_mul_f32 v135, v135, v167
    v_mul_f32 v136, v136, v168
    v_mul_f32 v137, v137, v169
    v_mul_f32 v138, v138, v170
    v_mul_f32 v139, v139, v171
    v_mul_f32 v140, v140, v172
    v_mul_f32 v141, v141, v173
    v_mul_f32 v142, v142, v174
    v_mul_f32 v143, v143, v175
    v_cvt_pk_bf16_f32 v144, v128, v129
    v_cvt_pk_bf16_f32 v145, v130, v131
    v_cvt_pk_bf16_f32 v146, v132, v133
    v_cvt_pk_bf16_f32 v147, v134, v135
    v_cvt_pk_bf16_f32 v148, v136, v137
    v_cvt_pk_bf16_f32 v149, v138, v139
    v_cvt_pk_bf16_f32 v150, v140, v141
    v_cvt_pk_bf16_f32 v151, v142, v143
    v_permlane32_swap_b32 v144, v146
    v_permlane32_swap_b32 v145, v147
    v_permlane32_swap_b32 v148, v150
    v_permlane32_swap_b32 v149, v151
    s_mul_i32 s72, s76, 1179648
    s_lshl_b32 s73, s75, 12
    s_add_u32 s72, s72, s73
    s_add_u32 s72, s72, 2048
    s_add_u32 s62, s60, s72
    s_addc_u32 s63, s61, 0
    global_store_dwordx4 v14, v[144:147], s[62:63] sc1
    global_store_dwordx4 v14, v[148:151], s[62:63] offset:1024 sc1
    v_accvgpr_read_b32 v128, a80
    v_accvgpr_read_b32 v129, a81
    v_accvgpr_read_b32 v130, a82
    v_accvgpr_read_b32 v131, a83
    v_accvgpr_read_b32 v132, a84
    v_accvgpr_read_b32 v133, a85
    v_accvgpr_read_b32 v134, a86
    v_accvgpr_read_b32 v135, a87
    v_accvgpr_read_b32 v136, a88
    v_accvgpr_read_b32 v137, a89
    v_accvgpr_read_b32 v138, a90
    v_accvgpr_read_b32 v139, a91
    v_accvgpr_read_b32 v140, a92
    v_accvgpr_read_b32 v141, a93
    v_accvgpr_read_b32 v142, a94
    v_accvgpr_read_b32 v143, a95
    v_mul_f32 v160, v128, v128
    v_mul_f32 v161, v129, v129
    v_mul_f32 v162, v130, v130
    v_mul_f32 v163, v131, v131
    v_mul_f32 v164, v132, v132
    v_mul_f32 v165, v133, v133
    v_mul_f32 v166, v134, v134
    v_mul_f32 v167, v135, v135
    v_mul_f32 v168, v136, v136
    v_mul_f32 v169, v137, v137
    v_mul_f32 v170, v138, v138
    v_mul_f32 v171, v139, v139
    v_mul_f32 v172, v140, v140
    v_mul_f32 v173, v141, v141
    v_mul_f32 v174, v142, v142
    v_mul_f32 v175, v143, v143
    v_fma_f32 v160, v160, s74, v15
    v_fma_f32 v161, v161, s74, v15
    v_fma_f32 v162, v162, s74, v15
    v_fma_f32 v163, v163, s74, v15
    v_fma_f32 v164, v164, s74, v15
    v_fma_f32 v165, v165, s74, v15
    v_fma_f32 v166, v166, s74, v15
    v_fma_f32 v167, v167, s74, v15
    v_fma_f32 v168, v168, s74, v15
    v_fma_f32 v169, v169, s74, v15
    v_fma_f32 v170, v170, s74, v15
    v_fma_f32 v171, v171, s74, v15
    v_fma_f32 v172, v172, s74, v15
    v_fma_f32 v173, v173, s74, v15
    v_fma_f32 v174, v174, s74, v15
    v_fma_f32 v175, v175, s74, v15
    v_mul_f32 v160, v160, v128
    v_mul_f32 v161, v161, v129
    v_mul_f32 v162, v162, v130
    v_mul_f32 v163, v163, v131
    v_mul_f32 v164, v164, v132
    v_mul_f32 v165, v165, v133
    v_mul_f32 v166, v166, v134
    v_mul_f32 v167, v167, v135
    v_mul_f32 v168, v168, v136
    v_mul_f32 v169, v169, v137
    v_mul_f32 v170, v170, v138
    v_mul_f32 v171, v171, v139
    v_mul_f32 v172, v172, v140
    v_mul_f32 v173, v173, v141
    v_mul_f32 v174, v174, v142
    v_mul_f32 v175, v175, v143
    v_exp_f32 v160, v160
    v_exp_f32 v161, v161
    v_exp_f32 v162, v162
    v_exp_f32 v163, v163
    v_exp_f32 v164, v164
    v_exp_f32 v165, v165
    v_exp_f32 v166, v166
    v_exp_f32 v167, v167
    v_exp_f32 v168, v168
    v_exp_f32 v169, v169
    v_exp_f32 v170, v170
    v_exp_f32 v171, v171
    v_exp_f32 v172, v172
    v_exp_f32 v173, v173
    v_exp_f32 v174, v174
    v_exp_f32 v175, v175
    v_add_f32 v160, 1.0, v160
    v_add_f32 v161, 1.0, v161
    v_add_f32 v162, 1.0, v162
    v_add_f32 v163, 1.0, v163
    v_add_f32 v164, 1.0, v164
    v_add_f32 v165, 1.0, v165
    v_add_f32 v166, 1.0, v166
    v_add_f32 v167, 1.0, v167
    v_add_f32 v168, 1.0, v168
    v_add_f32 v169, 1.0, v169
    v_add_f32 v170, 1.0, v170
    v_add_f32 v171, 1.0, v171
    v_add_f32 v172, 1.0, v172
    v_add_f32 v173, 1.0, v173
    v_add_f32 v174, 1.0, v174
    v_add_f32 v175, 1.0, v175
    v_rcp_f32 v160, v160
    v_rcp_f32 v161, v161
    v_rcp_f32 v162, v162
    v_rcp_f32 v163, v163
    v_rcp_f32 v164, v164
    v_rcp_f32 v165, v165
    v_rcp_f32 v166, v166
    v_rcp_f32 v167, v167
    v_rcp_f32 v168, v168
    v_rcp_f32 v169, v169
    v_rcp_f32 v170, v170
    v_rcp_f32 v171, v171
    v_rcp_f32 v172, v172
    v_rcp_f32 v173, v173
    v_rcp_f32 v174, v174
    v_rcp_f32 v175, v175
    v_mul_f32 v128, v128, v160
    v_mul_f32 v129, v129, v161
    v_mul_f32 v130, v130, v162
    v_mul_f32 v131, v131, v163
    v_mul_f32 v132, v132, v164
    v_mul_f32 v133, v133, v165
    v_mul_f32 v134, v134, v166
    v_mul_f32 v135, v135, v167
    v_mul_f32 v136, v136, v168
    v_mul_f32 v137, v137, v169
    v_mul_f32 v138, v138, v170
    v_mul_f32 v139, v139, v171
    v_mul_f32 v140, v140, v172
    v_mul_f32 v141, v141, v173
    v_mul_f32 v142, v142, v174
    v_mul_f32 v143, v143, v175
    v_accvgpr_read_b32 v160, a208
    v_accvgpr_read_b32 v161, a209
    v_accvgpr_read_b32 v162, a210
    v_accvgpr_read_b32 v163, a211
    v_accvgpr_read_b32 v164, a212
    v_accvgpr_read_b32 v165, a213
    v_accvgpr_read_b32 v166, a214
    v_accvgpr_read_b32 v167, a215
    v_accvgpr_read_b32 v168, a216
    v_accvgpr_read_b32 v169, a217
    v_accvgpr_read_b32 v170, a218
    v_accvgpr_read_b32 v171, a219
    v_accvgpr_read_b32 v172, a220
    v_accvgpr_read_b32 v173, a221
    v_accvgpr_read_b32 v174, a222
    v_accvgpr_read_b32 v175, a223
    v_mul_f32 v128, v128, v160
    v_mul_f32 v129, v129, v161
    v_mul_f32 v130, v130, v162
    v_mul_f32 v131, v131, v163
    v_mul_f32 v132, v132, v164
    v_mul_f32 v133, v133, v165
    v_mul_f32 v134, v134, v166
    v_mul_f32 v135, v135, v167
    v_mul_f32 v136, v136, v168
    v_mul_f32 v137, v137, v169
    v_mul_f32 v138, v138, v170
    v_mul_f32 v139, v139, v171
    v_mul_f32 v140, v140, v172
    v_mul_f32 v141, v141, v173
    v_mul_f32 v142, v142, v174
    v_mul_f32 v143, v143, v175
    v_cvt_pk_bf16_f32 v152, v128, v129
    v_cvt_pk_bf16_f32 v153, v130, v131
    v_cvt_pk_bf16_f32 v154, v132, v133
    v_cvt_pk_bf16_f32 v155, v134, v135
    v_cvt_pk_bf16_f32 v156, v136, v137
    v_cvt_pk_bf16_f32 v157, v138, v139
    v_cvt_pk_bf16_f32 v158, v140, v141
    v_cvt_pk_bf16_f32 v159, v142, v143
    v_permlane32_swap_b32 v152, v154
    v_permlane32_swap_b32 v153, v155
    v_permlane32_swap_b32 v156, v158
    v_permlane32_swap_b32 v157, v159
    s_mul_i32 s72, s76, 1179648
    s_lshl_b32 s73, s75, 12
    s_add_u32 s72, s72, s73
    s_add_u32 s72, s72, 296960
    s_add_u32 s62, s60, s72
    s_addc_u32 s63, s61, 0
    global_store_dwordx4 v14, v[152:155], s[62:63] sc1
    global_store_dwordx4 v14, v[156:159], s[62:63] offset:1024 sc1
    v_accvgpr_read_b32 v128, a96
    v_accvgpr_read_b32 v129, a97
    v_accvgpr_read_b32 v130, a98
    v_accvgpr_read_b32 v131, a99
    v_accvgpr_read_b32 v132, a100
    v_accvgpr_read_b32 v133, a101
    v_accvgpr_read_b32 v134, a102
    v_accvgpr_read_b32 v135, a103
    v_accvgpr_read_b32 v136, a104
    v_accvgpr_read_b32 v137, a105
    v_accvgpr_read_b32 v138, a106
    v_accvgpr_read_b32 v139, a107
    v_accvgpr_read_b32 v140, a108
    v_accvgpr_read_b32 v141, a109
    v_accvgpr_read_b32 v142, a110
    v_accvgpr_read_b32 v143, a111
    v_mul_f32 v160, v128, v128
    v_mul_f32 v161, v129, v129
    v_mul_f32 v162, v130, v130
    v_mul_f32 v163, v131, v131
    v_mul_f32 v164, v132, v132
    v_mul_f32 v165, v133, v133
    v_mul_f32 v166, v134, v134
    v_mul_f32 v167, v135, v135
    v_mul_f32 v168, v136, v136
    v_mul_f32 v169, v137, v137
    v_mul_f32 v170, v138, v138
    v_mul_f32 v171, v139, v139
    v_mul_f32 v172, v140, v140
    v_mul_f32 v173, v141, v141
    v_mul_f32 v174, v142, v142
    v_mul_f32 v175, v143, v143
    v_fma_f32 v160, v160, s74, v15
    v_fma_f32 v161, v161, s74, v15
    v_fma_f32 v162, v162, s74, v15
    v_fma_f32 v163, v163, s74, v15
    v_fma_f32 v164, v164, s74, v15
    v_fma_f32 v165, v165, s74, v15
    v_fma_f32 v166, v166, s74, v15
    v_fma_f32 v167, v167, s74, v15
    v_fma_f32 v168, v168, s74, v15
    v_fma_f32 v169, v169, s74, v15
    v_fma_f32 v170, v170, s74, v15
    v_fma_f32 v171, v171, s74, v15
    v_fma_f32 v172, v172, s74, v15
    v_fma_f32 v173, v173, s74, v15
    v_fma_f32 v174, v174, s74, v15
    v_fma_f32 v175, v175, s74, v15
    v_mul_f32 v160, v160, v128
    v_mul_f32 v161, v161, v129
    v_mul_f32 v162, v162, v130
    v_mul_f32 v163, v163, v131
    v_mul_f32 v164, v164, v132
    v_mul_f32 v165, v165, v133
    v_mul_f32 v166, v166, v134
    v_mul_f32 v167, v167, v135
    v_mul_f32 v168, v168, v136
    v_mul_f32 v169, v169, v137
    v_mul_f32 v170, v170, v138
    v_mul_f32 v171, v171, v139
    v_mul_f32 v172, v172, v140
    v_mul_f32 v173, v173, v141
    v_mul_f32 v174, v174, v142
    v_mul_f32 v175, v175, v143
    v_exp_f32 v160, v160
    v_exp_f32 v161, v161
    v_exp_f32 v162, v162
    v_exp_f32 v163, v163
    v_exp_f32 v164, v164
    v_exp_f32 v165, v165
    v_exp_f32 v166, v166
    v_exp_f32 v167, v167
    v_exp_f32 v168, v168
    v_exp_f32 v169, v169
    v_exp_f32 v170, v170
    v_exp_f32 v171, v171
    v_exp_f32 v172, v172
    v_exp_f32 v173, v173
    v_exp_f32 v174, v174
    v_exp_f32 v175, v175
    v_add_f32 v160, 1.0, v160
    v_add_f32 v161, 1.0, v161
    v_add_f32 v162, 1.0, v162
    v_add_f32 v163, 1.0, v163
    v_add_f32 v164, 1.0, v164
    v_add_f32 v165, 1.0, v165
    v_add_f32 v166, 1.0, v166
    v_add_f32 v167, 1.0, v167
    v_add_f32 v168, 1.0, v168
    v_add_f32 v169, 1.0, v169
    v_add_f32 v170, 1.0, v170
    v_add_f32 v171, 1.0, v171
    v_add_f32 v172, 1.0, v172
    v_add_f32 v173, 1.0, v173
    v_add_f32 v174, 1.0, v174
    v_add_f32 v175, 1.0, v175
    v_rcp_f32 v160, v160
    v_rcp_f32 v161, v161
    v_rcp_f32 v162, v162
    v_rcp_f32 v163, v163
    v_rcp_f32 v164, v164
    v_rcp_f32 v165, v165
    v_rcp_f32 v166, v166
    v_rcp_f32 v167, v167
    v_rcp_f32 v168, v168
    v_rcp_f32 v169, v169
    v_rcp_f32 v170, v170
    v_rcp_f32 v171, v171
    v_rcp_f32 v172, v172
    v_rcp_f32 v173, v173
    v_rcp_f32 v174, v174
    v_rcp_f32 v175, v175
    v_mul_f32 v128, v128, v160
    v_mul_f32 v129, v129, v161
    v_mul_f32 v130, v130, v162
    v_mul_f32 v131, v131, v163
    v_mul_f32 v132, v132, v164
    v_mul_f32 v133, v133, v165
    v_mul_f32 v134, v134, v166
    v_mul_f32 v135, v135, v167
    v_mul_f32 v136, v136, v168
    v_mul_f32 v137, v137, v169
    v_mul_f32 v138, v138, v170
    v_mul_f32 v139, v139, v171
    v_mul_f32 v140, v140, v172
    v_mul_f32 v141, v141, v173
    v_mul_f32 v142, v142, v174
    v_mul_f32 v143, v143, v175
    v_accvgpr_read_b32 v160, a224
    v_accvgpr_read_b32 v161, a225
    v_accvgpr_read_b32 v162, a226
    v_accvgpr_read_b32 v163, a227
    v_accvgpr_read_b32 v164, a228
    v_accvgpr_read_b32 v165, a229
    v_accvgpr_read_b32 v166, a230
    v_accvgpr_read_b32 v167, a231
    v_accvgpr_read_b32 v168, a232
    v_accvgpr_read_b32 v169, a233
    v_accvgpr_read_b32 v170, a234
    v_accvgpr_read_b32 v171, a235
    v_accvgpr_read_b32 v172, a236
    v_accvgpr_read_b32 v173, a237
    v_accvgpr_read_b32 v174, a238
    v_accvgpr_read_b32 v175, a239
    v_mul_f32 v128, v128, v160
    v_mul_f32 v129, v129, v161
    v_mul_f32 v130, v130, v162
    v_mul_f32 v131, v131, v163
    v_mul_f32 v132, v132, v164
    v_mul_f32 v133, v133, v165
    v_mul_f32 v134, v134, v166
    v_mul_f32 v135, v135, v167
    v_mul_f32 v136, v136, v168
    v_mul_f32 v137, v137, v169
    v_mul_f32 v138, v138, v170
    v_mul_f32 v139, v139, v171
    v_mul_f32 v140, v140, v172
    v_mul_f32 v141, v141, v173
    v_mul_f32 v142, v142, v174
    v_mul_f32 v143, v143, v175
    v_cvt_pk_bf16_f32 v144, v128, v129
    v_cvt_pk_bf16_f32 v145, v130, v131
    v_cvt_pk_bf16_f32 v146, v132, v133
    v_cvt_pk_bf16_f32 v147, v134, v135
    v_cvt_pk_bf16_f32 v148, v136, v137
    v_cvt_pk_bf16_f32 v149, v138, v139
    v_cvt_pk_bf16_f32 v150, v140, v141
    v_cvt_pk_bf16_f32 v151, v142, v143
    v_permlane32_swap_b32 v144, v146
    v_permlane32_swap_b32 v145, v147
    v_permlane32_swap_b32 v148, v150
    v_permlane32_swap_b32 v149, v151
    s_mul_i32 s72, s76, 1179648
    s_lshl_b32 s73, s75, 12
    s_add_u32 s72, s72, s73
    s_add_u32 s72, s72, 591872
    s_add_u32 s62, s60, s72
    s_addc_u32 s63, s61, 0
    global_store_dwordx4 v14, v[144:147], s[62:63] sc1
    global_store_dwordx4 v14, v[148:151], s[62:63] offset:1024 sc1
    v_accvgpr_read_b32 v128, a112
    v_accvgpr_read_b32 v129, a113
    v_accvgpr_read_b32 v130, a114
    v_accvgpr_read_b32 v131, a115
    v_accvgpr_read_b32 v132, a116
    v_accvgpr_read_b32 v133, a117
    v_accvgpr_read_b32 v134, a118
    v_accvgpr_read_b32 v135, a119
    v_accvgpr_read_b32 v136, a120
    v_accvgpr_read_b32 v137, a121
    v_accvgpr_read_b32 v138, a122
    v_accvgpr_read_b32 v139, a123
    v_accvgpr_read_b32 v140, a124
    v_accvgpr_read_b32 v141, a125
    v_accvgpr_read_b32 v142, a126
    v_accvgpr_read_b32 v143, a127
    v_mul_f32 v160, v128, v128
    v_mul_f32 v161, v129, v129
    v_mul_f32 v162, v130, v130
    v_mul_f32 v163, v131, v131
    v_mul_f32 v164, v132, v132
    v_mul_f32 v165, v133, v133
    v_mul_f32 v166, v134, v134
    v_mul_f32 v167, v135, v135
    v_mul_f32 v168, v136, v136
    v_mul_f32 v169, v137, v137
    v_mul_f32 v170, v138, v138
    v_mul_f32 v171, v139, v139
    v_mul_f32 v172, v140, v140
    v_mul_f32 v173, v141, v141
    v_mul_f32 v174, v142, v142
    v_mul_f32 v175, v143, v143
    v_fma_f32 v160, v160, s74, v15
    v_fma_f32 v161, v161, s74, v15
    v_fma_f32 v162, v162, s74, v15
    v_fma_f32 v163, v163, s74, v15
    v_fma_f32 v164, v164, s74, v15
    v_fma_f32 v165, v165, s74, v15
    v_fma_f32 v166, v166, s74, v15
    v_fma_f32 v167, v167, s74, v15
    v_fma_f32 v168, v168, s74, v15
    v_fma_f32 v169, v169, s74, v15
    v_fma_f32 v170, v170, s74, v15
    v_fma_f32 v171, v171, s74, v15
    v_fma_f32 v172, v172, s74, v15
    v_fma_f32 v173, v173, s74, v15
    v_fma_f32 v174, v174, s74, v15
    v_fma_f32 v175, v175, s74, v15
    v_mul_f32 v160, v160, v128
    v_mul_f32 v161, v161, v129
    v_mul_f32 v162, v162, v130
    v_mul_f32 v163, v163, v131
    v_mul_f32 v164, v164, v132
    v_mul_f32 v165, v165, v133
    v_mul_f32 v166, v166, v134
    v_mul_f32 v167, v167, v135
    v_mul_f32 v168, v168, v136
    v_mul_f32 v169, v169, v137
    v_mul_f32 v170, v170, v138
    v_mul_f32 v171, v171, v139
    v_mul_f32 v172, v172, v140
    v_mul_f32 v173, v173, v141
    v_mul_f32 v174, v174, v142
    v_mul_f32 v175, v175, v143
    v_exp_f32 v160, v160
    v_exp_f32 v161, v161
    v_exp_f32 v162, v162
    v_exp_f32 v163, v163
    v_exp_f32 v164, v164
    v_exp_f32 v165, v165
    v_exp_f32 v166, v166
    v_exp_f32 v167, v167
    v_exp_f32 v168, v168
    v_exp_f32 v169, v169
    v_exp_f32 v170, v170
    v_exp_f32 v171, v171
    v_exp_f32 v172, v172
    v_exp_f32 v173, v173
    v_exp_f32 v174, v174
    v_exp_f32 v175, v175
    v_add_f32 v160, 1.0, v160
    v_add_f32 v161, 1.0, v161
    v_add_f32 v162, 1.0, v162
    v_add_f32 v163, 1.0, v163
    v_add_f32 v164, 1.0, v164
    v_add_f32 v165, 1.0, v165
    v_add_f32 v166, 1.0, v166
    v_add_f32 v167, 1.0, v167
    v_add_f32 v168, 1.0, v168
    v_add_f32 v169, 1.0, v169
    v_add_f32 v170, 1.0, v170
    v_add_f32 v171, 1.0, v171
    v_add_f32 v172, 1.0, v172
    v_add_f32 v173, 1.0, v173
    v_add_f32 v174, 1.0, v174
    v_add_f32 v175, 1.0, v175
    v_rcp_f32 v160, v160
    v_rcp_f32 v161, v161
    v_rcp_f32 v162, v162
    v_rcp_f32 v163, v163
    v_rcp_f32 v164, v164
    v_rcp_f32 v165, v165
    v_rcp_f32 v166, v166
    v_rcp_f32 v167, v167
    v_rcp_f32 v168, v168
    v_rcp_f32 v169, v169
    v_rcp_f32 v170, v170
    v_rcp_f32 v171, v171
    v_rcp_f32 v172, v172
    v_rcp_f32 v173, v173
    v_rcp_f32 v174, v174
    v_rcp_f32 v175, v175
    v_mul_f32 v128, v128, v160
    v_mul_f32 v129, v129, v161
    v_mul_f32 v130, v130, v162
    v_mul_f32 v131, v131, v163
    v_mul_f32 v132, v132, v164
    v_mul_f32 v133, v133, v165
    v_mul_f32 v134, v134, v166
    v_mul_f32 v135, v135, v167
    v_mul_f32 v136, v136, v168
    v_mul_f32 v137, v137, v169
    v_mul_f32 v138, v138, v170
    v_mul_f32 v139, v139, v171
    v_mul_f32 v140, v140, v172
    v_mul_f32 v141, v141, v173
    v_mul_f32 v142, v142, v174
    v_mul_f32 v143, v143, v175
    v_accvgpr_read_b32 v160, a240
    v_accvgpr_read_b32 v161, a241
    v_accvgpr_read_b32 v162, a242
    v_accvgpr_read_b32 v163, a243
    v_accvgpr_read_b32 v164, a244
    v_accvgpr_read_b32 v165, a245
    v_accvgpr_read_b32 v166, a246
    v_accvgpr_read_b32 v167, a247
    v_accvgpr_read_b32 v168, a248
    v_accvgpr_read_b32 v169, a249
    v_accvgpr_read_b32 v170, a250
    v_accvgpr_read_b32 v171, a251
    v_accvgpr_read_b32 v172, a252
    v_accvgpr_read_b32 v173, a253
    v_accvgpr_read_b32 v174, a254
    v_accvgpr_read_b32 v175, a255
    v_mul_f32 v128, v128, v160
    v_mul_f32 v129, v129, v161
    v_mul_f32 v130, v130, v162
    v_mul_f32 v131, v131, v163
    v_mul_f32 v132, v132, v164
    v_mul_f32 v133, v133, v165
    v_mul_f32 v134, v134, v166
    v_mul_f32 v135, v135, v167
    v_mul_f32 v136, v136, v168
    v_mul_f32 v137, v137, v169
    v_mul_f32 v138, v138, v170
    v_mul_f32 v139, v139, v171
    v_mul_f32 v140, v140, v172
    v_mul_f32 v141, v141, v173
    v_mul_f32 v142, v142, v174
    v_mul_f32 v143, v143, v175
    v_cvt_pk_bf16_f32 v152, v128, v129
    v_cvt_pk_bf16_f32 v153, v130, v131
    v_cvt_pk_bf16_f32 v154, v132, v133
    v_cvt_pk_bf16_f32 v155, v134, v135
    v_cvt_pk_bf16_f32 v156, v136, v137
    v_cvt_pk_bf16_f32 v157, v138, v139
    v_cvt_pk_bf16_f32 v158, v140, v141
    v_cvt_pk_bf16_f32 v159, v142, v143
    v_permlane32_swap_b32 v152, v154
    v_permlane32_swap_b32 v153, v155
    v_permlane32_swap_b32 v156, v158
    v_permlane32_swap_b32 v157, v159
    s_mul_i32 s72, s76, 1179648
    s_lshl_b32 s73, s75, 12
    s_add_u32 s72, s72, s73
    s_add_u32 s72, s72, 886784
    s_add_u32 s62, s60, s72
    s_addc_u32 s63, s61, 0
    global_store_dwordx4 v14, v[152:155], s[62:63] sc1
    global_store_dwordx4 v14, v[156:159], s[62:63] offset:1024 sc1
    s_waitcnt vmcnt(0)
    s_barrier
    s_cmp_lg_u32 s16, 0
    s_cbranch_scc1 L_wk_gs
    s_lshl_b32 s18, s21, 2
    s_add_u32 s18, s18, 96
    v_mov_b32 v10, s18
    v_mov_b32 v11, 1
    s_mov_b64 exec, 1
    global_atomic_add v10, v11, s[6:7] sc1
    s_mov_b64 exec, -1
L_wk_gs:
    s_branch L_wk_next
L_wk_gate:
    s_sub_u32 s18, s17, 768
    s_load_dwordx2 s[10:11], s[0:1], 88
    s_waitcnt lgkmcnt(0)
    s_lshl_b32 s18, s18, 6
    s_lshl_b32 s19, s16, 4
    s_add_u32 s18, s18, s19
    v_lshrrev_b32 v10, 2, v1
    v_add_u32 v10, s18, v10
    v_and_b32 v12, 3, v1
    v_lshlrev_b32 v12, 4, v12
    v_mul_u32_u24 v11, 1152, v10
    v_add_u32 v11, v11, v12
    v_mov_b32 v30, 0
    global_load_dwordx4 v[32:35], v11, s[8:9] offset:0
    global_load_dwordx4 v[112:115], v12, s[10:11] offset:0
    global_load_dwordx4 v[36:39], v11, s[8:9] offset:64
    global_load_dwordx4 v[116:119], v12, s[10:11] offset:64
    global_load_dwordx4 v[40:43], v11, s[8:9] offset:128
    global_load_dwordx4 v[120:123], v12, s[10:11] offset:128
    global_load_dwordx4 v[44:47], v11, s[8:9] offset:192
    global_load_dwordx4 v[124:127], v12, s[10:11] offset:192
    global_load_dwordx4 v[48:51], v11, s[8:9] offset:256
    global_load_dwordx4 v[128:131], v12, s[10:11] offset:256
    global_load_dwordx4 v[52:55], v11, s[8:9] offset:320
    global_load_dwordx4 v[132:135], v12, s[10:11] offset:320
    global_load_dwordx4 v[56:59], v11, s[8:9] offset:384
    global_load_dwordx4 v[136:139], v12, s[10:11] offset:384
    global_load_dwordx4 v[60:63], v11, s[8:9] offset:448
    global_load_dwordx4 v[140:143], v12, s[10:11] offset:448
    global_load_dwordx4 v[64:67], v11, s[8:9] offset:512
    global_load_dwordx4 v[144:147], v12, s[10:11] offset:512
    global_load_dwordx4 v[68:71], v11, s[8:9] offset:576
    global_load_dwordx4 v[148:151], v12, s[10:11] offset:576
    global_load_dwordx4 v[72:75], v11, s[8:9] offset:640
    global_load_dwordx4 v[152:155], v12, s[10:11] offset:640
    global_load_dwordx4 v[76:79], v11, s[8:9] offset:704
    global_load_dwordx4 v[156:159], v12, s[10:11] offset:704
    global_load_dwordx4 v[80:83], v11, s[8:9] offset:768
    global_load_dwordx4 v[160:163], v12, s[10:11] offset:768
    global_load_dwordx4 v[84:87], v11, s[8:9] offset:832
    global_load_dwordx4 v[164:167], v12, s[10:11] offset:832
    global_load_dwordx4 v[88:91], v11, s[8:9] offset:896
    global_load_dwordx4 v[168:171], v12, s[10:11] offset:896
    global_load_dwordx4 v[92:95], v11, s[8:9] offset:960
    global_load_dwordx4 v[172:175], v12, s[10:11] offset:960
    global_load_dwordx4 v[96:99], v11, s[8:9] offset:1024
    global_load_dwordx4 v[176:179], v12, s[10:11] offset:1024
    global_load_dwordx4 v[100:103], v11, s[8:9] offset:1088
    global_load_dwordx4 v[180:183], v12, s[10:11] offset:1088
    s_waitcnt vmcnt(34)
    v_dot2_f32_bf16 v30, v32, v112, v30
    v_dot2_f32_bf16 v30, v33, v113, v30
    v_dot2_f32_bf16 v30, v34, v114, v30
    v_dot2_f32_bf16 v30, v35, v115, v30
    s_waitcnt vmcnt(32)
    v_dot2_f32_bf16 v30, v36, v116, v30
    v_dot2_f32_bf16 v30, v37, v117, v30
    v_dot2_f32_bf16 v30, v38, v118, v30
    v_dot2_f32_bf16 v30, v39, v119, v30
    s_waitcnt vmcnt(30)
    v_dot2_f32_bf16 v30, v40, v120, v30
    v_dot2_f32_bf16 v30, v41, v121, v30
    v_dot2_f32_bf16 v30, v42, v122, v30
    v_dot2_f32_bf16 v30, v43, v123, v30
    s_waitcnt vmcnt(28)
    v_dot2_f32_bf16 v30, v44, v124, v30
    v_dot2_f32_bf16 v30, v45, v125, v30
    v_dot2_f32_bf16 v30, v46, v126, v30
    v_dot2_f32_bf16 v30, v47, v127, v30
    s_waitcnt vmcnt(26)
    v_dot2_f32_bf16 v30, v48, v128, v30
    v_dot2_f32_bf16 v30, v49, v129, v30
    v_dot2_f32_bf16 v30, v50, v130, v30
    v_dot2_f32_bf16 v30, v51, v131, v30
    s_waitcnt vmcnt(24)
    v_dot2_f32_bf16 v30, v52, v132, v30
    v_dot2_f32_bf16 v30, v53, v133, v30
    v_dot2_f32_bf16 v30, v54, v134, v30
    v_dot2_f32_bf16 v30, v55, v135, v30
    s_waitcnt vmcnt(22)
    v_dot2_f32_bf16 v30, v56, v136, v30
    v_dot2_f32_bf16 v30, v57, v137, v30
    v_dot2_f32_bf16 v30, v58, v138, v30
    v_dot2_f32_bf16 v30, v59, v139, v30
    s_waitcnt vmcnt(20)
    v_dot2_f32_bf16 v30, v60, v140, v30
    v_dot2_f32_bf16 v30, v61, v141, v30
    v_dot2_f32_bf16 v30, v62, v142, v30
    v_dot2_f32_bf16 v30, v63, v143, v30
    s_waitcnt vmcnt(18)
    v_dot2_f32_bf16 v30, v64, v144, v30
    v_dot2_f32_bf16 v30, v65, v145, v30
    v_dot2_f32_bf16 v30, v66, v146, v30
    v_dot2_f32_bf16 v30, v67, v147, v30
    s_waitcnt vmcnt(16)
    v_dot2_f32_bf16 v30, v68, v148, v30
    v_dot2_f32_bf16 v30, v69, v149, v30
    v_dot2_f32_bf16 v30, v70, v150, v30
    v_dot2_f32_bf16 v30, v71, v151, v30
    s_waitcnt vmcnt(14)
    v_dot2_f32_bf16 v30, v72, v152, v30
    v_dot2_f32_bf16 v30, v73, v153, v30
    v_dot2_f32_bf16 v30, v74, v154, v30
    v_dot2_f32_bf16 v30, v75, v155, v30
    s_waitcnt vmcnt(12)
    v_dot2_f32_bf16 v30, v76, v156, v30
    v_dot2_f32_bf16 v30, v77, v157, v30
    v_dot2_f32_bf16 v30, v78, v158, v30
    v_dot2_f32_bf16 v30, v79, v159, v30
    s_waitcnt vmcnt(10)
    v_dot2_f32_bf16 v30, v80, v160, v30
    v_dot2_f32_bf16 v30, v81, v161, v30
    v_dot2_f32_bf16 v30, v82, v162, v30
    v_dot2_f32_bf16 v30, v83, v163, v30
    s_waitcnt vmcnt(8)
    v_dot2_f32_bf16 v30, v84, v164, v30
    v_dot2_f32_bf16 v30, v85, v165, v30
    v_dot2_f32_bf16 v30, v86, v166, v30
    v_dot2_f32_bf16 v30, v87, v167, v30
    s_waitcnt vmcnt(6)
    v_dot2_f32_bf16 v30, v88, v168, v30
    v_dot2_f32_bf16 v30, v89, v169, v30
    v_dot2_f32_bf16 v30, v90, v170, v30
    v_dot2_f32_bf16 v30, v91, v171, v30
    s_waitcnt vmcnt(4)
    v_dot2_f32_bf16 v30, v92, v172, v30
    v_dot2_f32_bf16 v30, v93, v173, v30
    v_dot2_f32_bf16 v30, v94, v174, v30
    v_dot2_f32_bf16 v30, v95, v175, v30
    s_waitcnt vmcnt(2)
    v_dot2_f32_bf16 v30, v96, v176, v30
    v_dot2_f32_bf16 v30, v97, v177, v30
    v_dot2_f32_bf16 v30, v98, v178, v30
    v_dot2_f32_bf16 v30, v99, v179, v30
    s_waitcnt vmcnt(0)
    v_dot2_f32_bf16 v30, v100, v180, v30
    v_dot2_f32_bf16 v30, v101, v181, v30
    v_dot2_f32_bf16 v30, v102, v182, v30
    v_dot2_f32_bf16 v30, v103, v183, v30
    s_nop 2
    v_add_f32_dpp v30, v30, v30 quad_perm:[1,0,3,2] row_mask:0xf bank_mask:0xf
    s_nop 1
    v_add_f32_dpp v30, v30, v30 quad_perm:[2,3,0,1] row_mask:0xf bank_mask:0xf
    v_mul_f32 v30, 0xbfb8aa3b, v30
    v_exp_f32 v30, v30
    s_nop 0
    v_add_f32 v30, 1.0, v30
    v_rcp_f32 v30, v30
    s_add_u32 s60, s4, 0x4d80000
    s_addc_u32 s61, s5, 0
    v_lshlrev_b32 v10, 2, v10
    s_mov_b32 s18, 0x11111111
    s_mov_b32 s19, 0x11111111
    s_mov_b32 exec_lo, s18
    s_mov_b32 exec_hi, s18
    global_store_dword v10, v30, s[60:61] sc1
    s_mov_b64 exec, -1
    s_mov_b32 s21, 0
    s_waitcnt vmcnt(0)
    s_barrier
    s_cmp_lg_u32 s16, 0
    s_cbranch_scc1 L_wk_gts
    s_lshl_b32 s18, s21, 2
    s_add_u32 s18, s18, 40
    v_mov_b32 v10, s18
    v_mov_b32 v11, 1
    s_mov_b64 exec, 1
    global_atomic_add v10, v11, s[6:7] sc1
    s_mov_b64 exec, -1
L_wk_gts:
    s_branch L_wk_next
L_wk_down:
    s_and_b32 s75, s16, 1
    s_lshr_b32 s76, s16, 1
    v_lshrrev_b32 v10, 2, v1
    v_mul_u32_u24 v2, 1152, v10
    v_and_b32 v10, 3, v1
    v_bfe_u32 v11, v1, 4, 2
    v_xor_b32 v10, v10, v11
    v_lshl_add_u32 v2, v10, 4, v2
    v_and_b32 v10, 31, v1
    v_lshrrev_b32 v11, 5, v1
    v_bfe_u32 v12, v1, 2, 2
    v_xor_b32 v11, v11, v12
    v_lshlrev_b32 v4, 6, v10
    v_lshl_add_u32 v4, v11, 4, v4
    s_lshl_b32 s72, s76, 13
    v_add_u32 v4, s72, v4
    v_xor_b32 v5, 32, v4
    s_lshl_b32 s72, s76, 12
    v_subrev_u32 v16, s72, v4
    v_xor_b32 v17, 32, v16
    v_bfe_u32 v10, v1, 2, 2
    v_lshrrev_b32 v11, 5, v1
    v_lshl_add_u32 v11, v11, 3, v10
    v_lshlrev_b32 v11, 8, v11
    v_bfe_u32 v12, v1, 4, 1
    v_lshlrev_b32 v12, 1, v12
    v_bfe_u32 v13, v1, 1, 1
    v_add_u32 v12, v12, v13
    v_lshl_add_u32 v11, v12, 4, v11
    v_and_b32 v12, 1, v1
    v_lshl_add_u32 v11, v12, 3, v11
    v_add_u32 v11, 16384, v11
    s_lshl_b32 s72, s75, 1
    v_xor_b32 v12, s72, v10
    v_lshl_add_u32 v6, v12, 6, v11
    v_xor_b32 v12, 1, v12
    v_lshl_add_u32 v7, v12, 6, v11
    v_subrev_u32 v18, 8192, v6
    v_subrev_u32 v19, 8192, v7
    v_and_b32 v10, 31, v1
    v_lshrrev_b32 v11, 5, v1
    v_lshrrev_b32 v12, 3, v10
    v_lshlrev_b32 v12, 2, v12
    v_and_b32 v13, 3, v10
    v_add_u32 v12, v12, v13
    v_lshl_add_u32 v12, v11, 4, v12
    v_lshlrev_b32 v12, 4, v12
    v_bfe_u32 v13, v10, 2, 1
    v_lshl_add_u32 v8, v13, 10, v12
    v_and_b32 v12, 15, v10
    v_lshl_add_u32 v12, v11, 4, v12
    v_lshlrev_b32 v12, 4, v12
    v_lshrrev_b32 v13, 4, v10
    v_lshl_add_u32 v9, v13, 10, v12
    v_lshlrev_b32 v14, 4, v1
    s_sub_u32 s18, s17, 672
    s_mul_i32 s19, s18, 10923
    s_lshr_b32 s19, s19, 16
    s_mul_i32 s74, s19, 6
    s_sub_u32 s17, s18, s74
    s_and_b32 s25, s17, 1
    s_lshr_b32 s17, s17, 1
    s_lshr_b32 s21, s19, 1
    s_mov_b32 s65, s19
    s_cmp_lg_u32 s16, 0
    s_cbranch_scc1 L_wk_dw_d
    s_lshl_b32 s18, s21, 2
    s_add_u32 s18, s18, 96
    v_mov_b32 v10, s18
    s_mov_b32 s20, 0
L_wk_dw_p:
    global_load_dword v11, v10, s[6:7] sc1
    s_waitcnt vmcnt(0)
    v_readfirstlane_b32 s18, v11
    s_add_u32 s20, s20, 1
    s_cmp_gt_u32 s20, 600000
    s_cbranch_scc1 L_wk_fail
    s_cmp_ge_u32 s18, 36
    s_cbranch_scc1 L_wk_dw_d
    s_sleep 8
    s_branch L_wk_dw_p
L_wk_dw_d:
    s_barrier
    buffer_inv sc1
    s_waitcnt vmcnt(0)
    s_load_dwordx2 s[10:11], s[0:1], 80
    s_waitcnt lgkmcnt(0)
    s_add_u32 s12, s4, 0x3000000
    s_addc_u32 s13, s5, 0
    s_mov_b32 s48, s12
    s_mov_b32 s49, s13
    s_mov_b32 s50, 18874368
    s_mov_b32 s51, 0x00020000
    s_mov_b32 s52, s10
    s_mov_b32 s53, s11
    s_mov_b32 s54, 5308416
    s_mov_b32 s55, 0x00020000
    s_mov_b32 s84, 576
    s_mov_b32 s83, 72
    v_lshrrev_b32 v10, 5, v1
    s_lshl_b32 s72, s84, 9
    v_mul_lo_u32 v20, v10, s72
    v_and_b32 v10, 31, v1
    v_lshl_add_u32 v20, v10, 4, v20
    s_mul_i32 s72, s16, 192
    s_add_u32 s72, s72, 0
    v_add_u32 v10, s72, v1
    v_mul_u32_u24 v11, 2731, v10
    v_lshrrev_b32 v11, 16, v11
    v_mul_u32_u24 v12, 24, v11
    v_sub_u32 v10, v10, v12
    v_bfe_u32 v12, v11, 1, 1
    v_lshlrev_b32 v12, 2, v12
    v_xor_b32 v10, v10, v12
    v_mul_u32_u24 v11, 1152, v11
    v_lshl_add_u32 v21, v10, 4, v11
    s_mul_i32 s72, s16, 192
    s_add_u32 s72, s72, 64
    v_add_u32 v10, s72, v1
    v_mul_u32_u24 v11, 2731, v10
    v_lshrrev_b32 v11, 16, v11
    v_mul_u32_u24 v12, 24, v11
    v_sub_u32 v10, v10, v12
    v_bfe_u32 v12, v11, 1, 1
    v_lshlrev_b32 v12, 2, v12
    v_xor_b32 v10, v10, v12
    v_mul_u32_u24 v11, 1152, v11
    v_lshl_add_u32 v22, v10, 4, v11
    s_mul_i32 s72, s16, 192
    s_add_u32 s72, s72, 128
    v_add_u32 v10, s72, v1
    v_mul_u32_u24 v11, 2731, v10
    v_lshrrev_b32 v11, 16, v11
    v_mul_u32_u24 v12, 24, v11
    v_sub_u32 v10, v10, v12
    v_bfe_u32 v12, v11, 1, 1
    v_lshlrev_b32 v12, 2, v12
    v_xor_b32 v10, v10, v12
    v_mul_u32_u24 v11, 1152, v11
    v_lshl_add_u32 v23, v10, 4, v11
    v_lshrrev_b32 v10, 5, v1
    v_lshlrev_b32 v10, 11, v10
    v_and_b32 v11, 31, v1
    v_lshl_add_u32 v24, v11, 4, v10
    s_lshl_b32 s72, s76, 10
    v_add_u32 v24, s72, v24
    v_bfe_u32 v10, v1, 2, 2
    v_lshrrev_b32 v11, 5, v1
    v_lshl_add_u32 v11, v11, 3, v10
    v_mul_u32_u24 v11, 384, v11
    v_bfe_u32 v12, v1, 4, 1
    v_lshlrev_b32 v12, 1, v12
    v_bfe_u32 v13, v1, 1, 1
    v_add_u32 v12, v12, v13
    v_lshl_add_u32 v11, v12, 4, v11
    v_and_b32 v12, 1, v1
    v_lshl_add_u32 v11, v12, 3, v11
    v_add_u32 v11, 98304, v11
    v_bfe_u32 v12, v1, 3, 1
    s_mul_i32 s72, s75, 3
    s_add_u32 s73, s72, 0
    v_xor_b32 v13, s73, v12
    v_lshl_add_u32 v25, v13, 6, v11
    s_add_u32 s73, s72, 1
    v_xor_b32 v13, s73, v12
    v_lshl_add_u32 v26, v13, 6, v11
    s_add_u32 s73, s72, 2
    v_xor_b32 v13, s73, v12
    v_lshl_add_u32 v27, v13, 6, v11
    s_mul_i32 s68, s65, 1179648
    s_mul_i32 s72, s25, 147456
    s_add_u32 s68, s68, s72
    s_mul_i32 s66, s17, 384
    s_mul_i32 s72, s25, 2654208
    s_add_u32 s66, s66, s72
    s_mul_i32 s72, s65, 294912
    s_mul_i32 s73, s17, 24576
    s_add_u32 s72, s72, s73
    s_mul_i32 s73, s25, 4718592
    s_add_u32 s72, s72, s73
    s_add_u32 s60, s4, 0x4400000
    s_addc_u32 s61, s5, 0
    s_add_u32 s60, s60, s72
    s_addc_u32 s61, s61, 0
    s_lshl_b32 s72, s16, 9
    s_add_u32 s68, s68, s72
    s_lshl_b32 s80, s84, 10
    s_lshl_b32 s78, s16, 11
    s_mul_i32 s81, s16, 3072
    s_add_u32 s81, s81, 98304
    s_mov_b32 s85, s78
    s_mov_b32 s86, s81
    s_mov_b32 s87, 0
    s_mov_b32 s88, 0
    s_add_u32 m0, s86, 0
    s_nop 0
    buffer_load_dwordx4 v21, s[52:55], s66 offen lds
    s_add_u32 m0, s86, 1024
    s_nop 0
    buffer_load_dwordx4 v22, s[52:55], s66 offen lds
    s_add_u32 m0, s86, 2048
    s_nop 0
    buffer_load_dwordx4 v23, s[52:55], s66 offen lds
    s_add_u32 s66, s66, 36864
    s_add_u32 s86, s86, 12288
    s_add_u32 s72, s81, 49152
    s_cmp_eq_u32 s86, s72
    s_cselect_b32 s86, s81, s86
    s_mov_b32 m0, s85
    s_add_u32 s73, s68, s80
    buffer_load_dwordx4 v20, s[48:51], s68 offen lds
    s_add_u32 m0, s85, 1024
    s_add_u32 s68, s68, 2048
    buffer_load_dwordx4 v20, s[48:51], s73 offen lds
    s_add_u32 s85, s85, 8192
    s_add_u32 s72, s78, 98304
    s_cmp_eq_u32 s85, s72
    s_cselect_b32 s85, s78, s85
    s_add_u32 m0, s86, 0
    s_nop 0
    buffer_load_dwordx4 v21, s[52:55], s66 offen lds
    s_add_u32 m0, s86, 1024
    s_nop 0
    buffer_load_dwordx4 v22, s[52:55], s66 offen lds
    s_add_u32 m0, s86, 2048
    s_nop 0
    buffer_load_dwordx4 v23, s[52:55], s66 offen lds
    s_add_u32 s66, s66, 36864
    s_add_u32 s86, s86, 12288
    s_add_u32 s72, s81, 49152
    s_cmp_eq_u32 s86, s72
    s_cselect_b32 s86, s81, s86
    s_mov_b32 m0, s85
    s_add_u32 s73, s68, s80
    buffer_load_dwordx4 v20, s[48:51], s68 offen lds
    s_add_u32 m0, s85, 1024
    s_add_u32 s68, s68, 2048
    buffer_load_dwordx4 v20, s[48:51], s73 offen lds
    s_add_u32 s85, s85, 8192
    s_add_u32 s72, s78, 98304
    s_cmp_eq_u32 s85, s72
    s_cselect_b32 s85, s78, s85
    s_add_u32 m0, s86, 0
    s_nop 0
    buffer_load_dwordx4 v21, s[52:55], s66 offen lds
    s_add_u32 m0, s86, 1024
    s_nop 0
    buffer_load_dwordx4 v22, s[52:55], s66 offen lds
    s_add_u32 m0, s86, 2048
    s_nop 0
    buffer_load_dwordx4 v23, s[52:55], s66 offen lds
    s_add_u32 s66, s66, 36864
    s_add_u32 s86, s86, 12288
    s_add_u32 s72, s81, 49152
    s_cmp_eq_u32 s86, s72
    s_cselect_b32 s86, s81, s86
    s_mov_b32 m0, s85
    s_add_u32 s73, s68, s80
    buffer_load_dwordx4 v20, s[48:51], s68 offen lds
    s_add_u32 m0, s85, 1024
    s_add_u32 s68, s68, 2048
    buffer_load_dwordx4 v20, s[48:51], s73 offen lds
    s_add_u32 s85, s85, 8192
    s_add_u32 s72, s78, 98304
    s_cmp_eq_u32 s85, s72
    s_cselect_b32 s85, s78, s85
    s_add_u32 m0, s86, 0
    s_nop 0
    buffer_load_dwordx4 v21, s[52:55], s66 offen lds
    s_add_u32 m0, s86, 1024
    s_nop 0
    buffer_load_dwordx4 v22, s[52:55], s66 offen lds
    s_add_u32 m0, s86, 2048
    s_nop 0
    buffer_load_dwordx4 v23, s[52:55], s66 offen lds
    s_add_u32 s66, s66, 36864
    s_add_u32 s86, s86, 12288
    s_add_u32 s72, s81, 49152
    s_cmp_eq_u32 s86, s72
    s_cselect_b32 s86, s81, s86
    s_mov_b32 m0, s85
    s_add_u32 s73, s68, s80
    buffer_load_dwordx4 v20, s[48:51], s68 offen lds
    s_add_u32 m0, s85, 1024
    s_add_u32 s68, s68, 2048
    buffer_load_dwordx4 v20, s[48:51], s73 offen lds
    s_add_u32 s85, s85, 8192
    s_add_u32 s72, s78, 98304
    s_cmp_eq_u32 s85, s72
    s_cselect_b32 s85, s78, s85
    s_mov_b32 m0, s85
    s_add_u32 s73, s68, s80
    buffer_load_dwordx4 v20, s[48:51], s68 offen lds
    s_add_u32 m0, s85, 1024
    s_add_u32 s68, s68, 2048
    buffer_load_dwordx4 v20, s[48:51], s73 offen lds
    s_add_u32 s85, s85, 8192
    s_add_u32 s72, s78, 98304
    s_cmp_eq_u32 s85, s72
    s_cselect_b32 s85, s78, s85
    s_mov_b32 m0, s85
    s_add_u32 s73, s68, s80
    buffer_load_dwordx4 v20, s[48:51], s68 offen lds
    s_add_u32 m0, s85, 1024
    s_add_u32 s68, s68, 2048
    buffer_load_dwordx4 v20, s[48:51], s73 offen lds
    s_add_u32 s85, s85, 8192
    s_add_u32 s72, s78, 98304
    s_cmp_eq_u32 s85, s72
    s_cselect_b32 s85, s78, s85
    s_mov_b32 m0, s85
    s_add_u32 s73, s68, s80
    buffer_load_dwordx4 v20, s[48:51], s68 offen lds
    s_add_u32 m0, s85, 1024
    s_add_u32 s68, s68, 2048
    buffer_load_dwordx4 v20, s[48:51], s73 offen lds
    s_add_u32 s85, s85, 8192
    s_add_u32 s72, s78, 98304
    s_cmp_eq_u32 s85, s72
    s_cselect_b32 s85, s78, s85
    s_mov_b32 m0, s85
    s_add_u32 s73, s68, s80
    buffer_load_dwordx4 v20, s[48:51], s68 offen lds
    s_add_u32 m0, s85, 1024
    s_add_u32 s68, s68, 2048
    buffer_load_dwordx4 v20, s[48:51], s73 offen lds
    s_add_u32 s85, s85, 8192
    s_add_u32 s72, s78, 98304
    s_cmp_eq_u32 s85, s72
    s_cselect_b32 s85, s78, s85
    s_mov_b32 m0, s85
    s_add_u32 s73, s68, s80
    buffer_load_dwordx4 v20, s[48:51], s68 offen lds
    s_add_u32 m0, s85, 1024
    s_add_u32 s68, s68, 2048
    buffer_load_dwordx4 v20, s[48:51], s73 offen lds
    s_add_u32 s85, s85, 8192
    s_add_u32 s72, s78, 98304
    s_cmp_eq_u32 s85, s72
    s_cselect_b32 s85, s78, s85
    s_mov_b32 m0, s85
    s_add_u32 s73, s68, s80
    buffer_load_dwordx4 v20, s[48:51], s68 offen lds
    s_add_u32 m0, s85, 1024
    s_add_u32 s68, s68, 2048
    buffer_load_dwordx4 v20, s[48:51], s73 offen lds
    s_add_u32 s85, s85, 8192
    s_add_u32 s72, s78, 98304
    s_cmp_eq_u32 s85, s72
    s_cselect_b32 s85, s78, s85
    s_mov_b32 m0, s85
    s_add_u32 s73, s68, s80
    buffer_load_dwordx4 v20, s[48:51], s68 offen lds
    s_add_u32 m0, s85, 1024
    s_add_u32 s68, s68, 2048
    buffer_load_dwordx4 v20, s[48:51], s73 offen lds
    s_add_u32 s85, s85, 8192
    s_add_u32 s72, s78, 98304
    s_cmp_eq_u32 s85, s72
    s_cselect_b32 s85, s78, s85
    s_mov_b32 m0, s85
    s_add_u32 s73, s68, s80
    buffer_load_dwordx4 v20, s[48:51], s68 offen lds
    s_add_u32 m0, s85, 1024
    s_add_u32 s68, s68, 2048
    buffer_load_dwordx4 v20, s[48:51], s73 offen lds
    s_add_u32 s85, s85, 8192
    s_add_u32 s72, s78, 98304
    s_cmp_eq_u32 s85, s72
    s_cselect_b32 s85, s78, s85
    v_accvgpr_write_b32 a0, 0
    v_accvgpr_write_b32 a1, 0
    v_accvgpr_write_b32 a2, 0
    v_accvgpr_write_b32 a3, 0
    v_accvgpr_write_b32 a4, 0
    v_accvgpr_write_b32 a5, 0
    v_accvgpr_write_b32 a6, 0
    v_accvgpr_write_b32 a7, 0
    v_accvgpr_write_b32 a8, 0
    v_accvgpr_write_b32 a9, 0
    v_accvgpr_write_b32 a10, 0
    v_accvgpr_write_b32 a11, 0
    v_accvgpr_write_b32 a12, 0
    v_accvgpr_write_b32 a13, 0
    v_accvgpr_write_b32 a14, 0
    v_accvgpr_write_b32 a15, 0
    v_accvgpr_write_b32 a16, 0
    v_accvgpr_write_b32 a17, 0
    v_accvgpr_write_b32 a18, 0
    v_accvgpr_write_b32 a19, 0
    v_accvgpr_write_b32 a20, 0
    v_accvgpr_write_b32 a21, 0
    v_accvgpr_write_b32 a22, 0
    v_accvgpr_write_b32 a23, 0
    v_accvgpr_write_b32 a24, 0
    v_accvgpr_write_b32 a25, 0
    v_accvgpr_write_b32 a26, 0
    v_accvgpr_write_b32 a27, 0
    v_accvgpr_write_b32 a28, 0
    v_accvgpr_write_b32 a29, 0
    v_accvgpr_write_b32 a30, 0
    v_accvgpr_write_b32 a31, 0
    v_accvgpr_write_b32 a32, 0
    v_accvgpr_write_b32 a33, 0
    v_accvgpr_write_b32 a34, 0
    v_accvgpr_write_b32 a35, 0
    v_accvgpr_write_b32 a36, 0
    v_accvgpr_write_b32 a37, 0
    v_accvgpr_write_b32 a38, 0
    v_accvgpr_write_b32 a39, 0
    v_accvgpr_write_b32 a40, 0
    v_accvgpr_write_b32 a41, 0
    v_accvgpr_write_b32 a42, 0
    v_accvgpr_write_b32 a43, 0
    v_accvgpr_write_b32 a44, 0
    v_accvgpr_write_b32 a45, 0
    v_accvgpr_write_b32 a46, 0
    v_accvgpr_write_b32 a47, 0
    v_accvgpr_write_b32 a48, 0
    v_accvgpr_write_b32 a49, 0
    v_accvgpr_write_b32 a50, 0
    v_accvgpr_write_b32 a51, 0
    v_accvgpr_write_b32 a52, 0
    v_accvgpr_write_b32 a53, 0
    v_accvgpr_write_b32 a54, 0
    v_accvgpr_write_b32 a55, 0
    v_accvgpr_write_b32 a56, 0
    v_accvgpr_write_b32 a57, 0
    v_accvgpr_write_b32 a58, 0
    v_accvgpr_write_b32 a59, 0
    v_accvgpr_write_b32 a60, 0
    v_accvgpr_write_b32 a61, 0
    v_accvgpr_write_b32 a62, 0
    v_accvgpr_write_b32 a63, 0
    v_accvgpr_write_b32 a64, 0
    v_accvgpr_write_b32 a65, 0
    v_accvgpr_write_b32 a66, 0
    v_accvgpr_write_b32 a67, 0
    v_accvgpr_write_b32 a68, 0
    v_accvgpr_write_b32 a69, 0
    v_accvgpr_write_b32 a70, 0
    v_accvgpr_write_b32 a71, 0
    v_accvgpr_write_b32 a72, 0
    v_accvgpr_write_b32 a73, 0
    v_accvgpr_write_b32 a74, 0
    v_accvgpr_write_b32 a75, 0
    v_accvgpr_write_b32 a76, 0
    v_accvgpr_write_b32 a77, 0
    v_accvgpr_write_b32 a78, 0
    v_accvgpr_write_b32 a79, 0
    v_accvgpr_write_b32 a80, 0
    v_accvgpr_write_b32 a81, 0
    v_accvgpr_write_b32 a82, 0
    v_accvgpr_write_b32 a83, 0
    v_accvgpr_write_b32 a84, 0
    v_accvgpr_write_b32 a85, 0
    v_accvgpr_write_b32 a86, 0
    v_accvgpr_write_b32 a87, 0
    v_accvgpr_write_b32 a88, 0
    v_accvgpr_write_b32 a89, 0
    v_accvgpr_write_b32 a90, 0
    v_accvgpr_write_b32 a91, 0
    v_accvgpr_write_b32 a92, 0
    v_accvgpr_write_b32 a93, 0
    v_accvgpr_write_b32 a94, 0
    v_accvgpr_write_b32 a95, 0
    s_waitcnt vmcnt(31)
    s_barrier
    ds_read_b128 v[80:83], v24 offset:0
    ds_read_b128 v[84:87], v24 offset:512
    ds_read_b64_tr_b16 v[64:65], v25 offset:0
    ds_read_b64_tr_b16 v[66:67], v25 offset:1536
    ds_read_b64_tr_b16 v[68:69], v26 offset:0
    ds_read_b64_tr_b16 v[70:71], v26 offset:1536
    ds_read_b64_tr_b16 v[72:73], v27 offset:0
    ds_read_b64_tr_b16 v[74:75], v27 offset:1536
    s_mov_b32 s69, 0
    s_waitcnt lgkmcnt(0)
L_g2_loopd:
    v_mfma_f32_32x32x16_bf16 a[0:15], v[64:67], v[80:83], a[0:15]
    ds_read_b128 v[112:115], v24 offset:4096
    ds_read_b128 v[116:119], v24 offset:4608
    ds_read_b64_tr_b16 v[96:97], v25 offset:6144
    v_mfma_f32_32x32x16_bf16 a[32:47], v[68:71], v[80:83], a[32:47]
    ds_read_b64_tr_b16 v[98:99], v25 offset:7680
    ds_read_b64_tr_b16 v[100:101], v26 offset:6144
    ds_read_b64_tr_b16 v[102:103], v26 offset:7680
    v_mfma_f32_32x32x16_bf16 a[64:79], v[72:75], v[80:83], a[64:79]
    ds_read_b64_tr_b16 v[104:105], v27 offset:6144
    ds_read_b64_tr_b16 v[106:107], v27 offset:7680
    v_mfma_f32_32x32x16_bf16 a[16:31], v[64:67], v[84:87], a[16:31]
    v_mfma_f32_32x32x16_bf16 a[48:63], v[68:71], v[84:87], a[48:63]
    v_mfma_f32_32x32x16_bf16 a[80:95], v[72:75], v[84:87], a[80:95]
    s_waitcnt lgkmcnt(0)
    s_cmp_lt_u32 s69, 3
    s_cbranch_scc1 L_g2_wpd
    s_add_u32 s72, s69, 12
    s_cmp_lt_u32 s72, s83
    s_cbranch_scc1 L_g2_wsd
    s_add_u32 s72, s69, 3
    s_cmp_lt_u32 s72, s83
    s_cbranch_scc1 L_g2_w6d
    s_waitcnt vmcnt(0)
    s_branch L_g2_wdd
L_g2_w6d:
    s_waitcnt vmcnt(6)
    s_branch L_g2_wdd
L_g2_wpd:
    s_waitcnt vmcnt(26)
    s_branch L_g2_wdd
L_g2_wsd:
    s_waitcnt vmcnt(12)
L_g2_wdd:
    s_barrier
    s_add_u32 s87, s87, 8192
    s_cmp_eq_u32 s87, 98304
    s_mov_b32 s72, 8192
    s_cselect_b32 s72, 0xfffea000, s72
    s_cselect_b32 s87, 0, s87
    v_add_u32 v24, s72, v24
    s_add_u32 s88, s88, 12288
    s_cmp_eq_u32 s88, 49152
    s_mov_b32 s72, 12288
    s_cselect_b32 s72, 0xffff7000, s72
    s_cselect_b32 s88, 0, s88
    v_add_u32 v25, s72, v25
    v_add_u32 v26, s72, v26
    v_add_u32 v27, s72, v27
    s_add_u32 s74, s69, 12
    s_cmp_lt_u32 s74, s83
    s_cbranch_scc0 L_g2_t1d
    v_mfma_f32_32x32x16_bf16 a[0:15], v[96:99], v[112:115], a[0:15]
    ds_read_b128 v[80:83], v24 offset:0
    ds_read_b128 v[84:87], v24 offset:512
    ds_read_b64_tr_b16 v[64:65], v25 offset:0
    v_mfma_f32_32x32x16_bf16 a[32:47], v[100:103], v[112:115], a[32:47]
    ds_read_b64_tr_b16 v[66:67], v25 offset:1536
    ds_read_b64_tr_b16 v[68:69], v26 offset:0
    ds_read_b64_tr_b16 v[70:71], v26 offset:1536
    s_add_u32 m0, s86, 0
    s_nop 0
    buffer_load_dwordx4 v21, s[52:55], s66 offen lds
    v_mfma_f32_32x32x16_bf16 a[64:79], v[104:107], v[112:115], a[64:79]
    ds_read_b64_tr_b16 v[72:73], v27 offset:0
    ds_read_b64_tr_b16 v[74:75], v27 offset:1536
    s_add_u32 m0, s86, 1024
    s_nop 0
    buffer_load_dwordx4 v22, s[52:55], s66 offen lds
    v_mfma_f32_32x32x16_bf16 a[16:31], v[96:99], v[116:119], a[16:31]
    s_add_u32 m0, s86, 2048
    s_nop 0
    buffer_load_dwordx4 v23, s[52:55], s66 offen lds
    s_add_u32 s66, s66, 36864
    s_add_u32 s86, s86, 12288
    s_add_u32 s72, s81, 49152
    s_cmp_eq_u32 s86, s72
    s_cselect_b32 s86, s81, s86
    v_mfma_f32_32x32x16_bf16 a[48:63], v[100:103], v[116:119], a[48:63]
    s_mov_b32 m0, s85
    s_add_u32 s73, s68, s80
    buffer_load_dwordx4 v20, s[48:51], s68 offen lds
    v_mfma_f32_32x32x16_bf16 a[80:95], v[104:107], v[116:119], a[80:95]
    s_add_u32 m0, s85, 1024
    s_add_u32 s68, s68, 2048
    buffer_load_dwordx4 v20, s[48:51], s73 offen lds
    s_add_u32 s85, s85, 8192
    s_add_u32 s72, s78, 98304
    s_cmp_eq_u32 s85, s72
    s_cselect_b32 s85, s78, s85
    s_branch L_g2_jd
L_g2_t1d:
    s_add_u32 s74, s69, 4
    s_cmp_lt_u32 s74, s83
    s_cbranch_scc0 L_g2_t2d
    v_mfma_f32_32x32x16_bf16 a[0:15], v[96:99], v[112:115], a[0:15]
    ds_read_b128 v[80:83], v24 offset:0
    ds_read_b128 v[84:87], v24 offset:512
    ds_read_b64_tr_b16 v[64:65], v25 offset:0
    v_mfma_f32_32x32x16_bf16 a[32:47], v[100:103], v[112:115], a[32:47]
    ds_read_b64_tr_b16 v[66:67], v25 offset:1536
    ds_read_b64_tr_b16 v[68:69], v26 offset:0
    ds_read_b64_tr_b16 v[70:71], v26 offset:1536
    s_add_u32 m0, s86, 0
    s_nop 0
    buffer_load_dwordx4 v21, s[52:55], s66 offen lds
    v_mfma_f32_32x32x16_bf16 a[64:79], v[104:107], v[112:115], a[64:79]
    ds_read_b64_tr_b16 v[72:73], v27 offset:0
    ds_read_b64_tr_b16 v[74:75], v27 offset:1536
    s_add_u32 m0, s86, 1024
    s_nop 0
    buffer_load_dwordx4 v22, s[52:55], s66 offen lds
    v_mfma_f32_32x32x16_bf16 a[16:31], v[96:99], v[116:119], a[16:31]
    s_add_u32 m0, s86, 2048
    s_nop 0
    buffer_load_dwordx4 v23, s[52:55], s66 offen lds
    s_add_u32 s66, s66, 36864
    s_add_u32 s86, s86, 12288
    s_add_u32 s72, s81, 49152
    s_cmp_eq_u32 s86, s72
    s_cselect_b32 s86, s81, s86
    v_mfma_f32_32x32x16_bf16 a[48:63], v[100:103], v[116:119], a[48:63]
    v_mfma_f32_32x32x16_bf16 a[80:95], v[104:107], v[116:119], a[80:95]
    s_branch L_g2_jd
L_g2_t2d:
    v_mfma_f32_32x32x16_bf16 a[0:15], v[96:99], v[112:115], a[0:15]
    ds_read_b128 v[80:83], v24 offset:0
    ds_read_b128 v[84:87], v24 offset:512
    ds_read_b64_tr_b16 v[64:65], v25 offset:0
    v_mfma_f32_32x32x16_bf16 a[32:47], v[100:103], v[112:115], a[32:47]
    ds_read_b64_tr_b16 v[66:67], v25 offset:1536
    ds_read_b64_tr_b16 v[68:69], v26 offset:0
    ds_read_b64_tr_b16 v[70:71], v26 offset:1536
    v_mfma_f32_32x32x16_bf16 a[64:79], v[104:107], v[112:115], a[64:79]
    ds_read_b64_tr_b16 v[72:73], v27 offset:0
    ds_read_b64_tr_b16 v[74:75], v27 offset:1536
    v_mfma_f32_32x32x16_bf16 a[16:31], v[96:99], v[116:119], a[16:31]
    v_mfma_f32_32x32x16_bf16 a[48:63], v[100:103], v[116:119], a[48:63]
    v_mfma_f32_32x32x16_bf16 a[80:95], v[104:107], v[116:119], a[80:95]
L_g2_jd:
    s_waitcnt lgkmcnt(0)
    s_add_u32 s69, s69, 1
    s_cmp_lt_u32 s69, s83
    s_cbranch_scc1 L_g2_loopd
    s_nop 15
    s_mul_i32 s72, s76, 147456
    s_mul_i32 s73, s75, 12288
    s_add_u32 s72, s72, s73
    s_add_u32 s72, s72, 0
    s_add_u32 s62, s60, s72
    s_addc_u32 s63, s61, 0
    global_store_dwordx4 v14, a[0:3], s[62:63] offset:0 sc1
    global_store_dwordx4 v14, a[4:7], s[62:63] offset:1024 sc1
    global_store_dwordx4 v14, a[8:11], s[62:63] offset:2048 sc1
    global_store_dwordx4 v14, a[12:15], s[62:63] offset:3072 sc1
    s_mul_i32 s72, s76, 147456
    s_mul_i32 s73, s75, 12288
    s_add_u32 s72, s72, s73
    s_add_u32 s72, s72, 73728
    s_add_u32 s62, s60, s72
    s_addc_u32 s63, s61, 0
    global_store_dwordx4 v14, a[16:19], s[62:63] offset:0 sc1
    global_store_dwordx4 v14, a[20:23], s[62:63] offset:1024 sc1
    global_store_dwordx4 v14, a[24:27], s[62:63] offset:2048 sc1
    global_store_dwordx4 v14, a[28:31], s[62:63] offset:3072 sc1
    s_mul_i32 s72, s76, 147456
    s_mul_i32 s73, s75, 12288
    s_add_u32 s72, s72, s73
    s_add_u32 s72, s72, 4096
    s_add_u32 s62, s60, s72
    s_addc_u32 s63, s61, 0
    global_store_dwordx4 v14, a[32:35], s[62:63] offset:0 sc1
    global_store_dwordx4 v14, a[36:39], s[62:63] offset:1024 sc1
    global_store_dwordx4 v14, a[40:43], s[62:63] offset:2048 sc1
    global_store_dwordx4 v14, a[44:47], s[62:63] offset:3072 sc1
    s_mul_i32 s72, s76, 147456
    s_mul_i32 s73, s75, 12288
    s_add_u32 s72, s72, s73
    s_add_u32 s72, s72, 77824
    s_add_u32 s62, s60, s72
    s_addc_u32 s63, s61, 0
    global_store_dwordx4 v14, a[48:51], s[62:63] offset:0 sc1
    global_store_dwordx4 v14, a[52:55], s[62:63] offset:1024 sc1
    global_store_dwordx4 v14, a[56:59], s[62:63] offset:2048 sc1
    global_store_dwordx4 v14, a[60:63], s[62:63] offset:3072 sc1
    s_mul_i32 s72, s76, 147456
    s_mul_i32 s73, s75, 12288
    s_add_u32 s72, s72, s73
    s_add_u32 s72, s72, 8192
    s_add_u32 s62, s60, s72
    s_addc_u32 s63, s61, 0
    global_store_dwordx4 v14, a[64:67], s[62:63] offset:0 sc1
    global_store_dwordx4 v14, a[68:71], s[62:63] offset:1024 sc1
    global_store_dwordx4 v14, a[72:75], s[62:63] offset:2048 sc1
    global_store_dwordx4 v14, a[76:79], s[62:63] offset:3072 sc1
    s_mul_i32 s72, s76, 147456
    s_mul_i32 s73, s75, 12288
    s_add_u32 s72, s72, s73
    s_add_u32 s72, s72, 81920
    s_add_u32 s62, s60, s72
    s_addc_u32 s63, s61, 0
    global_store_dwordx4 v14, a[80:83], s[62:63] offset:0 sc1
    global_store_dwordx4 v14, a[84:87], s[62:63] offset:1024 sc1
    global_store_dwordx4 v14, a[88:91], s[62:63] offset:2048 sc1
    global_store_dwordx4 v14, a[92:95], s[62:63] offset:3072 sc1
    s_cmp_lg_u32 s16, 0
    s_cbranch_scc1 L_wk_dg
    v_mov_b32 v10, 32
    s_mov_b32 s20, 0
L_wk_d0_p:
    global_load_dword v11, v10, s[6:7] sc1
    s_waitcnt vmcnt(0)
    v_readfirstlane_b32 s18, v11
    s_add_u32 s20, s20, 1
    s_cmp_gt_u32 s20, 600000
    s_cbranch_scc1 L_wk_fail
    s_cmp_ge_u32 s18, 32
    s_cbranch_scc1 L_wk_d0_d
    s_sleep 4
    s_branch L_wk_d0_p
L_wk_d0_d:
    v_mov_b32 v10, 40
    s_mov_b32 s20, 0
L_wk_d1_p:
    global_load_dword v11, v10, s[6:7] sc1
    s_waitcnt vmcnt(0)
    v_readfirstlane_b32 s18, v11
    s_add_u32 s20, s20, 1
    s_cmp_gt_u32 s20, 600000
    s_cbranch_scc1 L_wk_fail
    s_cmp_ge_u32 s18, 32
    s_cbranch_scc1 L_wk_d1_d
    s_sleep 4
    s_branch L_wk_d1_p
L_wk_d1_d:
L_wk_dg:
    s_lshl_b32 s42, s65, 2
    s_lshl_b32 s43, s17, 3
    s_lshl_b32 s43, 1, s43
    s_add_u32 s44, s42, 4
L_wk_dl:
    s_waitcnt vmcnt(0)
    s_barrier
    s_cmp_lg_u32 s16, 0
    s_cbranch_scc1 L_wk_ar1d
    s_add_u32 s10, s4, 0x5320000
    s_addc_u32 s11, s5, 0
    s_lshl_b32 s18, s42, 2
    v_mov_b32 v10, s18
    v_mov_b32 v11, s43
    s_mov_b64 exec, 1
    global_atomic_add v12, v10, v11, s[10:11] sc0 sc1
    s_waitcnt vmcnt(0)
    v_mov_b32 v10, 163836
    ds_write_b32 v10, v12
    s_waitcnt lgkmcnt(0)
    s_mov_b64 exec, -1
L_wk_ar1d:
    s_barrier
    v_mov_b32 v10, 163836
    ds_read_b32 v12, v10
    s_waitcnt lgkmcnt(0)
    v_readfirstlane_b32 s45, v12
    s_add_u32 s45, s45, s43
    s_load_dwordx2 s[28:29], s[0:1], 96
    s_waitcnt lgkmcnt(0)
    s_mov_b32 s46, 0
L_wk_cld:
    s_lshl_b32 s18, s46, 3
    s_lshr_b32 s19, s43, s18
    s_and_b32 s19, s19, 0xff
    s_cmp_eq_u32 s19, 0
    s_cbranch_scc1 L_wk_cnd
    s_lshr_b32 s19, s45, s18
    s_and_b32 s19, s19, 0xff
    s_cmp_lg_u32 s19, 10
    s_cbranch_scc1 L_wk_cnd
    v_and_b32 v2, 31, v1
    v_lshrrev_b32 v3, 5, v1
    s_lshl_b32 s38, s42, 7
    s_add_u32 s30, s4, 0x4d80000
    s_addc_u32 s31, s5, 0
    s_add_u32 s30, s30, s38
    s_addc_u32 s31, s31, 0
    v_lshlrev_b32 v4, 2, v2
    global_load_dword v5, v4, s[30:31] sc1
    s_mul_i32 s38, s42, 73728
    s_add_u32 s32, s4, 0x4400000
    s_addc_u32 s33, s5, 0
    s_add_u32 s32, s32, s38
    s_addc_u32 s33, s33, 0
    s_add_u32 s34, s4, 0x5400000
    s_addc_u32 s35, s5, 0
    s_add_u32 s34, s34, s38
    s_addc_u32 s35, s35, 0
    s_mul_i32 s38, s46, 24
    s_lshl_b32 s39, s16, 1
    s_add_u32 s38, s38, s39
    v_add_u32 v6, s38, v3
    s_lshl_b32 s39, s42, 5
    v_add_u32 v7, s39, v2
    v_mul_u32_u24 v7, 1152, v7
    v_lshlrev_b32 v8, 10, v6
    v_lshl_add_u32 v8, v2, 4, v8
    global_load_dwordx4 v[12:15], v8, s[32:33] sc1
    global_load_dwordx4 v[16:19], v8, s[32:33] offset:512 sc1
    s_add_u32 s36, s32, 0x480000
    s_addc_u32 s37, s33, 0
    global_load_dwordx4 v[84:87], v8, s[36:37] sc1
    global_load_dwordx4 v[88:91], v8, s[36:37] offset:512 sc1
    s_mov_b64 s[36:37], s[34:35]
    global_load_dwordx4 v[20:23], v8, s[36:37] sc1
    global_load_dwordx4 v[24:27], v8, s[36:37] offset:512 sc1
    s_add_u32 s36, s36, 0x480000
    s_addc_u32 s37, s37, 0
    global_load_dwordx4 v[28:31], v8, s[36:37] sc1
    global_load_dwordx4 v[32:35], v8, s[36:37] offset:512 sc1
    s_add_u32 s36, s36, 0x480000
    s_addc_u32 s37, s37, 0
    global_load_dwordx4 v[36:39], v8, s[36:37] sc1
    global_load_dwordx4 v[40:43], v8, s[36:37] offset:512 sc1
    s_add_u32 s36, s36, 0x480000
    s_addc_u32 s37, s37, 0
    global_load_dwordx4 v[44:47], v8, s[36:37] sc1
    global_load_dwordx4 v[48:51], v8, s[36:37] offset:512 sc1
    s_add_u32 s36, s36, 0x480000
    s_addc_u32 s37, s37, 0
    global_load_dwordx4 v[52:55], v8, s[36:37] sc1
    global_load_dwordx4 v[56:59], v8, s[36:37] offset:512 sc1
    s_add_u32 s36, s36, 0x480000
    s_addc_u32 s37, s37, 0
    global_load_dwordx4 v[60:63], v8, s[36:37] sc1
    global_load_dwordx4 v[64:67], v8, s[36:37] offset:512 sc1
    s_add_u32 s36, s36, 0x480000
    s_addc_u32 s37, s37, 0
    global_load_dwordx4 v[68:71], v8, s[36:37] sc1
    global_load_dwordx4 v[72:75], v8, s[36:37] offset:512 sc1
    s_add_u32 s36, s36, 0x480000
    s_addc_u32 s37, s37, 0
    global_load_dwordx4 v[76:79], v8, s[36:37] sc1
    global_load_dwordx4 v[80:83], v8, s[36:37] offset:512 sc1
    s_add_u32 s36, s36, 0x480000
    s_addc_u32 s37, s37, 0
    v_add_u32 v6, 8, v6
    v_lshlrev_b32 v8, 10, v6
    v_lshl_add_u32 v8, v2, 4, v8
    global_load_dwordx4 v[92:95], v8, s[32:33] sc1
    global_load_dwordx4 v[96:99], v8, s[32:33] offset:512 sc1
    s_add_u32 s36, s32, 0x480000
    s_addc_u32 s37, s33, 0
    global_load_dwordx4 v[164:167], v8, s[36:37] sc1
    global_load_dwordx4 v[168:171], v8, s[36:37] offset:512 sc1
    s_mov_b64 s[36:37], s[34:35]
    global_load_dwordx4 v[100:103], v8, s[36:37] sc1
    global_load_dwordx4 v[104:107], v8, s[36:37] offset:512 sc1
    s_add_u32 s36, s36, 0x480000
    s_addc_u32 s37, s37, 0
    global_load_dwordx4 v[108:111], v8, s[36:37] sc1
    global_load_dwordx4 v[112:115], v8, s[36:37] offset:512 sc1
    s_add_u32 s36, s36, 0x480000
    s_addc_u32 s37, s37, 0
    global_load_dwordx4 v[116:119], v8, s[36:37] sc1
    global_load_dwordx4 v[120:123], v8, s[36:37] offset:512 sc1
    s_add_u32 s36, s36, 0x480000
    s_addc_u32 s37, s37, 0
    global_load_dwordx4 v[124:127], v8, s[36:37] sc1
    global_load_dwordx4 v[128:131], v8, s[36:37] offset:512 sc1
    s_add_u32 s36, s36, 0x480000
    s_addc_u32 s37, s37, 0
    global_load_dwordx4 v[132:135], v8, s[36:37] sc1
    global_load_dwordx4 v[136:139], v8, s[36:37] offset:512 sc1
    s_add_u32 s36, s36, 0x480000
    s_addc_u32 s37, s37, 0
    global_load_dwordx4 v[140:143], v8, s[36:37] sc1
    global_load_dwordx4 v[144:147], v8, s[36:37] offset:512 sc1
    s_add_u32 s36, s36, 0x480000
    s_addc_u32 s37, s37, 0
    global_load_dwordx4 v[148:151], v8, s[36:37] sc1
    global_load_dwordx4 v[152:155], v8, s[36:37] offset:512 sc1
    s_add_u32 s36, s36, 0x480000
    s_addc_u32 s37, s37, 0
    global_load_dwordx4 v[156:159], v8, s[36:37] sc1
    global_load_dwordx4 v[160:163], v8, s[36:37] offset:512 sc1
    s_add_u32 s36, s36, 0x480000
    s_addc_u32 s37, s37, 0
    v_add_u32 v6, 8, v6
    v_lshlrev_b32 v8, 10, v6
    v_lshl_add_u32 v8, v2, 4, v8
    global_load_dwordx4 v[172:175], v8, s[32:33] sc1
    global_load_dwordx4 v[176:179], v8, s[32:33] offset:512 sc1
    s_add_u32 s36, s32, 0x480000
    s_addc_u32 s37, s33, 0
    global_load_dwordx4 v[244:247], v8, s[36:37] sc1
    global_load_dwordx4 v[248:251], v8, s[36:37] offset:512 sc1
    s_mov_b64 s[36:37], s[34:35]
    global_load_dwordx4 v[180:183], v8, s[36:37] sc1
    global_load_dwordx4 v[184:187], v8, s[36:37] offset:512 sc1
    s_add_u32 s36, s36, 0x480000
    s_addc_u32 s37, s37, 0
    global_load_dwordx4 v[188:191], v8, s[36:37] sc1
    global_load_dwordx4 v[192:195], v8, s[36:37] offset:512 sc1
    s_add_u32 s36, s36, 0x480000
    s_addc_u32 s37, s37, 0
    global_load_dwordx4 v[196:199], v8, s[36:37] sc1
    global_load_dwordx4 v[200:203], v8, s[36:37] offset:512 sc1
    s_add_u32 s36, s36, 0x480000
    s_addc_u32 s37, s37, 0
    global_load_dwordx4 v[204:207], v8, s[36:37] sc1
    global_load_dwordx4 v[208:211], v8, s[36:37] offset:512 sc1
    s_add_u32 s36, s36, 0x480000
    s_addc_u32 s37, s37, 0
    global_load_dwordx4 v[212:215], v8, s[36:37] sc1
    global_load_dwordx4 v[216:219], v8, s[36:37] offset:512 sc1
    s_add_u32 s36, s36, 0x480000
    s_addc_u32 s37, s37, 0
    global_load_dwordx4 v[220:223], v8, s[36:37] sc1
    global_load_dwordx4 v[224:227], v8, s[36:37] offset:512 sc1
    s_add_u32 s36, s36, 0x480000
    s_addc_u32 s37, s37, 0
    global_load_dwordx4 v[228:231], v8, s[36:37] sc1
    global_load_dwordx4 v[232:235], v8, s[36:37] offset:512 sc1
    s_add_u32 s36, s36, 0x480000
    s_addc_u32 s37, s37, 0
    global_load_dwordx4 v[236:239], v8, s[36:37] sc1
    global_load_dwordx4 v[240:243], v8, s[36:37] offset:512 sc1
    s_add_u32 s36, s36, 0x480000
    s_addc_u32 s37, s37, 0
    v_add_u32 v6, 8, v6
    v_subrev_u32 v6, 24, v6
    s_waitcnt vmcnt(60)
    v_sub_f32 v5, 1.0, v5
    s_waitcnt vmcnt(40)
    v_add_f32 v12, v12, v84
    v_add_f32 v13, v13, v85
    v_add_f32 v14, v14, v86
    v_add_f32 v15, v15, v87
    v_add_f32 v16, v16, v88
    v_add_f32 v17, v17, v89
    v_add_f32 v18, v18, v90
    v_add_f32 v19, v19, v91
    v_mul_f32 v12, v12, v5
    v_mul_f32 v13, v13, v5
    v_mul_f32 v14, v14, v5
    v_mul_f32 v15, v15, v5
    v_mul_f32 v16, v16, v5
    v_mul_f32 v17, v17, v5
    v_mul_f32 v18, v18, v5
    v_mul_f32 v19, v19, v5
    v_add_f32 v12, v12, v20
    v_add_f32 v13, v13, v21
    v_add_f32 v14, v14, v22
    v_add_f32 v15, v15, v23
    v_add_f32 v16, v16, v24
    v_add_f32 v17, v17, v25
    v_add_f32 v18, v18, v26
    v_add_f32 v19, v19, v27
    v_add_f32 v12, v12, v28
    v_add_f32 v13, v13, v29
    v_add_f32 v14, v14, v30
    v_add_f32 v15, v15, v31
    v_add_f32 v16, v16, v32
    v_add_f32 v17, v17, v33
    v_add_f32 v18, v18, v34
    v_add_f32 v19, v19, v35
    v_add_f32 v12, v12, v36
    v_add_f32 v13, v13, v37
    v_add_f32 v14, v14, v38
    v_add_f32 v15, v15, v39
    v_add_f32 v16, v16, v40
    v_add_f32 v17, v17, v41
    v_add_f32 v18, v18, v42
    v_add_f32 v19, v19, v43
    v_add_f32 v12, v12, v44
    v_add_f32 v13, v13, v45
    v_add_f32 v14, v14, v46
    v_add_f32 v15, v15, v47
    v_add_f32 v16, v16, v48
    v_add_f32 v17, v17, v49
    v_add_f32 v18, v18, v50
    v_add_f32 v19, v19, v51
    v_add_f32 v12, v12, v52
    v_add_f32 v13, v13, v53
    v_add_f32 v14, v14, v54
    v_add_f32 v15, v15, v55
    v_add_f32 v16, v16, v56
    v_add_f32 v17, v17, v57
    v_add_f32 v18, v18, v58
    v_add_f32 v19, v19, v59
    v_add_f32 v12, v12, v60
    v_add_f32 v13, v13, v61
    v_add_f32 v14, v14, v62
    v_add_f32 v15, v15, v63
    v_add_f32 v16, v16, v64
    v_add_f32 v17, v17, v65
    v_add_f32 v18, v18, v66
    v_add_f32 v19, v19, v67
    v_add_f32 v12, v12, v68
    v_add_f32 v13, v13, v69
    v_add_f32 v14, v14, v70
    v_add_f32 v15, v15, v71
    v_add_f32 v16, v16, v72
    v_add_f32 v17, v17, v73
    v_add_f32 v18, v18, v74
    v_add_f32 v19, v19, v75
    v_add_f32 v12, v12, v76
    v_add_f32 v13, v13, v77
    v_add_f32 v14, v14, v78
    v_add_f32 v15, v15, v79
    v_add_f32 v16, v16, v80
    v_add_f32 v17, v17, v81
    v_add_f32 v18, v18, v82
    v_add_f32 v19, v19, v83
    v_cvt_pk_bf16_f32 v20, v12, v13
    v_cvt_pk_bf16_f32 v21, v14, v15
    v_cvt_pk_bf16_f32 v22, v16, v17
    v_cvt_pk_bf16_f32 v23, v18, v19
    v_lshl_add_u32 v8, v6, 4, v7
    global_store_dwordx4 v8, v[20:23], s[28:29]
    v_add_u32 v6, 8, v6
    s_waitcnt vmcnt(21)
    v_add_f32 v92, v92, v164
    v_add_f32 v93, v93, v165
    v_add_f32 v94, v94, v166
    v_add_f32 v95, v95, v167
    v_add_f32 v96, v96, v168
    v_add_f32 v97, v97, v169
    v_add_f32 v98, v98, v170
    v_add_f32 v99, v99, v171
    v_mul_f32 v92, v92, v5
    v_mul_f32 v93, v93, v5
    v_mul_f32 v94, v94, v5
    v_mul_f32 v95, v95, v5
    v_mul_f32 v96, v96, v5
    v_mul_f32 v97, v97, v5
    v_mul_f32 v98, v98, v5
    v_mul_f32 v99, v99, v5
    v_add_f32 v92, v92, v100
    v_add_f32 v93, v93, v101
    v_add_f32 v94, v94, v102
    v_add_f32 v95, v95, v103
    v_add_f32 v96, v96, v104
    v_add_f32 v97, v97, v105
    v_add_f32 v98, v98, v106
    v_add_f32 v99, v99, v107
    v_add_f32 v92, v92, v108
    v_add_f32 v93, v93, v109
    v_add_f32 v94, v94, v110
    v_add_f32 v95, v95, v111
    v_add_f32 v96, v96, v112
    v_add_f32 v97, v97, v113
    v_add_f32 v98, v98, v114
    v_add_f32 v99, v99, v115
    v_add_f32 v92, v92, v116
    v_add_f32 v93, v93, v117
    v_add_f32 v94, v94, v118
    v_add_f32 v95, v95, v119
    v_add_f32 v96, v96, v120
    v_add_f32 v97, v97, v121
    v_add_f32 v98, v98, v122
    v_add_f32 v99, v99, v123
    v_add_f32 v92, v92, v124
    v_add_f32 v93, v93, v125
    v_add_f32 v94, v94, v126
    v_add_f32 v95, v95, v127
    v_add_f32 v96, v96, v128
    v_add_f32 v97, v97, v129
    v_add_f32 v98, v98, v130
    v_add_f32 v99, v99, v131
    v_add_f32 v92, v92, v132
    v_add_f32 v93, v93, v133
    v_add_f32 v94, v94, v134
    v_add_f32 v95, v95, v135
    v_add_f32 v96, v96, v136
    v_add_f32 v97, v97, v137
    v_add_f32 v98, v98, v138
    v_add_f32 v99, v99, v139
    v_add_f32 v92, v92, v140
    v_add_f32 v93, v93, v141
    v_add_f32 v94, v94, v142
    v_add_f32 v95, v95, v143
    v_add_f32 v96, v96, v144
    v_add_f32 v97, v97, v145
    v_add_f32 v98, v98, v146
    v_add_f32 v99, v99, v147
    v_add_f32 v92, v92, v148
    v_add_f32 v93, v93, v149
    v_add_f32 v94, v94, v150
    v_add_f32 v95, v95, v151
    v_add_f32 v96, v96, v152
    v_add_f32 v97, v97, v153
    v_add_f32 v98, v98, v154
    v_add_f32 v99, v99, v155
    v_add_f32 v92, v92, v156
    v_add_f32 v93, v93, v157
    v_add_f32 v94, v94, v158
    v_add_f32 v95, v95, v159
    v_add_f32 v96, v96, v160
    v_add_f32 v97, v97, v161
    v_add_f32 v98, v98, v162
    v_add_f32 v99, v99, v163
    v_cvt_pk_bf16_f32 v100, v92, v93
    v_cvt_pk_bf16_f32 v101, v94, v95
    v_cvt_pk_bf16_f32 v102, v96, v97
    v_cvt_pk_bf16_f32 v103, v98, v99
    v_lshl_add_u32 v8, v6, 4, v7
    global_store_dwordx4 v8, v[100:103], s[28:29]
    v_add_u32 v6, 8, v6
    s_waitcnt vmcnt(2)
    v_add_f32 v172, v172, v244
    v_add_f32 v173, v173, v245
    v_add_f32 v174, v174, v246
    v_add_f32 v175, v175, v247
    v_add_f32 v176, v176, v248
    v_add_f32 v177, v177, v249
    v_add_f32 v178, v178, v250
    v_add_f32 v179, v179, v251
    v_mul_f32 v172, v172, v5
    v_mul_f32 v173, v173, v5
    v_mul_f32 v174, v174, v5
    v_mul_f32 v175, v175, v5
    v_mul_f32 v176, v176, v5
    v_mul_f32 v177, v177, v5
    v_mul_f32 v178, v178, v5
    v_mul_f32 v179, v179, v5
    v_add_f32 v172, v172, v180
    v_add_f32 v173, v173, v181
    v_add_f32 v174, v174, v182
    v_add_f32 v175, v175, v183
    v_add_f32 v176, v176, v184
    v_add_f32 v177, v177, v185
    v_add_f32 v178, v178, v186
    v_add_f32 v179, v179, v187
    v_add_f32 v172, v172, v188
    v_add_f32 v173, v173, v189
    v_add_f32 v174, v174, v190
    v_add_f32 v175, v175, v191
    v_add_f32 v176, v176, v192
    v_add_f32 v177, v177, v193
    v_add_f32 v178, v178, v194
    v_add_f32 v179, v179, v195
    v_add_f32 v172, v172, v196
    v_add_f32 v173, v173, v197
    v_add_f32 v174, v174, v198
    v_add_f32 v175, v175, v199
    v_add_f32 v176, v176, v200
    v_add_f32 v177, v177, v201
    v_add_f32 v178, v178, v202
    v_add_f32 v179, v179, v203
    v_add_f32 v172, v172, v204
    v_add_f32 v173, v173, v205
    v_add_f32 v174, v174, v206
    v_add_f32 v175, v175, v207
    v_add_f32 v176, v176, v208
    v_add_f32 v177, v177, v209
    v_add_f32 v178, v178, v210
    v_add_f32 v179, v179, v211
    v_add_f32 v172, v172, v212
    v_add_f32 v173, v173, v213
    v_add_f32 v174, v174, v214
    v_add_f32 v175, v175, v215
    v_add_f32 v176, v176, v216
    v_add_f32 v177, v177, v217
    v_add_f32 v178, v178, v218
    v_add_f32 v179, v179, v219
    v_add_f32 v172, v172, v220
    v_add_f32 v173, v173, v221
    v_add_f32 v174, v174, v222
    v_add_f32 v175, v175, v223
    v_add_f32 v176, v176, v224
    v_add_f32 v177, v177, v225
    v_add_f32 v178, v178, v226
    v_add_f32 v179, v179, v227
    v_add_f32 v172, v172, v228
    v_add_f32 v173, v173, v229
    v_add_f32 v174, v174, v230
    v_add_f32 v175, v175, v231
    v_add_f32 v176, v176, v232
    v_add_f32 v177, v177, v233
    v_add_f32 v178, v178, v234
    v_add_f32 v179, v179, v235
    v_add_f32 v172, v172, v236
    v_add_f32 v173, v173, v237
    v_add_f32 v174, v174, v238
    v_add_f32 v175, v175, v239
    v_add_f32 v176, v176, v240
    v_add_f32 v177, v177, v241
    v_add_f32 v178, v178, v242
    v_add_f32 v179, v179, v243
    v_cvt_pk_bf16_f32 v180, v172, v173
    v_cvt_pk_bf16_f32 v181, v174, v175
    v_cvt_pk_bf16_f32 v182, v176, v177
    v_cvt_pk_bf16_f32 v183, v178, v179
    v_lshl_add_u32 v8, v6, 4, v7
    global_store_dwordx4 v8, v[180:183], s[28:29]
    v_add_u32 v6, 8, v6
L_wk_cnd:
    s_add_u32 s46, s46, 1
    s_cmp_lt_u32 s46, 3
    s_cbranch_scc1 L_wk_cld
    s_barrier
    s_add_u32 s42, s42, 1
    s_cmp_lt_u32 s42, s44
    s_cbranch_scc1 L_wk_dl
    s_branch L_wk_next
L_wk_att:
    s_cmp_ge_u32 s17, 1232
    s_cbranch_scc1 L_wk_attf
    s_sub_u32 s18, s17, 800
    s_lshr_b32 s72, s18, 3
    s_and_b32 s73, s18, 7
    s_mov_b32 s74, 0
    v_lshlrev_b32 v2, 4, v1
    v_and_b32 v3, 15, v1
    v_lshrrev_b32 v4, 4, v1
    s_mul_i32 s75, s16, 576
    s_add_u32 s75, s75, 0
    v_add_u32 v10, s75, v1
    v_mul_u32_u24 v11, 14564, v10
    v_lshrrev_b32 v11, 20, v11
    v_mul_u32_u24 v12, 72, v11
    v_sub_u32 v10, v10, v12
    v_bfe_u32 v12, v11, 1, 1
    v_bfe_u32 v13, v11, 3, 1
    v_lshl_add_u32 v12, v13, 1, v12
    v_lshlrev_b32 v12, 1, v12
    v_xor_b32 v10, v10, v12
    v_mul_u32_u24 v11, 1152, v11
    v_lshl_add_u32 v240, v10, 4, v11
    s_mul_i32 s75, s16, 576
    s_add_u32 s75, s75, 64
    v_add_u32 v10, s75, v1
    v_mul_u32_u24 v11, 14564, v10
    v_lshrrev_b32 v11, 20, v11
    v_mul_u32_u24 v12, 72, v11
    v_sub_u32 v10, v10, v12
    v_bfe_u32 v12, v11, 1, 1
    v_bfe_u32 v13, v11, 3, 1
    v_lshl_add_u32 v12, v13, 1, v12
    v_lshlrev_b32 v12, 1, v12
    v_xor_b32 v10, v10, v12
    v_mul_u32_u24 v11, 1152, v11
    v_lshl_add_u32 v241, v10, 4, v11
    s_mul_i32 s75, s16, 576
    s_add_u32 s75, s75, 128
    v_add_u32 v10, s75, v1
    v_mul_u32_u24 v11, 14564, v10
    v_lshrrev_b32 v11, 20, v11
    v_mul_u32_u24 v12, 72, v11
    v_sub_u32 v10, v10, v12
    v_bfe_u32 v12, v11, 1, 1
    v_bfe_u32 v13, v11, 3, 1
    v_lshl_add_u32 v12, v13, 1, v12
    v_lshlrev_b32 v12, 1, v12
    v_xor_b32 v10, v10, v12
    v_mul_u32_u24 v11, 1152, v11
    v_lshl_add_u32 v242, v10, 4, v11
    s_mul_i32 s75, s16, 576
    s_add_u32 s75, s75, 192
    v_add_u32 v10, s75, v1
    v_mul_u32_u24 v11, 14564, v10
    v_lshrrev_b32 v11, 20, v11
    v_mul_u32_u24 v12, 72, v11
    v_sub_u32 v10, v10, v12
    v_bfe_u32 v12, v11, 1, 1
    v_bfe_u32 v13, v11, 3, 1
    v_lshl_add_u32 v12, v13, 1, v12
    v_lshlrev_b32 v12, 1, v12
    v_xor_b32 v10, v10, v12
    v_mul_u32_u24 v11, 1152, v11
    v_lshl_add_u32 v243, v10, 4, v11
    s_mul_i32 s75, s16, 576
    s_add_u32 s75, s75, 256
    v_add_u32 v10, s75, v1
    v_mul_u32_u24 v11, 14564, v10
    v_lshrrev_b32 v11, 20, v11
    v_mul_u32_u24 v12, 72, v11
    v_sub_u32 v10, v10, v12
    v_bfe_u32 v12, v11, 1, 1
    v_bfe_u32 v13, v11, 3, 1
    v_lshl_add_u32 v12, v13, 1, v12
    v_lshlrev_b32 v12, 1, v12
    v_xor_b32 v10, v10, v12
    v_mul_u32_u24 v11, 1152, v11
    v_lshl_add_u32 v244, v10, 4, v11
    s_mul_i32 s75, s16, 576
    s_add_u32 s75, s75, 320
    v_add_u32 v10, s75, v1
    v_mul_u32_u24 v11, 14564, v10
    v_lshrrev_b32 v11, 20, v11
    v_mul_u32_u24 v12, 72, v11
    v_sub_u32 v10, v10, v12
    v_bfe_u32 v12, v11, 1, 1
    v_bfe_u32 v13, v11, 3, 1
    v_lshl_add_u32 v12, v13, 1, v12
    v_lshlrev_b32 v12, 1, v12
    v_xor_b32 v10, v10, v12
    v_mul_u32_u24 v11, 1152, v11
    v_lshl_add_u32 v245, v10, 4, v11
    s_mul_i32 s75, s16, 576
    s_add_u32 s75, s75, 384
    v_add_u32 v10, s75, v1
    v_mul_u32_u24 v11, 14564, v10
    v_lshrrev_b32 v11, 20, v11
    v_mul_u32_u24 v12, 72, v11
    v_sub_u32 v10, v10, v12
    v_bfe_u32 v12, v11, 1, 1
    v_bfe_u32 v13, v11, 3, 1
    v_lshl_add_u32 v12, v13, 1, v12
    v_lshlrev_b32 v12, 1, v12
    v_xor_b32 v10, v10, v12
    v_mul_u32_u24 v11, 1152, v11
    v_lshl_add_u32 v246, v10, 4, v11
    s_mul_i32 s75, s16, 576
    s_add_u32 s75, s75, 448
    v_add_u32 v10, s75, v1
    v_mul_u32_u24 v11, 14564, v10
    v_lshrrev_b32 v11, 20, v11
    v_mul_u32_u24 v12, 72, v11
    v_sub_u32 v10, v10, v12
    v_bfe_u32 v12, v11, 1, 1
    v_bfe_u32 v13, v11, 3, 1
    v_lshl_add_u32 v12, v13, 1, v12
    v_lshlrev_b32 v12, 1, v12
    v_xor_b32 v10, v10, v12
    v_mul_u32_u24 v11, 1152, v11
    v_lshl_add_u32 v247, v10, 4, v11
    s_mul_i32 s75, s16, 576
    s_add_u32 s75, s75, 512
    v_add_u32 v10, s75, v1
    v_mul_u32_u24 v11, 14564, v10
    v_lshrrev_b32 v11, 20, v11
    v_mul_u32_u24 v12, 72, v11
    v_sub_u32 v10, v10, v12
    v_bfe_u32 v12, v11, 1, 1
    v_bfe_u32 v13, v11, 3, 1
    v_lshl_add_u32 v12, v13, 1, v12
    v_lshlrev_b32 v12, 1, v12
    v_xor_b32 v10, v10, v12
    v_mul_u32_u24 v11, 1152, v11
    v_lshl_add_u32 v248, v10, 4, v11
    v_lshrrev_b32 v10, 2, v3
    v_lshl_add_u32 v11, v4, 3, v10
    v_mul_u32_u24 v11, 1152, v11
    v_and_b32 v12, 3, v3
    v_lshl_add_u32 v11, v12, 3, v11
    v_add_u32 v11, 32768, v11
    v_lshrrev_b32 v12, 1, v10
    v_and_b32 v13, 1, v4
    v_lshl_add_u32 v12, v13, 1, v12
    s_mul_i32 s75, s16, 9
    s_add_u32 s76, s75, 0
    v_xor_b32 v13, s76, v12
    v_lshl_add_u32 v230, v13, 5, v11
    s_add_u32 s76, s75, 1
    v_xor_b32 v13, s76, v12
    v_lshl_add_u32 v231, v13, 5, v11
    s_add_u32 s76, s75, 2
    v_xor_b32 v13, s76, v12
    v_lshl_add_u32 v232, v13, 5, v11
    s_add_u32 s76, s75, 3
    v_xor_b32 v13, s76, v12
    v_lshl_add_u32 v233, v13, 5, v11
    s_add_u32 s76, s75, 4
    v_xor_b32 v13, s76, v12
    v_lshl_add_u32 v234, v13, 5, v11
    s_add_u32 s76, s75, 5
    v_xor_b32 v13, s76, v12
    v_lshl_add_u32 v235, v13, 5, v11
    s_add_u32 s76, s75, 6
    v_xor_b32 v13, s76, v12
    v_lshl_add_u32 v236, v13, 5, v11
    s_add_u32 s76, s75, 7
    v_xor_b32 v13, s76, v12
    v_lshl_add_u32 v237, v13, 5, v11
    s_add_u32 s76, s75, 8
    v_xor_b32 v13, s76, v12
    v_lshl_add_u32 v238, v13, 5, v11
    v_lshlrev_b32 v229, 9, v4
    v_lshl_add_u32 v229, v3, 4, v229
    s_mov_b32 s68, -1
    s_mov_b32 s69, 0
    s_mov_b32 s81, 0x3e0293ee
    s_load_dwordx2 s[70:71], s[0:1], 40
    s_waitcnt lgkmcnt(0)
    s_mov_b32 s64, s70
    s_mov_b32 s65, s71
    s_mov_b32 s66, 4718592
    s_mov_b32 s67, 0x00020000
    s_mul_i32 s78, s73, 589824
    s_mul_i32 s82, s16, 9216
    s_mov_b32 s77, s82
    s_add_u32 m0, s77, 32768
    s_nop 0
    buffer_load_dwordx4 v240, s[64:67], s78 offen lds
    s_add_u32 m0, s77, 33792
    s_nop 0
    buffer_load_dwordx4 v241, s[64:67], s78 offen lds
    s_add_u32 m0, s77, 34816
    s_nop 0
    buffer_load_dwordx4 v242, s[64:67], s78 offen lds
    s_add_u32 m0, s77, 35840
    s_nop 0
    buffer_load_dwordx4 v243, s[64:67], s78 offen lds
    s_add_u32 m0, s77, 36864
    s_nop 0
    buffer_load_dwordx4 v244, s[64:67], s78 offen lds
    s_add_u32 m0, s77, 37888
    s_nop 0
    buffer_load_dwordx4 v245, s[64:67], s78 offen lds
    s_add_u32 m0, s77, 38912
    s_nop 0
    buffer_load_dwordx4 v246, s[64:67], s78 offen lds
    s_add_u32 m0, s77, 39936
    s_nop 0
    buffer_load_dwordx4 v247, s[64:67], s78 offen lds
    s_add_u32 m0, s77, 40960
    s_nop 0
    buffer_load_dwordx4 v248, s[64:67], s78 offen lds
    s_add_u32 s78, s78, 36864
    s_add_u32 s77, s77, 36864
    s_add_u32 s76, s82, 110592
    s_cmp_eq_u32 s77, s76
    s_cselect_b32 s77, s82, s77
    s_add_u32 m0, s77, 32768
    s_nop 0
    buffer_load_dwordx4 v240, s[64:67], s78 offen lds
    s_add_u32 m0, s77, 33792
    s_nop 0
    buffer_load_dwordx4 v241, s[64:67], s78 offen lds
    s_add_u32 m0, s77, 34816
    s_nop 0
    buffer_load_dwordx4 v242, s[64:67], s78 offen lds
    s_add_u32 m0, s77, 35840
    s_nop 0
    buffer_load_dwordx4 v243, s[64:67], s78 offen lds
    s_add_u32 m0, s77, 36864
    s_nop 0
    buffer_load_dwordx4 v244, s[64:67], s78 offen lds
    s_add_u32 m0, s77, 37888
    s_nop 0
    buffer_load_dwordx4 v245, s[64:67], s78 offen lds
    s_add_u32 m0, s77, 38912
    s_nop 0
    buffer_load_dwordx4 v246, s[64:67], s78 offen lds
    s_add_u32 m0, s77, 39936
    s_nop 0
    buffer_load_dwordx4 v247, s[64:67], s78 offen lds
    s_add_u32 m0, s77, 40960
    s_nop 0
    buffer_load_dwordx4 v248, s[64:67], s78 offen lds
    s_add_u32 s78, s78, 36864
    s_add_u32 s77, s77, 36864
    s_add_u32 s76, s82, 110592
    s_cmp_eq_u32 s77, s76
    s_cselect_b32 s77, s82, s77
    s_add_u32 m0, s77, 32768
    s_nop 0
    buffer_load_dwordx4 v240, s[64:67], s78 offen lds
    s_add_u32 m0, s77, 33792
    s_nop 0
    buffer_load_dwordx4 v241, s[64:67], s78 offen lds
    s_add_u32 m0, s77, 34816
    s_nop 0
    buffer_load_dwordx4 v242, s[64:67], s78 offen lds
    s_add_u32 m0, s77, 35840
    s_nop 0
    buffer_load_dwordx4 v243, s[64:67], s78 offen lds
    s_add_u32 m0, s77, 36864
    s_nop 0
    buffer_load_dwordx4 v244, s[64:67], s78 offen lds
    s_add_u32 m0, s77, 37888
    s_nop 0
    buffer_load_dwordx4 v245, s[64:67], s78 offen lds
    s_add_u32 m0, s77, 38912
    s_nop 0
    buffer_load_dwordx4 v246, s[64:67], s78 offen lds
    s_add_u32 m0, s77, 39936
    s_nop 0
    buffer_load_dwordx4 v247, s[64:67], s78 offen lds
    s_add_u32 m0, s77, 40960
    s_nop 0
    buffer_load_dwordx4 v248, s[64:67], s78 offen lds
    s_add_u32 s78, s78, 36864
    s_add_u32 s77, s77, 36864
    s_add_u32 s76, s82, 110592
    s_cmp_eq_u32 s77, s76
    s_cselect_b32 s77, s82, s77
    s_cmp_lg_u32 s16, 0
    s_cbranch_scc1 L_wk_ad0c
    v_mov_b32 v10, 32
    s_mov_b32 s20, 0
L_wk_a0c_p:
    global_load_dword v11, v10, s[6:7] sc1
    s_waitcnt vmcnt(0)
    v_readfirstlane_b32 s18, v11
    s_add_u32 s20, s20, 1
    s_cmp_gt_u32 s20, 600000
    s_cbranch_scc1 L_wk_fail
    s_cmp_ge_u32 s18, 32
    s_cbranch_scc1 L_wk_a0c_d
    s_sleep 4
    s_branch L_wk_a0c_p
L_wk_a0c_d:
    v_mov_b32 v10, 40
    s_mov_b32 s20, 0
L_wk_a1c_p:
    global_load_dword v11, v10, s[6:7] sc1
    s_waitcnt vmcnt(0)
    v_readfirstlane_b32 s18, v11
    s_add_u32 s20, s20, 1
    s_cmp_gt_u32 s20, 600000
    s_cbranch_scc1 L_wk_fail
    s_cmp_ge_u32 s18, 32
    s_cbranch_scc1 L_wk_a1c_d
    s_sleep 4
    s_branch L_wk_a1c_p
L_wk_a1c_d:
    s_lshr_b32 s21, s72, 3
    s_lshl_b32 s21, s21, 2
    s_add_u32 s21, s21, 128
    v_mov_b32 v10, s21
    s_mov_b32 s20, 0
L_wk_a2c_p:
    global_load_dword v11, v10, s[6:7] sc1
    s_waitcnt vmcnt(0)
    v_readfirstlane_b32 s18, v11
    s_add_u32 s20, s20, 1
    s_cmp_gt_u32 s20, 600000
    s_cbranch_scc1 L_wk_fail
    s_cmp_ge_u32 s18, 16
    s_cbranch_scc1 L_wk_a2c_d
    s_sleep 4
    s_branch L_wk_a2c_p
L_wk_a2c_d:
    s_sub_u32 s21, s21, 64
    v_mov_b32 v10, s21
    s_mov_b32 s20, 0
L_wk_a4c_p:
    global_load_dword v11, v10, s[6:7] sc1
    s_waitcnt vmcnt(0)
    v_readfirstlane_b32 s18, v11
    s_add_u32 s20, s20, 1
    s_cmp_gt_u32 s20, 600000
    s_cbranch_scc1 L_wk_fail
    s_cmp_ge_u32 s18, 32
    s_cbranch_scc1 L_wk_a4c_d
    s_sleep 4
    s_branch L_wk_a4c_p
L_wk_a4c_d:
    v_mov_b32 v10, 64
    s_mov_b32 s20, 0
L_wk_a6c_p:
    global_load_dword v11, v10, s[6:7] sc1
    s_waitcnt vmcnt(0)
    v_readfirstlane_b32 s18, v11
    s_add_u32 s20, s20, 1
    s_cmp_gt_u32 s20, 600000
    s_cbranch_scc1 L_wk_fail
    s_cmp_ge_u32 s18, 64
    s_cbranch_scc1 L_wk_a6c_d
    s_sleep 4
    s_branch L_wk_a6c_p
L_wk_a6c_d:
    v_mov_b32 v10, 48
    s_mov_b32 s20, 0
L_wk_a5c_p:
    global_load_dword v11, v10, s[6:7] sc1
    s_waitcnt vmcnt(0)
    v_readfirstlane_b32 s18, v11
    s_add_u32 s20, s20, 1
    s_cmp_gt_u32 s20, 600000
    s_cbranch_scc1 L_wk_fail
    s_cmp_ge_u32 s18, 64
    s_cbranch_scc1 L_wk_a5c_d
    s_sleep 4
    s_branch L_wk_a5c_p
L_wk_a5c_d:
L_wk_ad0c:
    s_barrier
    s_lshl_b32 s75, s72, 5
    s_lshl_b32 s76, s73, 2
    s_add_u32 s75, s75, s76
    s_add_u32 s75, s75, s16
    s_lshl_b32 s76, s75, 13
    s_add_u32 s48, s4, 0x2000000
    s_addc_u32 s49, s5, 0
    s_add_u32 s48, s48, s76
    s_addc_u32 s49, s49, 0
    s_add_u32 s50, s4, 0x0
    s_addc_u32 s51, s5, 0
    s_add_u32 s50, s50, s76
    s_addc_u32 s51, s51, 0
    s_add_u32 s52, s4, 0x1000000
    s_addc_u32 s53, s5, 0
    s_add_u32 s52, s52, s76
    s_addc_u32 s53, s53, 0
    s_lshl_b32 s76, s75, 11
    s_add_u32 s54, s4, 0x7a00000
    s_addc_u32 s55, s5, 0
    s_add_u32 s54, s54, s76
    s_addc_u32 s55, s55, 0
    s_add_u32 s56, s4, 0x4e00000
    s_addc_u32 s57, s5, 0
    s_add_u32 s56, s56, s76
    s_addc_u32 s57, s57, 0
    s_lshl_b32 s76, s72, 7
    s_add_u32 s58, s4, 0x4d80000
    s_addc_u32 s59, s5, 0
    s_add_u32 s58, s58, s76
    s_addc_u32 s59, s59, 0
    v_add_u32 v5, 4096, v2
    global_load_dwordx4 v[16:19], v2, s[48:49] offset:0 sc1
    global_load_dwordx4 v[20:23], v2, s[48:49] offset:1024 sc1
    global_load_dwordx4 v[24:27], v2, s[48:49] offset:2048 sc1
    global_load_dwordx4 v[28:31], v2, s[48:49] offset:3072 sc1
    global_load_dwordx4 v[32:35], v5, s[48:49] offset:0 sc1
    global_load_dwordx4 v[36:39], v5, s[48:49] offset:1024 sc1
    global_load_dwordx4 v[40:43], v5, s[48:49] offset:2048 sc1
    global_load_dwordx4 v[44:47], v5, s[48:49] offset:3072 sc1
    global_load_dwordx4 v[48:51], v2, s[50:51] offset:0 sc1
    global_load_dwordx4 v[52:55], v2, s[50:51] offset:1024 sc1
    global_load_dwordx4 v[56:59], v2, s[50:51] offset:2048 sc1
    global_load_dwordx4 v[60:63], v2, s[50:51] offset:3072 sc1
    global_load_dwordx4 v[64:67], v5, s[50:51] offset:0 sc1
    global_load_dwordx4 v[68:71], v5, s[50:51] offset:1024 sc1
    global_load_dwordx4 v[72:75], v5, s[50:51] offset:2048 sc1
    global_load_dwordx4 v[76:79], v5, s[50:51] offset:3072 sc1
    global_load_dwordx4 v[96:99], v2, s[52:53] offset:0 sc1
    global_load_dwordx4 v[100:103], v2, s[52:53] offset:1024 sc1
    global_load_dwordx4 v[104:107], v2, s[52:53] offset:2048 sc1
    global_load_dwordx4 v[108:111], v2, s[52:53] offset:3072 sc1
    global_load_dwordx4 v[112:115], v5, s[52:53] offset:0 sc1
    global_load_dwordx4 v[116:119], v5, s[52:53] offset:1024 sc1
    global_load_dwordx4 v[120:123], v5, s[52:53] offset:2048 sc1
    global_load_dwordx4 v[124:127], v5, s[52:53] offset:3072 sc1
    v_lshlrev_b32 v8, 2, v3
    global_load_dword v144, v8, s[58:59] sc1
    global_load_dword v145, v8, s[58:59] offset:64 sc1
    v_and_b32 v6, 7, v3
    v_lshl_add_u32 v6, v4, 3, v6
    v_lshlrev_b32 v6, 4, v6
    v_and_b32 v7, 1, v4
    v_lshlrev_b32 v7, 3, v7
    v_lshl_add_u32 v7, v3, 4, v7
    s_cmp_lg_u32 s16, 0
    s_cbranch_scc1 L_wk_ad1c
    s_add_u32 s10, s4, 0x5310000
    s_addc_u32 s11, s5, 0
    s_add_u32 s19, s72, 1
    s_lshl_b32 s21, s73, 9
    v_and_b32 v10, 3, v1
    v_lshlrev_b32 v10, 7, v10
    v_add_u32 v10, s21, v10
    s_mov_b32 s20, 0
L_wk_ppc:
    global_load_dword v11, v10, s[10:11] sc1
    s_waitcnt vmcnt(0)
    v_min_u32_dpp v11, v11, v11 quad_perm:[1,0,3,2] row_mask:0xf bank_mask:0xf
    s_nop 1
    v_min_u32_dpp v11, v11, v11 quad_perm:[2,3,0,1] row_mask:0xf bank_mask:0xf
    s_nop 0
    v_readfirstlane_b32 s18, v11
    s_cmp_ge_u32 s18, s19
    s_cbranch_scc1 L_wk_ad1c
    s_add_u32 s20, s20, 1
    s_cmp_gt_u32 s20, 600000
    s_cbranch_scc1 L_wk_fail
    s_sub_u32 s18, s19, s18
    s_cmp_ge_u32 s18, 3
    s_cbranch_scc1 L_wk_pfc
    s_sleep 2
    s_branch L_wk_ppc
L_wk_pfc:
    s_sleep 48
    s_branch L_wk_ppc
L_wk_ad1c:
    s_barrier
    global_load_dwordx4 v[80:83], v6, s[54:55] offset:0 sc1
    global_load_dwordx4 v[84:87], v6, s[54:55] offset:512 sc1
    global_load_dwordx4 v[88:91], v6, s[54:55] offset:1024 sc1
    global_load_dwordx4 v[92:95], v6, s[54:55] offset:1536 sc1
    global_load_dwordx2 v[128:129], v7, s[56:57] offset:0 sc1
    global_load_dwordx2 v[130:131], v7, s[56:57] offset:256 sc1
    global_load_dwordx2 v[132:133], v7, s[56:57] offset:512 sc1
    global_load_dwordx2 v[134:135], v7, s[56:57] offset:768 sc1
    global_load_dwordx2 v[136:137], v7, s[56:57] offset:1024 sc1
    global_load_dwordx2 v[138:139], v7, s[56:57] offset:1280 sc1
    global_load_dwordx2 v[140:141], v7, s[56:57] offset:1536 sc1
    global_load_dwordx2 v[142:143], v7, s[56:57] offset:1792 sc1
    s_waitcnt vmcnt(8)
    v_mfma_f32_16x16x32_bf16 v[148:151], v[48:51], v[16:19], 0
    v_mfma_f32_16x16x32_bf16 v[148:151], v[56:59], v[24:27], v[148:151]
    v_mfma_f32_16x16x32_bf16 v[148:151], v[64:67], v[32:35], v[148:151]
    v_mfma_f32_16x16x32_bf16 v[148:151], v[72:75], v[40:43], v[148:151]
    v_mfma_f32_16x16x32_bf16 v[152:155], v[52:55], v[16:19], 0
    v_mfma_f32_16x16x32_bf16 v[152:155], v[60:63], v[24:27], v[152:155]
    v_mfma_f32_16x16x32_bf16 v[152:155], v[68:71], v[32:35], v[152:155]
    v_mfma_f32_16x16x32_bf16 v[152:155], v[76:79], v[40:43], v[152:155]
    v_mfma_f32_16x16x32_bf16 v[156:159], v[80:83], v[16:19], 0
    v_mfma_f32_16x16x32_bf16 v[156:159], v[84:87], v[24:27], v[156:159]
    v_mfma_f32_16x16x32_bf16 v[156:159], v[88:91], v[32:35], v[156:159]
    v_mfma_f32_16x16x32_bf16 v[156:159], v[92:95], v[40:43], v[156:159]
    v_mfma_f32_16x16x32_bf16 v[160:163], v[48:51], v[20:23], 0
    v_mfma_f32_16x16x32_bf16 v[160:163], v[56:59], v[28:31], v[160:163]
    v_mfma_f32_16x16x32_bf16 v[160:163], v[64:67], v[36:39], v[160:163]
    v_mfma_f32_16x16x32_bf16 v[160:163], v[72:75], v[44:47], v[160:163]
    v_mfma_f32_16x16x32_bf16 v[164:167], v[52:55], v[20:23], 0
    v_mfma_f32_16x16x32_bf16 v[164:167], v[60:63], v[28:31], v[164:167]
    v_mfma_f32_16x16x32_bf16 v[164:167], v[68:71], v[36:39], v[164:167]
    v_mfma_f32_16x16x32_bf16 v[164:167], v[76:79], v[44:47], v[164:167]
    v_mfma_f32_16x16x32_bf16 v[168:171], v[80:83], v[20:23], 0
    v_mfma_f32_16x16x32_bf16 v[168:171], v[84:87], v[28:31], v[168:171]
    v_mfma_f32_16x16x32_bf16 v[168:171], v[88:91], v[36:39], v[168:171]
    v_mfma_f32_16x16x32_bf16 v[168:171], v[92:95], v[44:47], v[168:171]
    v_mov_b32 v9, 0xf149f2ca
    v_lshlrev_b32 v10, 3, v4
    v_add_u32 v11, 0, v10
    v_cmp_le_i32 vcc, v11, v3
    s_nop 1
    v_cndmask_b32 v148, v9, v148, vcc
    v_add_u32 v11, 1, v10
    v_cmp_le_i32 vcc, v11, v3
    s_nop 1
    v_cndmask_b32 v149, v9, v149, vcc
    v_add_u32 v11, 2, v10
    v_cmp_le_i32 vcc, v11, v3
    s_nop 1
    v_cndmask_b32 v150, v9, v150, vcc
    v_add_u32 v11, 3, v10
    v_cmp_le_i32 vcc, v11, v3
    s_nop 1
    v_cndmask_b32 v151, v9, v151, vcc
    v_add_u32 v11, 4, v10
    v_cmp_le_i32 vcc, v11, v3
    s_nop 1
    v_cndmask_b32 v152, v9, v152, vcc
    v_add_u32 v11, 5, v10
    v_cmp_le_i32 vcc, v11, v3
    s_nop 1
    v_cndmask_b32 v153, v9, v153, vcc
    v_add_u32 v11, 6, v10
    v_cmp_le_i32 vcc, v11, v3
    s_nop 1
    v_cndmask_b32 v154, v9, v154, vcc
    v_add_u32 v11, 7, v10
    v_cmp_le_i32 vcc, v11, v3
    s_nop 1
    v_cndmask_b32 v155, v9, v155, vcc
    v_max3_f32 v10, v148, v149, v150
    v_max3_f32 v10, v10, v151, v152
    v_max3_f32 v10, v10, v153, v154
    v_max3_f32 v10, v10, v155, v156
    v_max3_f32 v10, v10, v157, v158
    v_max_f32 v10, v10, v159
    v_mov_b32 v11, v10
    s_nop 1
    v_permlane16_swap_b32 v10, v11
    v_max_f32 v10, v10, v11
    v_mov_b32 v11, v10
    s_nop 1
    v_permlane32_swap_b32 v10, v11
    v_max_f32 v10, v10, v11
    v_mul_f32 v10, s81, v10
    v_fma_f32 v148, v148, s81, -v10
    v_fma_f32 v149, v149, s81, -v10
    v_fma_f32 v150, v150, s81, -v10
    v_fma_f32 v151, v151, s81, -v10
    v_fma_f32 v152, v152, s81, -v10
    v_fma_f32 v153, v153, s81, -v10
    v_fma_f32 v154, v154, s81, -v10
    v_fma_f32 v155, v155, s81, -v10
    v_fma_f32 v156, v156, s81, -v10
    v_fma_f32 v157, v157, s81, -v10
    v_fma_f32 v158, v158, s81, -v10
    v_fma_f32 v159, v159, s81, -v10
    v_exp_f32 v148, v148
    v_exp_f32 v149, v149
    v_exp_f32 v150, v150
    v_exp_f32 v151, v151
    v_exp_f32 v152, v152
    v_exp_f32 v153, v153
    v_exp_f32 v154, v154
    v_exp_f32 v155, v155
    v_exp_f32 v156, v156
    v_exp_f32 v157, v157
    v_exp_f32 v158, v158
    v_exp_f32 v159, v159
    v_cndmask_b32 v156, 0, v156, s[68:69]
    v_cndmask_b32 v157, 0, v157, s[68:69]
    v_cndmask_b32 v158, 0, v158, s[68:69]
    v_cndmask_b32 v159, 0, v159, s[68:69]
    v_add_f32 v10, v148, v149
    v_add_f32 v10, v10, v150
    v_add_f32 v10, v10, v151
    v_add_f32 v10, v10, v152
    v_add_f32 v10, v10, v153
    v_add_f32 v10, v10, v154
    v_add_f32 v10, v10, v155
    v_add_f32 v10, v10, v156
    v_add_f32 v10, v10, v157
    v_add_f32 v10, v10, v158
    v_add_f32 v10, v10, v159
    v_mov_b32 v11, v10
    s_nop 1
    v_permlane16_swap_b32 v10, v11
    v_add_f32 v10, v10, v11
    v_mov_b32 v11, v10
    s_nop 1
    v_permlane32_swap_b32 v10, v11
    v_add_f32 v10, v10, v11
    v_rcp_f32 v10, v10
    v_cvt_pk_bf16_f32 v172, v148, v149
    v_cvt_pk_bf16_f32 v173, v150, v151
    v_cvt_pk_bf16_f32 v174, v152, v153
    v_cvt_pk_bf16_f32 v175, v154, v155
    v_cvt_pk_bf16_f32 v176, v156, v157
    v_cvt_pk_bf16_f32 v177, v158, v159
    v_mov_b32 v146, v10
    v_lshlrev_b32 v10, 3, v4
    v_add_u32 v11, 4294967280, v10
    v_cmp_le_i32 vcc, v11, v3
    s_nop 1
    v_cndmask_b32 v160, v9, v160, vcc
    v_add_u32 v11, 4294967281, v10
    v_cmp_le_i32 vcc, v11, v3
    s_nop 1
    v_cndmask_b32 v161, v9, v161, vcc
    v_add_u32 v11, 4294967282, v10
    v_cmp_le_i32 vcc, v11, v3
    s_nop 1
    v_cndmask_b32 v162, v9, v162, vcc
    v_add_u32 v11, 4294967283, v10
    v_cmp_le_i32 vcc, v11, v3
    s_nop 1
    v_cndmask_b32 v163, v9, v163, vcc
    v_add_u32 v11, 4294967284, v10
    v_cmp_le_i32 vcc, v11, v3
    s_nop 1
    v_cndmask_b32 v164, v9, v164, vcc
    v_add_u32 v11, 4294967285, v10
    v_cmp_le_i32 vcc, v11, v3
    s_nop 1
    v_cndmask_b32 v165, v9, v165, vcc
    v_add_u32 v11, 4294967286, v10
    v_cmp_le_i32 vcc, v11, v3
    s_nop 1
    v_cndmask_b32 v166, v9, v166, vcc
    v_add_u32 v11, 4294967287, v10
    v_cmp_le_i32 vcc, v11, v3
    s_nop 1
    v_cndmask_b32 v167, v9, v167, vcc
    v_max3_f32 v10, v160, v161, v162
    v_max3_f32 v10, v10, v163, v164
    v_max3_f32 v10, v10, v165, v166
    v_max3_f32 v10, v10, v167, v168
    v_max3_f32 v10, v10, v169, v170
    v_max_f32 v10, v10, v171
    v_mov_b32 v11, v10
    s_nop 1
    v_permlane16_swap_b32 v10, v11
    v_max_f32 v10, v10, v11
    v_mov_b32 v11, v10
    s_nop 1
    v_permlane32_swap_b32 v10, v11
    v_max_f32 v10, v10, v11
    v_mul_f32 v10, s81, v10
    v_fma_f32 v160, v160, s81, -v10
    v_fma_f32 v161, v161, s81, -v10
    v_fma_f32 v162, v162, s81, -v10
    v_fma_f32 v163, v163, s81, -v10
    v_fma_f32 v164, v164, s81, -v10
    v_fma_f32 v165, v165, s81, -v10
    v_fma_f32 v166, v166, s81, -v10
    v_fma_f32 v167, v167, s81, -v10
    v_fma_f32 v168, v168, s81, -v10
    v_fma_f32 v169, v169, s81, -v10
    v_fma_f32 v170, v170, s81, -v10
    v_fma_f32 v171, v171, s81, -v10
    v_exp_f32 v160, v160
    v_exp_f32 v161, v161
    v_exp_f32 v162, v162
    v_exp_f32 v163, v163
    v_exp_f32 v164, v164
    v_exp_f32 v165, v165
    v_exp_f32 v166, v166
    v_exp_f32 v167, v167
    v_exp_f32 v168, v168
    v_exp_f32 v169, v169
    v_exp_f32 v170, v170
    v_exp_f32 v171, v171
    v_cndmask_b32 v168, 0, v168, s[68:69]
    v_cndmask_b32 v169, 0, v169, s[68:69]
    v_cndmask_b32 v170, 0, v170, s[68:69]
    v_cndmask_b32 v171, 0, v171, s[68:69]
    v_add_f32 v10, v160, v161
    v_add_f32 v10, v10, v162
    v_add_f32 v10, v10, v163
    v_add_f32 v10, v10, v164
    v_add_f32 v10, v10, v165
    v_add_f32 v10, v10, v166
    v_add_f32 v10, v10, v167
    v_add_f32 v10, v10, v168
    v_add_f32 v10, v10, v169
    v_add_f32 v10, v10, v170
    v_add_f32 v10, v10, v171
    v_mov_b32 v11, v10
    s_nop 1
    v_permlane16_swap_b32 v10, v11
    v_add_f32 v10, v10, v11
    v_mov_b32 v11, v10
    s_nop 1
    v_permlane32_swap_b32 v10, v11
    v_add_f32 v10, v10, v11
    v_rcp_f32 v10, v10
    v_cvt_pk_bf16_f32 v180, v160, v161
    v_cvt_pk_bf16_f32 v181, v162, v163
    v_cvt_pk_bf16_f32 v182, v164, v165
    v_cvt_pk_bf16_f32 v183, v166, v167
    v_cvt_pk_bf16_f32 v184, v168, v169
    v_cvt_pk_bf16_f32 v185, v170, v171
    v_mov_b32 v147, v10
    s_waitcnt vmcnt(0)
    v_mul_f32 v146, v146, v144
    v_mul_f32 v147, v147, v145
    v_lshrrev_b32 v10, 1, v4
    v_lshlrev_b32 v10, 9, v10
    v_add_u32 v10, v10, v7
    s_lshl_b32 s75, s16, 13
    v_add_u32 v10, s75, v10
    v_mfma_f32_16x16x32_bf16 v[192:195], v[96:99], v[172:175], 0
    v_mfma_f32_16x16x32_bf16 v[196:199], v[100:103], v[172:175], 0
    v_mfma_f32_16x16x32_bf16 v[200:203], v[104:107], v[172:175], 0
    s_nop 5
    v_mfma_f32_16x16x16_bf16 v[192:195], v[128:129], v[176:177], v[192:195]
    v_mfma_f32_16x16x32_bf16 v[204:207], v[108:111], v[172:175], 0
    v_mfma_f32_16x16x16_bf16 v[196:199], v[130:131], v[176:177], v[196:199]
    v_mfma_f32_16x16x32_bf16 v[208:211], v[112:115], v[172:175], 0
    v_mfma_f32_16x16x16_bf16 v[200:203], v[132:133], v[176:177], v[200:203]
    s_nop 3
    v_mul_f32 v192, v192, v146
    v_mul_f32 v193, v193, v146
    v_mul_f32 v194, v194, v146
    v_mul_f32 v195, v195, v146
    v_cvt_pk_bf16_f32 v192, v192, v193
    v_cvt_pk_bf16_f32 v193, v194, v195
    ds_write_b64 v10, v[192:193] offset:0
    v_mfma_f32_16x16x32_bf16 v[212:215], v[116:119], v[172:175], 0
    v_mfma_f32_16x16x16_bf16 v[204:207], v[134:135], v[176:177], v[204:207]
    v_mul_f32 v196, v196, v146
    v_mul_f32 v197, v197, v146
    v_mul_f32 v198, v198, v146
    v_mul_f32 v199, v199, v146
    v_cvt_pk_bf16_f32 v196, v196, v197
    v_cvt_pk_bf16_f32 v197, v198, v199
    ds_write_b64 v10, v[196:197] offset:1024
    v_mfma_f32_16x16x32_bf16 v[192:195], v[120:123], v[172:175], 0
    v_mfma_f32_16x16x16_bf16 v[208:211], v[136:137], v[176:177], v[208:211]
    v_mul_f32 v200, v200, v146
    v_mul_f32 v201, v201, v146
    v_mul_f32 v202, v202, v146
    v_mul_f32 v203, v203, v146
    v_cvt_pk_bf16_f32 v200, v200, v201
    v_cvt_pk_bf16_f32 v201, v202, v203
    ds_write_b64 v10, v[200:201] offset:2048
    v_mfma_f32_16x16x32_bf16 v[196:199], v[124:127], v[172:175], 0
    v_mfma_f32_16x16x16_bf16 v[212:215], v[138:139], v[176:177], v[212:215]
    v_mul_f32 v204, v204, v146
    v_mul_f32 v205, v205, v146
    v_mul_f32 v206, v206, v146
    v_mul_f32 v207, v207, v146
    v_cvt_pk_bf16_f32 v204, v204, v205
    v_cvt_pk_bf16_f32 v205, v206, v207
    ds_write_b64 v10, v[204:205] offset:3072
    v_mfma_f32_16x16x32_bf16 v[200:203], v[96:99], v[180:183], 0
    v_mfma_f32_16x16x16_bf16 v[192:195], v[140:141], v[176:177], v[192:195]
    v_mul_f32 v208, v208, v146
    v_mul_f32 v209, v209, v146
    v_mul_f32 v210, v210, v146
    v_mul_f32 v211, v211, v146
    v_cvt_pk_bf16_f32 v208, v208, v209
    v_cvt_pk_bf16_f32 v209, v210, v211
    ds_write_b64 v10, v[208:209] offset:4096
    v_mfma_f32_16x16x32_bf16 v[204:207], v[100:103], v[180:183], 0
    v_mfma_f32_16x16x16_bf16 v[196:199], v[142:143], v[176:177], v[196:199]
    v_mul_f32 v212, v212, v146
    v_mul_f32 v213, v213, v146
    v_mul_f32 v214, v214, v146
    v_mul_f32 v215, v215, v146
    v_cvt_pk_bf16_f32 v212, v212, v213
    v_cvt_pk_bf16_f32 v213, v214, v215
    ds_write_b64 v10, v[212:213] offset:5120
    v_mfma_f32_16x16x32_bf16 v[208:211], v[104:107], v[180:183], 0
    v_mfma_f32_16x16x16_bf16 v[200:203], v[128:129], v[184:185], v[200:203]
    v_mul_f32 v192, v192, v146
    v_mul_f32 v193, v193, v146
    v_mul_f32 v194, v194, v146
    v_mul_f32 v195, v195, v146
    v_cvt_pk_bf16_f32 v192, v192, v193
    v_cvt_pk_bf16_f32 v193, v194, v195
    ds_write_b64 v10, v[192:193] offset:6144
    v_mfma_f32_16x16x32_bf16 v[212:215], v[108:111], v[180:183], 0
    v_mfma_f32_16x16x16_bf16 v[204:207], v[130:131], v[184:185], v[204:207]
    v_mul_f32 v196, v196, v146
    v_mul_f32 v197, v197, v146
    v_mul_f32 v198, v198, v146
    v_mul_f32 v199, v199, v146
    v_cvt_pk_bf16_f32 v196, v196, v197
    v_cvt_pk_bf16_f32 v197, v198, v199
    ds_write_b64 v10, v[196:197] offset:7168
    v_mfma_f32_16x16x32_bf16 v[192:195], v[112:115], v[180:183], 0
    v_mfma_f32_16x16x16_bf16 v[208:211], v[132:133], v[184:185], v[208:211]
    v_mul_f32 v200, v200, v147
    v_mul_f32 v201, v201, v147
    v_mul_f32 v202, v202, v147
    v_mul_f32 v203, v203, v147
    v_cvt_pk_bf16_f32 v200, v200, v201
    v_cvt_pk_bf16_f32 v201, v202, v203
    ds_write_b64 v10, v[200:201] offset:256
    v_mfma_f32_16x16x32_bf16 v[196:199], v[116:119], v[180:183], 0
    v_mfma_f32_16x16x16_bf16 v[212:215], v[134:135], v[184:185], v[212:215]
    v_mul_f32 v204, v204, v147
    v_mul_f32 v205, v205, v147
    v_mul_f32 v206, v206, v147
    v_mul_f32 v207, v207, v147
    v_cvt_pk_bf16_f32 v204, v204, v205
    v_cvt_pk_bf16_f32 v205, v206, v207
    ds_write_b64 v10, v[204:205] offset:1280
    v_mfma_f32_16x16x32_bf16 v[200:203], v[120:123], v[180:183], 0
    v_mfma_f32_16x16x16_bf16 v[192:195], v[136:137], v[184:185], v[192:195]
    v_mul_f32 v208, v208, v147
    v_mul_f32 v209, v209, v147
    v_mul_f32 v210, v210, v147
    v_mul_f32 v211, v211, v147
    v_cvt_pk_bf16_f32 v208, v208, v209
    v_cvt_pk_bf16_f32 v209, v210, v211
    ds_write_b64 v10, v[208:209] offset:2304
    v_mfma_f32_16x16x32_bf16 v[204:207], v[124:127], v[180:183], 0
    v_mfma_f32_16x16x16_bf16 v[196:199], v[138:139], v[184:185], v[196:199]
    v_mul_f32 v212, v212, v147
    v_mul_f32 v213, v213, v147
    v_mul_f32 v214, v214, v147
    v_mul_f32 v215, v215, v147
    v_cvt_pk_bf16_f32 v212, v212, v213
    v_cvt_pk_bf16_f32 v213, v214, v215
    ds_write_b64 v10, v[212:213] offset:3328
    v_mfma_f32_16x16x16_bf16 v[200:203], v[140:141], v[184:185], v[200:203]
    v_mul_f32 v192, v192, v147
    v_mul_f32 v193, v193, v147
    v_mul_f32 v194, v194, v147
    v_mul_f32 v195, v195, v147
    v_cvt_pk_bf16_f32 v192, v192, v193
    v_cvt_pk_bf16_f32 v193, v194, v195
    ds_write_b64 v10, v[192:193] offset:4352
    v_mfma_f32_16x16x16_bf16 v[204:207], v[142:143], v[184:185], v[204:207]
    v_mul_f32 v196, v196, v147
    v_mul_f32 v197, v197, v147
    v_mul_f32 v198, v198, v147
    v_mul_f32 v199, v199, v147
    v_cvt_pk_bf16_f32 v196, v196, v197
    v_cvt_pk_bf16_f32 v197, v198, v199
    ds_write_b64 v10, v[196:197] offset:5376
    v_mul_f32 v200, v200, v147
    v_mul_f32 v201, v201, v147
    v_mul_f32 v202, v202, v147
    v_mul_f32 v203, v203, v147
    v_cvt_pk_bf16_f32 v200, v200, v201
    v_cvt_pk_bf16_f32 v201, v202, v203
    ds_write_b64 v10, v[200:201] offset:6400
    v_mul_f32 v204, v204, v147
    v_mul_f32 v205, v205, v147
    v_mul_f32 v206, v206, v147
    v_mul_f32 v207, v207, v147
    v_cvt_pk_bf16_f32 v204, v204, v205
    v_cvt_pk_bf16_f32 v205, v206, v207
    ds_write_b64 v10, v[204:205] offset:7424
    v_mov_b32 v16, 0
    v_mov_b32 v17, 0
    v_mov_b32 v18, 0
    v_mov_b32 v19, 0
    v_mov_b32 v20, 0
    v_mov_b32 v21, 0
    v_mov_b32 v22, 0
    v_mov_b32 v23, 0
    v_mov_b32 v24, 0
    v_mov_b32 v25, 0
    v_mov_b32 v26, 0
    v_mov_b32 v27, 0
    v_mov_b32 v28, 0
    v_mov_b32 v29, 0
    v_mov_b32 v30, 0
    v_mov_b32 v31, 0
    v_mov_b32 v32, 0
    v_mov_b32 v33, 0
    v_mov_b32 v34, 0
    v_mov_b32 v35, 0
    v_mov_b32 v36, 0
    v_mov_b32 v37, 0
    v_mov_b32 v38, 0
    v_mov_b32 v39, 0
    v_mov_b32 v40, 0
    v_mov_b32 v41, 0
    v_mov_b32 v42, 0
    v_mov_b32 v43, 0
    v_mov_b32 v44, 0
    v_mov_b32 v45, 0
    v_mov_b32 v46, 0
    v_mov_b32 v47, 0
    v_mov_b32 v48, 0
    v_mov_b32 v49, 0
    v_mov_b32 v50, 0
    v_mov_b32 v51, 0
    v_mov_b32 v52, 0
    v_mov_b32 v53, 0
    v_mov_b32 v54, 0
    v_mov_b32 v55, 0
    v_mov_b32 v56, 0
    v_mov_b32 v57, 0
    v_mov_b32 v58, 0
    v_mov_b32 v59, 0
    v_mov_b32 v60, 0
    v_mov_b32 v61, 0
    v_mov_b32 v62, 0
    v_mov_b32 v63, 0
    v_mov_b32 v64, 0
    v_mov_b32 v65, 0
    v_mov_b32 v66, 0
    v_mov_b32 v67, 0
    v_mov_b32 v68, 0
    v_mov_b32 v69, 0
    v_mov_b32 v70, 0
    v_mov_b32 v71, 0
    v_mov_b32 v72, 0
    v_mov_b32 v73, 0
    v_mov_b32 v74, 0
    v_mov_b32 v75, 0
    v_mov_b32 v76, 0
    v_mov_b32 v77, 0
    v_mov_b32 v78, 0
    v_mov_b32 v79, 0
    v_mov_b32 v80, 0
    v_mov_b32 v81, 0
    v_mov_b32 v82, 0
    v_mov_b32 v83, 0
    v_mov_b32 v84, 0
    v_mov_b32 v85, 0
    v_mov_b32 v86, 0
    v_mov_b32 v87, 0
    s_mov_b32 s79, 0
    s_mov_b32 s80, 0
    s_waitcnt lgkmcnt(0)
L_ao_loopc:
    s_cmp_lt_u32 s79, 14
    s_cbranch_scc1 L_ao_w18c
    s_waitcnt vmcnt(0)
    s_branch L_ao_wdc
L_ao_w18c:
    s_waitcnt vmcnt(18)
L_ao_wdc:
    s_barrier
    s_lshl_b32 s75, s79, 11
    v_add_u32 v10, s75, v229
    ds_read_b128 v[88:91], v10 offset:0
    ds_read_b128 v[92:95], v10 offset:256
    v_add_u32 v11, s80, v230
    ds_read_b64_tr_b16 v[96:97], v11
    ds_read_b64_tr_b16 v[98:99], v11 offset:4608
    v_add_u32 v11, s80, v231
    ds_read_b64_tr_b16 v[100:101], v11
    ds_read_b64_tr_b16 v[102:103], v11 offset:4608
    v_add_u32 v11, s80, v232
    ds_read_b64_tr_b16 v[104:105], v11
    ds_read_b64_tr_b16 v[106:107], v11 offset:4608
    v_add_u32 v11, s80, v233
    ds_read_b64_tr_b16 v[108:109], v11
    ds_read_b64_tr_b16 v[110:111], v11 offset:4608
    v_add_u32 v11, s80, v234
    ds_read_b64_tr_b16 v[112:113], v11
    ds_read_b64_tr_b16 v[114:115], v11 offset:4608
    v_add_u32 v11, s80, v235
    ds_read_b64_tr_b16 v[116:117], v11
    ds_read_b64_tr_b16 v[118:119], v11 offset:4608
    v_add_u32 v11, s80, v236
    ds_read_b64_tr_b16 v[120:121], v11
    ds_read_b64_tr_b16 v[122:123], v11 offset:4608
    v_add_u32 v11, s80, v237
    ds_read_b64_tr_b16 v[124:125], v11
    ds_read_b64_tr_b16 v[126:127], v11 offset:4608
    v_add_u32 v11, s80, v238
    ds_read_b64_tr_b16 v[128:129], v11
    ds_read_b64_tr_b16 v[130:131], v11 offset:4608
    s_waitcnt lgkmcnt(15)
    v_mfma_f32_16x16x32_bf16 v[16:19], v[96:99], v[88:91], v[16:19]
    v_mfma_f32_16x16x32_bf16 v[20:23], v[96:99], v[92:95], v[20:23]
    s_waitcnt lgkmcnt(14)
    v_mfma_f32_16x16x32_bf16 v[24:27], v[100:103], v[88:91], v[24:27]
    v_mfma_f32_16x16x32_bf16 v[28:31], v[100:103], v[92:95], v[28:31]
    s_waitcnt lgkmcnt(12)
    v_mfma_f32_16x16x32_bf16 v[32:35], v[104:107], v[88:91], v[32:35]
    v_mfma_f32_16x16x32_bf16 v[36:39], v[104:107], v[92:95], v[36:39]
    s_waitcnt lgkmcnt(10)
    v_mfma_f32_16x16x32_bf16 v[40:43], v[108:111], v[88:91], v[40:43]
    v_mfma_f32_16x16x32_bf16 v[44:47], v[108:111], v[92:95], v[44:47]
    s_waitcnt lgkmcnt(8)
    v_mfma_f32_16x16x32_bf16 v[48:51], v[112:115], v[88:91], v[48:51]
    v_mfma_f32_16x16x32_bf16 v[52:55], v[112:115], v[92:95], v[52:55]
    s_waitcnt lgkmcnt(6)
    v_mfma_f32_16x16x32_bf16 v[56:59], v[116:119], v[88:91], v[56:59]
    v_mfma_f32_16x16x32_bf16 v[60:63], v[116:119], v[92:95], v[60:63]
    s_waitcnt lgkmcnt(4)
    v_mfma_f32_16x16x32_bf16 v[64:67], v[120:123], v[88:91], v[64:67]
    v_mfma_f32_16x16x32_bf16 v[68:71], v[120:123], v[92:95], v[68:71]
    s_waitcnt lgkmcnt(2)
    v_mfma_f32_16x16x32_bf16 v[72:75], v[124:127], v[88:91], v[72:75]
    v_mfma_f32_16x16x32_bf16 v[76:79], v[124:127], v[92:95], v[76:79]
    s_waitcnt lgkmcnt(0)
    v_mfma_f32_16x16x32_bf16 v[80:83], v[128:131], v[88:91], v[80:83]
    v_mfma_f32_16x16x32_bf16 v[84:87], v[128:131], v[92:95], v[84:87]
    s_barrier
    s_add_u32 s75, s79, 3
    s_cmp_lt_u32 s75, 16
    s_cbranch_scc0 L_ao_ndc
    s_add_u32 m0, s77, 32768
    s_nop 0
    buffer_load_dwordx4 v240, s[64:67], s78 offen lds
    s_add_u32 m0, s77, 33792
    s_nop 0
    buffer_load_dwordx4 v241, s[64:67], s78 offen lds
    s_add_u32 m0, s77, 34816
    s_nop 0
    buffer_load_dwordx4 v242, s[64:67], s78 offen lds
    s_add_u32 m0, s77, 35840
    s_nop 0
    buffer_load_dwordx4 v243, s[64:67], s78 offen lds
    s_add_u32 m0, s77, 36864
    s_nop 0
    buffer_load_dwordx4 v244, s[64:67], s78 offen lds
    s_add_u32 m0, s77, 37888
    s_nop 0
    buffer_load_dwordx4 v245, s[64:67], s78 offen lds
    s_add_u32 m0, s77, 38912
    s_nop 0
    buffer_load_dwordx4 v246, s[64:67], s78 offen lds
    s_add_u32 m0, s77, 39936
    s_nop 0
    buffer_load_dwordx4 v247, s[64:67], s78 offen lds
    s_add_u32 m0, s77, 40960
    s_nop 0
    buffer_load_dwordx4 v248, s[64:67], s78 offen lds
    s_add_u32 s78, s78, 36864
    s_add_u32 s77, s77, 36864
    s_add_u32 s76, s82, 110592
    s_cmp_eq_u32 s77, s76
    s_cselect_b32 s77, s82, s77
L_ao_ndc:
    s_add_u32 s80, s80, 36864
    s_cmp_eq_u32 s80, 110592
    s_cselect_b32 s80, 0, s80
    s_add_u32 s79, s79, 1
    s_cmp_lt_u32 s79, 16
    s_cbranch_scc1 L_ao_loopc
    s_lshl_b32 s75, s73, 6
    s_add_u32 s75, s75, s72
    s_mul_i32 s75, s75, 73728
    s_mul_i32 s76, s16, 18432
    s_add_u32 s75, s75, s76
    s_add_u32 s60, s4, 0x5400000
    s_addc_u32 s61, s5, 0
    s_add_u32 s60, s60, s75
    s_addc_u32 s61, s61, 0
    s_nop 7
    v_add_u32 v10, 0, v229
    global_store_dwordx4 v10, v[16:19], s[60:61] offset:0 sc1
    global_store_dwordx4 v10, v[20:23], s[60:61] offset:256 sc1
    v_add_u32 v10, 2048, v229
    global_store_dwordx4 v10, v[24:27], s[60:61] offset:0 sc1
    global_store_dwordx4 v10, v[28:31], s[60:61] offset:256 sc1
    v_add_u32 v10, 4096, v229
    global_store_dwordx4 v10, v[32:35], s[60:61] offset:0 sc1
    global_store_dwordx4 v10, v[36:39], s[60:61] offset:256 sc1
    v_add_u32 v10, 6144, v229
    global_store_dwordx4 v10, v[40:43], s[60:61] offset:0 sc1
    global_store_dwordx4 v10, v[44:47], s[60:61] offset:256 sc1
    v_add_u32 v10, 8192, v229
    global_store_dwordx4 v10, v[48:51], s[60:61] offset:0 sc1
    global_store_dwordx4 v10, v[52:55], s[60:61] offset:256 sc1
    v_add_u32 v10, 10240, v229
    global_store_dwordx4 v10, v[56:59], s[60:61] offset:0 sc1
    global_store_dwordx4 v10, v[60:63], s[60:61] offset:256 sc1
    v_add_u32 v10, 12288, v229
    global_store_dwordx4 v10, v[64:67], s[60:61] offset:0 sc1
    global_store_dwordx4 v10, v[68:71], s[60:61] offset:256 sc1
    v_add_u32 v10, 14336, v229
    global_store_dwordx4 v10, v[72:75], s[60:61] offset:0 sc1
    global_store_dwordx4 v10, v[76:79], s[60:61] offset:256 sc1
    v_add_u32 v10, 16384, v229
    global_store_dwordx4 v10, v[80:83], s[60:61] offset:0 sc1
    global_store_dwordx4 v10, v[84:87], s[60:61] offset:256 sc1
    s_mov_b32 s42, s72
    s_mov_b32 s43, 0x010101
    s_waitcnt vmcnt(0)
    s_barrier
    s_cmp_lg_u32 s16, 0
    s_cbranch_scc1 L_wk_ar1c
    s_add_u32 s10, s4, 0x5320000
    s_addc_u32 s11, s5, 0
    s_lshl_b32 s18, s42, 2
    v_mov_b32 v10, s18
    v_mov_b32 v11, s43
    s_mov_b64 exec, 1
    global_atomic_add v12, v10, v11, s[10:11] sc0 sc1
    s_waitcnt vmcnt(0)
    v_mov_b32 v10, 163836
    ds_write_b32 v10, v12
    s_waitcnt lgkmcnt(0)
    s_mov_b64 exec, -1
L_wk_ar1c:
    s_barrier
    v_mov_b32 v10, 163836
    ds_read_b32 v12, v10
    s_waitcnt lgkmcnt(0)
    v_readfirstlane_b32 s45, v12
    s_add_u32 s45, s45, s43
    s_load_dwordx2 s[28:29], s[0:1], 96
    s_waitcnt lgkmcnt(0)
    s_mov_b32 s46, 0
L_wk_clc:
    s_lshl_b32 s18, s46, 3
    s_lshr_b32 s19, s43, s18
    s_and_b32 s19, s19, 0xff
    s_cmp_eq_u32 s19, 0
    s_cbranch_scc1 L_wk_cnc
    s_lshr_b32 s19, s45, s18
    s_and_b32 s19, s19, 0xff
    s_cmp_lg_u32 s19, 10
    s_cbranch_scc1 L_wk_cnc
    v_and_b32 v2, 31, v1
    v_lshrrev_b32 v3, 5, v1
    s_lshl_b32 s38, s42, 7
    s_add_u32 s30, s4, 0x4d80000
    s_addc_u32 s31, s5, 0
    s_add_u32 s30, s30, s38
    s_addc_u32 s31, s31, 0
    v_lshlrev_b32 v4, 2, v2
    global_load_dword v5, v4, s[30:31] sc1
    s_mul_i32 s38, s42, 73728
    s_add_u32 s32, s4, 0x4400000
    s_addc_u32 s33, s5, 0
    s_add_u32 s32, s32, s38
    s_addc_u32 s33, s33, 0
    s_add_u32 s34, s4, 0x5400000
    s_addc_u32 s35, s5, 0
    s_add_u32 s34, s34, s38
    s_addc_u32 s35, s35, 0
    s_mul_i32 s38, s46, 24
    s_lshl_b32 s39, s16, 1
    s_add_u32 s38, s38, s39
    v_add_u32 v6, s38, v3
    s_lshl_b32 s39, s42, 5
    v_add_u32 v7, s39, v2
    v_mul_u32_u24 v7, 1152, v7
    v_lshlrev_b32 v8, 10, v6
    v_lshl_add_u32 v8, v2, 4, v8
    global_load_dwordx4 v[12:15], v8, s[32:33] sc1
    global_load_dwordx4 v[16:19], v8, s[32:33] offset:512 sc1
    s_add_u32 s36, s32, 0x480000
    s_addc_u32 s37, s33, 0
    global_load_dwordx4 v[84:87], v8, s[36:37] sc1
    global_load_dwordx4 v[88:91], v8, s[36:37] offset:512 sc1
    s_mov_b64 s[36:37], s[34:35]
    global_load_dwordx4 v[20:23], v8, s[36:37] sc1
    global_load_dwordx4 v[24:27], v8, s[36:37] offset:512 sc1
    s_add_u32 s36, s36, 0x480000
    s_addc_u32 s37, s37, 0
    global_load_dwordx4 v[28:31], v8, s[36:37] sc1
    global_load_dwordx4 v[32:35], v8, s[36:37] offset:512 sc1
    s_add_u32 s36, s36, 0x480000
    s_addc_u32 s37, s37, 0
    global_load_dwordx4 v[36:39], v8, s[36:37] sc1
    global_load_dwordx4 v[40:43], v8, s[36:37] offset:512 sc1
    s_add_u32 s36, s36, 0x480000
    s_addc_u32 s37, s37, 0
    global_load_dwordx4 v[44:47], v8, s[36:37] sc1
    global_load_dwordx4 v[48:51], v8, s[36:37] offset:512 sc1
    s_add_u32 s36, s36, 0x480000
    s_addc_u32 s37, s37, 0
    global_load_dwordx4 v[52:55], v8, s[36:37] sc1
    global_load_dwordx4 v[56:59], v8, s[36:37] offset:512 sc1
    s_add_u32 s36, s36, 0x480000
    s_addc_u32 s37, s37, 0
    global_load_dwordx4 v[60:63], v8, s[36:37] sc1
    global_load_dwordx4 v[64:67], v8, s[36:37] offset:512 sc1
    s_add_u32 s36, s36, 0x480000
    s_addc_u32 s37, s37, 0
    global_load_dwordx4 v[68:71], v8, s[36:37] sc1
    global_load_dwordx4 v[72:75], v8, s[36:37] offset:512 sc1
    s_add_u32 s36, s36, 0x480000
    s_addc_u32 s37, s37, 0
    global_load_dwordx4 v[76:79], v8, s[36:37] sc1
    global_load_dwordx4 v[80:83], v8, s[36:37] offset:512 sc1
    s_add_u32 s36, s36, 0x480000
    s_addc_u32 s37, s37, 0
    v_add_u32 v6, 8, v6
    v_lshlrev_b32 v8, 10, v6
    v_lshl_add_u32 v8, v2, 4, v8
    global_load_dwordx4 v[92:95], v8, s[32:33] sc1
    global_load_dwordx4 v[96:99], v8, s[32:33] offset:512 sc1
    s_add_u32 s36, s32, 0x480000
    s_addc_u32 s37, s33, 0
    global_load_dwordx4 v[164:167], v8, s[36:37] sc1
    global_load_dwordx4 v[168:171], v8, s[36:37] offset:512 sc1
    s_mov_b64 s[36:37], s[34:35]
    global_load_dwordx4 v[100:103], v8, s[36:37] sc1
    global_load_dwordx4 v[104:107], v8, s[36:37] offset:512 sc1
    s_add_u32 s36, s36, 0x480000
    s_addc_u32 s37, s37, 0
    global_load_dwordx4 v[108:111], v8, s[36:37] sc1
    global_load_dwordx4 v[112:115], v8, s[36:37] offset:512 sc1
    s_add_u32 s36, s36, 0x480000
    s_addc_u32 s37, s37, 0
    global_load_dwordx4 v[116:119], v8, s[36:37] sc1
    global_load_dwordx4 v[120:123], v8, s[36:37] offset:512 sc1
    s_add_u32 s36, s36, 0x480000
    s_addc_u32 s37, s37, 0
    global_load_dwordx4 v[124:127], v8, s[36:37] sc1
    global_load_dwordx4 v[128:131], v8, s[36:37] offset:512 sc1
    s_add_u32 s36, s36, 0x480000
    s_addc_u32 s37, s37, 0
    global_load_dwordx4 v[132:135], v8, s[36:37] sc1
    global_load_dwordx4 v[136:139], v8, s[36:37] offset:512 sc1
    s_add_u32 s36, s36, 0x480000
    s_addc_u32 s37, s37, 0
    global_load_dwordx4 v[140:143], v8, s[36:37] sc1
    global_load_dwordx4 v[144:147], v8, s[36:37] offset:512 sc1
    s_add_u32 s36, s36, 0x480000
    s_addc_u32 s37, s37, 0
    global_load_dwordx4 v[148:151], v8, s[36:37] sc1
    global_load_dwordx4 v[152:155], v8, s[36:37] offset:512 sc1
    s_add_u32 s36, s36, 0x480000
    s_addc_u32 s37, s37, 0
    global_load_dwordx4 v[156:159], v8, s[36:37] sc1
    global_load_dwordx4 v[160:163], v8, s[36:37] offset:512 sc1
    s_add_u32 s36, s36, 0x480000
    s_addc_u32 s37, s37, 0
    v_add_u32 v6, 8, v6
    v_lshlrev_b32 v8, 10, v6
    v_lshl_add_u32 v8, v2, 4, v8
    global_load_dwordx4 v[172:175], v8, s[32:33] sc1
    global_load_dwordx4 v[176:179], v8, s[32:33] offset:512 sc1
    s_add_u32 s36, s32, 0x480000
    s_addc_u32 s37, s33, 0
    global_load_dwordx4 v[244:247], v8, s[36:37] sc1
    global_load_dwordx4 v[248:251], v8, s[36:37] offset:512 sc1
    s_mov_b64 s[36:37], s[34:35]
    global_load_dwordx4 v[180:183], v8, s[36:37] sc1
    global_load_dwordx4 v[184:187], v8, s[36:37] offset:512 sc1
    s_add_u32 s36, s36, 0x480000
    s_addc_u32 s37, s37, 0
    global_load_dwordx4 v[188:191], v8, s[36:37] sc1
    global_load_dwordx4 v[192:195], v8, s[36:37] offset:512 sc1
    s_add_u32 s36, s36, 0x480000
    s_addc_u32 s37, s37, 0
    global_load_dwordx4 v[196:199], v8, s[36:37] sc1
    global_load_dwordx4 v[200:203], v8, s[36:37] offset:512 sc1
    s_add_u32 s36, s36, 0x480000
    s_addc_u32 s37, s37, 0
    global_load_dwordx4 v[204:207], v8, s[36:37] sc1
    global_load_dwordx4 v[208:211], v8, s[36:37] offset:512 sc1
    s_add_u32 s36, s36, 0x480000
    s_addc_u32 s37, s37, 0
    global_load_dwordx4 v[212:215], v8, s[36:37] sc1
    global_load_dwordx4 v[216:219], v8, s[36:37] offset:512 sc1
    s_add_u32 s36, s36, 0x480000
    s_addc_u32 s37, s37, 0
    global_load_dwordx4 v[220:223], v8, s[36:37] sc1
    global_load_dwordx4 v[224:227], v8, s[36:37] offset:512 sc1
    s_add_u32 s36, s36, 0x480000
    s_addc_u32 s37, s37, 0
    global_load_dwordx4 v[228:231], v8, s[36:37] sc1
    global_load_dwordx4 v[232:235], v8, s[36:37] offset:512 sc1
    s_add_u32 s36, s36, 0x480000
    s_addc_u32 s37, s37, 0
    global_load_dwordx4 v[236:239], v8, s[36:37] sc1
    global_load_dwordx4 v[240:243], v8, s[36:37] offset:512 sc1
    s_add_u32 s36, s36, 0x480000
    s_addc_u32 s37, s37, 0
    v_add_u32 v6, 8, v6
    v_subrev_u32 v6, 24, v6
    s_waitcnt vmcnt(60)
    v_sub_f32 v5, 1.0, v5
    s_waitcnt vmcnt(40)
    v_add_f32 v12, v12, v84
    v_add_f32 v13, v13, v85
    v_add_f32 v14, v14, v86
    v_add_f32 v15, v15, v87
    v_add_f32 v16, v16, v88
    v_add_f32 v17, v17, v89
    v_add_f32 v18, v18, v90
    v_add_f32 v19, v19, v91
    v_mul_f32 v12, v12, v5
    v_mul_f32 v13, v13, v5
    v_mul_f32 v14, v14, v5
    v_mul_f32 v15, v15, v5
    v_mul_f32 v16, v16, v5
    v_mul_f32 v17, v17, v5
    v_mul_f32 v18, v18, v5
    v_mul_f32 v19, v19, v5
    v_add_f32 v12, v12, v20
    v_add_f32 v13, v13, v21
    v_add_f32 v14, v14, v22
    v_add_f32 v15, v15, v23
    v_add_f32 v16, v16, v24
    v_add_f32 v17, v17, v25
    v_add_f32 v18, v18, v26
    v_add_f32 v19, v19, v27
    v_add_f32 v12, v12, v28
    v_add_f32 v13, v13, v29
    v_add_f32 v14, v14, v30
    v_add_f32 v15, v15, v31
    v_add_f32 v16, v16, v32
    v_add_f32 v17, v17, v33
    v_add_f32 v18, v18, v34
    v_add_f32 v19, v19, v35
    v_add_f32 v12, v12, v36
    v_add_f32 v13, v13, v37
    v_add_f32 v14, v14, v38
    v_add_f32 v15, v15, v39
    v_add_f32 v16, v16, v40
    v_add_f32 v17, v17, v41
    v_add_f32 v18, v18, v42
    v_add_f32 v19, v19, v43
    v_add_f32 v12, v12, v44
    v_add_f32 v13, v13, v45
    v_add_f32 v14, v14, v46
    v_add_f32 v15, v15, v47
    v_add_f32 v16, v16, v48
    v_add_f32 v17, v17, v49
    v_add_f32 v18, v18, v50
    v_add_f32 v19, v19, v51
    v_add_f32 v12, v12, v52
    v_add_f32 v13, v13, v53
    v_add_f32 v14, v14, v54
    v_add_f32 v15, v15, v55
    v_add_f32 v16, v16, v56
    v_add_f32 v17, v17, v57
    v_add_f32 v18, v18, v58
    v_add_f32 v19, v19, v59
    v_add_f32 v12, v12, v60
    v_add_f32 v13, v13, v61
    v_add_f32 v14, v14, v62
    v_add_f32 v15, v15, v63
    v_add_f32 v16, v16, v64
    v_add_f32 v17, v17, v65
    v_add_f32 v18, v18, v66
    v_add_f32 v19, v19, v67
    v_add_f32 v12, v12, v68
    v_add_f32 v13, v13, v69
    v_add_f32 v14, v14, v70
    v_add_f32 v15, v15, v71
    v_add_f32 v16, v16, v72
    v_add_f32 v17, v17, v73
    v_add_f32 v18, v18, v74
    v_add_f32 v19, v19, v75
    v_add_f32 v12, v12, v76
    v_add_f32 v13, v13, v77
    v_add_f32 v14, v14, v78
    v_add_f32 v15, v15, v79
    v_add_f32 v16, v16, v80
    v_add_f32 v17, v17, v81
    v_add_f32 v18, v18, v82
    v_add_f32 v19, v19, v83
    v_cvt_pk_bf16_f32 v20, v12, v13
    v_cvt_pk_bf16_f32 v21, v14, v15
    v_cvt_pk_bf16_f32 v22, v16, v17
    v_cvt_pk_bf16_f32 v23, v18, v19
    v_lshl_add_u32 v8, v6, 4, v7
    global_store_dwordx4 v8, v[20:23], s[28:29]
    v_add_u32 v6, 8, v6
    s_waitcnt vmcnt(21)
    v_add_f32 v92, v92, v164
    v_add_f32 v93, v93, v165
    v_add_f32 v94, v94, v166
    v_add_f32 v95, v95, v167
    v_add_f32 v96, v96, v168
    v_add_f32 v97, v97, v169
    v_add_f32 v98, v98, v170
    v_add_f32 v99, v99, v171
    v_mul_f32 v92, v92, v5
    v_mul_f32 v93, v93, v5
    v_mul_f32 v94, v94, v5
    v_mul_f32 v95, v95, v5
    v_mul_f32 v96, v96, v5
    v_mul_f32 v97, v97, v5
    v_mul_f32 v98, v98, v5
    v_mul_f32 v99, v99, v5
    v_add_f32 v92, v92, v100
    v_add_f32 v93, v93, v101
    v_add_f32 v94, v94, v102
    v_add_f32 v95, v95, v103
    v_add_f32 v96, v96, v104
    v_add_f32 v97, v97, v105
    v_add_f32 v98, v98, v106
    v_add_f32 v99, v99, v107
    v_add_f32 v92, v92, v108
    v_add_f32 v93, v93, v109
    v_add_f32 v94, v94, v110
    v_add_f32 v95, v95, v111
    v_add_f32 v96, v96, v112
    v_add_f32 v97, v97, v113
    v_add_f32 v98, v98, v114
    v_add_f32 v99, v99, v115
    v_add_f32 v92, v92, v116
    v_add_f32 v93, v93, v117
    v_add_f32 v94, v94, v118
    v_add_f32 v95, v95, v119
    v_add_f32 v96, v96, v120
    v_add_f32 v97, v97, v121
    v_add_f32 v98, v98, v122
    v_add_f32 v99, v99, v123
    v_add_f32 v92, v92, v124
    v_add_f32 v93, v93, v125
    v_add_f32 v94, v94, v126
    v_add_f32 v95, v95, v127
    v_add_f32 v96, v96, v128
    v_add_f32 v97, v97, v129
    v_add_f32 v98, v98, v130
    v_add_f32 v99, v99, v131
    v_add_f32 v92, v92, v132
    v_add_f32 v93, v93, v133
    v_add_f32 v94, v94, v134
    v_add_f32 v95, v95, v135
    v_add_f32 v96, v96, v136
    v_add_f32 v97, v97, v137
    v_add_f32 v98, v98, v138
    v_add_f32 v99, v99, v139
    v_add_f32 v92, v92, v140
    v_add_f32 v93, v93, v141
    v_add_f32 v94, v94, v142
    v_add_f32 v95, v95, v143
    v_add_f32 v96, v96, v144
    v_add_f32 v97, v97, v145
    v_add_f32 v98, v98, v146
    v_add_f32 v99, v99, v147
    v_add_f32 v92, v92, v148
    v_add_f32 v93, v93, v149
    v_add_f32 v94, v94, v150
    v_add_f32 v95, v95, v151
    v_add_f32 v96, v96, v152
    v_add_f32 v97, v97, v153
    v_add_f32 v98, v98, v154
    v_add_f32 v99, v99, v155
    v_add_f32 v92, v92, v156
    v_add_f32 v93, v93, v157
    v_add_f32 v94, v94, v158
    v_add_f32 v95, v95, v159
    v_add_f32 v96, v96, v160
    v_add_f32 v97, v97, v161
    v_add_f32 v98, v98, v162
    v_add_f32 v99, v99, v163
    v_cvt_pk_bf16_f32 v100, v92, v93
    v_cvt_pk_bf16_f32 v101, v94, v95
    v_cvt_pk_bf16_f32 v102, v96, v97
    v_cvt_pk_bf16_f32 v103, v98, v99
    v_lshl_add_u32 v8, v6, 4, v7
    global_store_dwordx4 v8, v[100:103], s[28:29]
    v_add_u32 v6, 8, v6
    s_waitcnt vmcnt(2)
    v_add_f32 v172, v172, v244
    v_add_f32 v173, v173, v245
    v_add_f32 v174, v174, v246
    v_add_f32 v175, v175, v247
    v_add_f32 v176, v176, v248
    v_add_f32 v177, v177, v249
    v_add_f32 v178, v178, v250
    v_add_f32 v179, v179, v251
    v_mul_f32 v172, v172, v5
    v_mul_f32 v173, v173, v5
    v_mul_f32 v174, v174, v5
    v_mul_f32 v175, v175, v5
    v_mul_f32 v176, v176, v5
    v_mul_f32 v177, v177, v5
    v_mul_f32 v178, v178, v5
    v_mul_f32 v179, v179, v5
    v_add_f32 v172, v172, v180
    v_add_f32 v173, v173, v181
    v_add_f32 v174, v174, v182
    v_add_f32 v175, v175, v183
    v_add_f32 v176, v176, v184
    v_add_f32 v177, v177, v185
    v_add_f32 v178, v178, v186
    v_add_f32 v179, v179, v187
    v_add_f32 v172, v172, v188
    v_add_f32 v173, v173, v189
    v_add_f32 v174, v174, v190
    v_add_f32 v175, v175, v191
    v_add_f32 v176, v176, v192
    v_add_f32 v177, v177, v193
    v_add_f32 v178, v178, v194
    v_add_f32 v179, v179, v195
    v_add_f32 v172, v172, v196
    v_add_f32 v173, v173, v197
    v_add_f32 v174, v174, v198
    v_add_f32 v175, v175, v199
    v_add_f32 v176, v176, v200
    v_add_f32 v177, v177, v201
    v_add_f32 v178, v178, v202
    v_add_f32 v179, v179, v203
    v_add_f32 v172, v172, v204
    v_add_f32 v173, v173, v205
    v_add_f32 v174, v174, v206
    v_add_f32 v175, v175, v207
    v_add_f32 v176, v176, v208
    v_add_f32 v177, v177, v209
    v_add_f32 v178, v178, v210
    v_add_f32 v179, v179, v211
    v_add_f32 v172, v172, v212
    v_add_f32 v173, v173, v213
    v_add_f32 v174, v174, v214
    v_add_f32 v175, v175, v215
    v_add_f32 v176, v176, v216
    v_add_f32 v177, v177, v217
    v_add_f32 v178, v178, v218
    v_add_f32 v179, v179, v219
    v_add_f32 v172, v172, v220
    v_add_f32 v173, v173, v221
    v_add_f32 v174, v174, v222
    v_add_f32 v175, v175, v223
    v_add_f32 v176, v176, v224
    v_add_f32 v177, v177, v225
    v_add_f32 v178, v178, v226
    v_add_f32 v179, v179, v227
    v_add_f32 v172, v172, v228
    v_add_f32 v173, v173, v229
    v_add_f32 v174, v174, v230
    v_add_f32 v175, v175, v231
    v_add_f32 v176, v176, v232
    v_add_f32 v177, v177, v233
    v_add_f32 v178, v178, v234
    v_add_f32 v179, v179, v235
    v_add_f32 v172, v172, v236
    v_add_f32 v173, v173, v237
    v_add_f32 v174, v174, v238
    v_add_f32 v175, v175, v239
    v_add_f32 v176, v176, v240
    v_add_f32 v177, v177, v241
    v_add_f32 v178, v178, v242
    v_add_f32 v179, v179, v243
    v_cvt_pk_bf16_f32 v180, v172, v173
    v_cvt_pk_bf16_f32 v181, v174, v175
    v_cvt_pk_bf16_f32 v182, v176, v177
    v_cvt_pk_bf16_f32 v183, v178, v179
    v_lshl_add_u32 v8, v6, 4, v7
    global_store_dwordx4 v8, v[180:183], s[28:29]
    v_add_u32 v6, 8, v6
L_wk_cnc:
    s_add_u32 s46, s46, 1
    s_cmp_lt_u32 s46, 3
    s_cbranch_scc1 L_wk_clc
    s_barrier
    s_branch L_wk_next
L_wk_attf:
    s_sub_u32 s18, s17, 1232
    s_mul_i32 s72, s18, 43691
    s_lshr_b32 s72, s72, 20
    s_mul_i32 s19, s72, 24
    s_sub_u32 s18, s18, s19
    s_add_u32 s72, s72, 54
    s_mul_i32 s73, s18, 21846
    s_lshr_b32 s73, s73, 16
    s_mul_i32 s19, s73, 3
    s_sub_u32 s74, s18, s19
    v_lshlrev_b32 v2, 4, v1
    v_and_b32 v3, 15, v1
    v_lshrrev_b32 v4, 4, v1
    s_mul_i32 s75, s16, 192
    s_add_u32 s75, s75, 0
    v_add_u32 v10, s75, v1
    v_mul_u32_u24 v11, 2731, v10
    v_lshrrev_b32 v11, 16, v11
    v_mul_u32_u24 v12, 24, v11
    v_sub_u32 v10, v10, v12
    v_bfe_u32 v12, v11, 1, 1
    v_bfe_u32 v13, v11, 3, 1
    v_lshl_add_u32 v12, v13, 1, v12
    v_lshlrev_b32 v12, 1, v12
    v_xor_b32 v10, v10, v12
    v_mul_u32_u24 v11, 1152, v11
    v_lshl_add_u32 v240, v10, 4, v11
    s_mul_i32 s75, s16, 192
    s_add_u32 s75, s75, 64
    v_add_u32 v10, s75, v1
    v_mul_u32_u24 v11, 2731, v10
    v_lshrrev_b32 v11, 16, v11
    v_mul_u32_u24 v12, 24, v11
    v_sub_u32 v10, v10, v12
    v_bfe_u32 v12, v11, 1, 1
    v_bfe_u32 v13, v11, 3, 1
    v_lshl_add_u32 v12, v13, 1, v12
    v_lshlrev_b32 v12, 1, v12
    v_xor_b32 v10, v10, v12
    v_mul_u32_u24 v11, 1152, v11
    v_lshl_add_u32 v241, v10, 4, v11
    s_mul_i32 s75, s16, 192
    s_add_u32 s75, s75, 128
    v_add_u32 v10, s75, v1
    v_mul_u32_u24 v11, 2731, v10
    v_lshrrev_b32 v11, 16, v11
    v_mul_u32_u24 v12, 24, v11
    v_sub_u32 v10, v10, v12
    v_bfe_u32 v12, v11, 1, 1
    v_bfe_u32 v13, v11, 3, 1
    v_lshl_add_u32 v12, v13, 1, v12
    v_lshlrev_b32 v12, 1, v12
    v_xor_b32 v10, v10, v12
    v_mul_u32_u24 v11, 1152, v11
    v_lshl_add_u32 v242, v10, 4, v11
    v_lshrrev_b32 v10, 2, v3
    v_lshl_add_u32 v11, v4, 3, v10
    v_mul_u32_u24 v11, 384, v11
    v_and_b32 v12, 3, v3
    v_lshl_add_u32 v11, v12, 3, v11
    v_add_u32 v11, 32768, v11
    v_lshrrev_b32 v12, 1, v10
    v_and_b32 v13, 1, v4
    v_lshl_add_u32 v12, v13, 1, v12
    s_mul_i32 s75, s16, 3
    s_add_u32 s76, s75, 0
    v_xor_b32 v13, s76, v12
    v_lshl_add_u32 v230, v13, 5, v11
    s_add_u32 s76, s75, 1
    v_xor_b32 v13, s76, v12
    v_lshl_add_u32 v231, v13, 5, v11
    s_add_u32 s76, s75, 2
    v_xor_b32 v13, s76, v12
    v_lshl_add_u32 v232, v13, 5, v11
    v_lshlrev_b32 v229, 9, v4
    v_lshl_add_u32 v229, v3, 4, v229
    s_mov_b32 s68, -1
    s_mov_b32 s69, 0
    s_mov_b32 s81, 0x3e0293ee
    s_load_dwordx2 s[70:71], s[0:1], 40
    s_waitcnt lgkmcnt(0)
    s_mov_b32 s64, s70
    s_mov_b32 s65, s71
    s_mov_b32 s66, 4718592
    s_mov_b32 s67, 0x00020000
    s_mul_i32 s78, s73, 589824
    s_mul_i32 s75, s74, 384
    s_add_u32 s78, s78, s75
    s_mul_i32 s77, s16, 3072
    s_add_u32 m0, s77, 32768
    s_nop 0
    buffer_load_dwordx4 v240, s[64:67], s78 offen lds
    s_add_u32 m0, s77, 33792
    s_nop 0
    buffer_load_dwordx4 v241, s[64:67], s78 offen lds
    s_add_u32 m0, s77, 34816
    s_nop 0
    buffer_load_dwordx4 v242, s[64:67], s78 offen lds
    s_add_u32 s78, s78, 36864
    s_add_u32 m0, s77, 45056
    s_nop 0
    buffer_load_dwordx4 v240, s[64:67], s78 offen lds
    s_add_u32 m0, s77, 46080
    s_nop 0
    buffer_load_dwordx4 v241, s[64:67], s78 offen lds
    s_add_u32 m0, s77, 47104
    s_nop 0
    buffer_load_dwordx4 v242, s[64:67], s78 offen lds
    s_add_u32 s78, s78, 36864
    s_add_u32 m0, s77, 57344
    s_nop 0
    buffer_load_dwordx4 v240, s[64:67], s78 offen lds
    s_add_u32 m0, s77, 58368
    s_nop 0
    buffer_load_dwordx4 v241, s[64:67], s78 offen lds
    s_add_u32 m0, s77, 59392
    s_nop 0
    buffer_load_dwordx4 v242, s[64:67], s78 offen lds
    s_add_u32 s78, s78, 36864
    s_add_u32 m0, s77, 69632
    s_nop 0
    buffer_load_dwordx4 v240, s[64:67], s78 offen lds
    s_add_u32 m0, s77, 70656
    s_nop 0
    buffer_load_dwordx4 v241, s[64:67], s78 offen lds
    s_add_u32 m0, s77, 71680
    s_nop 0
    buffer_load_dwordx4 v242, s[64:67], s78 offen lds
    s_add_u32 s78, s78, 36864
    s_add_u32 m0, s77, 81920
    s_nop 0
    buffer_load_dwordx4 v240, s[64:67], s78 offen lds
    s_add_u32 m0, s77, 82944
    s_nop 0
    buffer_load_dwordx4 v241, s[64:67], s78 offen lds
    s_add_u32 m0, s77, 83968
    s_nop 0
    buffer_load_dwordx4 v242, s[64:67], s78 offen lds
    s_add_u32 s78, s78, 36864
    s_add_u32 m0, s77, 94208
    s_nop 0
    buffer_load_dwordx4 v240, s[64:67], s78 offen lds
    s_add_u32 m0, s77, 95232
    s_nop 0
    buffer_load_dwordx4 v241, s[64:67], s78 offen lds
    s_add_u32 m0, s77, 96256
    s_nop 0
    buffer_load_dwordx4 v242, s[64:67], s78 offen lds
    s_add_u32 s78, s78, 36864
    s_add_u32 m0, s77, 106496
    s_nop 0
    buffer_load_dwordx4 v240, s[64:67], s78 offen lds
    s_add_u32 m0, s77, 107520
    s_nop 0
    buffer_load_dwordx4 v241, s[64:67], s78 offen lds
    s_add_u32 m0, s77, 108544
    s_nop 0
    buffer_load_dwordx4 v242, s[64:67], s78 offen lds
    s_add_u32 s78, s78, 36864
    s_add_u32 m0, s77, 118784
    s_nop 0
    buffer_load_dwordx4 v240, s[64:67], s78 offen lds
    s_add_u32 m0, s77, 119808
    s_nop 0
    buffer_load_dwordx4 v241, s[64:67], s78 offen lds
    s_add_u32 m0, s77, 120832
    s_nop 0
    buffer_load_dwordx4 v242, s[64:67], s78 offen lds
    s_add_u32 s78, s78, 36864
    s_add_u32 m0, s77, 131072
    s_nop 0
    buffer_load_dwordx4 v240, s[64:67], s78 offen lds
    s_add_u32 m0, s77, 132096
    s_nop 0
    buffer_load_dwordx4 v241, s[64:67], s78 offen lds
    s_add_u32 m0, s77, 133120
    s_nop 0
    buffer_load_dwordx4 v242, s[64:67], s78 offen lds
    s_add_u32 s78, s78, 36864
    s_add_u32 m0, s77, 143360
    s_nop 0
    buffer_load_dwordx4 v240, s[64:67], s78 offen lds
    s_add_u32 m0, s77, 144384
    s_nop 0
    buffer_load_dwordx4 v241, s[64:67], s78 offen lds
    s_add_u32 m0, s77, 145408
    s_nop 0
    buffer_load_dwordx4 v242, s[64:67], s78 offen lds
    s_add_u32 s78, s78, 36864
    s_cmp_lg_u32 s16, 0
    s_cbranch_scc1 L_wk_ad0f
    v_mov_b32 v10, 32
    s_mov_b32 s20, 0
L_wk_a0f_p:
    global_load_dword v11, v10, s[6:7] sc1
    s_waitcnt vmcnt(0)
    v_readfirstlane_b32 s18, v11
    s_add_u32 s20, s20, 1
    s_cmp_gt_u32 s20, 600000
    s_cbranch_scc1 L_wk_fail
    s_cmp_ge_u32 s18, 32
    s_cbranch_scc1 L_wk_a0f_d
    s_sleep 4
    s_branch L_wk_a0f_p
L_wk_a0f_d:
    v_mov_b32 v10, 40
    s_mov_b32 s20, 0
L_wk_a1f_p:
    global_load_dword v11, v10, s[6:7] sc1
    s_waitcnt vmcnt(0)
    v_readfirstlane_b32 s18, v11
    s_add_u32 s20, s20, 1
    s_cmp_gt_u32 s20, 600000
    s_cbranch_scc1 L_wk_fail
    s_cmp_ge_u32 s18, 32
    s_cbranch_scc1 L_wk_a1f_d
    s_sleep 4
    s_branch L_wk_a1f_p
L_wk_a1f_d:
    s_lshr_b32 s21, s72, 3
    s_lshl_b32 s21, s21, 2
    s_add_u32 s21, s21, 128
    v_mov_b32 v10, s21
    s_mov_b32 s20, 0
L_wk_a2f_p:
    global_load_dword v11, v10, s[6:7] sc1
    s_waitcnt vmcnt(0)
    v_readfirstlane_b32 s18, v11
    s_add_u32 s20, s20, 1
    s_cmp_gt_u32 s20, 600000
    s_cbranch_scc1 L_wk_fail
    s_cmp_ge_u32 s18, 16
    s_cbranch_scc1 L_wk_a2f_d
    s_sleep 4
    s_branch L_wk_a2f_p
L_wk_a2f_d:
    s_sub_u32 s21, s21, 64
    v_mov_b32 v10, s21
    s_mov_b32 s20, 0
L_wk_a4f_p:
    global_load_dword v11, v10, s[6:7] sc1
    s_waitcnt vmcnt(0)
    v_readfirstlane_b32 s18, v11
    s_add_u32 s20, s20, 1
    s_cmp_gt_u32 s20, 600000
    s_cbranch_scc1 L_wk_fail
    s_cmp_ge_u32 s18, 32
    s_cbranch_scc1 L_wk_a4f_d
    s_sleep 4
    s_branch L_wk_a4f_p
L_wk_a4f_d:
    v_mov_b32 v10, 64
    s_mov_b32 s20, 0
L_wk_a6f_p:
    global_load_dword v11, v10, s[6:7] sc1
    s_waitcnt vmcnt(0)
    v_readfirstlane_b32 s18, v11
    s_add_u32 s20, s20, 1
    s_cmp_gt_u32 s20, 600000
    s_cbranch_scc1 L_wk_fail
    s_cmp_ge_u32 s18, 64
    s_cbranch_scc1 L_wk_a6f_d
    s_sleep 4
    s_branch L_wk_a6f_p
L_wk_a6f_d:
    v_mov_b32 v10, 48
    s_mov_b32 s20, 0
L_wk_a5f_p:
    global_load_dword v11, v10, s[6:7] sc1
    s_waitcnt vmcnt(0)
    v_readfirstlane_b32 s18, v11
    s_add_u32 s20, s20, 1
    s_cmp_gt_u32 s20, 600000
    s_cbranch_scc1 L_wk_fail
    s_cmp_ge_u32 s18, 64
    s_cbranch_scc1 L_wk_a5f_d
    s_sleep 4
    s_branch L_wk_a5f_p
L_wk_a5f_d:
L_wk_ad0f:
    s_barrier
    s_lshl_b32 s75, s72, 5
    s_lshl_b32 s76, s73, 2
    s_add_u32 s75, s75, s76
    s_add_u32 s75, s75, s16
    s_lshl_b32 s76, s75, 13
    s_add_u32 s48, s4, 0x2000000
    s_addc_u32 s49, s5, 0
    s_add_u32 s48, s48, s76
    s_addc_u32 s49, s49, 0
    s_add_u32 s50, s4, 0x0
    s_addc_u32 s51, s5, 0
    s_add_u32 s50, s50, s76
    s_addc_u32 s51, s51, 0
    s_add_u32 s52, s4, 0x1000000
    s_addc_u32 s53, s5, 0
    s_add_u32 s52, s52, s76
    s_addc_u32 s53, s53, 0
    s_lshl_b32 s76, s75, 11
    s_add_u32 s54, s4, 0x7a00000
    s_addc_u32 s55, s5, 0
    s_add_u32 s54, s54, s76
    s_addc_u32 s55, s55, 0
    s_add_u32 s56, s4, 0x4e00000
    s_addc_u32 s57, s5, 0
    s_add_u32 s56, s56, s76
    s_addc_u32 s57, s57, 0
    s_lshl_b32 s76, s72, 7
    s_add_u32 s58, s4, 0x4d80000
    s_addc_u32 s59, s5, 0
    s_add_u32 s58, s58, s76
    s_addc_u32 s59, s59, 0
    v_add_u32 v5, 4096, v2
    global_load_dwordx4 v[16:19], v2, s[48:49] offset:0 sc1
    global_load_dwordx4 v[20:23], v2, s[48:49] offset:1024 sc1
    global_load_dwordx4 v[24:27], v2, s[48:49] offset:2048 sc1
    global_load_dwordx4 v[28:31], v2, s[48:49] offset:3072 sc1
    global_load_dwordx4 v[32:35], v5, s[48:49] offset:0 sc1
    global_load_dwordx4 v[36:39], v5, s[48:49] offset:1024 sc1
    global_load_dwordx4 v[40:43], v5, s[48:49] offset:2048 sc1
    global_load_dwordx4 v[44:47], v5, s[48:49] offset:3072 sc1
    global_load_dwordx4 v[48:51], v2, s[50:51] offset:0 sc1
    global_load_dwordx4 v[52:55], v2, s[50:51] offset:1024 sc1
    global_load_dwordx4 v[56:59], v2, s[50:51] offset:2048 sc1
    global_load_dwordx4 v[60:63], v2, s[50:51] offset:3072 sc1
    global_load_dwordx4 v[64:67], v5, s[50:51] offset:0 sc1
    global_load_dwordx4 v[68:71], v5, s[50:51] offset:1024 sc1
    global_load_dwordx4 v[72:75], v5, s[50:51] offset:2048 sc1
    global_load_dwordx4 v[76:79], v5, s[50:51] offset:3072 sc1
    global_load_dwordx4 v[96:99], v2, s[52:53] offset:0 sc1
    global_load_dwordx4 v[100:103], v2, s[52:53] offset:1024 sc1
    global_load_dwordx4 v[104:107], v2, s[52:53] offset:2048 sc1
    global_load_dwordx4 v[108:111], v2, s[52:53] offset:3072 sc1
    global_load_dwordx4 v[112:115], v5, s[52:53] offset:0 sc1
    global_load_dwordx4 v[116:119], v5, s[52:53] offset:1024 sc1
    global_load_dwordx4 v[120:123], v5, s[52:53] offset:2048 sc1
    global_load_dwordx4 v[124:127], v5, s[52:53] offset:3072 sc1
    v_lshlrev_b32 v8, 2, v3
    global_load_dword v144, v8, s[58:59] sc1
    global_load_dword v145, v8, s[58:59] offset:64 sc1
    v_and_b32 v6, 7, v3
    v_lshl_add_u32 v6, v4, 3, v6
    v_lshlrev_b32 v6, 4, v6
    v_and_b32 v7, 1, v4
    v_lshlrev_b32 v7, 3, v7
    v_lshl_add_u32 v7, v3, 4, v7
    s_cmp_lg_u32 s16, 0
    s_cbranch_scc1 L_wk_ad1f
    s_add_u32 s10, s4, 0x5310000
    s_addc_u32 s11, s5, 0
    s_sub_u32 s19, s72, 1
    s_lshl_b32 s21, s73, 9
    v_and_b32 v10, 3, v1
    v_lshlrev_b32 v10, 7, v10
    v_add_u32 v10, s21, v10
    s_mov_b32 s20, 0
L_wk_ppf:
    global_load_dword v11, v10, s[10:11] sc1
    s_waitcnt vmcnt(0)
    v_min_u32_dpp v11, v11, v11 quad_perm:[1,0,3,2] row_mask:0xf bank_mask:0xf
    s_nop 1
    v_min_u32_dpp v11, v11, v11 quad_perm:[2,3,0,1] row_mask:0xf bank_mask:0xf
    s_nop 0
    v_readfirstlane_b32 s18, v11
    s_cmp_ge_u32 s18, s19
    s_cbranch_scc1 L_wk_ad1f
    s_add_u32 s20, s20, 1
    s_cmp_gt_u32 s20, 600000
    s_cbranch_scc1 L_wk_fail
    s_sub_u32 s18, s19, s18
    s_cmp_ge_u32 s18, 3
    s_cbranch_scc1 L_wk_pff
    s_sleep 2
    s_branch L_wk_ppf
L_wk_pff:
    s_sleep 48
    s_branch L_wk_ppf
L_wk_ad1f:
    s_barrier
    s_mov_b32 s79, 0
L_att_plf:
    global_load_dwordx4 v[80:83], v6, s[54:55] offset:0 sc1
    global_load_dwordx4 v[84:87], v6, s[54:55] offset:512 sc1
    global_load_dwordx4 v[88:91], v6, s[54:55] offset:1024 sc1
    global_load_dwordx4 v[92:95], v6, s[54:55] offset:1536 sc1
    global_load_dwordx2 v[128:129], v7, s[56:57] offset:0 sc1
    global_load_dwordx2 v[130:131], v7, s[56:57] offset:256 sc1
    global_load_dwordx2 v[132:133], v7, s[56:57] offset:512 sc1
    global_load_dwordx2 v[134:135], v7, s[56:57] offset:768 sc1
    global_load_dwordx2 v[136:137], v7, s[56:57] offset:1024 sc1
    global_load_dwordx2 v[138:139], v7, s[56:57] offset:1280 sc1
    global_load_dwordx2 v[140:141], v7, s[56:57] offset:1536 sc1
    global_load_dwordx2 v[142:143], v7, s[56:57] offset:1792 sc1
    s_waitcnt vmcnt(0)
    v_max3_u32 v10, v80, v81, v82
    v_max3_u32 v10, v10, v83, v84
    v_max3_u32 v10, v10, v85, v86
    v_max3_u32 v10, v10, v87, v88
    v_max3_u32 v10, v10, v89, v90
    v_max3_u32 v10, v10, v91, v92
    v_max3_u32 v10, v10, v93, v94
    v_max3_u32 v10, v10, v95, v128
    v_max3_u32 v10, v10, v129, v130
    v_max3_u32 v10, v10, v131, v132
    v_max3_u32 v10, v10, v133, v134
    v_max3_u32 v10, v10, v135, v136
    v_max3_u32 v10, v10, v137, v138
    v_max3_u32 v10, v10, v139, v140
    v_max3_u32 v10, v10, v141, v142
    v_max_u32 v10, v10, v143
    v_cmp_eq_u32 vcc, -1, v10
    s_cbranch_vccz L_att_okf
    s_add_u32 s79, s79, 1
    s_cmp_gt_u32 s79, 400000
    s_cbranch_scc1 L_att_okf
    s_sleep 6
    s_branch L_att_plf
L_att_okf:
    s_waitcnt vmcnt(8)
    v_mfma_f32_16x16x32_bf16 v[148:151], v[48:51], v[16:19], 0
    v_mfma_f32_16x16x32_bf16 v[148:151], v[56:59], v[24:27], v[148:151]
    v_mfma_f32_16x16x32_bf16 v[148:151], v[64:67], v[32:35], v[148:151]
    v_mfma_f32_16x16x32_bf16 v[148:151], v[72:75], v[40:43], v[148:151]
    v_mfma_f32_16x16x32_bf16 v[152:155], v[52:55], v[16:19], 0
    v_mfma_f32_16x16x32_bf16 v[152:155], v[60:63], v[24:27], v[152:155]
    v_mfma_f32_16x16x32_bf16 v[152:155], v[68:71], v[32:35], v[152:155]
    v_mfma_f32_16x16x32_bf16 v[152:155], v[76:79], v[40:43], v[152:155]
    v_mfma_f32_16x16x32_bf16 v[156:159], v[80:83], v[16:19], 0
    v_mfma_f32_16x16x32_bf16 v[156:159], v[84:87], v[24:27], v[156:159]
    v_mfma_f32_16x16x32_bf16 v[156:159], v[88:91], v[32:35], v[156:159]
    v_mfma_f32_16x16x32_bf16 v[156:159], v[92:95], v[40:43], v[156:159]
    v_mfma_f32_16x16x32_bf16 v[160:163], v[48:51], v[20:23], 0
    v_mfma_f32_16x16x32_bf16 v[160:163], v[56:59], v[28:31], v[160:163]
    v_mfma_f32_16x16x32_bf16 v[160:163], v[64:67], v[36:39], v[160:163]
    v_mfma_f32_16x16x32_bf16 v[160:163], v[72:75], v[44:47], v[160:163]
    v_mfma_f32_16x16x32_bf16 v[164:167], v[52:55], v[20:23], 0
    v_mfma_f32_16x16x32_bf16 v[164:167], v[60:63], v[28:31], v[164:167]
    v_mfma_f32_16x16x32_bf16 v[164:167], v[68:71], v[36:39], v[164:167]
    v_mfma_f32_16x16x32_bf16 v[164:167], v[76:79], v[44:47], v[164:167]
    v_mfma_f32_16x16x32_bf16 v[168:171], v[80:83], v[20:23], 0
    v_mfma_f32_16x16x32_bf16 v[168:171], v[84:87], v[28:31], v[168:171]
    v_mfma_f32_16x16x32_bf16 v[168:171], v[88:91], v[36:39], v[168:171]
    v_mfma_f32_16x16x32_bf16 v[168:171], v[92:95], v[44:47], v[168:171]
    v_mov_b32 v9, 0xf149f2ca
    v_lshlrev_b32 v10, 3, v4
    v_add_u32 v11, 0, v10
    v_cmp_le_i32 vcc, v11, v3
    s_nop 1
    v_cndmask_b32 v148, v9, v148, vcc
    v_add_u32 v11, 1, v10
    v_cmp_le_i32 vcc, v11, v3
    s_nop 1
    v_cndmask_b32 v149, v9, v149, vcc
    v_add_u32 v11, 2, v10
    v_cmp_le_i32 vcc, v11, v3
    s_nop 1
    v_cndmask_b32 v150, v9, v150, vcc
    v_add_u32 v11, 3, v10
    v_cmp_le_i32 vcc, v11, v3
    s_nop 1
    v_cndmask_b32 v151, v9, v151, vcc
    v_add_u32 v11, 4, v10
    v_cmp_le_i32 vcc, v11, v3
    s_nop 1
    v_cndmask_b32 v152, v9, v152, vcc
    v_add_u32 v11, 5, v10
    v_cmp_le_i32 vcc, v11, v3
    s_nop 1
    v_cndmask_b32 v153, v9, v153, vcc
    v_add_u32 v11, 6, v10
    v_cmp_le_i32 vcc, v11, v3
    s_nop 1
    v_cndmask_b32 v154, v9, v154, vcc
    v_add_u32 v11, 7, v10
    v_cmp_le_i32 vcc, v11, v3
    s_nop 1
    v_cndmask_b32 v155, v9, v155, vcc
    v_max3_f32 v10, v148, v149, v150
    v_max3_f32 v10, v10, v151, v152
    v_max3_f32 v10, v10, v153, v154
    v_max3_f32 v10, v10, v155, v156
    v_max3_f32 v10, v10, v157, v158
    v_max_f32 v10, v10, v159
    v_mov_b32 v11, v10
    s_nop 1
    v_permlane16_swap_b32 v10, v11
    v_max_f32 v10, v10, v11
    v_mov_b32 v11, v10
    s_nop 1
    v_permlane32_swap_b32 v10, v11
    v_max_f32 v10, v10, v11
    v_mul_f32 v10, s81, v10
    v_fma_f32 v148, v148, s81, -v10
    v_fma_f32 v149, v149, s81, -v10
    v_fma_f32 v150, v150, s81, -v10
    v_fma_f32 v151, v151, s81, -v10
    v_fma_f32 v152, v152, s81, -v10
    v_fma_f32 v153, v153, s81, -v10
    v_fma_f32 v154, v154, s81, -v10
    v_fma_f32 v155, v155, s81, -v10
    v_fma_f32 v156, v156, s81, -v10
    v_fma_f32 v157, v157, s81, -v10
    v_fma_f32 v158, v158, s81, -v10
    v_fma_f32 v159, v159, s81, -v10
    v_exp_f32 v148, v148
    v_exp_f32 v149, v149
    v_exp_f32 v150, v150
    v_exp_f32 v151, v151
    v_exp_f32 v152, v152
    v_exp_f32 v153, v153
    v_exp_f32 v154, v154
    v_exp_f32 v155, v155
    v_exp_f32 v156, v156
    v_exp_f32 v157, v157
    v_exp_f32 v158, v158
    v_exp_f32 v159, v159
    v_cndmask_b32 v156, 0, v156, s[68:69]
    v_cndmask_b32 v157, 0, v157, s[68:69]
    v_cndmask_b32 v158, 0, v158, s[68:69]
    v_cndmask_b32 v159, 0, v159, s[68:69]
    v_add_f32 v10, v148, v149
    v_add_f32 v10, v10, v150
    v_add_f32 v10, v10, v151
    v_add_f32 v10, v10, v152
    v_add_f32 v10, v10, v153
    v_add_f32 v10, v10, v154
    v_add_f32 v10, v10, v155
    v_add_f32 v10, v10, v156
    v_add_f32 v10, v10, v157
    v_add_f32 v10, v10, v158
    v_add_f32 v10, v10, v159
    v_mov_b32 v11, v10
    s_nop 1
    v_permlane16_swap_b32 v10, v11
    v_add_f32 v10, v10, v11
    v_mov_b32 v11, v10
    s_nop 1
    v_permlane32_swap_b32 v10, v11
    v_add_f32 v10, v10, v11
    v_rcp_f32 v10, v10
    v_cvt_pk_bf16_f32 v172, v148, v149
    v_cvt_pk_bf16_f32 v173, v150, v151
    v_cvt_pk_bf16_f32 v174, v152, v153
    v_cvt_pk_bf16_f32 v175, v154, v155
    v_cvt_pk_bf16_f32 v176, v156, v157
    v_cvt_pk_bf16_f32 v177, v158, v159
    v_mov_b32 v146, v10
    v_lshlrev_b32 v10, 3, v4
    v_add_u32 v11, 4294967280, v10
    v_cmp_le_i32 vcc, v11, v3
    s_nop 1
    v_cndmask_b32 v160, v9, v160, vcc
    v_add_u32 v11, 4294967281, v10
    v_cmp_le_i32 vcc, v11, v3
    s_nop 1
    v_cndmask_b32 v161, v9, v161, vcc
    v_add_u32 v11, 4294967282, v10
    v_cmp_le_i32 vcc, v11, v3
    s_nop 1
    v_cndmask_b32 v162, v9, v162, vcc
    v_add_u32 v11, 4294967283, v10
    v_cmp_le_i32 vcc, v11, v3
    s_nop 1
    v_cndmask_b32 v163, v9, v163, vcc
    v_add_u32 v11, 4294967284, v10
    v_cmp_le_i32 vcc, v11, v3
    s_nop 1
    v_cndmask_b32 v164, v9, v164, vcc
    v_add_u32 v11, 4294967285, v10
    v_cmp_le_i32 vcc, v11, v3
    s_nop 1
    v_cndmask_b32 v165, v9, v165, vcc
    v_add_u32 v11, 4294967286, v10
    v_cmp_le_i32 vcc, v11, v3
    s_nop 1
    v_cndmask_b32 v166, v9, v166, vcc
    v_add_u32 v11, 4294967287, v10
    v_cmp_le_i32 vcc, v11, v3
    s_nop 1
    v_cndmask_b32 v167, v9, v167, vcc
    v_max3_f32 v10, v160, v161, v162
    v_max3_f32 v10, v10, v163, v164
    v_max3_f32 v10, v10, v165, v166
    v_max3_f32 v10, v10, v167, v168
    v_max3_f32 v10, v10, v169, v170
    v_max_f32 v10, v10, v171
    v_mov_b32 v11, v10
    s_nop 1
    v_permlane16_swap_b32 v10, v11
    v_max_f32 v10, v10, v11
    v_mov_b32 v11, v10
    s_nop 1
    v_permlane32_swap_b32 v10, v11
    v_max_f32 v10, v10, v11
    v_mul_f32 v10, s81, v10
    v_fma_f32 v160, v160, s81, -v10
    v_fma_f32 v161, v161, s81, -v10
    v_fma_f32 v162, v162, s81, -v10
    v_fma_f32 v163, v163, s81, -v10
    v_fma_f32 v164, v164, s81, -v10
    v_fma_f32 v165, v165, s81, -v10
    v_fma_f32 v166, v166, s81, -v10
    v_fma_f32 v167, v167, s81, -v10
    v_fma_f32 v168, v168, s81, -v10
    v_fma_f32 v169, v169, s81, -v10
    v_fma_f32 v170, v170, s81, -v10
    v_fma_f32 v171, v171, s81, -v10
    v_exp_f32 v160, v160
    v_exp_f32 v161, v161
    v_exp_f32 v162, v162
    v_exp_f32 v163, v163
    v_exp_f32 v164, v164
    v_exp_f32 v165, v165
    v_exp_f32 v166, v166
    v_exp_f32 v167, v167
    v_exp_f32 v168, v168
    v_exp_f32 v169, v169
    v_exp_f32 v170, v170
    v_exp_f32 v171, v171
    v_cndmask_b32 v168, 0, v168, s[68:69]
    v_cndmask_b32 v169, 0, v169, s[68:69]
    v_cndmask_b32 v170, 0, v170, s[68:69]
    v_cndmask_b32 v171, 0, v171, s[68:69]
    v_add_f32 v10, v160, v161
    v_add_f32 v10, v10, v162
    v_add_f32 v10, v10, v163
    v_add_f32 v10, v10, v164
    v_add_f32 v10, v10, v165
    v_add_f32 v10, v10, v166
    v_add_f32 v10, v10, v167
    v_add_f32 v10, v10, v168
    v_add_f32 v10, v10, v169
    v_add_f32 v10, v10, v170
    v_add_f32 v10, v10, v171
    v_mov_b32 v11, v10
    s_nop 1
    v_permlane16_swap_b32 v10, v11
    v_add_f32 v10, v10, v11
    v_mov_b32 v11, v10
    s_nop 1
    v_permlane32_swap_b32 v10, v11
    v_add_f32 v10, v10, v11
    v_rcp_f32 v10, v10
    v_cvt_pk_bf16_f32 v180, v160, v161
    v_cvt_pk_bf16_f32 v181, v162, v163
    v_cvt_pk_bf16_f32 v182, v164, v165
    v_cvt_pk_bf16_f32 v183, v166, v167
    v_cvt_pk_bf16_f32 v184, v168, v169
    v_cvt_pk_bf16_f32 v185, v170, v171
    v_mov_b32 v147, v10
    s_waitcnt vmcnt(0)
    v_mul_f32 v146, v146, v144
    v_mul_f32 v147, v147, v145
    v_lshrrev_b32 v10, 1, v4
    v_lshlrev_b32 v10, 9, v10
    v_add_u32 v10, v10, v7
    s_lshl_b32 s75, s16, 13
    v_add_u32 v10, s75, v10
    v_mfma_f32_16x16x32_bf16 v[192:195], v[96:99], v[172:175], 0
    v_mfma_f32_16x16x32_bf16 v[196:199], v[100:103], v[172:175], 0
    v_mfma_f32_16x16x32_bf16 v[200:203], v[104:107], v[172:175], 0
    s_nop 5
    v_mfma_f32_16x16x16_bf16 v[192:195], v[128:129], v[176:177], v[192:195]
    v_mfma_f32_16x16x32_bf16 v[204:207], v[108:111], v[172:175], 0
    v_mfma_f32_16x16x16_bf16 v[196:199], v[130:131], v[176:177], v[196:199]
    v_mfma_f32_16x16x32_bf16 v[208:211], v[112:115], v[172:175], 0
    v_mfma_f32_16x16x16_bf16 v[200:203], v[132:133], v[176:177], v[200:203]
    s_nop 3
    v_mul_f32 v192, v192, v146
    v_mul_f32 v193, v193, v146
    v_mul_f32 v194, v194, v146
    v_mul_f32 v195, v195, v146
    v_cvt_pk_bf16_f32 v192, v192, v193
    v_cvt_pk_bf16_f32 v193, v194, v195
    ds_write_b64 v10, v[192:193] offset:0
    v_mfma_f32_16x16x32_bf16 v[212:215], v[116:119], v[172:175], 0
    v_mfma_f32_16x16x16_bf16 v[204:207], v[134:135], v[176:177], v[204:207]
    v_mul_f32 v196, v196, v146
    v_mul_f32 v197, v197, v146
    v_mul_f32 v198, v198, v146
    v_mul_f32 v199, v199, v146
    v_cvt_pk_bf16_f32 v196, v196, v197
    v_cvt_pk_bf16_f32 v197, v198, v199
    ds_write_b64 v10, v[196:197] offset:1024
    v_mfma_f32_16x16x32_bf16 v[192:195], v[120:123], v[172:175], 0
    v_mfma_f32_16x16x16_bf16 v[208:211], v[136:137], v[176:177], v[208:211]
    v_mul_f32 v200, v200, v146
    v_mul_f32 v201, v201, v146
    v_mul_f32 v202, v202, v146
    v_mul_f32 v203, v203, v146
    v_cvt_pk_bf16_f32 v200, v200, v201
    v_cvt_pk_bf16_f32 v201, v202, v203
    ds_write_b64 v10, v[200:201] offset:2048
    v_mfma_f32_16x16x32_bf16 v[196:199], v[124:127], v[172:175], 0
    v_mfma_f32_16x16x16_bf16 v[212:215], v[138:139], v[176:177], v[212:215]
    v_mul_f32 v204, v204, v146
    v_mul_f32 v205, v205, v146
    v_mul_f32 v206, v206, v146
    v_mul_f32 v207, v207, v146
    v_cvt_pk_bf16_f32 v204, v204, v205
    v_cvt_pk_bf16_f32 v205, v206, v207
    ds_write_b64 v10, v[204:205] offset:3072
    v_mfma_f32_16x16x32_bf16 v[200:203], v[96:99], v[180:183], 0
    v_mfma_f32_16x16x16_bf16 v[192:195], v[140:141], v[176:177], v[192:195]
    v_mul_f32 v208, v208, v146
    v_mul_f32 v209, v209, v146
    v_mul_f32 v210, v210, v146
    v_mul_f32 v211, v211, v146
    v_cvt_pk_bf16_f32 v208, v208, v209
    v_cvt_pk_bf16_f32 v209, v210, v211
    ds_write_b64 v10, v[208:209] offset:4096
    v_mfma_f32_16x16x32_bf16 v[204:207], v[100:103], v[180:183], 0
    v_mfma_f32_16x16x16_bf16 v[196:199], v[142:143], v[176:177], v[196:199]
    v_mul_f32 v212, v212, v146
    v_mul_f32 v213, v213, v146
    v_mul_f32 v214, v214, v146
    v_mul_f32 v215, v215, v146
    v_cvt_pk_bf16_f32 v212, v212, v213
    v_cvt_pk_bf16_f32 v213, v214, v215
    ds_write_b64 v10, v[212:213] offset:5120
    v_mfma_f32_16x16x32_bf16 v[208:211], v[104:107], v[180:183], 0
    v_mfma_f32_16x16x16_bf16 v[200:203], v[128:129], v[184:185], v[200:203]
    v_mul_f32 v192, v192, v146
    v_mul_f32 v193, v193, v146
    v_mul_f32 v194, v194, v146
    v_mul_f32 v195, v195, v146
    v_cvt_pk_bf16_f32 v192, v192, v193
    v_cvt_pk_bf16_f32 v193, v194, v195
    ds_write_b64 v10, v[192:193] offset:6144
    v_mfma_f32_16x16x32_bf16 v[212:215], v[108:111], v[180:183], 0
    v_mfma_f32_16x16x16_bf16 v[204:207], v[130:131], v[184:185], v[204:207]
    v_mul_f32 v196, v196, v146
    v_mul_f32 v197, v197, v146
    v_mul_f32 v198, v198, v146
    v_mul_f32 v199, v199, v146
    v_cvt_pk_bf16_f32 v196, v196, v197
    v_cvt_pk_bf16_f32 v197, v198, v199
    ds_write_b64 v10, v[196:197] offset:7168
    v_mfma_f32_16x16x32_bf16 v[192:195], v[112:115], v[180:183], 0
    v_mfma_f32_16x16x16_bf16 v[208:211], v[132:133], v[184:185], v[208:211]
    v_mul_f32 v200, v200, v147
    v_mul_f32 v201, v201, v147
    v_mul_f32 v202, v202, v147
    v_mul_f32 v203, v203, v147
    v_cvt_pk_bf16_f32 v200, v200, v201
    v_cvt_pk_bf16_f32 v201, v202, v203
    ds_write_b64 v10, v[200:201] offset:256
    v_mfma_f32_16x16x32_bf16 v[196:199], v[116:119], v[180:183], 0
    v_mfma_f32_16x16x16_bf16 v[212:215], v[134:135], v[184:185], v[212:215]
    v_mul_f32 v204, v204, v147
    v_mul_f32 v205, v205, v147
    v_mul_f32 v206, v206, v147
    v_mul_f32 v207, v207, v147
    v_cvt_pk_bf16_f32 v204, v204, v205
    v_cvt_pk_bf16_f32 v205, v206, v207
    ds_write_b64 v10, v[204:205] offset:1280
    v_mfma_f32_16x16x32_bf16 v[200:203], v[120:123], v[180:183], 0
    v_mfma_f32_16x16x16_bf16 v[192:195], v[136:137], v[184:185], v[192:195]
    v_mul_f32 v208, v208, v147
    v_mul_f32 v209, v209, v147
    v_mul_f32 v210, v210, v147
    v_mul_f32 v211, v211, v147
    v_cvt_pk_bf16_f32 v208, v208, v209
    v_cvt_pk_bf16_f32 v209, v210, v211
    ds_write_b64 v10, v[208:209] offset:2304
    v_mfma_f32_16x16x32_bf16 v[204:207], v[124:127], v[180:183], 0
    v_mfma_f32_16x16x16_bf16 v[196:199], v[138:139], v[184:185], v[196:199]
    v_mul_f32 v212, v212, v147
    v_mul_f32 v213, v213, v147
    v_mul_f32 v214, v214, v147
    v_mul_f32 v215, v215, v147
    v_cvt_pk_bf16_f32 v212, v212, v213
    v_cvt_pk_bf16_f32 v213, v214, v215
    ds_write_b64 v10, v[212:213] offset:3328
    v_mfma_f32_16x16x16_bf16 v[200:203], v[140:141], v[184:185], v[200:203]
    v_mul_f32 v192, v192, v147
    v_mul_f32 v193, v193, v147
    v_mul_f32 v194, v194, v147
    v_mul_f32 v195, v195, v147
    v_cvt_pk_bf16_f32 v192, v192, v193
    v_cvt_pk_bf16_f32 v193, v194, v195
    ds_write_b64 v10, v[192:193] offset:4352
    v_mfma_f32_16x16x16_bf16 v[204:207], v[142:143], v[184:185], v[204:207]
    v_mul_f32 v196, v196, v147
    v_mul_f32 v197, v197, v147
    v_mul_f32 v198, v198, v147
    v_mul_f32 v199, v199, v147
    v_cvt_pk_bf16_f32 v196, v196, v197
    v_cvt_pk_bf16_f32 v197, v198, v199
    ds_write_b64 v10, v[196:197] offset:5376
    v_mul_f32 v200, v200, v147
    v_mul_f32 v201, v201, v147
    v_mul_f32 v202, v202, v147
    v_mul_f32 v203, v203, v147
    v_cvt_pk_bf16_f32 v200, v200, v201
    v_cvt_pk_bf16_f32 v201, v202, v203
    ds_write_b64 v10, v[200:201] offset:6400
    v_mul_f32 v204, v204, v147
    v_mul_f32 v205, v205, v147
    v_mul_f32 v206, v206, v147
    v_mul_f32 v207, v207, v147
    v_cvt_pk_bf16_f32 v204, v204, v205
    v_cvt_pk_bf16_f32 v205, v206, v207
    ds_write_b64 v10, v[204:205] offset:7424
    v_mov_b32 v16, 0
    v_mov_b32 v17, 0
    v_mov_b32 v18, 0
    v_mov_b32 v19, 0
    v_mov_b32 v20, 0
    v_mov_b32 v21, 0
    v_mov_b32 v22, 0
    v_mov_b32 v23, 0
    v_mov_b32 v24, 0
    v_mov_b32 v25, 0
    v_mov_b32 v26, 0
    v_mov_b32 v27, 0
    v_mov_b32 v28, 0
    v_mov_b32 v29, 0
    v_mov_b32 v30, 0
    v_mov_b32 v31, 0
    v_mov_b32 v32, 0
    v_mov_b32 v33, 0
    v_mov_b32 v34, 0
    v_mov_b32 v35, 0
    v_mov_b32 v36, 0
    v_mov_b32 v37, 0
    v_mov_b32 v38, 0
    v_mov_b32 v39, 0
    s_waitcnt lgkmcnt(0)
    s_barrier
    v_add_u32 v233, 61440, v230
    v_add_u32 v234, 61440, v231
    v_add_u32 v235, 61440, v232
    ds_read_b128 v[48:51], v229 offset:0
    ds_read_b128 v[52:55], v229 offset:256
    ds_read_b64_tr_b16 v[56:57], v230 offset:0
    ds_read_b64_tr_b16 v[58:59], v230 offset:1536
    ds_read_b64_tr_b16 v[60:61], v231 offset:0
    ds_read_b64_tr_b16 v[62:63], v231 offset:1536
    ds_read_b64_tr_b16 v[64:65], v232 offset:0
    ds_read_b64_tr_b16 v[66:67], v232 offset:1536
    ds_read_b128 v[72:75], v229 offset:2048
    ds_read_b128 v[76:79], v229 offset:2304
    ds_read_b64_tr_b16 v[80:81], v230 offset:12288
    ds_read_b64_tr_b16 v[82:83], v230 offset:13824
    ds_read_b64_tr_b16 v[84:85], v231 offset:12288
    ds_read_b64_tr_b16 v[86:87], v231 offset:13824
    ds_read_b64_tr_b16 v[88:89], v232 offset:12288
    ds_read_b64_tr_b16 v[90:91], v232 offset:13824
    s_waitcnt lgkmcnt(8)
    v_mfma_f32_16x16x32_bf16 v[16:19], v[56:59], v[48:51], v[16:19]
    v_mfma_f32_16x16x32_bf16 v[20:23], v[56:59], v[52:55], v[20:23]
    v_mfma_f32_16x16x32_bf16 v[24:27], v[60:63], v[48:51], v[24:27]
    v_mfma_f32_16x16x32_bf16 v[28:31], v[60:63], v[52:55], v[28:31]
    v_mfma_f32_16x16x32_bf16 v[32:35], v[64:67], v[48:51], v[32:35]
    v_mfma_f32_16x16x32_bf16 v[36:39], v[64:67], v[52:55], v[36:39]
    ds_read_b128 v[48:51], v229 offset:4096
    ds_read_b128 v[52:55], v229 offset:4352
    ds_read_b64_tr_b16 v[56:57], v230 offset:24576
    ds_read_b64_tr_b16 v[58:59], v230 offset:26112
    ds_read_b64_tr_b16 v[60:61], v231 offset:24576
    ds_read_b64_tr_b16 v[62:63], v231 offset:26112
    ds_read_b64_tr_b16 v[64:65], v232 offset:24576
    ds_read_b64_tr_b16 v[66:67], v232 offset:26112
    s_waitcnt lgkmcnt(8)
    v_mfma_f32_16x16x32_bf16 v[16:19], v[80:83], v[72:75], v[16:19]
    v_mfma_f32_16x16x32_bf16 v[20:23], v[80:83], v[76:79], v[20:23]
    v_mfma_f32_16x16x32_bf16 v[24:27], v[84:87], v[72:75], v[24:27]
    v_mfma_f32_16x16x32_bf16 v[28:31], v[84:87], v[76:79], v[28:31]
    v_mfma_f32_16x16x32_bf16 v[32:35], v[88:91], v[72:75], v[32:35]
    v_mfma_f32_16x16x32_bf16 v[36:39], v[88:91], v[76:79], v[36:39]
    ds_read_b128 v[72:75], v229 offset:6144
    ds_read_b128 v[76:79], v229 offset:6400
    ds_read_b64_tr_b16 v[80:81], v230 offset:36864
    ds_read_b64_tr_b16 v[82:83], v230 offset:38400
    ds_read_b64_tr_b16 v[84:85], v231 offset:36864
    ds_read_b64_tr_b16 v[86:87], v231 offset:38400
    ds_read_b64_tr_b16 v[88:89], v232 offset:36864
    ds_read_b64_tr_b16 v[90:91], v232 offset:38400
    s_waitcnt lgkmcnt(8)
    v_mfma_f32_16x16x32_bf16 v[16:19], v[56:59], v[48:51], v[16:19]
    v_mfma_f32_16x16x32_bf16 v[20:23], v[56:59], v[52:55], v[20:23]
    v_mfma_f32_16x16x32_bf16 v[24:27], v[60:63], v[48:51], v[24:27]
    v_mfma_f32_16x16x32_bf16 v[28:31], v[60:63], v[52:55], v[28:31]
    v_mfma_f32_16x16x32_bf16 v[32:35], v[64:67], v[48:51], v[32:35]
    v_mfma_f32_16x16x32_bf16 v[36:39], v[64:67], v[52:55], v[36:39]
    ds_read_b128 v[48:51], v229 offset:8192
    ds_read_b128 v[52:55], v229 offset:8448
    ds_read_b64_tr_b16 v[56:57], v230 offset:49152
    ds_read_b64_tr_b16 v[58:59], v230 offset:50688
    ds_read_b64_tr_b16 v[60:61], v231 offset:49152
    ds_read_b64_tr_b16 v[62:63], v231 offset:50688
    ds_read_b64_tr_b16 v[64:65], v232 offset:49152
    ds_read_b64_tr_b16 v[66:67], v232 offset:50688
    s_waitcnt lgkmcnt(8)
    v_mfma_f32_16x16x32_bf16 v[16:19], v[80:83], v[72:75], v[16:19]
    v_mfma_f32_16x16x32_bf16 v[20:23], v[80:83], v[76:79], v[20:23]
    v_mfma_f32_16x16x32_bf16 v[24:27], v[84:87], v[72:75], v[24:27]
    v_mfma_f32_16x16x32_bf16 v[28:31], v[84:87], v[76:79], v[28:31]
    v_mfma_f32_16x16x32_bf16 v[32:35], v[88:91], v[72:75], v[32:35]
    v_mfma_f32_16x16x32_bf16 v[36:39], v[88:91], v[76:79], v[36:39]
    ds_read_b128 v[72:75], v229 offset:10240
    ds_read_b128 v[76:79], v229 offset:10496
    ds_read_b64_tr_b16 v[80:81], v233 offset:0
    ds_read_b64_tr_b16 v[82:83], v233 offset:1536
    ds_read_b64_tr_b16 v[84:85], v234 offset:0
    ds_read_b64_tr_b16 v[86:87], v234 offset:1536
    ds_read_b64_tr_b16 v[88:89], v235 offset:0
    ds_read_b64_tr_b16 v[90:91], v235 offset:1536
    s_waitcnt lgkmcnt(8)
    v_mfma_f32_16x16x32_bf16 v[16:19], v[56:59], v[48:51], v[16:19]
    v_mfma_f32_16x16x32_bf16 v[20:23], v[56:59], v[52:55], v[20:23]
    v_mfma_f32_16x16x32_bf16 v[24:27], v[60:63], v[48:51], v[24:27]
    v_mfma_f32_16x16x32_bf16 v[28:31], v[60:63], v[52:55], v[28:31]
    v_mfma_f32_16x16x32_bf16 v[32:35], v[64:67], v[48:51], v[32:35]
    v_mfma_f32_16x16x32_bf16 v[36:39], v[64:67], v[52:55], v[36:39]
    ds_read_b128 v[48:51], v229 offset:12288
    ds_read_b128 v[52:55], v229 offset:12544
    ds_read_b64_tr_b16 v[56:57], v233 offset:12288
    ds_read_b64_tr_b16 v[58:59], v233 offset:13824
    ds_read_b64_tr_b16 v[60:61], v234 offset:12288
    ds_read_b64_tr_b16 v[62:63], v234 offset:13824
    ds_read_b64_tr_b16 v[64:65], v235 offset:12288
    ds_read_b64_tr_b16 v[66:67], v235 offset:13824
    s_waitcnt lgkmcnt(8)
    v_mfma_f32_16x16x32_bf16 v[16:19], v[80:83], v[72:75], v[16:19]
    v_mfma_f32_16x16x32_bf16 v[20:23], v[80:83], v[76:79], v[20:23]
    v_mfma_f32_16x16x32_bf16 v[24:27], v[84:87], v[72:75], v[24:27]
    v_mfma_f32_16x16x32_bf16 v[28:31], v[84:87], v[76:79], v[28:31]
    v_mfma_f32_16x16x32_bf16 v[32:35], v[88:91], v[72:75], v[32:35]
    v_mfma_f32_16x16x32_bf16 v[36:39], v[88:91], v[76:79], v[36:39]
    ds_read_b128 v[72:75], v229 offset:14336
    ds_read_b128 v[76:79], v229 offset:14592
    ds_read_b64_tr_b16 v[80:81], v233 offset:24576
    ds_read_b64_tr_b16 v[82:83], v233 offset:26112
    ds_read_b64_tr_b16 v[84:85], v234 offset:24576
    ds_read_b64_tr_b16 v[86:87], v234 offset:26112
    ds_read_b64_tr_b16 v[88:89], v235 offset:24576
    ds_read_b64_tr_b16 v[90:91], v235 offset:26112
    s_waitcnt lgkmcnt(8)
    v_mfma_f32_16x16x32_bf16 v[16:19], v[56:59], v[48:51], v[16:19]
    v_mfma_f32_16x16x32_bf16 v[20:23], v[56:59], v[52:55], v[20:23]
    v_mfma_f32_16x16x32_bf16 v[24:27], v[60:63], v[48:51], v[24:27]
    v_mfma_f32_16x16x32_bf16 v[28:31], v[60:63], v[52:55], v[28:31]
    v_mfma_f32_16x16x32_bf16 v[32:35], v[64:67], v[48:51], v[32:35]
    v_mfma_f32_16x16x32_bf16 v[36:39], v[64:67], v[52:55], v[36:39]
    s_barrier
    s_add_u32 m0, s77, 32768
    s_nop 0
    buffer_load_dwordx4 v240, s[64:67], s78 offen lds
    s_add_u32 m0, s77, 33792
    s_nop 0
    buffer_load_dwordx4 v241, s[64:67], s78 offen lds
    s_add_u32 m0, s77, 34816
    s_nop 0
    buffer_load_dwordx4 v242, s[64:67], s78 offen lds
    s_add_u32 s78, s78, 36864
    s_add_u32 m0, s77, 45056
    s_nop 0
    buffer_load_dwordx4 v240, s[64:67], s78 offen lds
    s_add_u32 m0, s77, 46080
    s_nop 0
    buffer_load_dwordx4 v241, s[64:67], s78 offen lds
    s_add_u32 m0, s77, 47104
    s_nop 0
    buffer_load_dwordx4 v242, s[64:67], s78 offen lds
    s_add_u32 s78, s78, 36864
    s_add_u32 m0, s77, 57344
    s_nop 0
    buffer_load_dwordx4 v240, s[64:67], s78 offen lds
    s_add_u32 m0, s77, 58368
    s_nop 0
    buffer_load_dwordx4 v241, s[64:67], s78 offen lds
    s_add_u32 m0, s77, 59392
    s_nop 0
    buffer_load_dwordx4 v242, s[64:67], s78 offen lds
    s_add_u32 s78, s78, 36864
    s_add_u32 m0, s77, 69632
    s_nop 0
    buffer_load_dwordx4 v240, s[64:67], s78 offen lds
    s_add_u32 m0, s77, 70656
    s_nop 0
    buffer_load_dwordx4 v241, s[64:67], s78 offen lds
    s_add_u32 m0, s77, 71680
    s_nop 0
    buffer_load_dwordx4 v242, s[64:67], s78 offen lds
    s_add_u32 s78, s78, 36864
    s_add_u32 m0, s77, 81920
    s_nop 0
    buffer_load_dwordx4 v240, s[64:67], s78 offen lds
    s_add_u32 m0, s77, 82944
    s_nop 0
    buffer_load_dwordx4 v241, s[64:67], s78 offen lds
    s_add_u32 m0, s77, 83968
    s_nop 0
    buffer_load_dwordx4 v242, s[64:67], s78 offen lds
    s_add_u32 s78, s78, 36864
    s_add_u32 m0, s77, 94208
    s_nop 0
    buffer_load_dwordx4 v240, s[64:67], s78 offen lds
    s_add_u32 m0, s77, 95232
    s_nop 0
    buffer_load_dwordx4 v241, s[64:67], s78 offen lds
    s_add_u32 m0, s77, 96256
    s_nop 0
    buffer_load_dwordx4 v242, s[64:67], s78 offen lds
    s_add_u32 s78, s78, 36864
    ds_read_b128 v[48:51], v229 offset:16384
    ds_read_b128 v[52:55], v229 offset:16640
    ds_read_b64_tr_b16 v[56:57], v233 offset:36864
    ds_read_b64_tr_b16 v[58:59], v233 offset:38400
    ds_read_b64_tr_b16 v[60:61], v234 offset:36864
    ds_read_b64_tr_b16 v[62:63], v234 offset:38400
    ds_read_b64_tr_b16 v[64:65], v235 offset:36864
    ds_read_b64_tr_b16 v[66:67], v235 offset:38400
    s_waitcnt lgkmcnt(8)
    v_mfma_f32_16x16x32_bf16 v[16:19], v[80:83], v[72:75], v[16:19]
    v_mfma_f32_16x16x32_bf16 v[20:23], v[80:83], v[76:79], v[20:23]
    v_mfma_f32_16x16x32_bf16 v[24:27], v[84:87], v[72:75], v[24:27]
    v_mfma_f32_16x16x32_bf16 v[28:31], v[84:87], v[76:79], v[28:31]
    v_mfma_f32_16x16x32_bf16 v[32:35], v[88:91], v[72:75], v[32:35]
    v_mfma_f32_16x16x32_bf16 v[36:39], v[88:91], v[76:79], v[36:39]
    ds_read_b128 v[72:75], v229 offset:18432
    ds_read_b128 v[76:79], v229 offset:18688
    ds_read_b64_tr_b16 v[80:81], v233 offset:49152
    ds_read_b64_tr_b16 v[82:83], v233 offset:50688
    ds_read_b64_tr_b16 v[84:85], v234 offset:49152
    ds_read_b64_tr_b16 v[86:87], v234 offset:50688
    ds_read_b64_tr_b16 v[88:89], v235 offset:49152
    ds_read_b64_tr_b16 v[90:91], v235 offset:50688
    s_waitcnt lgkmcnt(8)
    v_mfma_f32_16x16x32_bf16 v[16:19], v[56:59], v[48:51], v[16:19]
    v_mfma_f32_16x16x32_bf16 v[20:23], v[56:59], v[52:55], v[20:23]
    v_mfma_f32_16x16x32_bf16 v[24:27], v[60:63], v[48:51], v[24:27]
    v_mfma_f32_16x16x32_bf16 v[28:31], v[60:63], v[52:55], v[28:31]
    v_mfma_f32_16x16x32_bf16 v[32:35], v[64:67], v[48:51], v[32:35]
    v_mfma_f32_16x16x32_bf16 v[36:39], v[64:67], v[52:55], v[36:39]
    s_waitcnt vmcnt(0)
    s_barrier
    ds_read_b128 v[48:51], v229 offset:20480
    ds_read_b128 v[52:55], v229 offset:20736
    ds_read_b64_tr_b16 v[56:57], v230 offset:0
    ds_read_b64_tr_b16 v[58:59], v230 offset:1536
    ds_read_b64_tr_b16 v[60:61], v231 offset:0
    ds_read_b64_tr_b16 v[62:63], v231 offset:1536
    ds_read_b64_tr_b16 v[64:65], v232 offset:0
    ds_read_b64_tr_b16 v[66:67], v232 offset:1536
    s_waitcnt lgkmcnt(8)
    v_mfma_f32_16x16x32_bf16 v[16:19], v[80:83], v[72:75], v[16:19]
    v_mfma_f32_16x16x32_bf16 v[20:23], v[80:83], v[76:79], v[20:23]
    v_mfma_f32_16x16x32_bf16 v[24:27], v[84:87], v[72:75], v[24:27]
    v_mfma_f32_16x16x32_bf16 v[28:31], v[84:87], v[76:79], v[28:31]
    v_mfma_f32_16x16x32_bf16 v[32:35], v[88:91], v[72:75], v[32:35]
    v_mfma_f32_16x16x32_bf16 v[36:39], v[88:91], v[76:79], v[36:39]
    ds_read_b128 v[72:75], v229 offset:22528
    ds_read_b128 v[76:79], v229 offset:22784
    ds_read_b64_tr_b16 v[80:81], v230 offset:12288
    ds_read_b64_tr_b16 v[82:83], v230 offset:13824
    ds_read_b64_tr_b16 v[84:85], v231 offset:12288
    ds_read_b64_tr_b16 v[86:87], v231 offset:13824
    ds_read_b64_tr_b16 v[88:89], v232 offset:12288
    ds_read_b64_tr_b16 v[90:91], v232 offset:13824
    s_waitcnt lgkmcnt(8)
    v_mfma_f32_16x16x32_bf16 v[16:19], v[56:59], v[48:51], v[16:19]
    v_mfma_f32_16x16x32_bf16 v[20:23], v[56:59], v[52:55], v[20:23]
    v_mfma_f32_16x16x32_bf16 v[24:27], v[60:63], v[48:51], v[24:27]
    v_mfma_f32_16x16x32_bf16 v[28:31], v[60:63], v[52:55], v[28:31]
    v_mfma_f32_16x16x32_bf16 v[32:35], v[64:67], v[48:51], v[32:35]
    v_mfma_f32_16x16x32_bf16 v[36:39], v[64:67], v[52:55], v[36:39]
    ds_read_b128 v[48:51], v229 offset:24576
    ds_read_b128 v[52:55], v229 offset:24832
    ds_read_b64_tr_b16 v[56:57], v230 offset:24576
    ds_read_b64_tr_b16 v[58:59], v230 offset:26112
    ds_read_b64_tr_b16 v[60:61], v231 offset:24576
    ds_read_b64_tr_b16 v[62:63], v231 offset:26112
    ds_read_b64_tr_b16 v[64:65], v232 offset:24576
    ds_read_b64_tr_b16 v[66:67], v232 offset:26112
    s_waitcnt lgkmcnt(8)
    v_mfma_f32_16x16x32_bf16 v[16:19], v[80:83], v[72:75], v[16:19]
    v_mfma_f32_16x16x32_bf16 v[20:23], v[80:83], v[76:79], v[20:23]
    v_mfma_f32_16x16x32_bf16 v[24:27], v[84:87], v[72:75], v[24:27]
    v_mfma_f32_16x16x32_bf16 v[28:31], v[84:87], v[76:79], v[28:31]
    v_mfma_f32_16x16x32_bf16 v[32:35], v[88:91], v[72:75], v[32:35]
    v_mfma_f32_16x16x32_bf16 v[36:39], v[88:91], v[76:79], v[36:39]
    ds_read_b128 v[72:75], v229 offset:26624
    ds_read_b128 v[76:79], v229 offset:26880
    ds_read_b64_tr_b16 v[80:81], v230 offset:36864
    ds_read_b64_tr_b16 v[82:83], v230 offset:38400
    ds_read_b64_tr_b16 v[84:85], v231 offset:36864
    ds_read_b64_tr_b16 v[86:87], v231 offset:38400
    ds_read_b64_tr_b16 v[88:89], v232 offset:36864
    ds_read_b64_tr_b16 v[90:91], v232 offset:38400
    s_waitcnt lgkmcnt(8)
    v_mfma_f32_16x16x32_bf16 v[16:19], v[56:59], v[48:51], v[16:19]
    v_mfma_f32_16x16x32_bf16 v[20:23], v[56:59], v[52:55], v[20:23]
    v_mfma_f32_16x16x32_bf16 v[24:27], v[60:63], v[48:51], v[24:27]
    v_mfma_f32_16x16x32_bf16 v[28:31], v[60:63], v[52:55], v[28:31]
    v_mfma_f32_16x16x32_bf16 v[32:35], v[64:67], v[48:51], v[32:35]
    v_mfma_f32_16x16x32_bf16 v[36:39], v[64:67], v[52:55], v[36:39]
    ds_read_b128 v[48:51], v229 offset:28672
    ds_read_b128 v[52:55], v229 offset:28928
    ds_read_b64_tr_b16 v[56:57], v230 offset:49152
    ds_read_b64_tr_b16 v[58:59], v230 offset:50688
    ds_read_b64_tr_b16 v[60:61], v231 offset:49152
    ds_read_b64_tr_b16 v[62:63], v231 offset:50688
    ds_read_b64_tr_b16 v[64:65], v232 offset:49152
    ds_read_b64_tr_b16 v[66:67], v232 offset:50688
    s_waitcnt lgkmcnt(8)
    v_mfma_f32_16x16x32_bf16 v[16:19], v[80:83], v[72:75], v[16:19]
    v_mfma_f32_16x16x32_bf16 v[20:23], v[80:83], v[76:79], v[20:23]
    v_mfma_f32_16x16x32_bf16 v[24:27], v[84:87], v[72:75], v[24:27]
    v_mfma_f32_16x16x32_bf16 v[28:31], v[84:87], v[76:79], v[28:31]
    v_mfma_f32_16x16x32_bf16 v[32:35], v[88:91], v[72:75], v[32:35]
    v_mfma_f32_16x16x32_bf16 v[36:39], v[88:91], v[76:79], v[36:39]
    ds_read_b128 v[72:75], v229 offset:30720
    ds_read_b128 v[76:79], v229 offset:30976
    ds_read_b64_tr_b16 v[80:81], v233 offset:0
    ds_read_b64_tr_b16 v[82:83], v233 offset:1536
    ds_read_b64_tr_b16 v[84:85], v234 offset:0
    ds_read_b64_tr_b16 v[86:87], v234 offset:1536
    ds_read_b64_tr_b16 v[88:89], v235 offset:0
    ds_read_b64_tr_b16 v[90:91], v235 offset:1536
    s_waitcnt lgkmcnt(8)
    v_mfma_f32_16x16x32_bf16 v[16:19], v[56:59], v[48:51], v[16:19]
    v_mfma_f32_16x16x32_bf16 v[20:23], v[56:59], v[52:55], v[20:23]
    v_mfma_f32_16x16x32_bf16 v[24:27], v[60:63], v[48:51], v[24:27]
    v_mfma_f32_16x16x32_bf16 v[28:31], v[60:63], v[52:55], v[28:31]
    v_mfma_f32_16x16x32_bf16 v[32:35], v[64:67], v[48:51], v[32:35]
    v_mfma_f32_16x16x32_bf16 v[36:39], v[64:67], v[52:55], v[36:39]
    s_waitcnt lgkmcnt(0)
    v_mfma_f32_16x16x32_bf16 v[16:19], v[80:83], v[72:75], v[16:19]
    v_mfma_f32_16x16x32_bf16 v[20:23], v[80:83], v[76:79], v[20:23]
    v_mfma_f32_16x16x32_bf16 v[24:27], v[84:87], v[72:75], v[24:27]
    v_mfma_f32_16x16x32_bf16 v[28:31], v[84:87], v[76:79], v[28:31]
    v_mfma_f32_16x16x32_bf16 v[32:35], v[88:91], v[72:75], v[32:35]
    v_mfma_f32_16x16x32_bf16 v[36:39], v[88:91], v[76:79], v[36:39]
    s_lshl_b32 s75, s73, 6
    s_add_u32 s75, s75, s72
    s_mul_i32 s75, s75, 73728
    s_mul_i32 s76, s16, 6144
    s_add_u32 s75, s75, s76
    s_mul_i32 s76, s74, 24576
    s_add_u32 s75, s75, s76
    s_add_u32 s60, s4, 0x5400000
    s_addc_u32 s61, s5, 0
    s_add_u32 s60, s60, s75
    s_addc_u32 s61, s61, 0
    s_nop 7
    v_add_u32 v10, 0, v229
    global_store_dwordx4 v10, v[16:19], s[60:61] offset:0 sc1
    global_store_dwordx4 v10, v[20:23], s[60:61] offset:256 sc1
    v_add_u32 v10, 2048, v229
    global_store_dwordx4 v10, v[24:27], s[60:61] offset:0 sc1
    global_store_dwordx4 v10, v[28:31], s[60:61] offset:256 sc1
    v_add_u32 v10, 4096, v229
    global_store_dwordx4 v10, v[32:35], s[60:61] offset:0 sc1
    global_store_dwordx4 v10, v[36:39], s[60:61] offset:256 sc1
    s_mov_b32 s42, s72
    s_lshl_b32 s43, s74, 3
    s_lshl_b32 s43, 1, s43
    s_waitcnt vmcnt(0)
    s_barrier
    s_cmp_lg_u32 s16, 0
    s_cbranch_scc1 L_wk_ar1f
    s_add_u32 s10, s4, 0x5320000
    s_addc_u32 s11, s5, 0
    s_lshl_b32 s18, s42, 2
    v_mov_b32 v10, s18
    v_mov_b32 v11, s43
    s_mov_b64 exec, 1
    global_atomic_add v12, v10, v11, s[10:11] sc0 sc1
    s_waitcnt vmcnt(0)
    v_mov_b32 v10, 163836
    ds_write_b32 v10, v12
    s_waitcnt lgkmcnt(0)
    s_mov_b64 exec, -1
L_wk_ar1f:
    s_barrier
    v_mov_b32 v10, 163836
    ds_read_b32 v12, v10
    s_waitcnt lgkmcnt(0)
    v_readfirstlane_b32 s45, v12
    s_add_u32 s45, s45, s43
    s_load_dwordx2 s[28:29], s[0:1], 96
    s_waitcnt lgkmcnt(0)
    s_mov_b32 s46, 0
L_wk_clf:
    s_lshl_b32 s18, s46, 3
    s_lshr_b32 s19, s43, s18
    s_and_b32 s19, s19, 0xff
    s_cmp_eq_u32 s19, 0
    s_cbranch_scc1 L_wk_cnf
    s_lshr_b32 s19, s45, s18
    s_and_b32 s19, s19, 0xff
    s_cmp_lg_u32 s19, 10
    s_cbranch_scc1 L_wk_cnf
    v_and_b32 v2, 31, v1
    v_lshrrev_b32 v3, 5, v1
    s_lshl_b32 s38, s42, 7
    s_add_u32 s30, s4, 0x4d80000
    s_addc_u32 s31, s5, 0
    s_add_u32 s30, s30, s38
    s_addc_u32 s31, s31, 0
    v_lshlrev_b32 v4, 2, v2
    global_load_dword v5, v4, s[30:31] sc1
    s_mul_i32 s38, s42, 73728
    s_add_u32 s32, s4, 0x4400000
    s_addc_u32 s33, s5, 0
    s_add_u32 s32, s32, s38
    s_addc_u32 s33, s33, 0
    s_add_u32 s34, s4, 0x5400000
    s_addc_u32 s35, s5, 0
    s_add_u32 s34, s34, s38
    s_addc_u32 s35, s35, 0
    s_mul_i32 s38, s46, 24
    s_lshl_b32 s39, s16, 1
    s_add_u32 s38, s38, s39
    v_add_u32 v6, s38, v3
    s_lshl_b32 s39, s42, 5
    v_add_u32 v7, s39, v2
    v_mul_u32_u24 v7, 1152, v7
    v_lshlrev_b32 v8, 10, v6
    v_lshl_add_u32 v8, v2, 4, v8
    global_load_dwordx4 v[12:15], v8, s[32:33] sc1
    global_load_dwordx4 v[16:19], v8, s[32:33] offset:512 sc1
    s_add_u32 s36, s32, 0x480000
    s_addc_u32 s37, s33, 0
    global_load_dwordx4 v[84:87], v8, s[36:37] sc1
    global_load_dwordx4 v[88:91], v8, s[36:37] offset:512 sc1
    s_mov_b64 s[36:37], s[34:35]
    global_load_dwordx4 v[20:23], v8, s[36:37] sc1
    global_load_dwordx4 v[24:27], v8, s[36:37] offset:512 sc1
    s_add_u32 s36, s36, 0x480000
    s_addc_u32 s37, s37, 0
    global_load_dwordx4 v[28:31], v8, s[36:37] sc1
    global_load_dwordx4 v[32:35], v8, s[36:37] offset:512 sc1
    s_add_u32 s36, s36, 0x480000
    s_addc_u32 s37, s37, 0
    global_load_dwordx4 v[36:39], v8, s[36:37] sc1
    global_load_dwordx4 v[40:43], v8, s[36:37] offset:512 sc1
    s_add_u32 s36, s36, 0x480000
    s_addc_u32 s37, s37, 0
    global_load_dwordx4 v[44:47], v8, s[36:37] sc1
    global_load_dwordx4 v[48:51], v8, s[36:37] offset:512 sc1
    s_add_u32 s36, s36, 0x480000
    s_addc_u32 s37, s37, 0
    global_load_dwordx4 v[52:55], v8, s[36:37] sc1
    global_load_dwordx4 v[56:59], v8, s[36:37] offset:512 sc1
    s_add_u32 s36, s36, 0x480000
    s_addc_u32 s37, s37, 0
    global_load_dwordx4 v[60:63], v8, s[36:37] sc1
    global_load_dwordx4 v[64:67], v8, s[36:37] offset:512 sc1
    s_add_u32 s36, s36, 0x480000
    s_addc_u32 s37, s37, 0
    global_load_dwordx4 v[68:71], v8, s[36:37] sc1
    global_load_dwordx4 v[72:75], v8, s[36:37] offset:512 sc1
    s_add_u32 s36, s36, 0x480000
    s_addc_u32 s37, s37, 0
    global_load_dwordx4 v[76:79], v8, s[36:37] sc1
    global_load_dwordx4 v[80:83], v8, s[36:37] offset:512 sc1
    s_add_u32 s36, s36, 0x480000
    s_addc_u32 s37, s37, 0
    v_add_u32 v6, 8, v6
    v_lshlrev_b32 v8, 10, v6
    v_lshl_add_u32 v8, v2, 4, v8
    global_load_dwordx4 v[92:95], v8, s[32:33] sc1
    global_load_dwordx4 v[96:99], v8, s[32:33] offset:512 sc1
    s_add_u32 s36, s32, 0x480000
    s_addc_u32 s37, s33, 0
    global_load_dwordx4 v[164:167], v8, s[36:37] sc1
    global_load_dwordx4 v[168:171], v8, s[36:37] offset:512 sc1
    s_mov_b64 s[36:37], s[34:35]
    global_load_dwordx4 v[100:103], v8, s[36:37] sc1
    global_load_dwordx4 v[104:107], v8, s[36:37] offset:512 sc1
    s_add_u32 s36, s36, 0x480000
    s_addc_u32 s37, s37, 0
    global_load_dwordx4 v[108:111], v8, s[36:37] sc1
    global_load_dwordx4 v[112:115], v8, s[36:37] offset:512 sc1
    s_add_u32 s36, s36, 0x480000
    s_addc_u32 s37, s37, 0
    global_load_dwordx4 v[116:119], v8, s[36:37] sc1
    global_load_dwordx4 v[120:123], v8, s[36:37] offset:512 sc1
    s_add_u32 s36, s36, 0x480000
    s_addc_u32 s37, s37, 0
    global_load_dwordx4 v[124:127], v8, s[36:37] sc1
    global_load_dwordx4 v[128:131], v8, s[36:37] offset:512 sc1
    s_add_u32 s36, s36, 0x480000
    s_addc_u32 s37, s37, 0
    global_load_dwordx4 v[132:135], v8, s[36:37] sc1
    global_load_dwordx4 v[136:139], v8, s[36:37] offset:512 sc1
    s_add_u32 s36, s36, 0x480000
    s_addc_u32 s37, s37, 0
    global_load_dwordx4 v[140:143], v8, s[36:37] sc1
    global_load_dwordx4 v[144:147], v8, s[36:37] offset:512 sc1
    s_add_u32 s36, s36, 0x480000
    s_addc_u32 s37, s37, 0
    global_load_dwordx4 v[148:151], v8, s[36:37] sc1
    global_load_dwordx4 v[152:155], v8, s[36:37] offset:512 sc1
    s_add_u32 s36, s36, 0x480000
    s_addc_u32 s37, s37, 0
    global_load_dwordx4 v[156:159], v8, s[36:37] sc1
    global_load_dwordx4 v[160:163], v8, s[36:37] offset:512 sc1
    s_add_u32 s36, s36, 0x480000
    s_addc_u32 s37, s37, 0
    v_add_u32 v6, 8, v6
    v_lshlrev_b32 v8, 10, v6
    v_lshl_add_u32 v8, v2, 4, v8
    global_load_dwordx4 v[172:175], v8, s[32:33] sc1
    global_load_dwordx4 v[176:179], v8, s[32:33] offset:512 sc1
    s_add_u32 s36, s32, 0x480000
    s_addc_u32 s37, s33, 0
    global_load_dwordx4 v[244:247], v8, s[36:37] sc1
    global_load_dwordx4 v[248:251], v8, s[36:37] offset:512 sc1
    s_mov_b64 s[36:37], s[34:35]
    global_load_dwordx4 v[180:183], v8, s[36:37] sc1
    global_load_dwordx4 v[184:187], v8, s[36:37] offset:512 sc1
    s_add_u32 s36, s36, 0x480000
    s_addc_u32 s37, s37, 0
    global_load_dwordx4 v[188:191], v8, s[36:37] sc1
    global_load_dwordx4 v[192:195], v8, s[36:37] offset:512 sc1
    s_add_u32 s36, s36, 0x480000
    s_addc_u32 s37, s37, 0
    global_load_dwordx4 v[196:199], v8, s[36:37] sc1
    global_load_dwordx4 v[200:203], v8, s[36:37] offset:512 sc1
    s_add_u32 s36, s36, 0x480000
    s_addc_u32 s37, s37, 0
    global_load_dwordx4 v[204:207], v8, s[36:37] sc1
    global_load_dwordx4 v[208:211], v8, s[36:37] offset:512 sc1
    s_add_u32 s36, s36, 0x480000
    s_addc_u32 s37, s37, 0
    global_load_dwordx4 v[212:215], v8, s[36:37] sc1
    global_load_dwordx4 v[216:219], v8, s[36:37] offset:512 sc1
    s_add_u32 s36, s36, 0x480000
    s_addc_u32 s37, s37, 0
    global_load_dwordx4 v[220:223], v8, s[36:37] sc1
    global_load_dwordx4 v[224:227], v8, s[36:37] offset:512 sc1
    s_add_u32 s36, s36, 0x480000
    s_addc_u32 s37, s37, 0
    global_load_dwordx4 v[228:231], v8, s[36:37] sc1
    global_load_dwordx4 v[232:235], v8, s[36:37] offset:512 sc1
    s_add_u32 s36, s36, 0x480000
    s_addc_u32 s37, s37, 0
    global_load_dwordx4 v[236:239], v8, s[36:37] sc1
    global_load_dwordx4 v[240:243], v8, s[36:37] offset:512 sc1
    s_add_u32 s36, s36, 0x480000
    s_addc_u32 s37, s37, 0
    v_add_u32 v6, 8, v6
    v_subrev_u32 v6, 24, v6
    s_waitcnt vmcnt(60)
    v_sub_f32 v5, 1.0, v5
    s_waitcnt vmcnt(40)
    v_add_f32 v12, v12, v84
    v_add_f32 v13, v13, v85
    v_add_f32 v14, v14, v86
    v_add_f32 v15, v15, v87
    v_add_f32 v16, v16, v88
    v_add_f32 v17, v17, v89
    v_add_f32 v18, v18, v90
    v_add_f32 v19, v19, v91
    v_mul_f32 v12, v12, v5
    v_mul_f32 v13, v13, v5
    v_mul_f32 v14, v14, v5
    v_mul_f32 v15, v15, v5
    v_mul_f32 v16, v16, v5
    v_mul_f32 v17, v17, v5
    v_mul_f32 v18, v18, v5
    v_mul_f32 v19, v19, v5
    v_add_f32 v12, v12, v20
    v_add_f32 v13, v13, v21
    v_add_f32 v14, v14, v22
    v_add_f32 v15, v15, v23
    v_add_f32 v16, v16, v24
    v_add_f32 v17, v17, v25
    v_add_f32 v18, v18, v26
    v_add_f32 v19, v19, v27
    v_add_f32 v12, v12, v28
    v_add_f32 v13, v13, v29
    v_add_f32 v14, v14, v30
    v_add_f32 v15, v15, v31
    v_add_f32 v16, v16, v32
    v_add_f32 v17, v17, v33
    v_add_f32 v18, v18, v34
    v_add_f32 v19, v19, v35
    v_add_f32 v12, v12, v36
    v_add_f32 v13, v13, v37
    v_add_f32 v14, v14, v38
    v_add_f32 v15, v15, v39
    v_add_f32 v16, v16, v40
    v_add_f32 v17, v17, v41
    v_add_f32 v18, v18, v42
    v_add_f32 v19, v19, v43
    v_add_f32 v12, v12, v44
    v_add_f32 v13, v13, v45
    v_add_f32 v14, v14, v46
    v_add_f32 v15, v15, v47
    v_add_f32 v16, v16, v48
    v_add_f32 v17, v17, v49
    v_add_f32 v18, v18, v50
    v_add_f32 v19, v19, v51
    v_add_f32 v12, v12, v52
    v_add_f32 v13, v13, v53
    v_add_f32 v14, v14, v54
    v_add_f32 v15, v15, v55
    v_add_f32 v16, v16, v56
    v_add_f32 v17, v17, v57
    v_add_f32 v18, v18, v58
    v_add_f32 v19, v19, v59
    v_add_f32 v12, v12, v60
    v_add_f32 v13, v13, v61
    v_add_f32 v14, v14, v62
    v_add_f32 v15, v15, v63
    v_add_f32 v16, v16, v64
    v_add_f32 v17, v17, v65
    v_add_f32 v18, v18, v66
    v_add_f32 v19, v19, v67
    v_add_f32 v12, v12, v68
    v_add_f32 v13, v13, v69
    v_add_f32 v14, v14, v70
    v_add_f32 v15, v15, v71
    v_add_f32 v16, v16, v72
    v_add_f32 v17, v17, v73
    v_add_f32 v18, v18, v74
    v_add_f32 v19, v19, v75
    v_add_f32 v12, v12, v76
    v_add_f32 v13, v13, v77
    v_add_f32 v14, v14, v78
    v_add_f32 v15, v15, v79
    v_add_f32 v16, v16, v80
    v_add_f32 v17, v17, v81
    v_add_f32 v18, v18, v82
    v_add_f32 v19, v19, v83
    v_cvt_pk_bf16_f32 v20, v12, v13
    v_cvt_pk_bf16_f32 v21, v14, v15
    v_cvt_pk_bf16_f32 v22, v16, v17
    v_cvt_pk_bf16_f32 v23, v18, v19
    v_lshl_add_u32 v8, v6, 4, v7
    global_store_dwordx4 v8, v[20:23], s[28:29]
    v_add_u32 v6, 8, v6
    s_waitcnt vmcnt(21)
    v_add_f32 v92, v92, v164
    v_add_f32 v93, v93, v165
    v_add_f32 v94, v94, v166
    v_add_f32 v95, v95, v167
    v_add_f32 v96, v96, v168
    v_add_f32 v97, v97, v169
    v_add_f32 v98, v98, v170
    v_add_f32 v99, v99, v171
    v_mul_f32 v92, v92, v5
    v_mul_f32 v93, v93, v5
    v_mul_f32 v94, v94, v5
    v_mul_f32 v95, v95, v5
    v_mul_f32 v96, v96, v5
    v_mul_f32 v97, v97, v5
    v_mul_f32 v98, v98, v5
    v_mul_f32 v99, v99, v5
    v_add_f32 v92, v92, v100
    v_add_f32 v93, v93, v101
    v_add_f32 v94, v94, v102
    v_add_f32 v95, v95, v103
    v_add_f32 v96, v96, v104
    v_add_f32 v97, v97, v105
    v_add_f32 v98, v98, v106
    v_add_f32 v99, v99, v107
    v_add_f32 v92, v92, v108
    v_add_f32 v93, v93, v109
    v_add_f32 v94, v94, v110
    v_add_f32 v95, v95, v111
    v_add_f32 v96, v96, v112
    v_add_f32 v97, v97, v113
    v_add_f32 v98, v98, v114
    v_add_f32 v99, v99, v115
    v_add_f32 v92, v92, v116
    v_add_f32 v93, v93, v117
    v_add_f32 v94, v94, v118
    v_add_f32 v95, v95, v119
    v_add_f32 v96, v96, v120
    v_add_f32 v97, v97, v121
    v_add_f32 v98, v98, v122
    v_add_f32 v99, v99, v123
    v_add_f32 v92, v92, v124
    v_add_f32 v93, v93, v125
    v_add_f32 v94, v94, v126
    v_add_f32 v95, v95, v127
    v_add_f32 v96, v96, v128
    v_add_f32 v97, v97, v129
    v_add_f32 v98, v98, v130
    v_add_f32 v99, v99, v131
    v_add_f32 v92, v92, v132
    v_add_f32 v93, v93, v133
    v_add_f32 v94, v94, v134
    v_add_f32 v95, v95, v135
    v_add_f32 v96, v96, v136
    v_add_f32 v97, v97, v137
    v_add_f32 v98, v98, v138
    v_add_f32 v99, v99, v139
    v_add_f32 v92, v92, v140
    v_add_f32 v93, v93, v141
    v_add_f32 v94, v94, v142
    v_add_f32 v95, v95, v143
    v_add_f32 v96, v96, v144
    v_add_f32 v97, v97, v145
    v_add_f32 v98, v98, v146
    v_add_f32 v99, v99, v147
    v_add_f32 v92, v92, v148
    v_add_f32 v93, v93, v149
    v_add_f32 v94, v94, v150
    v_add_f32 v95, v95, v151
    v_add_f32 v96, v96, v152
    v_add_f32 v97, v97, v153
    v_add_f32 v98, v98, v154
    v_add_f32 v99, v99, v155
    v_add_f32 v92, v92, v156
    v_add_f32 v93, v93, v157
    v_add_f32 v94, v94, v158
    v_add_f32 v95, v95, v159
    v_add_f32 v96, v96, v160
    v_add_f32 v97, v97, v161
    v_add_f32 v98, v98, v162
    v_add_f32 v99, v99, v163
    v_cvt_pk_bf16_f32 v100, v92, v93
    v_cvt_pk_bf16_f32 v101, v94, v95
    v_cvt_pk_bf16_f32 v102, v96, v97
    v_cvt_pk_bf16_f32 v103, v98, v99
    v_lshl_add_u32 v8, v6, 4, v7
    global_store_dwordx4 v8, v[100:103], s[28:29]
    v_add_u32 v6, 8, v6
    s_waitcnt vmcnt(2)
    v_add_f32 v172, v172, v244
    v_add_f32 v173, v173, v245
    v_add_f32 v174, v174, v246
    v_add_f32 v175, v175, v247
    v_add_f32 v176, v176, v248
    v_add_f32 v177, v177, v249
    v_add_f32 v178, v178, v250
    v_add_f32 v179, v179, v251
    v_mul_f32 v172, v172, v5
    v_mul_f32 v173, v173, v5
    v_mul_f32 v174, v174, v5
    v_mul_f32 v175, v175, v5
    v_mul_f32 v176, v176, v5
    v_mul_f32 v177, v177, v5
    v_mul_f32 v178, v178, v5
    v_mul_f32 v179, v179, v5
    v_add_f32 v172, v172, v180
    v_add_f32 v173, v173, v181
    v_add_f32 v174, v174, v182
    v_add_f32 v175, v175, v183
    v_add_f32 v176, v176, v184
    v_add_f32 v177, v177, v185
    v_add_f32 v178, v178, v186
    v_add_f32 v179, v179, v187
    v_add_f32 v172, v172, v188
    v_add_f32 v173, v173, v189
    v_add_f32 v174, v174, v190
    v_add_f32 v175, v175, v191
    v_add_f32 v176, v176, v192
    v_add_f32 v177, v177, v193
    v_add_f32 v178, v178, v194
    v_add_f32 v179, v179, v195
    v_add_f32 v172, v172, v196
    v_add_f32 v173, v173, v197
    v_add_f32 v174, v174, v198
    v_add_f32 v175, v175, v199
    v_add_f32 v176, v176, v200
    v_add_f32 v177, v177, v201
    v_add_f32 v178, v178, v202
    v_add_f32 v179, v179, v203
    v_add_f32 v172, v172, v204
    v_add_f32 v173, v173, v205
    v_add_f32 v174, v174, v206
    v_add_f32 v175, v175, v207
    v_add_f32 v176, v176, v208
    v_add_f32 v177, v177, v209
    v_add_f32 v178, v178, v210
    v_add_f32 v179, v179, v211
    v_add_f32 v172, v172, v212
    v_add_f32 v173, v173, v213
    v_add_f32 v174, v174, v214
    v_add_f32 v175, v175, v215
    v_add_f32 v176, v176, v216
    v_add_f32 v177, v177, v217
    v_add_f32 v178, v178, v218
    v_add_f32 v179, v179, v219
    v_add_f32 v172, v172, v220
    v_add_f32 v173, v173, v221
    v_add_f32 v174, v174, v222
    v_add_f32 v175, v175, v223
    v_add_f32 v176, v176, v224
    v_add_f32 v177, v177, v225
    v_add_f32 v178, v178, v226
    v_add_f32 v179, v179, v227
    v_add_f32 v172, v172, v228
    v_add_f32 v173, v173, v229
    v_add_f32 v174, v174, v230
    v_add_f32 v175, v175, v231
    v_add_f32 v176, v176, v232
    v_add_f32 v177, v177, v233
    v_add_f32 v178, v178, v234
    v_add_f32 v179, v179, v235
    v_add_f32 v172, v172, v236
    v_add_f32 v173, v173, v237
    v_add_f32 v174, v174, v238
    v_add_f32 v175, v175, v239
    v_add_f32 v176, v176, v240
    v_add_f32 v177, v177, v241
    v_add_f32 v178, v178, v242
    v_add_f32 v179, v179, v243
    v_cvt_pk_bf16_f32 v180, v172, v173
    v_cvt_pk_bf16_f32 v181, v174, v175
    v_cvt_pk_bf16_f32 v182, v176, v177
    v_cvt_pk_bf16_f32 v183, v178, v179
    v_lshl_add_u32 v8, v6, 4, v7
    global_store_dwordx4 v8, v[180:183], s[28:29]
    v_add_u32 v6, 8, v6
L_wk_cnf:
    s_add_u32 s46, s46, 1
    s_cmp_lt_u32 s46, 3
    s_cbranch_scc1 L_wk_clf
    s_barrier
    s_branch L_wk_next
L_wk_fail:
    v_mov_b32 v10, 164
    v_mov_b32 v11, s17
    s_mov_b64 exec, 1
    global_store_dword v10, v11, s[6:7] sc1
    s_mov_b64 exec, -1
L_wk_exit:
    s_waitcnt vmcnt(0)
    s_endpgm
L_main_exit:
    s_endpgm
.section .rodata,"a"
.p2align 6
.amdhsa_kernel gated_mix__memory_aug_recurrent_mem_tr__glu_gated_geglu__prompt_kernel
  .amdhsa_next_free_vgpr 512
  .amdhsa_next_free_sgpr 102
  .amdhsa_accum_offset 256
  .amdhsa_group_segment_fixed_size 0
  .amdhsa_kernarg_size 120
  .amdhsa_user_sgpr_count 2
  .amdhsa_user_sgpr_kernarg_segment_ptr 1
  .amdhsa_system_sgpr_workgroup_id_x 1
  .amdhsa_float_denorm_mode_32 3
  .amdhsa_float_denorm_mode_16_64 3
.end_amdhsa_kernel
.text
```
